```python
import torch

def _softmax(x, axis=-1):
    return torch.softmax(x, dim=axis)
def _gelu(x):
    return torch.nn.functional.gelu(x, approximate="tanh")
def _silu(x):
    return torch.nn.functional.silu(x)
def _sigmoid(x):
    return torch.sigmoid(x)
def _layernorm(x, axis=-1, eps=1e-5):
    m = x.mean(dim=axis, keepdim=True)
    v = x.var(dim=axis, keepdim=True, unbiased=False)
    return (x - m) / torch.sqrt(v + eps)
def _scatter_add(tgt, idx, src, axis=0):
    return tgt.clone().index_add_(axis, idx, src)
def _segment_sum(src, seg, n):
    out = torch.zeros((n,) + src.shape[1:], dtype=src.dtype)
    return out.index_add_(0, seg, src)
def _pad(x, pw):
    flat = tuple(v for pair in reversed(pw) for v in pair)
    return torch.nn.functional.pad(x, flat)

kernel_name = 'recurrent_scan__compressed_kv_cla__dense_activation_squared_relu__prompt'

def setup_inputs():

    _w = (lambda a: (lambda t: t.to(torch.bfloat16) if t.is_floating_point() else t)(torch.as_tensor(a)))
    def _A_setup():
        B, H, Sq, Sk, D, M = 1, 32, 2048, 2048, 128, 512
        Dc = 4 * D
        return {
            "x": _w((lambda *s: torch.randn(*s, dtype=torch.bfloat16) * 0.05)(B, Sq, M)),
            "c_kv": _w((lambda *s: torch.randn(*s, dtype=torch.bfloat16) * 0.2)(B, Sk, Dc)),
            "w_q": _w((lambda *s: torch.randn(*s, dtype=torch.bfloat16) * 3.2)(M, H, D) * (M ** -0.5)),
            "w_uk": _w((lambda *s: torch.randn(*s, dtype=torch.bfloat16) * 3.2)(Dc, H, D) * (Dc ** -0.5)),
            "w_uv": _w((lambda *s: torch.randn(*s, dtype=torch.bfloat16) * 0.2)(Dc, H, D) * (Dc ** -0.5)),
            "w_o": _w((lambda *s: torch.randn(*s, dtype=torch.bfloat16) * 0.2)(H, D, M) * ((H * D) ** -0.5)),
        }
    _A_in = _A_setup()

    def _B_setup():
        B, S, D, F = 1, 2048, 512, 1792
        return {
            "x": _w((lambda *s: torch.randn(*s, dtype=torch.bfloat16) * 0.05)(B, S, D)),
            "w1": _w((lambda *s: torch.randn(*s, dtype=torch.bfloat16) * 0.1)(D, F)),
            "b1": _w((lambda *s: torch.randn(*s, dtype=torch.bfloat16) * 0.8)(F)),
            "w2": _w((lambda *s: torch.randn(*s, dtype=torch.bfloat16) * 0.1)(F, D)),
            "b2": _w((lambda *s: torch.randn(*s, dtype=torch.bfloat16) * 6.4)(D)),
        }
    _B_in = _B_setup()

    return {
        "A_x": _A_in["x"],
        "A_c_kv": _A_in["c_kv"],
        "A_w_q": _A_in["w_q"],
        "A_w_uk": _A_in["w_uk"],
        "A_w_uv": _A_in["w_uv"],
        "A_w_o": _A_in["w_o"],
        "B_x": _B_in["x"],
        "B_w1": _B_in["w1"],
        "B_b1": _B_in["b1"],
        "B_w2": _B_in["w2"],
        "B_b2": _B_in["b2"],
    }

def reference(A_x, A_c_kv, A_w_q, A_w_uk, A_w_uv, A_w_o, B_x, B_w1, B_b1, B_w2, B_b2):
    def _A_ref(x, c_kv, w_q, w_uk, w_uv, w_o):
        B, Sq, M = x.shape[0], x.shape[1], x.shape[2]
        Sk = c_kv.shape[1]
        H, D = w_q.shape[1], w_q.shape[2]
        q = torch.einsum("bqm,mhd->bhqd", x, w_q)
        k = torch.einsum("bkc,chd->bhkd", c_kv, w_uk)
        v = torch.einsum("bkc,chd->bhkd", c_kv, w_uv)
        scores = torch.einsum("bhqd,bhkd->bhqk", q, k) * (D ** -0.5)
        off = Sk - Sq
        qi = torch.arange(Sq)[:, None]
        kj = torch.arange(Sk)[None, :]
        cmask = kj <= (qi + off)
        scores = torch.where(cmask[None, None], scores, -1e9)
        p = _softmax(scores, axis=-1)
        ctx = torch.einsum("bhqk,bhkd->bhqd", p, v)
        return torch.einsum("bhqd,hdm->bqm", ctx, w_o)

    def _B_ref(x, w1, b1, w2, b2):
        h = torch.einsum("bsd,df->bsf", x, w1) + b1
        zero = torch.zeros_like(h)
        r = torch.where(h > zero, h, zero)
        h = r * r
        out = torch.einsum("bsf,fd->bsd", h, w2) + b2
        return out

    x = A_x
    xn = _layernorm(x, axis=-1)
    s = _A_ref(xn, A_c_kv, A_w_q, A_w_uk, A_w_uv, A_w_o)
    g = _silu(_B_ref(xn, B_w1, B_b1, B_w2, B_b2))
    return x + s * g
```

```asm
; @launch grid=(256,1,1) block=(256,1,1) lds=163840
.amdgcn_target "amdgcn-amd-amdhsa--gfx950"
.text
.globl recurrent_scan__compressed_kv_cla__dense_activation_squared_relu__prompt_kernel
.p2align 8
.type recurrent_scan__compressed_kv_cla__dense_activation_squared_relu__prompt_kernel,@function
recurrent_scan__compressed_kv_cla__dense_activation_squared_relu__prompt_kernel:
    s_cmp_ge_u32 s2, 256
    s_cbranch_scc1 L_exit
    s_load_dwordx16 s[64:79], s[0:1], 0
    s_load_dwordx8 s[80:87], s[0:1], 64
    s_load_dwordx4 s[88:91], s[0:1], 96
    v_and_b32 v254, 63, v0
    v_lshrrev_b32 v1, 6, v0
    v_lshlrev_b32 v255, 4, v254
    v_readfirstlane_b32 s56, v1
    s_and_b32 s57, s2, 7
    s_lshl_b32 s57, s57, 2
    s_bfe_u32 s3, s2, 0x20003
    s_add_u32 s57, s57, s3
    s_lshr_b32 s58, s2, 5
    s_mov_b32 s59, 0
    v_mov_b32 v251, 1
    v_bfe_u32 v2, v254, 2, 2
    v_lshlrev_b32 v2, 13, v2
    v_lshrrev_b32 v3, 4, v254
    v_lshl_add_u32 v2, v3, 6, v2
    v_and_b32 v4, 3, v254
    v_lshl_add_u32 v228, v4, 4, v2
    v_xor_b32 v5, 32, v228
    v_add_u32 v229, 31744, v228
    v_add_u32 v230, 63488, v5
    v_add_u32 v231, 95232, v5
    v_lshrrev_b32 v2, 4, v254
    v_and_b32 v3, 7, v254
    v_xor_b32 v3, v3, v2
    v_lshrrev_b32 v4, 3, v254
    v_lshlrev_b32 v4, 10, v4
    v_lshl_add_u32 v232, v3, 4, v4
    v_xor_b32 v3, 64, v232
    v_add_u32 v233, 7168, v3
    v_add_u32 v234, 14336, v232
    v_add_u32 v235, 21504, v3
    s_lshl_b32 s92, s56, 16
    s_lshl_b32 s93, s58, 18
    s_add_u32 s92, s92, s93
    s_lshl_b32 s93, s56, 17
    s_lshl_b32 s94, s57, 8
    s_add_u32 s93, s93, s94
    s_mov_b32 s14, 2097152
    s_mov_b32 s15, 0x20000
    s_mov_b32 s22, 4194304
    s_mov_b32 s23, 0x20000
    s_mov_b32 s6, 268435456
    s_mov_b32 s7, 0x20000
    s_mov_b32 s10, 2097152
    s_mov_b32 s11, 0x20000
    s_mov_b32 s18, 4194304
    s_mov_b32 s19, 0x20000
    s_mov_b32 s26, 4194304
    s_mov_b32 s27, 0x20000
    s_mov_b32 s30, 4194304
    s_mov_b32 s31, 0x20000
    s_mov_b32 s34, 1835008
    s_mov_b32 s35, 0x20000
    s_mov_b32 s38, 1835008
    s_mov_b32 s39, 0x20000
    s_mov_b32 s42, 2097152
    s_mov_b32 s43, 0x20000
    s_mov_b32 s46, 3584
    s_mov_b32 s47, 0x20000
    s_mov_b32 s50, 1024
    s_mov_b32 s51, 0x20000
    s_mov_b32 s54, 256
    s_mov_b32 s55, 0x20000
    s_lshr_b32 s98, s2, 3
    s_lshl_b32 s98, s98, 2
    s_add_u32 s98, s98, s56
    v_lshrrev_b32 v2, 3, v254
    v_and_b32 v3, 7, v254
    v_lshlrev_b32 v3, 7, v3
    v_lshl_add_u32 v249, v2, 13, v3
    v_lshlrev_b32 v248, 7, v254
    s_and_b32 s96, s2, 7
    s_lshl_b32 s94, s98, 16
    s_lshl_b32 s95, s96, 10
    s_add_u32 s94, s94, s95
    s_add_u32 s94, s94, 1048576
    s_cmp_lt_u32 s98, 48
    s_cselect_b32 s94, s94, 1073741824
    s_sub_u32 s97, s98, 48
    s_lshl_b32 s95, s96, 5
    s_add_u32 s95, s95, s97
    s_lshl_b32 s95, s95, 13
    s_cmp_lt_u32 s97, 32
    s_cselect_b32 s95, s95, 1073741824
    s_waitcnt lgkmcnt(0)
    s_mov_b32 s12, s66
    s_mov_b32 s13, s67
    s_mov_b32 s20, s70
    s_mov_b32 s21, s71
    buffer_load_dword v246, v249, s[20:23], s94 offen
    buffer_load_dword v247, v248, s[12:15], s95 offen
    s_mov_b32 s4, s90
    s_mov_b32 s5, s91
    s_mov_b32 s8, s64
    s_mov_b32 s9, s65
    s_mov_b32 s16, s68
    s_mov_b32 s17, s69
    s_mov_b32 s24, s72
    s_mov_b32 s25, s73
    s_mov_b32 s28, s74
    s_mov_b32 s29, s75
    s_mov_b32 s32, s78
    s_mov_b32 s33, s79
    s_mov_b32 s36, s82
    s_mov_b32 s37, s83
    s_mov_b32 s40, s86
    s_mov_b32 s41, s87
    s_mov_b32 s44, s80
    s_mov_b32 s45, s81
    s_mov_b32 s48, s84
    s_mov_b32 s49, s85
    s_mov_b32 s52, s88
    s_mov_b32 s53, s89
    s_lshl_b32 s68, s56, 12
    s_lshl_b32 s86, s56, 13
    s_mov_b32 s82, s92
    s_mov_b32 s83, s93
    s_add_u32 m0, s86, 0
    s_add_u32 s64, s82, 0
    buffer_load_dwordx4 v232, s[12:15], s64 offen offset:0 lds
    buffer_load_dwordx4 v233, s[12:15], s64 offen offset:1024 lds
    buffer_load_dwordx4 v234, s[12:15], s64 offen offset:2048 lds
    buffer_load_dwordx4 v235, s[12:15], s64 offen offset:3072 lds
    s_add_u32 m0, s86, 4096
    s_add_u32 s64, s82, 32768
    buffer_load_dwordx4 v232, s[12:15], s64 offen offset:0 lds
    buffer_load_dwordx4 v233, s[12:15], s64 offen offset:1024 lds
    buffer_load_dwordx4 v234, s[12:15], s64 offen offset:2048 lds
    buffer_load_dwordx4 v235, s[12:15], s64 offen offset:3072 lds
    s_add_u32 m0, s68, 98304
    s_add_u32 s64, s83, 0
    buffer_load_dwordx4 v228, s[20:23], s64 offen offset:0 lds
    buffer_load_dwordx4 v229, s[20:23], s64 offen offset:1024 lds
    buffer_load_dwordx4 v230, s[20:23], s64 offen offset:2048 lds
    buffer_load_dwordx4 v231, s[20:23], s64 offen offset:3072 lds
    s_lshl_b32 s92, s2, 3
    s_lshl_b32 s89, s56, 1
    s_add_u32 s92, s92, s89
    s_lshl_b32 s89, s92, 10
    buffer_load_dwordx4 v[128:131], v255, s[8:11], s89 offen
    buffer_load_dwordx4 v[132:135], v255, s[8:11], s89 offen offset:1024
    v_bfe_u32 v4, v254, 2, 2
    v_lshlrev_b32 v4, 6, v4
    v_and_b32 v5, 3, v254
    v_lshl_add_u32 v4, v5, 3, v4
    v_bfe_u32 v5, v254, 4, 1
    v_lshl_add_u32 v4, v5, 5, v4
    v_lshrrev_b32 v5, 4, v254
    v_lshl_add_u32 v2, v5, 11, v4
    v_xor_b32 v3, 32, v2
    v_add_u32 v238, 98304, v2
    v_add_u32 v239, 98304, v3
    v_bfe_u32 v4, v254, 2, 2
    v_lshlrev_b32 v4, 6, v4
    v_and_b32 v5, 3, v254
    v_lshl_add_u32 v4, v5, 3, v4
    v_bfe_u32 v5, v254, 4, 1
    v_lshl_add_u32 v4, v5, 5, v4
    v_lshrrev_b32 v5, 4, v254
    v_lshl_add_u32 v2, v5, 10, v4
    v_xor_b32 v3, 32, v2
    v_add_u32 v240, 98304, v2
    v_add_u32 v241, 98304, v3
    v_and_b32 v2, 15, v254
    v_lshrrev_b32 v3, 1, v2
    v_lshrrev_b32 v4, 4, v254
    v_xor_b32 v3, v3, v4
    v_lshlrev_b32 v2, 7, v2
    v_lshl_add_u32 v2, v3, 4, v2
    v_add_u32 v236, s86, v2
    v_xor_b32 v237, 64, v236
    s_lshl_b32 s87, s57, 8
    s_lshl_b32 s89, s56, 18
    s_add_u32 s87, s87, s89
    s_lshl_b32 s85, s57, 7
    s_mul_i32 s89, s56, 114688
    s_add_u32 s85, s85, s89
    s_cmp_lt_u32 s57, 28
    s_cselect_b32 s85, s85, 1073741824
    s_and_b32 s89, s56, 1
    s_lshl_b32 s90, s58, 1
    s_add_u32 s89, s89, s90
    s_sub_u32 s72, 31, s89
    s_lshl_b32 s90, s89, 1
    s_add_u32 s90, s90, 2
    s_cmp_lt_u32 s56, 2
    s_cselect_b32 s71, s72, s89
    s_cselect_b32 s70, 99, s90
    s_lshl_b32 s84, s71, 16
    s_add_u32 s84, s84, 1048576
    s_lshl_b32 s73, s58, 2
    s_add_u32 s73, s73, 2
    s_sub_u32 s74, s56, 1
    s_max_i32 s74, s74, 0
    s_lshl_b32 s69, s57, 20
    s_add_u32 s69, s69, 4194304
    s_lshl_b32 s89, s58, 17
    s_lshl_b32 s90, s56, 15
    s_add_u32 s89, s89, s90
    s_add_u32 s88, s89, s69
    s_add_u32 s69, s69, s68
    s_lshl_b32 s89, s57, 5
    s_add_u32 s89, s89, s71
    s_lshl_b32 s89, s89, 13
    s_add_u32 s61, s89, 37748736
    s_cmp_lt_u32 s57, 28
    s_cselect_b32 s61, s61, 1073741824
    s_mov_b64 s[62:63], 0
    s_sub_u32 s89, s70, 2
    s_bfm_b64 s[0:1], 1, s89
    s_min_u32 s65, s70, 34
    s_cmp_lt_u32 s56, 2
    s_cselect_b64 s[62:63], s[62:63], s[0:1]
    s_cselect_b32 s95, s72, 0
    s_cmp_eq_u32 s95, 16
    s_cselect_b32 s89, 32, 0
    s_bitset1_b64 s[62:63], s89
    s_bfe_u32 s96, s2, 0x30003
    s_mul_i32 s96, s96, 3
    s_lshr_b32 s96, s96, 3
    s_lshl_b32 s96, s96, 2
    s_add_u32 s96, s96, 17
    s_bitset1_b64 s[62:63], s96
    s_mov_b64 s[66:67], 0
    s_sub_u32 s89, 4, s74
    s_lshl_b32 s75, s89, 14
    s_add_u32 s75, s75, s69
    s_sub_u32 s90, 65, s89
    s_lshl_b32 s90, s90, 14
    s_add_u32 s77, s90, s69
    s_mov_b32 s81, s68
    s_add_u32 s80, s81, 32768
    s_mov_b32 s79, 1
    s_mov_b32 s97, 0x3e0293ee
    s_barrier
    s_add_u32 m0, s86, 32768
    s_add_u32 s64, s82, 128
    buffer_load_dwordx4 v232, s[12:15], s64 offen offset:0 lds
    buffer_load_dwordx4 v233, s[12:15], s64 offen offset:1024 lds
    buffer_load_dwordx4 v234, s[12:15], s64 offen offset:2048 lds
    buffer_load_dwordx4 v235, s[12:15], s64 offen offset:3072 lds
    s_add_u32 m0, s86, 36864
    s_add_u32 s64, s82, 32896
    buffer_load_dwordx4 v232, s[12:15], s64 offen offset:0 lds
    buffer_load_dwordx4 v233, s[12:15], s64 offen offset:1024 lds
    buffer_load_dwordx4 v234, s[12:15], s64 offen offset:2048 lds
    buffer_load_dwordx4 v235, s[12:15], s64 offen offset:3072 lds
    s_add_u32 m0, s68, 114688
    s_add_u32 s64, s83, 524288
    buffer_load_dwordx4 v228, s[20:23], s64 offen offset:0 lds
    buffer_load_dwordx4 v229, s[20:23], s64 offen offset:1024 lds
    buffer_load_dwordx4 v230, s[20:23], s64 offen offset:2048 lds
    buffer_load_dwordx4 v231, s[20:23], s64 offen offset:3072 lds
    s_sub_u32 s89, s98, 80
    s_lshl_b32 s90, s89, 16
    s_and_b32 s91, s2, 7
    s_lshl_b32 s91, s91, 10
    s_add_u32 s90, s90, s91
    s_add_u32 s90, s90, 0
    s_cmp_lt_u32 s89, 48
    s_cselect_b32 s3, s90, 1073741824
    buffer_load_dword v244, v249, s[24:27], s3 offen
    s_sub_u32 s89, s98, 0
    s_lshl_b32 s90, s89, 16
    s_and_b32 s91, s2, 7
    s_lshl_b32 s91, s91, 10
    s_add_u32 s90, s90, s91
    s_add_u32 s90, s90, 3145728
    s_cmp_lt_u32 s89, 16
    s_cselect_b32 s3, s90, 1073741824
    buffer_load_dword v245, v249, s[24:27], s3 offen
    s_getpc_b64 s[0:1]
    s_and_b32 s89, s98, 127
    s_lshl_b32 s89, s89, 13
    v_lshl_add_u32 v2, v254, 7, s89
    v_min_u32 v2, L_code_end-L_pf_base-4, v2
    v_mov_b32 v3, s1
L_pf_base:
    v_add_co_u32 v2, vcc, s0, v2
    s_nop 1
    v_addc_co_u32 v3, vcc, 0, v3, vcc
    global_load_dword v225, v[2:3], off
    v_and_b32 v2, 31, v254
    v_lshlrev_b32 v2, 2, v2
    s_lshl_b32 s89, s2, 7
    s_cmp_lt_u32 s2, 192
    s_cselect_b32 s89, s89, 1073741824
    v_mov_b32 v3, 0
    buffer_store_dword v3, v2, s[4:7], s89 offen sc1
    s_waitcnt vmcnt(16)
    s_barrier
    ds_read_b128 a[0:3], v236 offset:0
    ds_read_b128 a[4:7], v237 offset:0
    ds_read_b128 a[8:11], v236 offset:2048
    ds_read_b128 a[12:15], v237 offset:2048
    ds_read_b128 a[16:19], v236 offset:4096
    ds_read_b128 a[20:23], v237 offset:4096
    ds_read_b128 a[24:27], v236 offset:6144
    ds_read_b128 a[28:31], v237 offset:6144
    s_waitcnt lgkmcnt(4)
    ds_read_b64_tr_b16 v[192:193], v238 offset:0
    ds_read_b64_tr_b16 v[194:195], v238 offset:1024
    ds_read_b64_tr_b16 v[196:197], v238 offset:8192
    ds_read_b64_tr_b16 v[198:199], v238 offset:9216
    ds_read_b64_tr_b16 v[200:201], v239 offset:0
    ds_read_b64_tr_b16 v[202:203], v239 offset:1024
    ds_read_b64_tr_b16 v[204:205], v239 offset:8192
    ds_read_b64_tr_b16 v[206:207], v239 offset:9216
    s_waitcnt lgkmcnt(0)
    v_mfma_f32_16x16x32_bf16 v[0:3], v[192:195], a[0:3], 0
    s_add_u32 m0, s86, 65536
    ds_read_b64_tr_b16 v[208:209], v238 offset:256
    v_mfma_f32_16x16x32_bf16 v[0:3], v[196:199], a[4:7], v[0:3]
    s_add_u32 s64, s82, 256
    ds_read_b64_tr_b16 v[210:211], v238 offset:1280
    v_mfma_f32_16x16x32_bf16 v[4:7], v[200:203], a[0:3], 0
    v_lshlrev_b32 v136, 16, v128
    v_mfma_f32_16x16x32_bf16 v[4:7], v[204:207], a[4:7], v[4:7]
    ds_read_b64_tr_b16 v[212:213], v238 offset:8448
    v_and_b32 v137, 0xffff0000, v128
    v_mfma_f32_16x16x32_bf16 v[32:35], v[192:195], a[8:11], 0
    buffer_load_dwordx4 v232, s[12:15], s64 offen offset:0 lds
    v_mfma_f32_16x16x32_bf16 v[32:35], v[196:199], a[12:15], v[32:35]
    ds_read_b64_tr_b16 v[214:215], v238 offset:9472
    v_lshlrev_b32 v138, 16, v129
    v_mfma_f32_16x16x32_bf16 v[36:39], v[200:203], a[8:11], 0
    buffer_load_dwordx4 v233, s[12:15], s64 offen offset:1024 lds
    v_mfma_f32_16x16x32_bf16 v[36:39], v[204:207], a[12:15], v[36:39]
    ds_read_b64_tr_b16 v[216:217], v239 offset:256
    v_and_b32 v139, 0xffff0000, v129
    v_mfma_f32_16x16x32_bf16 v[64:67], v[192:195], a[16:19], 0
    v_lshlrev_b32 v140, 16, v130
    v_and_b32 v141, 0xffff0000, v130
    v_mfma_f32_16x16x32_bf16 v[64:67], v[196:199], a[20:23], v[64:67]
    buffer_load_dwordx4 v234, s[12:15], s64 offen offset:2048 lds
    v_mfma_f32_16x16x32_bf16 v[68:71], v[200:203], a[16:19], 0
    ds_read_b64_tr_b16 v[218:219], v239 offset:1280
    v_lshlrev_b32 v142, 16, v131
    v_mfma_f32_16x16x32_bf16 v[68:71], v[204:207], a[20:23], v[68:71]
    buffer_load_dwordx4 v235, s[12:15], s64 offen offset:3072 lds
    v_mfma_f32_16x16x32_bf16 v[96:99], v[192:195], a[24:27], 0
    s_add_u32 m0, s86, 69632
    ds_read_b64_tr_b16 v[220:221], v239 offset:8448
    v_and_b32 v143, 0xffff0000, v131
    v_mfma_f32_16x16x32_bf16 v[96:99], v[196:199], a[28:31], v[96:99]
    s_add_u32 s64, s82, 33024
    ds_read_b64_tr_b16 v[222:223], v239 offset:9472
    v_lshlrev_b32 v144, 16, v132
    v_mfma_f32_16x16x32_bf16 v[100:103], v[200:203], a[24:27], 0
    v_and_b32 v145, 0xffff0000, v132
    v_lshlrev_b32 v146, 16, v133
    v_mfma_f32_16x16x32_bf16 v[100:103], v[204:207], a[28:31], v[100:103]
    s_waitcnt lgkmcnt(0)
    v_and_b32 v147, 0xffff0000, v133
    v_lshlrev_b32 v148, 16, v134
    v_mfma_f32_16x16x32_bf16 v[8:11], v[208:211], a[0:3], 0
    buffer_load_dwordx4 v232, s[12:15], s64 offen offset:0 lds
    v_mfma_f32_16x16x32_bf16 v[8:11], v[212:215], a[4:7], v[8:11]
    s_waitcnt vmcnt(13)
    ds_read_b64_tr_b16 v[192:193], v238 offset:512
    v_and_b32 v149, 0xffff0000, v134
    v_mfma_f32_16x16x32_bf16 v[12:15], v[216:219], a[0:3], 0
    buffer_load_dwordx4 v233, s[12:15], s64 offen offset:1024 lds
    v_mfma_f32_16x16x32_bf16 v[12:15], v[220:223], a[4:7], v[12:15]
    buffer_load_dwordx4 v234, s[12:15], s64 offen offset:2048 lds
    v_mfma_f32_16x16x32_bf16 v[40:43], v[208:211], a[8:11], 0
    ds_read_b64_tr_b16 v[194:195], v238 offset:1536
    v_lshlrev_b32 v150, 16, v135
    v_mfma_f32_16x16x32_bf16 v[40:43], v[212:215], a[12:15], v[40:43]
    ds_read_b128 a[32:35], v236 offset:32768
    v_and_b32 v151, 0xffff0000, v135
    v_mfma_f32_16x16x32_bf16 v[44:47], v[216:219], a[8:11], 0
    buffer_load_dwordx4 v235, s[12:15], s64 offen offset:3072 lds
    v_mfma_f32_16x16x32_bf16 v[44:47], v[220:223], a[12:15], v[44:47]
    s_add_u32 m0, s68, 131072
    ds_read_b64_tr_b16 v[196:197], v238 offset:8704
    v_add_f32 v152, v136, v137
    v_mfma_f32_16x16x32_bf16 v[72:75], v[208:211], a[16:19], 0
    s_add_u32 s64, s83, 1048576
    ds_read_b64_tr_b16 v[198:199], v238 offset:9728
    v_add_f32 v152, v152, v138
    v_mfma_f32_16x16x32_bf16 v[72:75], v[212:215], a[20:23], v[72:75]
    ds_read_b128 a[36:39], v237 offset:32768
    v_add_f32 v152, v152, v139
    v_mfma_f32_16x16x32_bf16 v[76:79], v[216:219], a[16:19], 0
    ds_read_b64_tr_b16 v[200:201], v239 offset:512
    v_add_f32 v152, v152, v140
    v_mfma_f32_16x16x32_bf16 v[76:79], v[220:223], a[20:23], v[76:79]
    ds_read_b64_tr_b16 v[202:203], v239 offset:1536
    ds_read_b64_tr_b16 v[204:205], v239 offset:8704
    v_add_f32 v152, v152, v141
    v_mfma_f32_16x16x32_bf16 v[104:107], v[208:211], a[24:27], 0
    ds_read_b128 a[40:43], v236 offset:34816
    ds_read_b64_tr_b16 v[206:207], v239 offset:9728
    v_add_f32 v152, v152, v142
    v_mfma_f32_16x16x32_bf16 v[104:107], v[212:215], a[28:31], v[104:107]
    buffer_load_dwordx4 v228, s[20:23], s64 offen offset:0 lds
    v_mfma_f32_16x16x32_bf16 v[108:111], v[216:219], a[24:27], 0
    v_add_f32 v152, v152, v143
    v_add_f32 v153, v144, v145
    v_mfma_f32_16x16x32_bf16 v[108:111], v[220:223], a[28:31], v[108:111]
    s_waitcnt lgkmcnt(0)
    ds_read_b128 a[44:47], v237 offset:34816
    v_add_f32 v153, v153, v146
    v_mfma_f32_16x16x32_bf16 v[16:19], v[192:195], a[0:3], 0
    buffer_load_dwordx4 v229, s[20:23], s64 offen offset:1024 lds
    v_mfma_f32_16x16x32_bf16 v[16:19], v[196:199], a[4:7], v[16:19]
    buffer_load_dwordx4 v230, s[20:23], s64 offen offset:2048 lds
    v_mfma_f32_16x16x32_bf16 v[20:23], v[200:203], a[0:3], 0
    v_add_f32 v153, v153, v147
    v_add_f32 v153, v153, v148
    v_mfma_f32_16x16x32_bf16 v[20:23], v[204:207], a[4:7], v[20:23]
    ds_read_b128 a[48:51], v236 offset:36864
    v_add_f32 v153, v153, v149
    v_mfma_f32_16x16x32_bf16 v[48:51], v[192:195], a[8:11], 0
    buffer_load_dwordx4 v231, s[20:23], s64 offen offset:3072 lds
    v_mfma_f32_16x16x32_bf16 v[48:51], v[196:199], a[12:15], v[48:51]
    s_add_u32 m0, s86, 0
    ds_read_b64_tr_b16 v[208:209], v238 offset:768
    v_add_f32 v153, v153, v150
    v_mfma_f32_16x16x32_bf16 v[52:55], v[200:203], a[8:11], 0
    s_add_u32 s64, s82, 384
    ds_read_b128 a[52:55], v237 offset:36864
    v_add_f32 v153, v153, v151
    v_mfma_f32_16x16x32_bf16 v[52:55], v[204:207], a[12:15], v[52:55]
    ds_read_b64_tr_b16 v[210:211], v238 offset:1792
    ds_read_b64_tr_b16 v[212:213], v238 offset:8960
    v_mfma_f32_16x16x32_bf16 v[80:83], v[192:195], a[16:19], 0
    ds_read_b128 a[56:59], v236 offset:38912
    v_add_f32_dpp v152, v152, v152 row_shr:1 row_mask:0xf bank_mask:0xf bound_ctrl:0
    v_mfma_f32_16x16x32_bf16 v[80:83], v[196:199], a[20:23], v[80:83]
    ds_read_b64_tr_b16 v[214:215], v238 offset:9984
    v_add_f32_dpp v153, v153, v153 row_shr:1 row_mask:0xf bank_mask:0xf bound_ctrl:0
    v_mfma_f32_16x16x32_bf16 v[84:87], v[200:203], a[16:19], 0
    ds_read_b64_tr_b16 v[216:217], v239 offset:768
    v_add_f32_dpp v152, v152, v152 row_shr:2 row_mask:0xf bank_mask:0xf bound_ctrl:0
    v_mfma_f32_16x16x32_bf16 v[84:87], v[204:207], a[20:23], v[84:87]
    ds_read_b128 a[60:63], v237 offset:38912
    v_add_f32_dpp v153, v153, v153 row_shr:2 row_mask:0xf bank_mask:0xf bound_ctrl:0
    v_mfma_f32_16x16x32_bf16 v[112:115], v[192:195], a[24:27], 0
    ds_read_b64_tr_b16 v[218:219], v239 offset:1792
    ds_read_b64_tr_b16 v[220:221], v239 offset:8960
    ds_read_b64_tr_b16 v[222:223], v239 offset:9984
    v_add_f32_dpp v152, v152, v152 row_shr:4 row_mask:0xf bank_mask:0xf bound_ctrl:0
    v_mfma_f32_16x16x32_bf16 v[112:115], v[196:199], a[28:31], v[112:115]
    buffer_load_dwordx4 v232, s[12:15], s64 offen offset:0 lds
    v_mfma_f32_16x16x32_bf16 v[116:119], v[200:203], a[24:27], 0
    v_add_f32_dpp v153, v153, v153 row_shr:4 row_mask:0xf bank_mask:0xf bound_ctrl:0
    v_mfma_f32_16x16x32_bf16 v[116:119], v[204:207], a[28:31], v[116:119]
    s_waitcnt vmcnt(13) lgkmcnt(0)
    s_barrier
    v_mfma_f32_16x16x32_bf16 v[24:27], v[208:211], a[0:3], 0
    ds_read_b64_tr_b16 v[192:193], v238 offset:16384
    v_add_f32_dpp v152, v152, v152 row_shr:8 row_mask:0xf bank_mask:0xf bound_ctrl:0
    v_mfma_f32_16x16x32_bf16 v[24:27], v[212:215], a[4:7], v[24:27]
    buffer_load_dwordx4 v233, s[12:15], s64 offen offset:1024 lds
    v_mfma_f32_16x16x32_bf16 v[28:31], v[216:219], a[0:3], 0
    ds_read_b64_tr_b16 v[194:195], v238 offset:17408
    v_add_f32_dpp v153, v153, v153 row_shr:8 row_mask:0xf bank_mask:0xf bound_ctrl:0
    v_mfma_f32_16x16x32_bf16 v[28:31], v[220:223], a[4:7], v[28:31]
    v_add_f32_dpp v152, v152, v152 row_bcast:15 row_mask:0xa bank_mask:0xf
    v_cmp_eq_u32 vcc, 0, v254
    v_mfma_f32_16x16x32_bf16 v[56:59], v[208:211], a[8:11], 0
    buffer_load_dwordx4 v234, s[12:15], s64 offen offset:2048 lds
    v_mfma_f32_16x16x32_bf16 v[56:59], v[212:215], a[12:15], v[56:59]
    ds_read_b64_tr_b16 v[196:197], v238 offset:24576
    v_add_f32_dpp v153, v153, v153 row_bcast:15 row_mask:0xa bank_mask:0xf
    v_mfma_f32_16x16x32_bf16 v[60:63], v[216:219], a[8:11], 0
    v_add_f32_dpp v152, v152, v152 row_bcast:31 row_mask:0xc bank_mask:0xf
    v_mov_b32 v250, 1073741824
    v_mfma_f32_16x16x32_bf16 v[60:63], v[220:223], a[12:15], v[60:63]
    buffer_load_dwordx4 v235, s[12:15], s64 offen offset:3072 lds
    v_mfma_f32_16x16x32_bf16 v[88:91], v[208:211], a[16:19], 0
    s_add_u32 m0, s86, 4096
    s_add_u32 s64, s82, 33152
    v_add_f32_dpp v153, v153, v153 row_bcast:31 row_mask:0xc bank_mask:0xf
    v_mfma_f32_16x16x32_bf16 v[88:91], v[212:215], a[20:23], v[88:91]
    ds_read_b64_tr_b16 v[198:199], v238 offset:25600
    v_readlane_b32 s93, v152, 63
    v_mfma_f32_16x16x32_bf16 v[92:95], v[216:219], a[16:19], 0
    ds_read_b64_tr_b16 v[200:201], v239 offset:16384
    ds_read_b64_tr_b16 v[202:203], v239 offset:17408
    v_readlane_b32 s94, v153, 63
    v_mfma_f32_16x16x32_bf16 v[92:95], v[220:223], a[20:23], v[92:95]
    buffer_load_dwordx4 v232, s[12:15], s64 offen offset:0 lds
    v_mfma_f32_16x16x32_bf16 v[120:123], v[208:211], a[24:27], 0
    ds_read_b64_tr_b16 v[204:205], v239 offset:24576
    v_mov_b32 v154, s93
    v_mul_f32 v154, 0x3b000000, v154
    v_mfma_f32_16x16x32_bf16 v[120:123], v[212:215], a[28:31], v[120:123]
    ds_read_b64_tr_b16 v[206:207], v239 offset:25600
    v_cvt_pk_bf16_f32 v156, v154, v154
    v_lshlrev_b32 v156, 16, v156
    v_mfma_f32_16x16x32_bf16 v[124:127], v[216:219], a[24:27], 0
    v_sub_f32 v158, v136, v154
    v_mul_f32 v152, v158, v158
    v_mfma_f32_16x16x32_bf16 v[124:127], v[220:223], a[28:31], v[124:127]
    s_waitcnt lgkmcnt(0)
    v_sub_f32 v158, v137, v154
    v_fmac_f32 v152, v158, v158
    v_mfma_f32_16x16x32_bf16 v[0:3], v[192:195], a[32:35], v[0:3]
    buffer_load_dwordx4 v233, s[12:15], s64 offen offset:1024 lds
    v_mfma_f32_16x16x32_bf16 v[0:3], v[196:199], a[36:39], v[0:3]
    s_and_b32 s91, s2, 1
    s_lshl_b32 s91, s91, 7
    s_cmp_eq_u32 s56, 0
    s_cselect_b32 s91, s91, 1073741824
    v_cndmask_b32 v250, v250, 0, vcc
    buffer_atomic_add v251, v250, s[52:55], s91 offen sc1
    v_mfma_f32_16x16x32_bf16 v[4:7], v[200:203], a[32:35], v[4:7]
    buffer_load_dwordx4 v234, s[12:15], s64 offen offset:2048 lds
    v_mfma_f32_16x16x32_bf16 v[4:7], v[204:207], a[36:39], v[4:7]
    v_sub_f32 v158, v138, v154
    v_fmac_f32 v152, v158, v158
    v_mfma_f32_16x16x32_bf16 v[32:35], v[192:195], a[40:43], v[32:35]
    buffer_load_dwordx4 v235, s[12:15], s64 offen offset:3072 lds
    v_mfma_f32_16x16x32_bf16 v[32:35], v[196:199], a[44:47], v[32:35]
    s_add_u32 m0, s68, 147456
    v_sub_f32 v158, v139, v154
    v_fmac_f32 v152, v158, v158
    v_mfma_f32_16x16x32_bf16 v[36:39], v[200:203], a[40:43], v[36:39]
    s_add_u32 s64, s83, 1572864
    v_sub_f32 v158, v140, v154
    v_fmac_f32 v152, v158, v158
    v_mfma_f32_16x16x32_bf16 v[36:39], v[204:207], a[44:47], v[36:39]
    ds_read_b64_tr_b16 v[208:209], v238 offset:16640
    v_sub_f32 v158, v141, v154
    v_mfma_f32_16x16x32_bf16 v[64:67], v[192:195], a[48:51], v[64:67]
    v_fmac_f32 v152, v158, v158
    v_sub_f32 v158, v142, v154
    v_mfma_f32_16x16x32_bf16 v[64:67], v[196:199], a[52:55], v[64:67]
    ds_read_b64_tr_b16 v[210:211], v238 offset:17664
    v_fmac_f32 v152, v158, v158
    v_mfma_f32_16x16x32_bf16 v[68:71], v[200:203], a[48:51], v[68:71]
    ds_read_b64_tr_b16 v[212:213], v238 offset:24832
    v_sub_f32 v158, v143, v154
    v_mfma_f32_16x16x32_bf16 v[68:71], v[204:207], a[52:55], v[68:71]
    buffer_load_dwordx4 v228, s[20:23], s64 offen offset:0 lds
    v_mfma_f32_16x16x32_bf16 v[96:99], v[192:195], a[56:59], v[96:99]
    ds_read_b64_tr_b16 v[214:215], v238 offset:25856
    v_fmac_f32 v152, v158, v158
    v_mfma_f32_16x16x32_bf16 v[96:99], v[196:199], a[60:63], v[96:99]
    ds_read_b64_tr_b16 v[216:217], v239 offset:16640
    ds_read_b64_tr_b16 v[218:219], v239 offset:17664
    ds_read_b64_tr_b16 v[220:221], v239 offset:24832
    ds_read_b64_tr_b16 v[222:223], v239 offset:25856
    v_mov_b32 v155, s94
    v_mfma_f32_16x16x32_bf16 v[100:103], v[200:203], a[56:59], v[100:103]
    buffer_load_dwordx4 v229, s[20:23], s64 offen offset:1024 lds
    v_mfma_f32_16x16x32_bf16 v[100:103], v[204:207], a[60:63], v[100:103]
    s_waitcnt lgkmcnt(0)
    v_mul_f32 v155, 0x3b000000, v155
    v_cvt_pk_bf16_f32 v157, v155, v155
    v_mfma_f32_16x16x32_bf16 v[8:11], v[208:211], a[32:35], v[8:11]
    buffer_load_dwordx4 v230, s[20:23], s64 offen offset:2048 lds
    v_mfma_f32_16x16x32_bf16 v[8:11], v[212:215], a[36:39], v[8:11]
    s_waitcnt vmcnt(16)
    v_lshlrev_b32 v157, 16, v157
    v_sub_f32 v158, v144, v155
    v_mfma_f32_16x16x32_bf16 v[12:15], v[216:219], a[32:35], v[12:15]
    buffer_load_dwordx4 v231, s[20:23], s64 offen offset:3072 lds
    v_mfma_f32_16x16x32_bf16 v[12:15], v[220:223], a[36:39], v[12:15]
    s_add_u32 m0, s86, 32768
    v_mul_f32 v153, v158, v158
    v_sub_f32 v158, v145, v155
    v_mfma_f32_16x16x32_bf16 v[40:43], v[208:211], a[40:43], v[40:43]
    s_add_u32 s64, s82, 512
    v_fmac_f32 v153, v158, v158
    v_sub_f32 v158, v146, v155
    v_mfma_f32_16x16x32_bf16 v[40:43], v[212:215], a[44:47], v[40:43]
    v_add_u32 v236, 65536, v236
    v_fmac_f32 v153, v158, v158
    v_mfma_f32_16x16x32_bf16 v[44:47], v[216:219], a[40:43], v[44:47]
    v_add_u32 v237, 65536, v237
    v_sub_f32 v158, v147, v155
    v_mfma_f32_16x16x32_bf16 v[44:47], v[220:223], a[44:47], v[44:47]
    ds_read_b64_tr_b16 v[192:193], v238 offset:16896
    v_fmac_f32 v153, v158, v158
    v_mfma_f32_16x16x32_bf16 v[72:75], v[208:211], a[48:51], v[72:75]
    ds_read_b64_tr_b16 v[194:195], v238 offset:17920
    ds_read_b128 a[64:67], v236 offset:0
    v_mfma_f32_16x16x32_bf16 v[72:75], v[212:215], a[52:55], v[72:75]
    ds_read_b64_tr_b16 v[196:197], v238 offset:25088
    v_sub_f32 v158, v148, v155
    v_mfma_f32_16x16x32_bf16 v[76:79], v[216:219], a[48:51], v[76:79]
    v_fmac_f32 v153, v158, v158
    v_sub_f32 v158, v149, v155
    v_mfma_f32_16x16x32_bf16 v[76:79], v[220:223], a[52:55], v[76:79]
    ds_read_b64_tr_b16 v[198:199], v238 offset:26112
    ds_read_b128 a[68:71], v237 offset:0
    v_mfma_f32_16x16x32_bf16 v[104:107], v[208:211], a[56:59], v[104:107]
    buffer_load_dwordx4 v232, s[12:15], s64 offen offset:0 lds
    v_mfma_f32_16x16x32_bf16 v[104:107], v[212:215], a[60:63], v[104:107]
    ds_read_b64_tr_b16 v[200:201], v239 offset:16896
    ds_read_b64_tr_b16 v[202:203], v239 offset:17920
    ds_read_b64_tr_b16 v[204:205], v239 offset:25088
    ds_read_b64_tr_b16 v[206:207], v239 offset:26112
    v_fmac_f32 v153, v158, v158
    v_mfma_f32_16x16x32_bf16 v[108:111], v[216:219], a[56:59], v[108:111]
    v_sub_f32 v158, v150, v155
    v_fmac_f32 v153, v158, v158
    v_mfma_f32_16x16x32_bf16 v[108:111], v[220:223], a[60:63], v[108:111]
    s_waitcnt lgkmcnt(0)
    ds_read_b128 a[72:75], v236 offset:2048
    v_sub_f32 v158, v151, v155
    v_mfma_f32_16x16x32_bf16 v[16:19], v[192:195], a[32:35], v[16:19]
    buffer_load_dwordx4 v233, s[12:15], s64 offen offset:1024 lds
    v_mfma_f32_16x16x32_bf16 v[16:19], v[196:199], a[36:39], v[16:19]
    ds_read_b128 a[76:79], v237 offset:2048
    v_fmac_f32 v153, v158, v158
    v_mfma_f32_16x16x32_bf16 v[20:23], v[200:203], a[32:35], v[20:23]
    buffer_load_dwordx4 v234, s[12:15], s64 offen offset:2048 lds
    v_mfma_f32_16x16x32_bf16 v[20:23], v[204:207], a[36:39], v[20:23]
    ds_read_b128 a[80:83], v236 offset:4096
    v_add_f32_dpp v152, v152, v152 row_shr:1 row_mask:0xf bank_mask:0xf bound_ctrl:0
    v_mfma_f32_16x16x32_bf16 v[48:51], v[192:195], a[40:43], v[48:51]
    ds_read_b64_tr_b16 v[208:209], v238 offset:17152
    v_add_f32_dpp v153, v153, v153 row_shr:1 row_mask:0xf bank_mask:0xf bound_ctrl:0
    v_mfma_f32_16x16x32_bf16 v[48:51], v[196:199], a[44:47], v[48:51]
    buffer_load_dwordx4 v235, s[12:15], s64 offen offset:3072 lds
    v_mfma_f32_16x16x32_bf16 v[52:55], v[200:203], a[40:43], v[52:55]
    s_add_u32 m0, s86, 36864
    ds_read_b128 a[84:87], v237 offset:4096
    v_add_f32_dpp v152, v152, v152 row_shr:2 row_mask:0xf bank_mask:0xf bound_ctrl:0
    v_mfma_f32_16x16x32_bf16 v[52:55], v[204:207], a[44:47], v[52:55]
    s_add_u32 s64, s82, 33280
    ds_read_b64_tr_b16 v[210:211], v238 offset:18176
    v_add_f32_dpp v153, v153, v153 row_shr:2 row_mask:0xf bank_mask:0xf bound_ctrl:0
    v_mfma_f32_16x16x32_bf16 v[80:83], v[192:195], a[48:51], v[80:83]
    ds_read_b64_tr_b16 v[212:213], v238 offset:25344
    v_add_f32_dpp v152, v152, v152 row_shr:4 row_mask:0xf bank_mask:0xf bound_ctrl:0
    v_mfma_f32_16x16x32_bf16 v[80:83], v[196:199], a[52:55], v[80:83]
    ds_read_b128 a[88:91], v236 offset:6144
    v_add_f32_dpp v153, v153, v153 row_shr:4 row_mask:0xf bank_mask:0xf bound_ctrl:0
    v_mfma_f32_16x16x32_bf16 v[84:87], v[200:203], a[48:51], v[84:87]
    ds_read_b64_tr_b16 v[214:215], v238 offset:26368
    v_add_f32_dpp v152, v152, v152 row_shr:8 row_mask:0xf bank_mask:0xf bound_ctrl:0
    v_mfma_f32_16x16x32_bf16 v[84:87], v[204:207], a[52:55], v[84:87]
    ds_read_b64_tr_b16 v[216:217], v239 offset:17152
    v_add_f32_dpp v153, v153, v153 row_shr:8 row_mask:0xf bank_mask:0xf bound_ctrl:0
    v_mfma_f32_16x16x32_bf16 v[112:115], v[192:195], a[56:59], v[112:115]
    ds_read_b128 a[92:95], v237 offset:6144
    v_add_f32_dpp v152, v152, v152 row_bcast:15 row_mask:0xa bank_mask:0xf
    v_mfma_f32_16x16x32_bf16 v[112:115], v[196:199], a[60:63], v[112:115]
    ds_read_b64_tr_b16 v[218:219], v239 offset:18176
    ds_read_b64_tr_b16 v[220:221], v239 offset:25344
    ds_read_b64_tr_b16 v[222:223], v239 offset:26368
    v_add_f32_dpp v153, v153, v153 row_bcast:15 row_mask:0xa bank_mask:0xf
    v_mfma_f32_16x16x32_bf16 v[116:119], v[200:203], a[56:59], v[116:119]
    buffer_load_dwordx4 v232, s[12:15], s64 offen offset:0 lds
    v_mfma_f32_16x16x32_bf16 v[116:119], v[204:207], a[60:63], v[116:119]
    s_waitcnt vmcnt(18) lgkmcnt(0)
    s_barrier
    v_mfma_f32_16x16x32_bf16 v[24:27], v[208:211], a[32:35], v[24:27]
    ds_read_b64_tr_b16 v[192:193], v238 offset:32768
    v_add_f32_dpp v152, v152, v152 row_bcast:31 row_mask:0xc bank_mask:0xf
    v_mfma_f32_16x16x32_bf16 v[24:27], v[212:215], a[36:39], v[24:27]
    ds_read_b64_tr_b16 v[194:195], v238 offset:33792
    v_add_f32_dpp v153, v153, v153 row_bcast:31 row_mask:0xc bank_mask:0xf
    v_mfma_f32_16x16x32_bf16 v[28:31], v[216:219], a[32:35], v[28:31]
    buffer_load_dwordx4 v233, s[12:15], s64 offen offset:1024 lds
    v_mfma_f32_16x16x32_bf16 v[28:31], v[220:223], a[36:39], v[28:31]
    ds_read_b64_tr_b16 v[196:197], v238 offset:40960
    v_readlane_b32 s93, v152, 63
    v_mfma_f32_16x16x32_bf16 v[56:59], v[208:211], a[40:43], v[56:59]
    ds_read_b64_tr_b16 v[198:199], v238 offset:41984
    v_readlane_b32 s94, v153, 63
    v_mfma_f32_16x16x32_bf16 v[56:59], v[212:215], a[44:47], v[56:59]
    buffer_load_dwordx4 v234, s[12:15], s64 offen offset:2048 lds
    v_mfma_f32_16x16x32_bf16 v[60:63], v[216:219], a[40:43], v[60:63]
    v_mov_b32 v154, s93
    v_mul_f32 v154, 0x3b000000, v154
    v_mfma_f32_16x16x32_bf16 v[60:63], v[220:223], a[44:47], v[60:63]
    v_cvt_pk_bf16_f32 v154, v154, v154
    v_lshlrev_b32 v154, 16, v154
    v_mfma_f32_16x16x32_bf16 v[88:91], v[208:211], a[48:51], v[88:91]
    buffer_load_dwordx4 v235, s[12:15], s64 offen offset:3072 lds
    v_mfma_f32_16x16x32_bf16 v[88:91], v[212:215], a[52:55], v[88:91]
    s_add_u32 m0, s68, 98304
    v_add_f32 v154, 0x3727c5ac, v154
    v_cvt_pk_bf16_f32 v154, v154, v154
    v_mfma_f32_16x16x32_bf16 v[92:95], v[216:219], a[48:51], v[92:95]
    s_add_u32 s64, s83, 2097152
    ds_read_b64_tr_b16 v[200:201], v239 offset:32768
    v_lshlrev_b32 v154, 16, v154
    v_mfma_f32_16x16x32_bf16 v[92:95], v[220:223], a[52:55], v[92:95]
    ds_read_b64_tr_b16 v[202:203], v239 offset:33792
    v_sqrt_f32 v154, v154
    v_mfma_f32_16x16x32_bf16 v[120:123], v[208:211], a[56:59], v[120:123]
    ds_read_b64_tr_b16 v[204:205], v239 offset:40960
    v_cvt_pk_bf16_f32 v154, v154, v154
    v_lshlrev_b32 v154, 16, v154
    v_mfma_f32_16x16x32_bf16 v[120:123], v[212:215], a[60:63], v[120:123]
    ds_read_b64_tr_b16 v[206:207], v239 offset:41984
    v_rcp_f32 v154, v154
    v_mfma_f32_16x16x32_bf16 v[124:127], v[216:219], a[56:59], v[124:127]
    v_sub_f32 v136, v136, v156
    v_sub_f32 v137, v137, v156
    v_mfma_f32_16x16x32_bf16 v[124:127], v[220:223], a[60:63], v[124:127]
    s_waitcnt lgkmcnt(0)
    v_cvt_pk_bf16_f32 v158, v136, v137
    v_lshlrev_b32 v136, 16, v158
    v_mfma_f32_16x16x32_bf16 v[0:3], v[192:195], a[64:67], v[0:3]
    buffer_load_dwordx4 v228, s[20:23], s64 offen offset:0 lds
    v_mfma_f32_16x16x32_bf16 v[0:3], v[196:199], a[68:71], v[0:3]
    buffer_load_dwordx4 v229, s[20:23], s64 offen offset:1024 lds
    v_mfma_f32_16x16x32_bf16 v[4:7], v[200:203], a[64:67], v[4:7]
    buffer_load_dwordx4 v230, s[20:23], s64 offen offset:2048 lds
    v_mfma_f32_16x16x32_bf16 v[4:7], v[204:207], a[68:71], v[4:7]
    v_and_b32 v137, 0xffff0000, v158
    v_mul_f32 v136, v136, v154
    v_mfma_f32_16x16x32_bf16 v[32:35], v[192:195], a[72:75], v[32:35]
    buffer_load_dwordx4 v231, s[20:23], s64 offen offset:3072 lds
    v_mfma_f32_16x16x32_bf16 v[32:35], v[196:199], a[76:79], v[32:35]
    s_add_u32 m0, s86, 65536
    v_mul_f32 v137, v137, v154
    v_cvt_pk_bf16_f32 v128, v136, v137
    v_mfma_f32_16x16x32_bf16 v[36:39], v[200:203], a[72:75], v[36:39]
    s_add_u32 s64, s82, 640
    v_sub_f32 v138, v138, v156
    v_sub_f32 v139, v139, v156
    v_mfma_f32_16x16x32_bf16 v[36:39], v[204:207], a[76:79], v[36:39]
    ds_read_b64_tr_b16 v[208:209], v238 offset:33024
    v_cvt_pk_bf16_f32 v158, v138, v139
    v_mfma_f32_16x16x32_bf16 v[64:67], v[192:195], a[80:83], v[64:67]
    v_lshlrev_b32 v138, 16, v158
    v_and_b32 v139, 0xffff0000, v158
    v_mfma_f32_16x16x32_bf16 v[64:67], v[196:199], a[84:87], v[64:67]
    ds_read_b64_tr_b16 v[210:211], v238 offset:34048
    v_mul_f32 v138, v138, v154
    v_mfma_f32_16x16x32_bf16 v[68:71], v[200:203], a[80:83], v[68:71]
    ds_read_b64_tr_b16 v[212:213], v238 offset:41216
    v_mul_f32 v139, v139, v154
    v_mfma_f32_16x16x32_bf16 v[68:71], v[204:207], a[84:87], v[68:71]
    ds_read_b64_tr_b16 v[214:215], v238 offset:42240
    v_cvt_pk_bf16_f32 v129, v138, v139
    v_mfma_f32_16x16x32_bf16 v[96:99], v[192:195], a[88:91], v[96:99]
    ds_read_b64_tr_b16 v[216:217], v239 offset:33024
    v_sub_f32 v140, v140, v156
    v_mfma_f32_16x16x32_bf16 v[96:99], v[196:199], a[92:95], v[96:99]
    ds_read_b64_tr_b16 v[218:219], v239 offset:34048
    ds_read_b64_tr_b16 v[220:221], v239 offset:41216
    ds_read_b64_tr_b16 v[222:223], v239 offset:42240
    v_sub_f32 v141, v141, v156
    v_mfma_f32_16x16x32_bf16 v[100:103], v[200:203], a[88:91], v[100:103]
    buffer_load_dwordx4 v232, s[12:15], s64 offen offset:0 lds
    v_mfma_f32_16x16x32_bf16 v[100:103], v[204:207], a[92:95], v[100:103]
    s_waitcnt lgkmcnt(0)
    v_cvt_pk_bf16_f32 v158, v140, v141
    v_lshlrev_b32 v140, 16, v158
    v_mfma_f32_16x16x32_bf16 v[8:11], v[208:211], a[64:67], v[8:11]
    buffer_load_dwordx4 v233, s[12:15], s64 offen offset:1024 lds
    v_mfma_f32_16x16x32_bf16 v[8:11], v[212:215], a[68:71], v[8:11]
    s_waitcnt vmcnt(18)
    v_and_b32 v141, 0xffff0000, v158
    v_mul_f32 v140, v140, v154
    v_mfma_f32_16x16x32_bf16 v[12:15], v[216:219], a[64:67], v[12:15]
    v_mul_f32 v141, v141, v154
    v_cvt_pk_bf16_f32 v130, v140, v141
    v_mfma_f32_16x16x32_bf16 v[12:15], v[220:223], a[68:71], v[12:15]
    buffer_load_dwordx4 v234, s[12:15], s64 offen offset:2048 lds
    v_mfma_f32_16x16x32_bf16 v[40:43], v[208:211], a[72:75], v[40:43]
    v_subrev_u32 v236, 65536, v236
    v_sub_f32 v142, v142, v156
    v_mfma_f32_16x16x32_bf16 v[40:43], v[212:215], a[76:79], v[40:43]
    buffer_load_dwordx4 v235, s[12:15], s64 offen offset:3072 lds
    v_mfma_f32_16x16x32_bf16 v[44:47], v[216:219], a[72:75], v[44:47]
    s_add_u32 m0, s86, 69632
    v_subrev_u32 v237, 65536, v237
    v_sub_f32 v143, v143, v156
    v_mfma_f32_16x16x32_bf16 v[44:47], v[220:223], a[76:79], v[44:47]
    s_add_u32 s64, s82, 33408
    ds_read_b64_tr_b16 v[192:193], v238 offset:33280
    v_cvt_pk_bf16_f32 v158, v142, v143
    v_mfma_f32_16x16x32_bf16 v[72:75], v[208:211], a[80:83], v[72:75]
    ds_read_b64_tr_b16 v[194:195], v238 offset:34304
    v_lshlrev_b32 v142, 16, v158
    v_mfma_f32_16x16x32_bf16 v[72:75], v[212:215], a[84:87], v[72:75]
    ds_read_b128 a[96:99], v236 offset:0
    v_and_b32 v143, 0xffff0000, v158
    v_mfma_f32_16x16x32_bf16 v[76:79], v[216:219], a[80:83], v[76:79]
    ds_read_b64_tr_b16 v[196:197], v238 offset:41472
    v_mul_f32 v142, v142, v154
    v_mfma_f32_16x16x32_bf16 v[76:79], v[220:223], a[84:87], v[76:79]
    ds_read_b64_tr_b16 v[198:199], v238 offset:42496
    ds_read_b64_tr_b16 v[200:201], v239 offset:33280
    v_mul_f32 v143, v143, v154
    v_mfma_f32_16x16x32_bf16 v[104:107], v[208:211], a[88:91], v[104:107]
    ds_read_b128 a[100:103], v237 offset:0
    ds_read_b64_tr_b16 v[202:203], v239 offset:34304
    ds_read_b64_tr_b16 v[204:205], v239 offset:41472
    v_cvt_pk_bf16_f32 v131, v142, v143
    v_mfma_f32_16x16x32_bf16 v[104:107], v[212:215], a[92:95], v[104:107]
    buffer_load_dwordx4 v232, s[12:15], s64 offen offset:0 lds
    ds_read_b64_tr_b16 v[206:207], v239 offset:42496
    v_mfma_f32_16x16x32_bf16 v[108:111], v[216:219], a[88:91], v[108:111]
    v_mov_b32 v155, s94
    v_mul_f32 v155, 0x3b000000, v155
    v_mfma_f32_16x16x32_bf16 v[108:111], v[220:223], a[92:95], v[108:111]
    s_waitcnt lgkmcnt(0)
    ds_read_b128 a[104:107], v236 offset:2048
    v_cvt_pk_bf16_f32 v155, v155, v155
    v_mfma_f32_16x16x32_bf16 v[16:19], v[192:195], a[64:67], v[16:19]
    buffer_load_dwordx4 v233, s[12:15], s64 offen offset:1024 lds
    v_mfma_f32_16x16x32_bf16 v[16:19], v[196:199], a[68:71], v[16:19]
    v_lshlrev_b32 v155, 16, v155
    v_add_f32 v155, 0x3727c5ac, v155
    v_mfma_f32_16x16x32_bf16 v[20:23], v[200:203], a[64:67], v[20:23]
    buffer_load_dwordx4 v234, s[12:15], s64 offen offset:2048 lds
    v_mfma_f32_16x16x32_bf16 v[20:23], v[204:207], a[68:71], v[20:23]
    ds_read_b128 a[108:111], v237 offset:2048
    v_cvt_pk_bf16_f32 v155, v155, v155
    v_mfma_f32_16x16x32_bf16 v[48:51], v[192:195], a[72:75], v[48:51]
    ds_read_b128 a[112:115], v236 offset:4096
    v_lshlrev_b32 v155, 16, v155
    v_mfma_f32_16x16x32_bf16 v[48:51], v[196:199], a[76:79], v[48:51]
    buffer_load_dwordx4 v235, s[12:15], s64 offen offset:3072 lds
    v_mfma_f32_16x16x32_bf16 v[52:55], v[200:203], a[72:75], v[52:55]
    v_sqrt_f32 v155, v155
    v_mfma_f32_16x16x32_bf16 v[52:55], v[204:207], a[76:79], v[52:55]
    v_cvt_pk_bf16_f32 v155, v155, v155
    v_lshlrev_b32 v155, 16, v155
    v_mfma_f32_16x16x32_bf16 v[80:83], v[192:195], a[80:83], v[80:83]
    ds_read_b64_tr_b16 v[208:209], v238 offset:33536
    ds_read_b128 a[116:119], v237 offset:4096
    v_mfma_f32_16x16x32_bf16 v[80:83], v[196:199], a[84:87], v[80:83]
    v_rcp_f32 v155, v155
    v_mfma_f32_16x16x32_bf16 v[84:87], v[200:203], a[80:83], v[84:87]
    ds_read_b64_tr_b16 v[210:211], v238 offset:34560
    v_sub_f32 v144, v144, v157
    v_mfma_f32_16x16x32_bf16 v[84:87], v[204:207], a[84:87], v[84:87]
    ds_read_b64_tr_b16 v[212:213], v238 offset:41728
    v_sub_f32 v145, v145, v157
    v_mfma_f32_16x16x32_bf16 v[112:115], v[192:195], a[88:91], v[112:115]
    ds_read_b128 a[120:123], v236 offset:6144
    ds_read_b128 a[124:127], v237 offset:6144
    v_cvt_pk_bf16_f32 v158, v144, v145
    v_mfma_f32_16x16x32_bf16 v[112:115], v[196:199], a[92:95], v[112:115]
    ds_read_b64_tr_b16 v[214:215], v238 offset:42752
    ds_read_b64_tr_b16 v[216:217], v239 offset:33536
    ds_read_b64_tr_b16 v[218:219], v239 offset:34560
    ds_read_b64_tr_b16 v[220:221], v239 offset:41728
    ds_read_b64_tr_b16 v[222:223], v239 offset:42752
    v_lshlrev_b32 v144, 16, v158
    v_mfma_f32_16x16x32_bf16 v[116:119], v[200:203], a[88:91], v[116:119]
    v_and_b32 v145, 0xffff0000, v158
    v_mul_f32 v144, v144, v155
    v_mfma_f32_16x16x32_bf16 v[116:119], v[204:207], a[92:95], v[116:119]
    s_waitcnt vmcnt(20) lgkmcnt(0)
    s_barrier
    v_mfma_f32_16x16x32_bf16 v[24:27], v[208:211], a[64:67], v[24:27]
    v_mul_f32 v145, v145, v155
    v_cvt_pk_bf16_f32 v132, v144, v145
    v_mfma_f32_16x16x32_bf16 v[24:27], v[212:215], a[68:71], v[24:27]
    s_add_u32 m0, s68, 114688
    v_sub_f32 v146, v146, v157
    v_sub_f32 v147, v147, v157
    v_mfma_f32_16x16x32_bf16 v[28:31], v[216:219], a[64:67], v[28:31]
    v_cvt_pk_bf16_f32 v158, v146, v147
    v_lshlrev_b32 v146, 16, v158
    v_mfma_f32_16x16x32_bf16 v[28:31], v[220:223], a[68:71], v[28:31]
    s_add_u32 s64, s83, 2621440
    v_and_b32 v147, 0xffff0000, v158
    v_mul_f32 v146, v146, v155
    v_mfma_f32_16x16x32_bf16 v[56:59], v[208:211], a[72:75], v[56:59]
    ds_read_b64_tr_b16 v[192:193], v238 offset:49152
    v_mul_f32 v147, v147, v155
    v_mfma_f32_16x16x32_bf16 v[56:59], v[212:215], a[76:79], v[56:59]
    ds_read_b64_tr_b16 v[194:195], v238 offset:50176
    v_cvt_pk_bf16_f32 v133, v146, v147
    v_mfma_f32_16x16x32_bf16 v[60:63], v[216:219], a[72:75], v[60:63]
    ds_read_b64_tr_b16 v[196:197], v238 offset:57344
    v_sub_f32 v148, v148, v157
    v_mfma_f32_16x16x32_bf16 v[60:63], v[220:223], a[76:79], v[60:63]
    ds_read_b64_tr_b16 v[198:199], v238 offset:58368
    v_sub_f32 v149, v149, v157
    v_mfma_f32_16x16x32_bf16 v[88:91], v[208:211], a[80:83], v[88:91]
    buffer_load_dwordx4 v228, s[20:23], s64 offen offset:0 lds
    v_mfma_f32_16x16x32_bf16 v[88:91], v[212:215], a[84:87], v[88:91]
    ds_read_b64_tr_b16 v[200:201], v239 offset:49152
    v_cvt_pk_bf16_f32 v158, v148, v149
    v_mfma_f32_16x16x32_bf16 v[92:95], v[216:219], a[80:83], v[92:95]
    v_lshlrev_b32 v148, 16, v158
    v_and_b32 v149, 0xffff0000, v158
    v_mfma_f32_16x16x32_bf16 v[92:95], v[220:223], a[84:87], v[92:95]
    buffer_load_dwordx4 v229, s[20:23], s64 offen offset:1024 lds
    v_mfma_f32_16x16x32_bf16 v[120:123], v[208:211], a[88:91], v[120:123]
    ds_read_b64_tr_b16 v[202:203], v239 offset:50176
    ds_read_b64_tr_b16 v[204:205], v239 offset:57344
    ds_read_b64_tr_b16 v[206:207], v239 offset:58368
    v_mul_f32 v148, v148, v155
    v_mfma_f32_16x16x32_bf16 v[120:123], v[212:215], a[92:95], v[120:123]
    buffer_load_dwordx4 v230, s[20:23], s64 offen offset:2048 lds
    v_mfma_f32_16x16x32_bf16 v[124:127], v[216:219], a[88:91], v[124:127]
    v_mul_f32 v149, v149, v155
    v_cvt_pk_bf16_f32 v134, v148, v149
    v_mfma_f32_16x16x32_bf16 v[124:127], v[220:223], a[92:95], v[124:127]
    s_waitcnt lgkmcnt(0)
    v_sub_f32 v150, v150, v157
    v_sub_f32 v151, v151, v157
    v_mfma_f32_16x16x32_bf16 v[0:3], v[192:195], a[96:99], v[0:3]
    buffer_load_dwordx4 v231, s[20:23], s64 offen offset:3072 lds
    v_mfma_f32_16x16x32_bf16 v[0:3], v[196:199], a[100:103], v[0:3]
    v_cvt_pk_bf16_f32 v158, v150, v151
    v_lshlrev_b32 v150, 16, v158
    v_mfma_f32_16x16x32_bf16 v[4:7], v[200:203], a[96:99], v[4:7]
    s_add_u32 m0, s86, 0
    ds_read_b64_tr_b16 v[208:209], v238 offset:49408
    v_and_b32 v151, 0xffff0000, v158
    v_mfma_f32_16x16x32_bf16 v[4:7], v[204:207], a[100:103], v[4:7]
    v_lshrrev_b32 v224, 5, v254
    v_mul_f32 v150, v150, v155
    v_mfma_f32_16x16x32_bf16 v[32:35], v[192:195], a[104:107], v[32:35]
    s_add_u32 s64, s82, 768
    ds_read_b64_tr_b16 v[210:211], v238 offset:50432
    v_mul_f32 v151, v151, v155
    v_mfma_f32_16x16x32_bf16 v[32:35], v[196:199], a[108:111], v[32:35]
    ds_read_b64_tr_b16 v[212:213], v238 offset:57600
    v_cvt_pk_bf16_f32 v135, v150, v151
    v_mfma_f32_16x16x32_bf16 v[36:39], v[200:203], a[104:107], v[36:39]
    s_lshl_b32 s93, s92, 10
    s_add_u32 s93, s93, 1048576
    ds_read_b64_tr_b16 v[214:215], v238 offset:58624
    v_mfma_f32_16x16x32_bf16 v[36:39], v[204:207], a[108:111], v[36:39]
    ds_read_b64_tr_b16 v[216:217], v239 offset:49408
    v_bfe_u32 v225, v254, 2, 2
    v_mfma_f32_16x16x32_bf16 v[64:67], v[192:195], a[112:115], v[64:67]
    buffer_store_dwordx4 v[128:131], v255, s[4:7], s93 offen sc1
    v_mfma_f32_16x16x32_bf16 v[64:67], v[196:199], a[116:119], v[64:67]
    buffer_store_dwordx4 v[132:135], v255, s[4:7], s93 offen offset:1024 sc1
    v_mfma_f32_16x16x32_bf16 v[68:71], v[200:203], a[112:115], v[68:71]
    buffer_load_dwordx4 v232, s[12:15], s64 offen offset:0 lds
    v_mfma_f32_16x16x32_bf16 v[68:71], v[204:207], a[116:119], v[68:71]
    ds_read_b64_tr_b16 v[218:219], v239 offset:50432
    ds_read_b64_tr_b16 v[220:221], v239 offset:57600
    v_mfma_f32_16x16x32_bf16 v[96:99], v[192:195], a[120:123], v[96:99]
    buffer_load_dwordx4 v233, s[12:15], s64 offen offset:1024 lds
    v_mfma_f32_16x16x32_bf16 v[96:99], v[196:199], a[124:127], v[96:99]
    ds_read_b64_tr_b16 v[222:223], v239 offset:58624
    v_lshl_add_u32 v224, v224, 2, v225
    v_mfma_f32_16x16x32_bf16 v[100:103], v[200:203], a[120:123], v[100:103]
    buffer_load_dwordx4 v234, s[12:15], s64 offen offset:2048 lds
    v_mfma_f32_16x16x32_bf16 v[100:103], v[204:207], a[124:127], v[100:103]
    s_waitcnt lgkmcnt(0)
    v_mfma_f32_16x16x32_bf16 v[8:11], v[208:211], a[96:99], v[8:11]
    buffer_load_dwordx4 v235, s[12:15], s64 offen offset:3072 lds
    v_mfma_f32_16x16x32_bf16 v[8:11], v[212:215], a[100:103], v[8:11]
    s_waitcnt vmcnt(22)
    ds_read_b64_tr_b16 v[192:193], v238 offset:49664
    v_mul_u32_u24 v224, 8192, v224
    v_mfma_f32_16x16x32_bf16 v[12:15], v[216:219], a[96:99], v[12:15]
    s_add_u32 m0, s86, 4096
    ds_read_b64_tr_b16 v[194:195], v238 offset:50688
    ds_read_b128 a[128:131], v236 offset:32768
    v_mfma_f32_16x16x32_bf16 v[12:15], v[220:223], a[100:103], v[12:15]
    s_add_u32 s64, s82, 33536
    ds_read_b64_tr_b16 v[196:197], v238 offset:57856
    v_mfma_f32_16x16x32_bf16 v[40:43], v[208:211], a[104:107], v[40:43]
    ds_read_b64_tr_b16 v[198:199], v238 offset:58880
    v_mfma_f32_16x16x32_bf16 v[40:43], v[212:215], a[108:111], v[40:43]
    ds_read_b128 a[132:135], v237 offset:32768
    v_bfe_u32 v225, v254, 4, 1
    v_mfma_f32_16x16x32_bf16 v[44:47], v[216:219], a[104:107], v[44:47]
    buffer_load_dwordx4 v232, s[12:15], s64 offen offset:0 lds
    v_mfma_f32_16x16x32_bf16 v[44:47], v[220:223], a[108:111], v[44:47]
    ds_read_b64_tr_b16 v[200:201], v239 offset:49664
    ds_read_b64_tr_b16 v[202:203], v239 offset:50688
    v_mfma_f32_16x16x32_bf16 v[72:75], v[208:211], a[112:115], v[72:75]
    ds_read_b128 a[136:139], v236 offset:34816
    v_mfma_f32_16x16x32_bf16 v[72:75], v[212:215], a[116:119], v[72:75]
    buffer_load_dwordx4 v233, s[12:15], s64 offen offset:1024 lds
    v_mfma_f32_16x16x32_bf16 v[76:79], v[216:219], a[112:115], v[76:79]
    ds_read_b64_tr_b16 v[204:205], v239 offset:57856
    ds_read_b64_tr_b16 v[206:207], v239 offset:58880
    v_mfma_f32_16x16x32_bf16 v[76:79], v[220:223], a[116:119], v[76:79]
    ds_read_b128 a[140:143], v237 offset:34816
    v_lshl_add_u32 v224, v225, 6, v224
    v_mfma_f32_16x16x32_bf16 v[104:107], v[208:211], a[120:123], v[104:107]
    buffer_load_dwordx4 v234, s[12:15], s64 offen offset:2048 lds
    v_mfma_f32_16x16x32_bf16 v[104:107], v[212:215], a[124:127], v[104:107]
    buffer_load_dwordx4 v235, s[12:15], s64 offen offset:3072 lds
    v_mfma_f32_16x16x32_bf16 v[108:111], v[216:219], a[120:123], v[108:111]
    ds_read_b128 a[144:147], v236 offset:36864
    v_mfma_f32_16x16x32_bf16 v[108:111], v[220:223], a[124:127], v[108:111]
    s_waitcnt lgkmcnt(0)
    v_mfma_f32_16x16x32_bf16 v[16:19], v[192:195], a[96:99], v[16:19]
    ds_read_b64_tr_b16 v[208:209], v238 offset:49920
    v_and_b32 v225, 3, v254
    v_mfma_f32_16x16x32_bf16 v[16:19], v[196:199], a[100:103], v[16:19]
    ds_read_b128 a[148:151], v237 offset:36864
    ds_read_b64_tr_b16 v[210:211], v238 offset:50944
    v_mfma_f32_16x16x32_bf16 v[20:23], v[200:203], a[96:99], v[20:23]
    v_mfma_f32_16x16x32_bf16 v[20:23], v[204:207], a[100:103], v[20:23]
    ds_read_b64_tr_b16 v[212:213], v238 offset:58112
    v_mfma_f32_16x16x32_bf16 v[48:51], v[192:195], a[104:107], v[48:51]
    ds_read_b128 a[152:155], v236 offset:38912
    ds_read_b64_tr_b16 v[214:215], v238 offset:59136
    v_mfma_f32_16x16x32_bf16 v[48:51], v[196:199], a[108:111], v[48:51]
    v_lshl_add_u32 v242, v225, 4, v224
    v_mfma_f32_16x16x32_bf16 v[52:55], v[200:203], a[104:107], v[52:55]
    ds_read_b64_tr_b16 v[216:217], v239 offset:49920
    v_mfma_f32_16x16x32_bf16 v[52:55], v[204:207], a[108:111], v[52:55]
    ds_read_b128 a[156:159], v237 offset:38912
    ds_read_b64_tr_b16 v[218:219], v239 offset:50944
    v_mfma_f32_16x16x32_bf16 v[80:83], v[192:195], a[112:115], v[80:83]
    v_mfma_f32_16x16x32_bf16 v[80:83], v[196:199], a[116:119], v[80:83]
    ds_read_b64_tr_b16 v[220:221], v239 offset:58112
    v_mfma_f32_16x16x32_bf16 v[84:87], v[200:203], a[112:115], v[84:87]
    ds_read_b64_tr_b16 v[222:223], v239 offset:59136
    v_xor_b32 v225, 32, v242
    v_mfma_f32_16x16x32_bf16 v[84:87], v[204:207], a[116:119], v[84:87]
    v_mfma_f32_16x16x32_bf16 v[112:115], v[192:195], a[120:123], v[112:115]
    v_min_u32 v252, 1, v254
    v_mfma_f32_16x16x32_bf16 v[112:115], v[196:199], a[124:127], v[112:115]
    v_mfma_f32_16x16x32_bf16 v[116:119], v[200:203], a[120:123], v[116:119]
    v_lshlrev_b32 v252, 7, v252
    v_mfma_f32_16x16x32_bf16 v[116:119], v[204:207], a[124:127], v[116:119]
    s_waitcnt vmcnt(22) lgkmcnt(0)
    s_barrier
    v_mfma_f32_16x16x32_bf16 v[24:27], v[208:211], a[96:99], v[24:27]
    ds_read_b64_tr_b16 v[192:193], v238 offset:0
    v_add_u32 v243, 64512, v225
    v_mfma_f32_16x16x32_bf16 v[24:27], v[212:215], a[100:103], v[24:27]
    s_mov_b32 s89, 0
    v_add_u32 v252, s89, v252
    v_mfma_f32_16x16x32_bf16 v[28:31], v[216:219], a[96:99], v[28:31]
    s_add_u32 m0, s68, 131072
    ds_read_b64_tr_b16 v[194:195], v238 offset:1024
    v_mfma_f32_16x16x32_bf16 v[28:31], v[220:223], a[100:103], v[28:31]
    buffer_load_dword v253, v252, s[52:55], 0 offen sc1
    v_mfma_f32_16x16x32_bf16 v[56:59], v[208:211], a[104:107], v[56:59]
    s_add_u32 s64, s83, 3145728
    ds_read_b64_tr_b16 v[196:197], v238 offset:8192
    ds_read_b64_tr_b16 v[198:199], v238 offset:9216
    v_mfma_f32_16x16x32_bf16 v[56:59], v[212:215], a[108:111], v[56:59]
    buffer_load_dwordx4 v228, s[20:23], s64 offen offset:0 lds
    v_mfma_f32_16x16x32_bf16 v[60:63], v[216:219], a[104:107], v[60:63]
    ds_read_b64_tr_b16 v[200:201], v239 offset:0
    v_add_u32 v244, 129024, v242
    v_mfma_f32_16x16x32_bf16 v[60:63], v[220:223], a[108:111], v[60:63]
    buffer_load_dwordx4 v229, s[20:23], s64 offen offset:1024 lds
    v_mfma_f32_16x16x32_bf16 v[88:91], v[208:211], a[112:115], v[88:91]
    ds_read_b64_tr_b16 v[202:203], v239 offset:1024
    v_mfma_f32_16x16x32_bf16 v[88:91], v[212:215], a[116:119], v[88:91]
    buffer_load_dwordx4 v230, s[20:23], s64 offen offset:2048 lds
    v_mfma_f32_16x16x32_bf16 v[92:95], v[216:219], a[112:115], v[92:95]
    ds_read_b64_tr_b16 v[204:205], v239 offset:8192
    ds_read_b64_tr_b16 v[206:207], v239 offset:9216
    v_mfma_f32_16x16x32_bf16 v[92:95], v[220:223], a[116:119], v[92:95]
    v_add_u32 v245, 193536, v225
    v_mfma_f32_16x16x32_bf16 v[120:123], v[208:211], a[120:123], v[120:123]
    buffer_load_dwordx4 v231, s[20:23], s64 offen offset:3072 lds
    v_mfma_f32_16x16x32_bf16 v[120:123], v[212:215], a[124:127], v[120:123]
    v_mfma_f32_16x16x32_bf16 v[124:127], v[216:219], a[120:123], v[124:127]
    v_mfma_f32_16x16x32_bf16 v[124:127], v[220:223], a[124:127], v[124:127]
    s_waitcnt lgkmcnt(0)
    v_mfma_f32_16x16x32_bf16 v[0:3], v[192:195], a[128:131], v[0:3]
    ds_read_b64_tr_b16 v[208:209], v238 offset:256
    v_mfma_f32_16x16x32_bf16 v[0:3], v[196:199], a[132:135], v[0:3]
    ds_read_b64_tr_b16 v[210:211], v238 offset:1280
    v_mfma_f32_16x16x32_bf16 v[4:7], v[200:203], a[128:131], v[4:7]
    s_add_u32 m0, s86, 32768
    v_mfma_f32_16x16x32_bf16 v[4:7], v[204:207], a[132:135], v[4:7]
    ds_read_b64_tr_b16 v[212:213], v238 offset:8448
    v_mfma_f32_16x16x32_bf16 v[32:35], v[192:195], a[136:139], v[32:35]
    s_add_u32 s64, s82, 896
    ds_read_b64_tr_b16 v[214:215], v238 offset:9472
    v_mfma_f32_16x16x32_bf16 v[32:35], v[196:199], a[140:143], v[32:35]
    v_mfma_f32_16x16x32_bf16 v[36:39], v[200:203], a[136:139], v[36:39]
    ds_read_b64_tr_b16 v[216:217], v239 offset:256
    v_mfma_f32_16x16x32_bf16 v[36:39], v[204:207], a[140:143], v[36:39]
    buffer_load_dwordx4 v232, s[12:15], s64 offen offset:0 lds
    v_mfma_f32_16x16x32_bf16 v[64:67], v[192:195], a[144:147], v[64:67]
    ds_read_b64_tr_b16 v[218:219], v239 offset:1280
    v_mfma_f32_16x16x32_bf16 v[64:67], v[196:199], a[148:151], v[64:67]
    ds_read_b64_tr_b16 v[220:221], v239 offset:8448
    v_mfma_f32_16x16x32_bf16 v[68:71], v[200:203], a[144:147], v[68:71]
    buffer_load_dwordx4 v233, s[12:15], s64 offen offset:1024 lds
    v_mfma_f32_16x16x32_bf16 v[68:71], v[204:207], a[148:151], v[68:71]
    ds_read_b64_tr_b16 v[222:223], v239 offset:9472
    v_mfma_f32_16x16x32_bf16 v[96:99], v[192:195], a[152:155], v[96:99]
    buffer_load_dwordx4 v234, s[12:15], s64 offen offset:2048 lds
    v_mfma_f32_16x16x32_bf16 v[96:99], v[196:199], a[156:159], v[96:99]
    v_mfma_f32_16x16x32_bf16 v[100:103], v[200:203], a[152:155], v[100:103]
    v_add_u32 v236, 65536, v236
    v_mfma_f32_16x16x32_bf16 v[100:103], v[204:207], a[156:159], v[100:103]
    s_waitcnt lgkmcnt(0)
    v_add_u32 v237, 65536, v237
    v_mfma_f32_16x16x32_bf16 v[8:11], v[208:211], a[128:131], v[8:11]
    buffer_load_dwordx4 v235, s[12:15], s64 offen offset:3072 lds
    v_mfma_f32_16x16x32_bf16 v[8:11], v[212:215], a[132:135], v[8:11]
    s_waitcnt vmcnt(23)
    s_add_u32 m0, s86, 36864
    ds_read_b64_tr_b16 v[192:193], v238 offset:512
    v_mfma_f32_16x16x32_bf16 v[12:15], v[216:219], a[128:131], v[12:15]
    ds_read_b64_tr_b16 v[194:195], v238 offset:1536
    ds_read_b128 a[160:163], v236 offset:0
    v_mfma_f32_16x16x32_bf16 v[12:15], v[220:223], a[132:135], v[12:15]
    s_add_u32 s64, s82, 33664
    ds_read_b64_tr_b16 v[196:197], v238 offset:8704
    v_mfma_f32_16x16x32_bf16 v[40:43], v[208:211], a[136:139], v[40:43]
    ds_read_b64_tr_b16 v[198:199], v238 offset:9728
    v_mfma_f32_16x16x32_bf16 v[40:43], v[212:215], a[140:143], v[40:43]
    ds_read_b128 a[164:167], v237 offset:0
    v_mfma_f32_16x16x32_bf16 v[44:47], v[216:219], a[136:139], v[44:47]
    buffer_load_dwordx4 v232, s[12:15], s64 offen offset:0 lds
    v_mfma_f32_16x16x32_bf16 v[44:47], v[220:223], a[140:143], v[44:47]
    ds_read_b64_tr_b16 v[200:201], v239 offset:512
    ds_read_b64_tr_b16 v[202:203], v239 offset:1536
    v_mfma_f32_16x16x32_bf16 v[72:75], v[208:211], a[144:147], v[72:75]
    ds_read_b128 a[168:171], v236 offset:2048
    v_mfma_f32_16x16x32_bf16 v[72:75], v[212:215], a[148:151], v[72:75]
    buffer_load_dwordx4 v233, s[12:15], s64 offen offset:1024 lds
    v_mfma_f32_16x16x32_bf16 v[76:79], v[216:219], a[144:147], v[76:79]
    ds_read_b64_tr_b16 v[204:205], v239 offset:8704
    ds_read_b64_tr_b16 v[206:207], v239 offset:9728
    v_mfma_f32_16x16x32_bf16 v[76:79], v[220:223], a[148:151], v[76:79]
    buffer_load_dwordx4 v234, s[12:15], s64 offen offset:2048 lds
    v_mfma_f32_16x16x32_bf16 v[104:107], v[208:211], a[152:155], v[104:107]
    ds_read_b128 a[172:175], v237 offset:2048
    v_mfma_f32_16x16x32_bf16 v[104:107], v[212:215], a[156:159], v[104:107]
    buffer_load_dwordx4 v235, s[12:15], s64 offen offset:3072 lds
    v_mfma_f32_16x16x32_bf16 v[108:111], v[216:219], a[152:155], v[108:111]
    ds_read_b128 a[176:179], v236 offset:4096
    v_mfma_f32_16x16x32_bf16 v[108:111], v[220:223], a[156:159], v[108:111]
    s_waitcnt lgkmcnt(0)
    v_mfma_f32_16x16x32_bf16 v[16:19], v[192:195], a[128:131], v[16:19]
    ds_read_b64_tr_b16 v[208:209], v238 offset:768
    v_mfma_f32_16x16x32_bf16 v[16:19], v[196:199], a[132:135], v[16:19]
    ds_read_b128 a[180:183], v237 offset:4096
    ds_read_b64_tr_b16 v[210:211], v238 offset:1792
    v_mfma_f32_16x16x32_bf16 v[20:23], v[200:203], a[128:131], v[20:23]
    v_mfma_f32_16x16x32_bf16 v[20:23], v[204:207], a[132:135], v[20:23]
    ds_read_b64_tr_b16 v[212:213], v238 offset:8960
    v_mfma_f32_16x16x32_bf16 v[48:51], v[192:195], a[136:139], v[48:51]
    ds_read_b128 a[184:187], v236 offset:6144
    ds_read_b64_tr_b16 v[214:215], v238 offset:9984
    v_mfma_f32_16x16x32_bf16 v[48:51], v[196:199], a[140:143], v[48:51]
    v_mfma_f32_16x16x32_bf16 v[52:55], v[200:203], a[136:139], v[52:55]
    ds_read_b64_tr_b16 v[216:217], v239 offset:768
    v_mfma_f32_16x16x32_bf16 v[52:55], v[204:207], a[140:143], v[52:55]
    ds_read_b128 a[188:191], v237 offset:6144
    ds_read_b64_tr_b16 v[218:219], v239 offset:1792
    v_mfma_f32_16x16x32_bf16 v[80:83], v[192:195], a[144:147], v[80:83]
    s_waitcnt vmcnt(12)
    v_cmp_gt_u32 vcc, 128, v253
    s_nop 0
    s_cbranch_vccnz L_spin_103
L_spinret_104:
    v_mfma_f32_16x16x32_bf16 v[80:83], v[196:199], a[148:151], v[80:83]
    ds_read_b64_tr_b16 v[220:221], v239 offset:8960
    v_mfma_f32_16x16x32_bf16 v[84:87], v[200:203], a[144:147], v[84:87]
    ds_read_b64_tr_b16 v[222:223], v239 offset:9984
    v_mfma_f32_16x16x32_bf16 v[84:87], v[204:207], a[148:151], v[84:87]
    v_mfma_f32_16x16x32_bf16 v[112:115], v[192:195], a[152:155], v[112:115]
    s_lshl_b32 s89, s2, 4
    s_lshl_b32 s90, s56, 2
    s_add_u32 s89, s89, s90
    s_add_u32 s89, s89, 20480
    v_mov_b32 v250, s89
    v_mfma_f32_16x16x32_bf16 v[112:115], v[196:199], a[156:159], v[112:115]
    v_mfma_f32_16x16x32_bf16 v[116:119], v[200:203], a[152:155], v[116:119]
    buffer_store_dword v251, v250, s[4:7], 0 offen sc1
    v_mfma_f32_16x16x32_bf16 v[116:119], v[204:207], a[156:159], v[116:119]
    s_waitcnt lgkmcnt(0)
    s_barrier
    v_mfma_f32_16x16x32_bf16 v[24:27], v[208:211], a[128:131], v[24:27]
    ds_read_b64_tr_b16 v[192:193], v238 offset:16384
    v_mfma_f32_16x16x32_bf16 v[24:27], v[212:215], a[132:135], v[24:27]
    s_add_u32 m0, s68, 147456
    ds_read_b64_tr_b16 v[194:195], v238 offset:17408
    v_mfma_f32_16x16x32_bf16 v[28:31], v[216:219], a[128:131], v[28:31]
    v_mfma_f32_16x16x32_bf16 v[28:31], v[220:223], a[132:135], v[28:31]
    s_add_u32 s64, s83, 3670016
    ds_read_b64_tr_b16 v[196:197], v238 offset:24576
    v_mfma_f32_16x16x32_bf16 v[56:59], v[208:211], a[136:139], v[56:59]
    ds_read_b64_tr_b16 v[198:199], v238 offset:25600
    v_mfma_f32_16x16x32_bf16 v[56:59], v[212:215], a[140:143], v[56:59]
    buffer_load_dwordx4 v228, s[20:23], s64 offen offset:0 lds
    v_mfma_f32_16x16x32_bf16 v[60:63], v[216:219], a[136:139], v[60:63]
    ds_read_b64_tr_b16 v[200:201], v239 offset:16384
    v_mfma_f32_16x16x32_bf16 v[60:63], v[220:223], a[140:143], v[60:63]
    buffer_load_dwordx4 v229, s[20:23], s64 offen offset:1024 lds
    v_mfma_f32_16x16x32_bf16 v[88:91], v[208:211], a[144:147], v[88:91]
    ds_read_b64_tr_b16 v[202:203], v239 offset:17408
    v_mfma_f32_16x16x32_bf16 v[88:91], v[212:215], a[148:151], v[88:91]
    buffer_load_dwordx4 v230, s[20:23], s64 offen offset:2048 lds
    v_mfma_f32_16x16x32_bf16 v[92:95], v[216:219], a[144:147], v[92:95]
    ds_read_b64_tr_b16 v[204:205], v239 offset:24576
    ds_read_b64_tr_b16 v[206:207], v239 offset:25600
    v_mfma_f32_16x16x32_bf16 v[92:95], v[220:223], a[148:151], v[92:95]
    buffer_load_dwordx4 v231, s[20:23], s64 offen offset:3072 lds
    v_mfma_f32_16x16x32_bf16 v[120:123], v[208:211], a[152:155], v[120:123]
    s_sub_u32 s89, s98, 64
    s_lshl_b32 s90, s89, 16
    s_and_b32 s91, s2, 7
    s_lshl_b32 s91, s91, 10
    s_add_u32 s90, s90, s91
    s_add_u32 s90, s90, 0
    s_cmp_lt_u32 s89, 64
    s_cselect_b32 s3, s90, 1073741824
    v_mfma_f32_16x16x32_bf16 v[120:123], v[212:215], a[156:159], v[120:123]
    buffer_load_dword v247, v249, s[16:19], s3 offen
    v_mfma_f32_16x16x32_bf16 v[124:127], v[216:219], a[152:155], v[124:127]
    v_mfma_f32_16x16x32_bf16 v[124:127], v[220:223], a[156:159], v[124:127]
    s_waitcnt lgkmcnt(0)
    v_mfma_f32_16x16x32_bf16 v[0:3], v[192:195], a[160:163], v[0:3]
    s_add_u32 m0, s68, 98304
    ds_read_b64_tr_b16 v[208:209], v238 offset:16640
    v_lshrrev_b32 v249, 2, v254
    v_mfma_f32_16x16x32_bf16 v[0:3], v[196:199], a[164:167], v[0:3]
    ds_read_b64_tr_b16 v[210:211], v238 offset:17664
    v_mul_u32_u24 v249, 3584, v249
    v_mfma_f32_16x16x32_bf16 v[4:7], v[200:203], a[160:163], v[4:7]
    v_and_b32 v248, 3, v254
    v_mfma_f32_16x16x32_bf16 v[4:7], v[204:207], a[164:167], v[4:7]
    ds_read_b64_tr_b16 v[212:213], v238 offset:24832
    v_mfma_f32_16x16x32_bf16 v[32:35], v[192:195], a[168:171], v[32:35]
    ds_read_b64_tr_b16 v[214:215], v238 offset:25856
    v_lshl_add_u32 v249, v248, 7, v249
    v_mfma_f32_16x16x32_bf16 v[32:35], v[196:199], a[172:175], v[32:35]
    s_sub_u32 s89, s98, 0
    s_mul_i32 s90, s89, 57344
    s_and_b32 s91, s2, 7
    s_lshl_b32 s91, s91, 9
    s_add_u32 s90, s90, s91
    s_cmp_lt_u32 s89, 32
    s_cselect_b32 s3, s90, 1073741824
    v_mfma_f32_16x16x32_bf16 v[36:39], v[200:203], a[168:171], v[36:39]
    s_add_u32 s64, s87, 0
    ds_read_b64_tr_b16 v[216:217], v239 offset:16640
    v_mfma_f32_16x16x32_bf16 v[36:39], v[204:207], a[172:175], v[36:39]
    buffer_load_dword v246, v249, s[32:35], s3 offen
    v_mfma_f32_16x16x32_bf16 v[64:67], v[192:195], a[176:179], v[64:67]
    ds_read_b64_tr_b16 v[218:219], v239 offset:17664
    v_mfma_f32_16x16x32_bf16 v[64:67], v[196:199], a[180:183], v[64:67]
    ds_read_b64_tr_b16 v[220:221], v239 offset:24832
    v_mfma_f32_16x16x32_bf16 v[68:71], v[200:203], a[176:179], v[68:71]
    ds_read_b64_tr_b16 v[222:223], v239 offset:25856
    v_mfma_f32_16x16x32_bf16 v[68:71], v[204:207], a[180:183], v[68:71]
    v_mfma_f32_16x16x32_bf16 v[96:99], v[192:195], a[184:187], v[96:99]
    v_mfma_f32_16x16x32_bf16 v[96:99], v[196:199], a[188:191], v[96:99]
    buffer_load_dwordx4 v242, s[24:27], s64 offen offset:0 lds
    v_mfma_f32_16x16x32_bf16 v[100:103], v[200:203], a[184:187], v[100:103]
    v_subrev_u32 v236, 65536, v236
    v_mfma_f32_16x16x32_bf16 v[100:103], v[204:207], a[188:191], v[100:103]
    s_waitcnt lgkmcnt(0)
    v_subrev_u32 v237, 65536, v237
    v_mfma_f32_16x16x32_bf16 v[8:11], v[208:211], a[160:163], v[8:11]
    ds_read_b64_tr_b16 v[192:193], v238 offset:16896
    v_mfma_f32_16x16x32_bf16 v[8:11], v[212:215], a[164:167], v[8:11]
    ds_read_b64_tr_b16 v[194:195], v238 offset:17920
    v_mfma_f32_16x16x32_bf16 v[12:15], v[216:219], a[160:163], v[12:15]
    ds_read_b128 a[192:195], v236 offset:0
    v_mfma_f32_16x16x32_bf16 v[12:15], v[220:223], a[164:167], v[12:15]
    ds_read_b64_tr_b16 v[196:197], v238 offset:25088
    v_mfma_f32_16x16x32_bf16 v[40:43], v[208:211], a[168:171], v[40:43]
    buffer_load_dwordx4 v243, s[24:27], s64 offen offset:1024 lds
    v_mfma_f32_16x16x32_bf16 v[40:43], v[212:215], a[172:175], v[40:43]
    ds_read_b64_tr_b16 v[198:199], v238 offset:26112
    ds_read_b128 a[196:199], v237 offset:0
    v_mfma_f32_16x16x32_bf16 v[44:47], v[216:219], a[168:171], v[44:47]
    ds_read_b64_tr_b16 v[200:201], v239 offset:16896
    v_mfma_f32_16x16x32_bf16 v[44:47], v[220:223], a[172:175], v[44:47]
    ds_read_b64_tr_b16 v[202:203], v239 offset:17920
    v_mfma_f32_16x16x32_bf16 v[72:75], v[208:211], a[176:179], v[72:75]
    ds_read_b128 a[200:203], v236 offset:2048
    v_mfma_f32_16x16x32_bf16 v[72:75], v[212:215], a[180:183], v[72:75]
    ds_read_b64_tr_b16 v[204:205], v239 offset:25088
    v_mfma_f32_16x16x32_bf16 v[76:79], v[216:219], a[176:179], v[76:79]
    ds_read_b64_tr_b16 v[206:207], v239 offset:26112
    v_mfma_f32_16x16x32_bf16 v[76:79], v[220:223], a[180:183], v[76:79]
    buffer_load_dwordx4 v244, s[24:27], s64 offen offset:2048 lds
    v_mfma_f32_16x16x32_bf16 v[104:107], v[208:211], a[184:187], v[104:107]
    ds_read_b128 a[204:207], v237 offset:2048
    v_mfma_f32_16x16x32_bf16 v[104:107], v[212:215], a[188:191], v[104:107]
    v_mfma_f32_16x16x32_bf16 v[108:111], v[216:219], a[184:187], v[108:111]
    ds_read_b128 a[208:211], v236 offset:4096
    v_mfma_f32_16x16x32_bf16 v[108:111], v[220:223], a[188:191], v[108:111]
    s_waitcnt lgkmcnt(0)
    v_mfma_f32_16x16x32_bf16 v[16:19], v[192:195], a[160:163], v[16:19]
    ds_read_b64_tr_b16 v[208:209], v238 offset:17152
    v_mfma_f32_16x16x32_bf16 v[16:19], v[196:199], a[164:167], v[16:19]
    ds_read_b128 a[212:215], v237 offset:4096
    ds_read_b64_tr_b16 v[210:211], v238 offset:18176
    v_mfma_f32_16x16x32_bf16 v[20:23], v[200:203], a[160:163], v[20:23]
    buffer_load_dwordx4 v245, s[24:27], s64 offen offset:3072 lds
    v_mfma_f32_16x16x32_bf16 v[20:23], v[204:207], a[164:167], v[20:23]
    ds_read_b64_tr_b16 v[212:213], v238 offset:25344
    v_mfma_f32_16x16x32_bf16 v[48:51], v[192:195], a[168:171], v[48:51]
    ds_read_b128 a[216:219], v236 offset:6144
    ds_read_b64_tr_b16 v[214:215], v238 offset:26368
    v_mfma_f32_16x16x32_bf16 v[48:51], v[196:199], a[172:175], v[48:51]
    v_mfma_f32_16x16x32_bf16 v[52:55], v[200:203], a[168:171], v[52:55]
    ds_read_b64_tr_b16 v[216:217], v239 offset:17152
    v_mfma_f32_16x16x32_bf16 v[52:55], v[204:207], a[172:175], v[52:55]
    ds_read_b128 a[220:223], v237 offset:6144
    ds_read_b64_tr_b16 v[218:219], v239 offset:18176
    v_mfma_f32_16x16x32_bf16 v[80:83], v[192:195], a[176:179], v[80:83]
    v_mfma_f32_16x16x32_bf16 v[80:83], v[196:199], a[180:183], v[80:83]
    ds_read_b64_tr_b16 v[220:221], v239 offset:25344
    v_mfma_f32_16x16x32_bf16 v[84:87], v[200:203], a[176:179], v[84:87]
    ds_read_b64_tr_b16 v[222:223], v239 offset:26368
    v_mfma_f32_16x16x32_bf16 v[84:87], v[204:207], a[180:183], v[84:87]
    v_mfma_f32_16x16x32_bf16 v[112:115], v[192:195], a[184:187], v[112:115]
    v_mfma_f32_16x16x32_bf16 v[112:115], v[196:199], a[188:191], v[112:115]
    v_mfma_f32_16x16x32_bf16 v[116:119], v[200:203], a[184:187], v[116:119]
    v_mfma_f32_16x16x32_bf16 v[116:119], v[204:207], a[188:191], v[116:119]
    s_waitcnt vmcnt(19) lgkmcnt(0)
    s_barrier
    v_mfma_f32_16x16x32_bf16 v[24:27], v[208:211], a[160:163], v[24:27]
    ds_read_b64_tr_b16 v[192:193], v238 offset:32768
    v_mfma_f32_16x16x32_bf16 v[24:27], v[212:215], a[164:167], v[24:27]
    ds_read_b64_tr_b16 v[194:195], v238 offset:33792
    v_mfma_f32_16x16x32_bf16 v[28:31], v[216:219], a[160:163], v[28:31]
    v_mfma_f32_16x16x32_bf16 v[28:31], v[220:223], a[164:167], v[28:31]
    ds_read_b64_tr_b16 v[196:197], v238 offset:40960
    v_mfma_f32_16x16x32_bf16 v[56:59], v[208:211], a[168:171], v[56:59]
    ds_read_b64_tr_b16 v[198:199], v238 offset:41984
    v_mfma_f32_16x16x32_bf16 v[56:59], v[212:215], a[172:175], v[56:59]
    v_mfma_f32_16x16x32_bf16 v[60:63], v[216:219], a[168:171], v[60:63]
    ds_read_b64_tr_b16 v[200:201], v239 offset:32768
    v_mfma_f32_16x16x32_bf16 v[60:63], v[220:223], a[172:175], v[60:63]
    ds_read_b64_tr_b16 v[202:203], v239 offset:33792
    v_mfma_f32_16x16x32_bf16 v[88:91], v[208:211], a[176:179], v[88:91]
    v_mfma_f32_16x16x32_bf16 v[88:91], v[212:215], a[180:183], v[88:91]
    ds_read_b64_tr_b16 v[204:205], v239 offset:40960
    v_mfma_f32_16x16x32_bf16 v[92:95], v[216:219], a[176:179], v[92:95]
    ds_read_b64_tr_b16 v[206:207], v239 offset:41984
    v_mfma_f32_16x16x32_bf16 v[92:95], v[220:223], a[180:183], v[92:95]
    v_mfma_f32_16x16x32_bf16 v[120:123], v[208:211], a[184:187], v[120:123]
    v_mfma_f32_16x16x32_bf16 v[120:123], v[212:215], a[188:191], v[120:123]
    v_mfma_f32_16x16x32_bf16 v[124:127], v[216:219], a[184:187], v[124:127]
    v_mfma_f32_16x16x32_bf16 v[124:127], v[220:223], a[188:191], v[124:127]
    s_waitcnt lgkmcnt(0)
    v_mfma_f32_16x16x32_bf16 v[0:3], v[192:195], a[192:195], v[0:3]
    s_add_u32 m0, s68, 114688
    ds_read_b64_tr_b16 v[208:209], v238 offset:33024
    v_mfma_f32_16x16x32_bf16 v[0:3], v[196:199], a[196:199], v[0:3]
    ds_read_b64_tr_b16 v[210:211], v238 offset:34048
    v_mfma_f32_16x16x32_bf16 v[4:7], v[200:203], a[192:195], v[4:7]
    v_mfma_f32_16x16x32_bf16 v[4:7], v[204:207], a[196:199], v[4:7]
    ds_read_b64_tr_b16 v[212:213], v238 offset:41216
    v_mfma_f32_16x16x32_bf16 v[32:35], v[192:195], a[200:203], v[32:35]
    ds_read_b64_tr_b16 v[214:215], v238 offset:42240
    v_mfma_f32_16x16x32_bf16 v[32:35], v[196:199], a[204:207], v[32:35]
    v_mfma_f32_16x16x32_bf16 v[36:39], v[200:203], a[200:203], v[36:39]
    s_add_u32 s64, s87, 128
    ds_read_b64_tr_b16 v[216:217], v239 offset:33024
    v_mfma_f32_16x16x32_bf16 v[36:39], v[204:207], a[204:207], v[36:39]
    ds_read_b64_tr_b16 v[218:219], v239 offset:34048
    v_mfma_f32_16x16x32_bf16 v[64:67], v[192:195], a[208:211], v[64:67]
    v_mfma_f32_16x16x32_bf16 v[64:67], v[196:199], a[212:215], v[64:67]
    ds_read_b64_tr_b16 v[220:221], v239 offset:41216
    v_mfma_f32_16x16x32_bf16 v[68:71], v[200:203], a[208:211], v[68:71]
    ds_read_b64_tr_b16 v[222:223], v239 offset:42240
    v_mfma_f32_16x16x32_bf16 v[68:71], v[204:207], a[212:215], v[68:71]
    v_mfma_f32_16x16x32_bf16 v[96:99], v[192:195], a[216:219], v[96:99]
    v_mfma_f32_16x16x32_bf16 v[96:99], v[196:199], a[220:223], v[96:99]
    buffer_load_dwordx4 v242, s[24:27], s64 offen offset:0 lds
    v_mfma_f32_16x16x32_bf16 v[100:103], v[200:203], a[216:219], v[100:103]
    v_mfma_f32_16x16x32_bf16 v[100:103], v[204:207], a[220:223], v[100:103]
    s_waitcnt lgkmcnt(0)
    v_mfma_f32_16x16x32_bf16 v[8:11], v[208:211], a[192:195], v[8:11]
    ds_read_b64_tr_b16 v[192:193], v238 offset:33280
    v_mfma_f32_16x16x32_bf16 v[8:11], v[212:215], a[196:199], v[8:11]
    s_waitcnt vmcnt(12)
    ds_read_b64_tr_b16 v[194:195], v238 offset:34304
    v_mfma_f32_16x16x32_bf16 v[12:15], v[216:219], a[192:195], v[12:15]
    ds_read_b128 a[224:227], v236 offset:32768
    v_mfma_f32_16x16x32_bf16 v[12:15], v[220:223], a[196:199], v[12:15]
    ds_read_b64_tr_b16 v[196:197], v238 offset:41472
    v_mfma_f32_16x16x32_bf16 v[40:43], v[208:211], a[200:203], v[40:43]
    buffer_load_dwordx4 v243, s[24:27], s64 offen offset:1024 lds
    v_mfma_f32_16x16x32_bf16 v[40:43], v[212:215], a[204:207], v[40:43]
    ds_read_b64_tr_b16 v[198:199], v238 offset:42496
    ds_read_b128 a[228:231], v237 offset:32768
    v_mfma_f32_16x16x32_bf16 v[44:47], v[216:219], a[200:203], v[44:47]
    ds_read_b64_tr_b16 v[200:201], v239 offset:33280
    v_mfma_f32_16x16x32_bf16 v[44:47], v[220:223], a[204:207], v[44:47]
    ds_read_b64_tr_b16 v[202:203], v239 offset:34304
    v_mfma_f32_16x16x32_bf16 v[72:75], v[208:211], a[208:211], v[72:75]
    ds_read_b128 a[232:235], v236 offset:34816
    v_mfma_f32_16x16x32_bf16 v[72:75], v[212:215], a[212:215], v[72:75]
    ds_read_b64_tr_b16 v[204:205], v239 offset:41472
    v_mfma_f32_16x16x32_bf16 v[76:79], v[216:219], a[208:211], v[76:79]
    ds_read_b64_tr_b16 v[206:207], v239 offset:42496
    v_mfma_f32_16x16x32_bf16 v[76:79], v[220:223], a[212:215], v[76:79]
    buffer_load_dwordx4 v244, s[24:27], s64 offen offset:2048 lds
    v_mfma_f32_16x16x32_bf16 v[104:107], v[208:211], a[216:219], v[104:107]
    ds_read_b128 a[236:239], v237 offset:34816
    v_mfma_f32_16x16x32_bf16 v[104:107], v[212:215], a[220:223], v[104:107]
    v_mfma_f32_16x16x32_bf16 v[108:111], v[216:219], a[216:219], v[108:111]
    ds_read_b128 a[240:243], v236 offset:36864
    v_mfma_f32_16x16x32_bf16 v[108:111], v[220:223], a[220:223], v[108:111]
    s_waitcnt lgkmcnt(0)
    v_mfma_f32_16x16x32_bf16 v[16:19], v[192:195], a[192:195], v[16:19]
    ds_read_b64_tr_b16 v[208:209], v238 offset:33536
    v_mfma_f32_16x16x32_bf16 v[16:19], v[196:199], a[196:199], v[16:19]
    ds_read_b128 a[244:247], v237 offset:36864
    ds_read_b64_tr_b16 v[210:211], v238 offset:34560
    v_mfma_f32_16x16x32_bf16 v[20:23], v[200:203], a[192:195], v[20:23]
    buffer_load_dwordx4 v245, s[24:27], s64 offen offset:3072 lds
    v_mfma_f32_16x16x32_bf16 v[20:23], v[204:207], a[196:199], v[20:23]
    ds_read_b64_tr_b16 v[212:213], v238 offset:41728
    v_mfma_f32_16x16x32_bf16 v[48:51], v[192:195], a[200:203], v[48:51]
    ds_read_b128 a[248:251], v236 offset:38912
    ds_read_b64_tr_b16 v[214:215], v238 offset:42752
    v_mfma_f32_16x16x32_bf16 v[48:51], v[196:199], a[204:207], v[48:51]
    v_mfma_f32_16x16x32_bf16 v[52:55], v[200:203], a[200:203], v[52:55]
    ds_read_b64_tr_b16 v[216:217], v239 offset:33536
    v_mfma_f32_16x16x32_bf16 v[52:55], v[204:207], a[204:207], v[52:55]
    ds_read_b128 a[252:255], v237 offset:38912
    ds_read_b64_tr_b16 v[218:219], v239 offset:34560
    v_mfma_f32_16x16x32_bf16 v[80:83], v[192:195], a[208:211], v[80:83]
    v_mfma_f32_16x16x32_bf16 v[80:83], v[196:199], a[212:215], v[80:83]
    ds_read_b64_tr_b16 v[220:221], v239 offset:41728
    v_mfma_f32_16x16x32_bf16 v[84:87], v[200:203], a[208:211], v[84:87]
    ds_read_b64_tr_b16 v[222:223], v239 offset:42752
    v_mfma_f32_16x16x32_bf16 v[84:87], v[204:207], a[212:215], v[84:87]
    v_mfma_f32_16x16x32_bf16 v[112:115], v[192:195], a[216:219], v[112:115]
    v_mfma_f32_16x16x32_bf16 v[112:115], v[196:199], a[220:223], v[112:115]
    v_mfma_f32_16x16x32_bf16 v[116:119], v[200:203], a[216:219], v[116:119]
    v_mfma_f32_16x16x32_bf16 v[116:119], v[204:207], a[220:223], v[116:119]
    s_waitcnt vmcnt(10) lgkmcnt(0)
    s_barrier
    v_mfma_f32_16x16x32_bf16 v[24:27], v[208:211], a[192:195], v[24:27]
    ds_read_b64_tr_b16 v[192:193], v238 offset:49152
    v_mfma_f32_16x16x32_bf16 v[24:27], v[212:215], a[196:199], v[24:27]
    ds_read_b64_tr_b16 v[194:195], v238 offset:50176
    v_mfma_f32_16x16x32_bf16 v[28:31], v[216:219], a[192:195], v[28:31]
    v_mfma_f32_16x16x32_bf16 v[28:31], v[220:223], a[196:199], v[28:31]
    ds_read_b64_tr_b16 v[196:197], v238 offset:57344
    v_mfma_f32_16x16x32_bf16 v[56:59], v[208:211], a[200:203], v[56:59]
    ds_read_b64_tr_b16 v[198:199], v238 offset:58368
    v_mfma_f32_16x16x32_bf16 v[56:59], v[212:215], a[204:207], v[56:59]
    v_mfma_f32_16x16x32_bf16 v[60:63], v[216:219], a[200:203], v[60:63]
    ds_read_b64_tr_b16 v[200:201], v239 offset:49152
    v_mfma_f32_16x16x32_bf16 v[60:63], v[220:223], a[204:207], v[60:63]
    ds_read_b64_tr_b16 v[202:203], v239 offset:50176
    v_mfma_f32_16x16x32_bf16 v[88:91], v[208:211], a[208:211], v[88:91]
    v_mfma_f32_16x16x32_bf16 v[88:91], v[212:215], a[212:215], v[88:91]
    ds_read_b64_tr_b16 v[204:205], v239 offset:57344
    v_mfma_f32_16x16x32_bf16 v[92:95], v[216:219], a[208:211], v[92:95]
    ds_read_b64_tr_b16 v[206:207], v239 offset:58368
    v_mfma_f32_16x16x32_bf16 v[92:95], v[220:223], a[212:215], v[92:95]
    v_mfma_f32_16x16x32_bf16 v[120:123], v[208:211], a[216:219], v[120:123]
    v_mfma_f32_16x16x32_bf16 v[120:123], v[212:215], a[220:223], v[120:123]
    v_mfma_f32_16x16x32_bf16 v[124:127], v[216:219], a[216:219], v[124:127]
    v_mfma_f32_16x16x32_bf16 v[124:127], v[220:223], a[220:223], v[124:127]
    s_waitcnt lgkmcnt(0)
    v_mfma_f32_16x16x32_bf16 v[0:3], v[192:195], a[224:227], v[0:3]
    s_add_u32 m0, s68, 131072
    ds_read_b64_tr_b16 v[208:209], v238 offset:49408
    v_mfma_f32_16x16x32_bf16 v[0:3], v[196:199], a[228:231], v[0:3]
    ds_read_b64_tr_b16 v[210:211], v238 offset:50432
    v_mfma_f32_16x16x32_bf16 v[4:7], v[200:203], a[224:227], v[4:7]
    v_mfma_f32_16x16x32_bf16 v[4:7], v[204:207], a[228:231], v[4:7]
    ds_read_b64_tr_b16 v[212:213], v238 offset:57600
    v_mfma_f32_16x16x32_bf16 v[32:35], v[192:195], a[232:235], v[32:35]
    ds_read_b64_tr_b16 v[214:215], v238 offset:58624
    v_mfma_f32_16x16x32_bf16 v[32:35], v[196:199], a[236:239], v[32:35]
    v_mfma_f32_16x16x32_bf16 v[36:39], v[200:203], a[232:235], v[36:39]
    s_add_u32 s64, s87, 1048576
    ds_read_b64_tr_b16 v[216:217], v239 offset:49408
    v_mfma_f32_16x16x32_bf16 v[36:39], v[204:207], a[236:239], v[36:39]
    ds_read_b64_tr_b16 v[218:219], v239 offset:50432
    v_mfma_f32_16x16x32_bf16 v[64:67], v[192:195], a[240:243], v[64:67]
    v_mfma_f32_16x16x32_bf16 v[64:67], v[196:199], a[244:247], v[64:67]
    ds_read_b64_tr_b16 v[220:221], v239 offset:57600
    v_mfma_f32_16x16x32_bf16 v[68:71], v[200:203], a[240:243], v[68:71]
    ds_read_b64_tr_b16 v[222:223], v239 offset:58624
    v_mfma_f32_16x16x32_bf16 v[68:71], v[204:207], a[244:247], v[68:71]
    v_mfma_f32_16x16x32_bf16 v[96:99], v[192:195], a[248:251], v[96:99]
    v_mfma_f32_16x16x32_bf16 v[96:99], v[196:199], a[252:255], v[96:99]
    buffer_load_dwordx4 v242, s[24:27], s64 offen offset:0 lds
    v_mfma_f32_16x16x32_bf16 v[100:103], v[200:203], a[248:251], v[100:103]
    v_mfma_f32_16x16x32_bf16 v[100:103], v[204:207], a[252:255], v[100:103]
    s_waitcnt lgkmcnt(0)
    v_mfma_f32_16x16x32_bf16 v[8:11], v[208:211], a[224:227], v[8:11]
    ds_read_b64_tr_b16 v[192:193], v238 offset:49664
    v_mfma_f32_16x16x32_bf16 v[8:11], v[212:215], a[228:231], v[8:11]
    ds_read_b64_tr_b16 v[194:195], v238 offset:50688
    v_mfma_f32_16x16x32_bf16 v[12:15], v[216:219], a[224:227], v[12:15]
    v_mfma_f32_16x16x32_bf16 v[12:15], v[220:223], a[228:231], v[12:15]
    ds_read_b64_tr_b16 v[196:197], v238 offset:57856
    v_mfma_f32_16x16x32_bf16 v[40:43], v[208:211], a[232:235], v[40:43]
    buffer_load_dwordx4 v243, s[24:27], s64 offen offset:1024 lds
    v_mfma_f32_16x16x32_bf16 v[40:43], v[212:215], a[236:239], v[40:43]
    ds_read_b64_tr_b16 v[198:199], v238 offset:58880
    v_cvt_pk_bf16_f32 v0, v0, v1
    v_mfma_f32_16x16x32_bf16 v[44:47], v[216:219], a[232:235], v[44:47]
    ds_read_b64_tr_b16 v[200:201], v239 offset:49664
    v_cvt_pk_bf16_f32 v1, v2, v3
    v_mfma_f32_16x16x32_bf16 v[44:47], v[220:223], a[236:239], v[44:47]
    v_cvt_pk_bf16_f32 v2, v4, v5
    v_cvt_pk_bf16_f32 v3, v6, v7
    v_mfma_f32_16x16x32_bf16 v[72:75], v[208:211], a[240:243], v[72:75]
    ds_read_b64_tr_b16 v[202:203], v239 offset:50688
    v_cvt_pk_bf16_f32 v32, v32, v33
    v_mfma_f32_16x16x32_bf16 v[72:75], v[212:215], a[244:247], v[72:75]
    ds_read_b64_tr_b16 v[204:205], v239 offset:57856
    v_cvt_pk_bf16_f32 v33, v34, v35
    v_mfma_f32_16x16x32_bf16 v[76:79], v[216:219], a[240:243], v[76:79]
    ds_read_b64_tr_b16 v[206:207], v239 offset:58880
    v_cvt_pk_bf16_f32 v34, v36, v37
    v_mfma_f32_16x16x32_bf16 v[76:79], v[220:223], a[244:247], v[76:79]
    buffer_load_dwordx4 v244, s[24:27], s64 offen offset:2048 lds
    v_mfma_f32_16x16x32_bf16 v[104:107], v[208:211], a[248:251], v[104:107]
    v_cvt_pk_bf16_f32 v35, v38, v39
    v_cvt_pk_bf16_f32 v64, v64, v65
    v_mfma_f32_16x16x32_bf16 v[104:107], v[212:215], a[252:255], v[104:107]
    v_cvt_pk_bf16_f32 v65, v66, v67
    v_mfma_f32_16x16x32_bf16 v[108:111], v[216:219], a[248:251], v[108:111]
    v_min_u32 v252, 31, v254
    v_cvt_pk_bf16_f32 v66, v68, v69
    v_mfma_f32_16x16x32_bf16 v[108:111], v[220:223], a[252:255], v[108:111]
    s_waitcnt lgkmcnt(0)
    v_cvt_pk_bf16_f32 v67, v70, v71
    v_mfma_f32_16x16x32_bf16 v[16:19], v[192:195], a[224:227], v[16:19]
    ds_read_b64_tr_b16 v[208:209], v238 offset:49920
    v_lshlrev_b32 v252, 2, v252
    v_mfma_f32_16x16x32_bf16 v[16:19], v[196:199], a[228:231], v[16:19]
    v_cvt_pk_bf16_f32 v96, v96, v97
    v_cvt_pk_bf16_f32 v97, v98, v99
    v_mfma_f32_16x16x32_bf16 v[20:23], v[200:203], a[224:227], v[20:23]
    buffer_load_dwordx4 v245, s[24:27], s64 offen offset:3072 lds
    v_mfma_f32_16x16x32_bf16 v[20:23], v[204:207], a[228:231], v[20:23]
    ds_read_b64_tr_b16 v[210:211], v238 offset:50944
    v_cvt_pk_bf16_f32 v98, v100, v101
    v_mfma_f32_16x16x32_bf16 v[48:51], v[192:195], a[232:235], v[48:51]
    s_lshl_b32 s89, s71, 7
    s_add_u32 s89, s89, 20480
    v_add_u32 v252, s89, v252
    v_mfma_f32_16x16x32_bf16 v[48:51], v[196:199], a[236:239], v[48:51]
    ds_read_b64_tr_b16 v[212:213], v238 offset:58112
    v_cvt_pk_bf16_f32 v99, v102, v103
    v_mfma_f32_16x16x32_bf16 v[52:55], v[200:203], a[232:235], v[52:55]
    buffer_load_dword v253, v252, s[4:7], 0 offen sc1
    v_mfma_f32_16x16x32_bf16 v[52:55], v[204:207], a[236:239], v[52:55]
    ds_read_b64_tr_b16 v[214:215], v238 offset:59136
    v_cvt_pk_bf16_f32 v8, v8, v9
    v_mfma_f32_16x16x32_bf16 v[80:83], v[192:195], a[240:243], v[80:83]
    ds_read_b64_tr_b16 v[216:217], v239 offset:49920
    v_cvt_pk_bf16_f32 v9, v10, v11
    v_mfma_f32_16x16x32_bf16 v[80:83], v[196:199], a[244:247], v[80:83]
    v_cvt_pk_bf16_f32 v10, v12, v13
    v_cvt_pk_bf16_f32 v11, v14, v15
    v_mfma_f32_16x16x32_bf16 v[84:87], v[200:203], a[240:243], v[84:87]
    ds_read_b64_tr_b16 v[218:219], v239 offset:50944
    v_cvt_pk_bf16_f32 v40, v40, v41
    v_mfma_f32_16x16x32_bf16 v[84:87], v[204:207], a[244:247], v[84:87]
    ds_read_b64_tr_b16 v[220:221], v239 offset:58112
    v_cvt_pk_bf16_f32 v41, v42, v43
    v_mfma_f32_16x16x32_bf16 v[112:115], v[192:195], a[248:251], v[112:115]
    ds_read_b64_tr_b16 v[222:223], v239 offset:59136
    v_cvt_pk_bf16_f32 v42, v44, v45
    v_mfma_f32_16x16x32_bf16 v[112:115], v[196:199], a[252:255], v[112:115]
    v_cvt_pk_bf16_f32 v43, v46, v47
    v_cvt_pk_bf16_f32 v72, v72, v73
    v_mfma_f32_16x16x32_bf16 v[116:119], v[200:203], a[248:251], v[116:119]
    v_cvt_pk_bf16_f32 v73, v74, v75
    v_cvt_pk_bf16_f32 v74, v76, v77
    v_mfma_f32_16x16x32_bf16 v[116:119], v[204:207], a[252:255], v[116:119]
    s_waitcnt vmcnt(9) lgkmcnt(0)
    s_barrier
    v_mfma_f32_16x16x32_bf16 v[24:27], v[208:211], a[224:227], v[24:27]
    ds_read_b64_tr_b16 v[192:193], v240 offset:0
    v_cvt_pk_bf16_f32 v75, v78, v79
    v_mfma_f32_16x16x32_bf16 v[24:27], v[212:215], a[228:231], v[24:27]
    v_cvt_pk_bf16_f32 v104, v104, v105
    v_cvt_pk_bf16_f32 v105, v106, v107
    v_mfma_f32_16x16x32_bf16 v[28:31], v[216:219], a[224:227], v[28:31]
    ds_read_b64_tr_b16 v[194:195], v240 offset:512
    v_cvt_pk_bf16_f32 v106, v108, v109
    v_mfma_f32_16x16x32_bf16 v[28:31], v[220:223], a[228:231], v[28:31]
    ds_read_b64_tr_b16 v[196:197], v240 offset:4096
    v_cvt_pk_bf16_f32 v107, v110, v111
    v_mfma_f32_16x16x32_bf16 v[56:59], v[208:211], a[232:235], v[56:59]
    ds_read_b64_tr_b16 v[198:199], v240 offset:4608
    v_cvt_pk_bf16_f32 v16, v16, v17
    v_mfma_f32_16x16x32_bf16 v[56:59], v[212:215], a[236:239], v[56:59]
    v_cvt_pk_bf16_f32 v17, v18, v19
    v_mfma_f32_16x16x32_bf16 v[60:63], v[216:219], a[232:235], v[60:63]
    ds_read_b64_tr_b16 v[200:201], v240 offset:8192
    v_cvt_pk_bf16_f32 v18, v20, v21
    v_mfma_f32_16x16x32_bf16 v[60:63], v[220:223], a[236:239], v[60:63]
    ds_read_b64_tr_b16 v[202:203], v240 offset:8704
    v_cvt_pk_bf16_f32 v19, v22, v23
    v_mfma_f32_16x16x32_bf16 v[88:91], v[208:211], a[240:243], v[88:91]
    v_cvt_pk_bf16_f32 v48, v48, v49
    v_mfma_f32_16x16x32_bf16 v[88:91], v[212:215], a[244:247], v[88:91]
    ds_read_b64_tr_b16 v[204:205], v240 offset:12288
    v_cvt_pk_bf16_f32 v49, v50, v51
    v_mfma_f32_16x16x32_bf16 v[92:95], v[216:219], a[240:243], v[92:95]
    ds_read_b64_tr_b16 v[206:207], v240 offset:12800
    v_cvt_pk_bf16_f32 v50, v52, v53
    v_mfma_f32_16x16x32_bf16 v[92:95], v[220:223], a[244:247], v[92:95]
    v_cvt_pk_bf16_f32 v51, v54, v55
    v_mfma_f32_16x16x32_bf16 v[120:123], v[208:211], a[248:251], v[120:123]
    v_cvt_pk_bf16_f32 v80, v80, v81
    v_mfma_f32_16x16x32_bf16 v[120:123], v[212:215], a[252:255], v[120:123]
    v_cvt_pk_bf16_f32 v81, v82, v83
    v_mfma_f32_16x16x32_bf16 v[124:127], v[216:219], a[248:251], v[124:127]
    v_cvt_pk_bf16_f32 v82, v84, v85
    v_mfma_f32_16x16x32_bf16 v[124:127], v[220:223], a[252:255], v[124:127]
    s_waitcnt lgkmcnt(0)
    v_cvt_pk_bf16_f32 v83, v86, v87
    v_mfma_f32_16x16x32_bf16 v[128:131], a[0:3], v[192:195], 0
    s_add_u32 m0, s68, 147456
    ds_read_b64_tr_b16 v[208:209], v241 offset:0
    v_cvt_pk_bf16_f32 v112, v112, v113
    v_mfma_f32_16x16x32_bf16 v[128:131], a[4:7], v[196:199], v[128:131]
    ds_read_b64_tr_b16 v[210:211], v241 offset:512
    v_cvt_pk_bf16_f32 v113, v114, v115
    v_mfma_f32_16x16x32_bf16 v[128:131], a[32:35], v[200:203], v[128:131]
    v_cvt_pk_bf16_f32 v114, v116, v117
    v_mfma_f32_16x16x32_bf16 v[128:131], a[36:39], v[204:207], v[128:131]
    ds_read_b64_tr_b16 v[212:213], v241 offset:4096
    v_cvt_pk_bf16_f32 v115, v118, v119
    v_mfma_f32_16x16x32_bf16 v[132:135], a[8:11], v[192:195], 0
    ds_read_b64_tr_b16 v[214:215], v241 offset:4608
    v_cvt_pk_bf16_f32 v24, v24, v25
    v_mfma_f32_16x16x32_bf16 v[132:135], a[12:15], v[196:199], v[132:135]
    v_cvt_pk_bf16_f32 v25, v26, v27
    v_mfma_f32_16x16x32_bf16 v[132:135], a[40:43], v[200:203], v[132:135]
    s_add_u32 s64, s87, 1048704
    ds_read_b64_tr_b16 v[216:217], v241 offset:8192
    v_cvt_pk_bf16_f32 v26, v28, v29
    v_mfma_f32_16x16x32_bf16 v[132:135], a[44:47], v[204:207], v[132:135]
    ds_read_b64_tr_b16 v[218:219], v241 offset:8704
    v_cvt_pk_bf16_f32 v27, v30, v31
    v_mfma_f32_16x16x32_bf16 v[160:163], a[16:19], v[192:195], 0
    v_cvt_pk_bf16_f32 v56, v56, v57
    v_mfma_f32_16x16x32_bf16 v[160:163], a[20:23], v[196:199], v[160:163]
    ds_read_b64_tr_b16 v[220:221], v241 offset:12288
    v_cvt_pk_bf16_f32 v57, v58, v59
    v_mfma_f32_16x16x32_bf16 v[160:163], a[48:51], v[200:203], v[160:163]
    ds_read_b64_tr_b16 v[222:223], v241 offset:12800
    v_cvt_pk_bf16_f32 v58, v60, v61
    v_mfma_f32_16x16x32_bf16 v[160:163], a[52:55], v[204:207], v[160:163]
    v_cvt_pk_bf16_f32 v59, v62, v63
    v_mfma_f32_16x16x32_bf16 v[164:167], a[24:27], v[192:195], 0
    v_cvt_pk_bf16_f32 v88, v88, v89
    v_mfma_f32_16x16x32_bf16 v[164:167], a[28:31], v[196:199], v[164:167]
    v_cvt_pk_bf16_f32 v89, v90, v91
    v_mfma_f32_16x16x32_bf16 v[164:167], a[56:59], v[200:203], v[164:167]
    buffer_load_dwordx4 v242, s[24:27], s64 offen offset:0 lds
    v_mfma_f32_16x16x32_bf16 v[164:167], a[60:63], v[204:207], v[164:167]
    s_waitcnt lgkmcnt(0)
    v_cvt_pk_bf16_f32 v90, v92, v93
    v_cvt_pk_bf16_f32 v91, v94, v95
    v_mfma_f32_16x16x32_bf16 v[136:139], a[0:3], v[208:211], 0
    ds_read_b64_tr_b16 v[192:193], v240 offset:256
    v_cvt_pk_bf16_f32 v120, v120, v121
    v_mfma_f32_16x16x32_bf16 v[136:139], a[4:7], v[212:215], v[136:139]
    ds_read_b64_tr_b16 v[194:195], v240 offset:768
    v_cvt_pk_bf16_f32 v121, v122, v123
    v_mfma_f32_16x16x32_bf16 v[136:139], a[32:35], v[216:219], v[136:139]
    v_cvt_pk_bf16_f32 v122, v124, v125
    v_mfma_f32_16x16x32_bf16 v[136:139], a[36:39], v[220:223], v[136:139]
    ds_read_b64_tr_b16 v[196:197], v240 offset:4352
    v_cvt_pk_bf16_f32 v123, v126, v127
    v_mfma_f32_16x16x32_bf16 v[140:143], a[8:11], v[208:211], 0
    buffer_load_dwordx4 v243, s[24:27], s64 offen offset:1024 lds
    v_mfma_f32_16x16x32_bf16 v[140:143], a[12:15], v[212:215], v[140:143]
    ds_read_b64_tr_b16 v[198:199], v240 offset:4864
    v_lshrrev_b32 v224, 5, v254
    v_mfma_f32_16x16x32_bf16 v[140:143], a[40:43], v[216:219], v[140:143]
    ds_read_b64_tr_b16 v[200:201], v240 offset:8448
    v_mfma_f32_16x16x32_bf16 v[140:143], a[44:47], v[220:223], v[140:143]
    s_add_u32 s60, s88, 0
    ds_read_b64_tr_b16 v[202:203], v240 offset:8960
    v_mfma_f32_16x16x32_bf16 v[168:171], a[16:19], v[208:211], 0
    buffer_store_dwordx4 v[0:3], v255, s[4:7], s60 offen offset:0 sc1
    v_mfma_f32_16x16x32_bf16 v[168:171], a[20:23], v[212:215], v[168:171]
    ds_read_b64_tr_b16 v[204:205], v240 offset:12544
    v_mfma_f32_16x16x32_bf16 v[168:171], a[48:51], v[216:219], v[168:171]
    ds_read_b64_tr_b16 v[206:207], v240 offset:13056
    v_mfma_f32_16x16x32_bf16 v[168:171], a[52:55], v[220:223], v[168:171]
    buffer_load_dwordx4 v244, s[24:27], s64 offen offset:2048 lds
    v_mfma_f32_16x16x32_bf16 v[172:175], a[24:27], v[208:211], 0
    v_bfe_u32 v225, v254, 2, 2
    v_mfma_f32_16x16x32_bf16 v[172:175], a[28:31], v[212:215], v[172:175]
    v_mfma_f32_16x16x32_bf16 v[172:175], a[56:59], v[216:219], v[172:175]
    v_mfma_f32_16x16x32_bf16 v[172:175], a[60:63], v[220:223], v[172:175]
    s_waitcnt lgkmcnt(0)
    v_mfma_f32_16x16x32_bf16 v[144:147], a[0:3], v[192:195], 0
    ds_read_b64_tr_b16 v[208:209], v241 offset:256
    v_mfma_f32_16x16x32_bf16 v[144:147], a[4:7], v[196:199], v[144:147]
    buffer_load_dwordx4 v245, s[24:27], s64 offen offset:3072 lds
    v_mfma_f32_16x16x32_bf16 v[144:147], a[32:35], v[200:203], v[144:147]
    ds_read_b64_tr_b16 v[210:211], v241 offset:768
    v_lshl_add_u32 v224, v224, 2, v225
    v_mfma_f32_16x16x32_bf16 v[144:147], a[36:39], v[204:207], v[144:147]
    ds_read_b64_tr_b16 v[212:213], v241 offset:4352
    v_mfma_f32_16x16x32_bf16 v[148:151], a[8:11], v[192:195], 0
    ds_read_b64_tr_b16 v[214:215], v241 offset:4864
    v_mfma_f32_16x16x32_bf16 v[148:151], a[12:15], v[196:199], v[148:151]
    v_mfma_f32_16x16x32_bf16 v[148:151], a[40:43], v[200:203], v[148:151]
    ds_read_b64_tr_b16 v[216:217], v241 offset:8448
    v_mfma_f32_16x16x32_bf16 v[148:151], a[44:47], v[204:207], v[148:151]
    ds_read_b64_tr_b16 v[218:219], v241 offset:8960
    v_mfma_f32_16x16x32_bf16 v[176:179], a[16:19], v[192:195], 0
    v_mfma_f32_16x16x32_bf16 v[176:179], a[20:23], v[196:199], v[176:179]
    ds_read_b64_tr_b16 v[220:221], v241 offset:12544
    v_mul_u32_u24 v224, 3584, v224
    v_mfma_f32_16x16x32_bf16 v[176:179], a[48:51], v[200:203], v[176:179]
    ds_read_b64_tr_b16 v[222:223], v241 offset:13056
    v_mfma_f32_16x16x32_bf16 v[176:179], a[52:55], v[204:207], v[176:179]
    v_mfma_f32_16x16x32_bf16 v[180:183], a[24:27], v[192:195], 0
    v_mfma_f32_16x16x32_bf16 v[180:183], a[28:31], v[196:199], v[180:183]
    v_mfma_f32_16x16x32_bf16 v[180:183], a[56:59], v[200:203], v[180:183]
    v_mfma_f32_16x16x32_bf16 v[180:183], a[60:63], v[204:207], v[180:183]
    s_waitcnt vmcnt(10) lgkmcnt(0)
    s_barrier
    v_mfma_f32_16x16x32_bf16 v[152:155], a[0:3], v[208:211], 0
    ds_read_b64_tr_b16 v[192:193], v240 offset:16384
    v_bfe_u32 v225, v254, 4, 1
    v_mfma_f32_16x16x32_bf16 v[152:155], a[4:7], v[212:215], v[152:155]
    ds_read_b64_tr_b16 v[194:195], v240 offset:16896
    v_mfma_f32_16x16x32_bf16 v[152:155], a[32:35], v[216:219], v[152:155]
    v_mfma_f32_16x16x32_bf16 v[152:155], a[36:39], v[220:223], v[152:155]
    ds_read_b64_tr_b16 v[196:197], v240 offset:20480
    v_mfma_f32_16x16x32_bf16 v[156:159], a[8:11], v[208:211], 0
    ds_read_b64_tr_b16 v[198:199], v240 offset:20992
    v_mfma_f32_16x16x32_bf16 v[156:159], a[12:15], v[212:215], v[156:159]
    buffer_store_dwordx4 v[8:11], v255, s[4:7], s60 offen offset:1024 sc1
    v_mfma_f32_16x16x32_bf16 v[156:159], a[40:43], v[216:219], v[156:159]
    ds_read_b64_tr_b16 v[200:201], v240 offset:24576
    v_mfma_f32_16x16x32_bf16 v[156:159], a[44:47], v[220:223], v[156:159]
    s_waitcnt vmcnt(6)
    v_cmp_gt_u32 vcc, 1, v253
    s_nop 0
    s_cbranch_vccnz L_spin_105
L_spinret_106:
    v_mfma_f32_16x16x32_bf16 v[184:187], a[16:19], v[208:211], 0
    ds_read_b64_tr_b16 v[202:203], v240 offset:25088
    v_lshl_add_u32 v224, v225, 6, v224
    v_mfma_f32_16x16x32_bf16 v[184:187], a[20:23], v[212:215], v[184:187]
    ds_read_b64_tr_b16 v[204:205], v240 offset:28672
    v_mfma_f32_16x16x32_bf16 v[184:187], a[48:51], v[216:219], v[184:187]
    ds_read_b64_tr_b16 v[206:207], v240 offset:29184
    v_mfma_f32_16x16x32_bf16 v[184:187], a[52:55], v[220:223], v[184:187]
    v_mfma_f32_16x16x32_bf16 v[188:191], a[24:27], v[208:211], 0
    v_mfma_f32_16x16x32_bf16 v[188:191], a[28:31], v[212:215], v[188:191]
    v_mfma_f32_16x16x32_bf16 v[188:191], a[56:59], v[216:219], v[188:191]
    v_and_b32 v225, 3, v254
    v_mfma_f32_16x16x32_bf16 v[188:191], a[60:63], v[220:223], v[188:191]
    s_waitcnt lgkmcnt(0)
    v_mfma_f32_16x16x32_bf16 v[4:7], a[0:3], v[192:195], 0
    s_add_u32 m0, s86, 0
    ds_read_b64_tr_b16 v[208:209], v241 offset:16384
    v_mfma_f32_16x16x32_bf16 v[4:7], a[4:7], v[196:199], v[4:7]
    ds_read_b64_tr_b16 v[210:211], v241 offset:16896
    v_mfma_f32_16x16x32_bf16 v[4:7], a[32:35], v[200:203], v[4:7]
    s_add_u32 s64, s84, 0
    v_mfma_f32_16x16x32_bf16 v[4:7], a[36:39], v[204:207], v[4:7]
    ds_read_b64_tr_b16 v[212:213], v241 offset:20480
    v_mfma_f32_16x16x32_bf16 v[12:15], a[8:11], v[192:195], 0
    ds_read_b64_tr_b16 v[214:215], v241 offset:20992
    v_mfma_f32_16x16x32_bf16 v[12:15], a[12:15], v[196:199], v[12:15]
    buffer_load_dwordx4 v232, s[4:7], s64 offen offset:0 sc1 lds
    v_mfma_f32_16x16x32_bf16 v[12:15], a[40:43], v[200:203], v[12:15]
    ds_read_b64_tr_b16 v[216:217], v241 offset:24576
    v_lshl_add_u32 v228, v225, 4, v224
    v_mfma_f32_16x16x32_bf16 v[12:15], a[44:47], v[204:207], v[12:15]
    ds_read_b64_tr_b16 v[218:219], v241 offset:25088
    v_mfma_f32_16x16x32_bf16 v[68:71], a[16:19], v[192:195], 0
    buffer_load_dwordx4 v233, s[4:7], s64 offen offset:1024 sc1 lds
    v_mfma_f32_16x16x32_bf16 v[68:71], a[20:23], v[196:199], v[68:71]
    ds_read_b64_tr_b16 v[220:221], v241 offset:28672
    v_mfma_f32_16x16x32_bf16 v[68:71], a[48:51], v[200:203], v[68:71]
    buffer_load_dwordx4 v234, s[4:7], s64 offen offset:2048 sc1 lds
    v_mfma_f32_16x16x32_bf16 v[68:71], a[52:55], v[204:207], v[68:71]
    ds_read_b64_tr_b16 v[222:223], v241 offset:29184
    v_mfma_f32_16x16x32_bf16 v[76:79], a[24:27], v[192:195], 0
    v_xor_b32 v225, 32, v228
    v_mfma_f32_16x16x32_bf16 v[76:79], a[28:31], v[196:199], v[76:79]
    buffer_load_dwordx4 v235, s[4:7], s64 offen offset:3072 sc1 lds
    v_mfma_f32_16x16x32_bf16 v[76:79], a[56:59], v[200:203], v[76:79]
    v_mfma_f32_16x16x32_bf16 v[76:79], a[60:63], v[204:207], v[76:79]
    s_waitcnt lgkmcnt(0)
    s_add_u32 m0, s86, 4096
    v_mfma_f32_16x16x32_bf16 v[20:23], a[0:3], v[208:211], 0
    ds_read_b64_tr_b16 v[192:193], v240 offset:16640
    v_mfma_f32_16x16x32_bf16 v[20:23], a[4:7], v[212:215], v[20:23]
    s_add_u32 s64, s84, 32768
    ds_read_b64_tr_b16 v[194:195], v240 offset:17152
    v_mfma_f32_16x16x32_bf16 v[20:23], a[32:35], v[216:219], v[20:23]
    buffer_store_dwordx4 v[16:19], v255, s[4:7], s60 offen offset:2048 sc1
    v_mfma_f32_16x16x32_bf16 v[20:23], a[36:39], v[220:223], v[20:23]
    ds_read_b64_tr_b16 v[196:197], v240 offset:20736
    v_add_u32 v229, 27648, v225
    v_mfma_f32_16x16x32_bf16 v[28:31], a[8:11], v[208:211], 0
    buffer_load_dwordx4 v232, s[4:7], s64 offen offset:0 sc1 lds
    v_mfma_f32_16x16x32_bf16 v[28:31], a[12:15], v[212:215], v[28:31]
    ds_read_b64_tr_b16 v[198:199], v240 offset:21248
    v_mfma_f32_16x16x32_bf16 v[28:31], a[40:43], v[216:219], v[28:31]
    ds_read_b64_tr_b16 v[200:201], v240 offset:24832
    v_mfma_f32_16x16x32_bf16 v[28:31], a[44:47], v[220:223], v[28:31]
    buffer_load_dwordx4 v233, s[4:7], s64 offen offset:1024 sc1 lds
    v_mfma_f32_16x16x32_bf16 v[84:87], a[16:19], v[208:211], 0
    ds_read_b64_tr_b16 v[202:203], v240 offset:25344
    v_mfma_f32_16x16x32_bf16 v[84:87], a[20:23], v[212:215], v[84:87]
    ds_read_b64_tr_b16 v[204:205], v240 offset:28928
    v_mfma_f32_16x16x32_bf16 v[84:87], a[48:51], v[216:219], v[84:87]
    buffer_load_dwordx4 v234, s[4:7], s64 offen offset:2048 sc1 lds
    v_mfma_f32_16x16x32_bf16 v[84:87], a[52:55], v[220:223], v[84:87]
    ds_read_b64_tr_b16 v[206:207], v240 offset:29440
    v_add_u32 v230, 55296, v228
    v_mfma_f32_16x16x32_bf16 v[92:95], a[24:27], v[208:211], 0
    buffer_load_dwordx4 v235, s[4:7], s64 offen offset:3072 sc1 lds
    v_mfma_f32_16x16x32_bf16 v[92:95], a[28:31], v[212:215], v[92:95]
    v_mfma_f32_16x16x32_bf16 v[92:95], a[56:59], v[216:219], v[92:95]
    v_mfma_f32_16x16x32_bf16 v[92:95], a[60:63], v[220:223], v[92:95]
    s_waitcnt lgkmcnt(0)
    v_mfma_f32_16x16x32_bf16 v[36:39], a[0:3], v[192:195], 0
    s_add_u32 m0, s68, 98304
    ds_read_b64_tr_b16 v[208:209], v241 offset:16640
    v_mfma_f32_16x16x32_bf16 v[36:39], a[4:7], v[196:199], v[36:39]
    ds_read_b64_tr_b16 v[210:211], v241 offset:17152
    v_add_u32 v231, 82944, v225
    v_mfma_f32_16x16x32_bf16 v[36:39], a[32:35], v[200:203], v[36:39]
    v_mfma_f32_16x16x32_bf16 v[36:39], a[36:39], v[204:207], v[36:39]
    ds_read_b64_tr_b16 v[212:213], v241 offset:20736
    v_mfma_f32_16x16x32_bf16 v[44:47], a[8:11], v[192:195], 0
    ds_read_b64_tr_b16 v[214:215], v241 offset:21248
    v_mfma_f32_16x16x32_bf16 v[44:47], a[12:15], v[196:199], v[44:47]
    s_add_u32 s64, s87, 2097152
    v_mfma_f32_16x16x32_bf16 v[44:47], a[40:43], v[200:203], v[44:47]
    ds_read_b64_tr_b16 v[216:217], v241 offset:24832
    v_mfma_f32_16x16x32_bf16 v[44:47], a[44:47], v[204:207], v[44:47]
    ds_read_b64_tr_b16 v[218:219], v241 offset:25344
    v_mfma_f32_16x16x32_bf16 v[100:103], a[16:19], v[192:195], 0
    v_mfma_f32_16x16x32_bf16 v[100:103], a[20:23], v[196:199], v[100:103]
    ds_read_b64_tr_b16 v[220:221], v241 offset:28928
    v_mfma_f32_16x16x32_bf16 v[100:103], a[48:51], v[200:203], v[100:103]
    buffer_load_dwordx4 v242, s[24:27], s64 offen offset:0 lds
    v_mfma_f32_16x16x32_bf16 v[100:103], a[52:55], v[204:207], v[100:103]
    ds_read_b64_tr_b16 v[222:223], v241 offset:29440
    v_mfma_f32_16x16x32_bf16 v[108:111], a[24:27], v[192:195], 0
    v_mfma_f32_16x16x32_bf16 v[108:111], a[28:31], v[196:199], v[108:111]
    v_mfma_f32_16x16x32_bf16 v[108:111], a[56:59], v[200:203], v[108:111]
    v_mfma_f32_16x16x32_bf16 v[108:111], a[60:63], v[204:207], v[108:111]
    s_waitcnt lgkmcnt(0)
    s_barrier
    v_mfma_f32_16x16x32_bf16 v[52:55], a[0:3], v[208:211], 0
    buffer_store_dwordx4 v[24:27], v255, s[4:7], s60 offen offset:3072 sc1
    v_mfma_f32_16x16x32_bf16 v[52:55], a[4:7], v[212:215], v[52:55]
    buffer_load_dwordx4 v243, s[24:27], s64 offen offset:1024 lds
    v_mfma_f32_16x16x32_bf16 v[52:55], a[32:35], v[216:219], v[52:55]
    ds_read_b64_tr_b16 v[192:193], v240 offset:32768
    ds_read_b64_tr_b16 v[194:195], v240 offset:33280
    v_mfma_f32_16x16x32_bf16 v[52:55], a[36:39], v[220:223], v[52:55]
    ds_read_b64_tr_b16 v[196:197], v240 offset:36864
    v_mfma_f32_16x16x32_bf16 v[60:63], a[8:11], v[208:211], 0
    ds_read_b64_tr_b16 v[198:199], v240 offset:37376
    v_mfma_f32_16x16x32_bf16 v[60:63], a[12:15], v[212:215], v[60:63]
    buffer_load_dwordx4 v244, s[24:27], s64 offen offset:2048 lds
    v_mfma_f32_16x16x32_bf16 v[60:63], a[40:43], v[216:219], v[60:63]
    ds_read_b64_tr_b16 v[200:201], v240 offset:40960
    v_mfma_f32_16x16x32_bf16 v[60:63], a[44:47], v[220:223], v[60:63]
    ds_read_b64_tr_b16 v[202:203], v240 offset:41472
    v_mfma_f32_16x16x32_bf16 v[116:119], a[16:19], v[208:211], 0
    v_mfma_f32_16x16x32_bf16 v[116:119], a[20:23], v[212:215], v[116:119]
    ds_read_b64_tr_b16 v[204:205], v240 offset:45056
    v_mfma_f32_16x16x32_bf16 v[116:119], a[48:51], v[216:219], v[116:119]
    buffer_load_dwordx4 v245, s[24:27], s64 offen offset:3072 lds
    v_mfma_f32_16x16x32_bf16 v[116:119], a[52:55], v[220:223], v[116:119]
    ds_read_b64_tr_b16 v[206:207], v240 offset:45568
    v_mfma_f32_16x16x32_bf16 v[124:127], a[24:27], v[208:211], 0
    v_mfma_f32_16x16x32_bf16 v[124:127], a[28:31], v[212:215], v[124:127]
    v_mfma_f32_16x16x32_bf16 v[124:127], a[56:59], v[216:219], v[124:127]
    v_mfma_f32_16x16x32_bf16 v[124:127], a[60:63], v[220:223], v[124:127]
    s_waitcnt lgkmcnt(0)
    v_mfma_f32_16x16x32_bf16 v[128:131], a[64:67], v[192:195], v[128:131]
    s_add_u32 m0, s86, 32768
    ds_read_b64_tr_b16 v[208:209], v241 offset:32768
    v_mfma_f32_16x16x32_bf16 v[128:131], a[68:71], v[196:199], v[128:131]
    ds_read_b64_tr_b16 v[210:211], v241 offset:33280
    v_mfma_f32_16x16x32_bf16 v[128:131], a[96:99], v[200:203], v[128:131]
    s_add_u32 s64, s84, 128
    v_mfma_f32_16x16x32_bf16 v[128:131], a[100:103], v[204:207], v[128:131]
    ds_read_b64_tr_b16 v[212:213], v241 offset:36864
    v_mfma_f32_16x16x32_bf16 v[132:135], a[72:75], v[192:195], v[132:135]
    ds_read_b64_tr_b16 v[214:215], v241 offset:37376
    v_mfma_f32_16x16x32_bf16 v[132:135], a[76:79], v[196:199], v[132:135]
    buffer_load_dwordx4 v232, s[4:7], s64 offen offset:0 sc1 lds
    v_mfma_f32_16x16x32_bf16 v[132:135], a[104:107], v[200:203], v[132:135]
    ds_read_b64_tr_b16 v[216:217], v241 offset:40960
    v_mfma_f32_16x16x32_bf16 v[132:135], a[108:111], v[204:207], v[132:135]
    ds_read_b64_tr_b16 v[218:219], v241 offset:41472
    v_mfma_f32_16x16x32_bf16 v[160:163], a[80:83], v[192:195], v[160:163]
    buffer_load_dwordx4 v233, s[4:7], s64 offen offset:1024 sc1 lds
    v_mfma_f32_16x16x32_bf16 v[160:163], a[84:87], v[196:199], v[160:163]
    ds_read_b64_tr_b16 v[220:221], v241 offset:45056
    v_mfma_f32_16x16x32_bf16 v[160:163], a[112:115], v[200:203], v[160:163]
    buffer_load_dwordx4 v234, s[4:7], s64 offen offset:2048 sc1 lds
    v_mfma_f32_16x16x32_bf16 v[160:163], a[116:119], v[204:207], v[160:163]
    s_add_u32 s60, s88, 4096
    ds_read_b64_tr_b16 v[222:223], v241 offset:45568
    v_mfma_f32_16x16x32_bf16 v[164:167], a[88:91], v[192:195], v[164:167]
    buffer_store_dwordx4 v[32:35], v255, s[4:7], s60 offen offset:0 sc1
    v_mfma_f32_16x16x32_bf16 v[164:167], a[92:95], v[196:199], v[164:167]
    buffer_load_dwordx4 v235, s[4:7], s64 offen offset:3072 sc1 lds
    v_mfma_f32_16x16x32_bf16 v[164:167], a[120:123], v[200:203], v[164:167]
    v_mfma_f32_16x16x32_bf16 v[164:167], a[124:127], v[204:207], v[164:167]
    s_waitcnt lgkmcnt(0)
    s_add_u32 m0, s86, 36864
    v_mfma_f32_16x16x32_bf16 v[136:139], a[64:67], v[208:211], v[136:139]
    ds_read_b64_tr_b16 v[192:193], v240 offset:33024
    v_mfma_f32_16x16x32_bf16 v[136:139], a[68:71], v[212:215], v[136:139]
    s_add_u32 s64, s84, 32896
    ds_read_b64_tr_b16 v[194:195], v240 offset:33536
    v_mfma_f32_16x16x32_bf16 v[136:139], a[96:99], v[216:219], v[136:139]
    v_mfma_f32_16x16x32_bf16 v[136:139], a[100:103], v[220:223], v[136:139]
    ds_read_b64_tr_b16 v[196:197], v240 offset:37120
    v_mfma_f32_16x16x32_bf16 v[140:143], a[72:75], v[208:211], v[140:143]
    buffer_load_dwordx4 v232, s[4:7], s64 offen offset:0 sc1 lds
    v_mfma_f32_16x16x32_bf16 v[140:143], a[76:79], v[212:215], v[140:143]
    ds_read_b64_tr_b16 v[198:199], v240 offset:37632
    v_mfma_f32_16x16x32_bf16 v[140:143], a[104:107], v[216:219], v[140:143]
    ds_read_b64_tr_b16 v[200:201], v240 offset:41216
    v_mfma_f32_16x16x32_bf16 v[140:143], a[108:111], v[220:223], v[140:143]
    buffer_load_dwordx4 v233, s[4:7], s64 offen offset:1024 sc1 lds
    v_mfma_f32_16x16x32_bf16 v[168:171], a[80:83], v[208:211], v[168:171]
    ds_read_b64_tr_b16 v[202:203], v240 offset:41728
    v_mfma_f32_16x16x32_bf16 v[168:171], a[84:87], v[212:215], v[168:171]
    ds_read_b64_tr_b16 v[204:205], v240 offset:45312
    v_mfma_f32_16x16x32_bf16 v[168:171], a[112:115], v[216:219], v[168:171]
    buffer_load_dwordx4 v234, s[4:7], s64 offen offset:2048 sc1 lds
    v_mfma_f32_16x16x32_bf16 v[168:171], a[116:119], v[220:223], v[168:171]
    ds_read_b64_tr_b16 v[206:207], v240 offset:45824
    v_mfma_f32_16x16x32_bf16 v[172:175], a[88:91], v[208:211], v[172:175]
    buffer_load_dwordx4 v235, s[4:7], s64 offen offset:3072 sc1 lds
    v_mfma_f32_16x16x32_bf16 v[172:175], a[92:95], v[212:215], v[172:175]
    v_mfma_f32_16x16x32_bf16 v[172:175], a[120:123], v[216:219], v[172:175]
    v_mfma_f32_16x16x32_bf16 v[172:175], a[124:127], v[220:223], v[172:175]
    s_waitcnt lgkmcnt(0)
    v_mfma_f32_16x16x32_bf16 v[144:147], a[64:67], v[192:195], v[144:147]
    s_add_u32 m0, s68, 114688
    ds_read_b64_tr_b16 v[208:209], v241 offset:33024
    v_mfma_f32_16x16x32_bf16 v[144:147], a[68:71], v[196:199], v[144:147]
    ds_read_b64_tr_b16 v[210:211], v241 offset:33536
    v_mfma_f32_16x16x32_bf16 v[144:147], a[96:99], v[200:203], v[144:147]
    v_mfma_f32_16x16x32_bf16 v[144:147], a[100:103], v[204:207], v[144:147]
    ds_read_b64_tr_b16 v[212:213], v241 offset:37120
    v_mfma_f32_16x16x32_bf16 v[148:151], a[72:75], v[192:195], v[148:151]
    ds_read_b64_tr_b16 v[214:215], v241 offset:37632
    v_mfma_f32_16x16x32_bf16 v[148:151], a[76:79], v[196:199], v[148:151]
    s_add_u32 s64, s87, 2097280
    v_mfma_f32_16x16x32_bf16 v[148:151], a[104:107], v[200:203], v[148:151]
    ds_read_b64_tr_b16 v[216:217], v241 offset:41216
    v_mfma_f32_16x16x32_bf16 v[148:151], a[108:111], v[204:207], v[148:151]
    ds_read_b64_tr_b16 v[218:219], v241 offset:41728
    v_mfma_f32_16x16x32_bf16 v[176:179], a[80:83], v[192:195], v[176:179]
    v_mfma_f32_16x16x32_bf16 v[176:179], a[84:87], v[196:199], v[176:179]
    ds_read_b64_tr_b16 v[220:221], v241 offset:45312
    v_mfma_f32_16x16x32_bf16 v[176:179], a[112:115], v[200:203], v[176:179]
    buffer_store_dwordx4 v[40:43], v255, s[4:7], s60 offen offset:1024 sc1
    v_mfma_f32_16x16x32_bf16 v[176:179], a[116:119], v[204:207], v[176:179]
    buffer_load_dwordx4 v242, s[24:27], s64 offen offset:0 lds
    v_mfma_f32_16x16x32_bf16 v[180:183], a[88:91], v[192:195], v[180:183]
    ds_read_b64_tr_b16 v[222:223], v241 offset:45824
    v_mfma_f32_16x16x32_bf16 v[180:183], a[92:95], v[196:199], v[180:183]
    v_mfma_f32_16x16x32_bf16 v[180:183], a[120:123], v[200:203], v[180:183]
    v_mfma_f32_16x16x32_bf16 v[180:183], a[124:127], v[204:207], v[180:183]
    s_waitcnt vmcnt(26) lgkmcnt(0)
    s_barrier
    v_mfma_f32_16x16x32_bf16 v[152:155], a[64:67], v[208:211], v[152:155]
    buffer_load_dwordx4 v243, s[24:27], s64 offen offset:1024 lds
    v_mfma_f32_16x16x32_bf16 v[152:155], a[68:71], v[212:215], v[152:155]
    ds_read_b64_tr_b16 v[192:193], v240 offset:49152
    ds_read_b64_tr_b16 v[194:195], v240 offset:49664
    v_mfma_f32_16x16x32_bf16 v[152:155], a[96:99], v[216:219], v[152:155]
    v_mfma_f32_16x16x32_bf16 v[152:155], a[100:103], v[220:223], v[152:155]
    ds_read_b64_tr_b16 v[196:197], v240 offset:53248
    v_mfma_f32_16x16x32_bf16 v[156:159], a[72:75], v[208:211], v[156:159]
    ds_read_b64_tr_b16 v[198:199], v240 offset:53760
    v_mfma_f32_16x16x32_bf16 v[156:159], a[76:79], v[212:215], v[156:159]
    buffer_load_dwordx4 v244, s[24:27], s64 offen offset:2048 lds
    v_mfma_f32_16x16x32_bf16 v[156:159], a[104:107], v[216:219], v[156:159]
    ds_read_b64_tr_b16 v[200:201], v240 offset:57344
    v_mfma_f32_16x16x32_bf16 v[156:159], a[108:111], v[220:223], v[156:159]
    ds_read_b64_tr_b16 v[202:203], v240 offset:57856
    v_mfma_f32_16x16x32_bf16 v[184:187], a[80:83], v[208:211], v[184:187]
    v_mfma_f32_16x16x32_bf16 v[184:187], a[84:87], v[212:215], v[184:187]
    ds_read_b64_tr_b16 v[204:205], v240 offset:61440
    v_mfma_f32_16x16x32_bf16 v[184:187], a[112:115], v[216:219], v[184:187]
    buffer_load_dwordx4 v245, s[24:27], s64 offen offset:3072 lds
    v_mfma_f32_16x16x32_bf16 v[184:187], a[116:119], v[220:223], v[184:187]
    ds_read_b64_tr_b16 v[206:207], v240 offset:61952
    v_mfma_f32_16x16x32_bf16 v[188:191], a[88:91], v[208:211], v[188:191]
    v_mfma_f32_16x16x32_bf16 v[188:191], a[92:95], v[212:215], v[188:191]
    v_mfma_f32_16x16x32_bf16 v[188:191], a[120:123], v[216:219], v[188:191]
    v_mfma_f32_16x16x32_bf16 v[188:191], a[124:127], v[220:223], v[188:191]
    s_waitcnt lgkmcnt(0)
    v_mfma_f32_16x16x32_bf16 v[4:7], a[64:67], v[192:195], v[4:7]
    s_add_u32 m0, s68, 131072
    ds_read_b64_tr_b16 v[208:209], v241 offset:49152
    v_mfma_f32_16x16x32_bf16 v[4:7], a[68:71], v[196:199], v[4:7]
    ds_read_b64_tr_b16 v[210:211], v241 offset:49664
    v_mfma_f32_16x16x32_bf16 v[4:7], a[96:99], v[200:203], v[4:7]
    v_mfma_f32_16x16x32_bf16 v[4:7], a[100:103], v[204:207], v[4:7]
    ds_read_b64_tr_b16 v[212:213], v241 offset:53248
    v_mfma_f32_16x16x32_bf16 v[12:15], a[72:75], v[192:195], v[12:15]
    ds_read_b64_tr_b16 v[214:215], v241 offset:53760
    v_mfma_f32_16x16x32_bf16 v[12:15], a[76:79], v[196:199], v[12:15]
    v_mfma_f32_16x16x32_bf16 v[12:15], a[104:107], v[200:203], v[12:15]
    s_add_u32 s64, s87, 3145728
    ds_read_b64_tr_b16 v[216:217], v241 offset:57344
    v_mfma_f32_16x16x32_bf16 v[12:15], a[108:111], v[204:207], v[12:15]
    buffer_store_dwordx4 v[48:51], v255, s[4:7], s60 offen offset:2048 sc1
    v_mfma_f32_16x16x32_bf16 v[68:71], a[80:83], v[192:195], v[68:71]
    ds_read_b64_tr_b16 v[218:219], v241 offset:57856
    v_mfma_f32_16x16x32_bf16 v[68:71], a[84:87], v[196:199], v[68:71]
    ds_read_b64_tr_b16 v[220:221], v241 offset:61440
    v_mfma_f32_16x16x32_bf16 v[68:71], a[112:115], v[200:203], v[68:71]
    ds_read_b64_tr_b16 v[222:223], v241 offset:61952
    v_mfma_f32_16x16x32_bf16 v[68:71], a[116:119], v[204:207], v[68:71]
    v_mfma_f32_16x16x32_bf16 v[76:79], a[88:91], v[192:195], v[76:79]
    v_mfma_f32_16x16x32_bf16 v[76:79], a[92:95], v[196:199], v[76:79]
    buffer_load_dwordx4 v242, s[24:27], s64 offen offset:0 lds
    v_mfma_f32_16x16x32_bf16 v[76:79], a[120:123], v[200:203], v[76:79]
    v_mfma_f32_16x16x32_bf16 v[76:79], a[124:127], v[204:207], v[76:79]
    s_waitcnt lgkmcnt(0)
    v_mfma_f32_16x16x32_bf16 v[20:23], a[64:67], v[208:211], v[20:23]
    ds_read_b64_tr_b16 v[192:193], v240 offset:49408
    v_mfma_f32_16x16x32_bf16 v[20:23], a[68:71], v[212:215], v[20:23]
    s_waitcnt vmcnt(21)
    ds_read_b64_tr_b16 v[194:195], v240 offset:49920
    v_mfma_f32_16x16x32_bf16 v[20:23], a[96:99], v[216:219], v[20:23]
    ds_read_b128 a[0:3], v236 offset:0
    v_mfma_f32_16x16x32_bf16 v[20:23], a[100:103], v[220:223], v[20:23]
    ds_read_b64_tr_b16 v[196:197], v240 offset:53504
    v_mfma_f32_16x16x32_bf16 v[28:31], a[72:75], v[208:211], v[28:31]
    buffer_load_dwordx4 v243, s[24:27], s64 offen offset:1024 lds
    v_mfma_f32_16x16x32_bf16 v[28:31], a[76:79], v[212:215], v[28:31]
    ds_read_b64_tr_b16 v[198:199], v240 offset:54016
    ds_read_b128 a[4:7], v237 offset:0
    v_mfma_f32_16x16x32_bf16 v[28:31], a[104:107], v[216:219], v[28:31]
    ds_read_b64_tr_b16 v[200:201], v240 offset:57600
    v_mfma_f32_16x16x32_bf16 v[28:31], a[108:111], v[220:223], v[28:31]
    ds_read_b64_tr_b16 v[202:203], v240 offset:58112
    v_mfma_f32_16x16x32_bf16 v[84:87], a[80:83], v[208:211], v[84:87]
    ds_read_b128 a[8:11], v236 offset:2048
    v_mfma_f32_16x16x32_bf16 v[84:87], a[84:87], v[212:215], v[84:87]
    ds_read_b64_tr_b16 v[204:205], v240 offset:61696
    v_mfma_f32_16x16x32_bf16 v[84:87], a[112:115], v[216:219], v[84:87]
    ds_read_b64_tr_b16 v[206:207], v240 offset:62208
    v_mfma_f32_16x16x32_bf16 v[84:87], a[116:119], v[220:223], v[84:87]
    buffer_load_dwordx4 v244, s[24:27], s64 offen offset:2048 lds
    v_mfma_f32_16x16x32_bf16 v[92:95], a[88:91], v[208:211], v[92:95]
    ds_read_b128 a[12:15], v237 offset:2048
    v_mfma_f32_16x16x32_bf16 v[92:95], a[92:95], v[212:215], v[92:95]
    v_mfma_f32_16x16x32_bf16 v[92:95], a[120:123], v[216:219], v[92:95]
    ds_read_b128 a[16:19], v236 offset:4096
    v_mfma_f32_16x16x32_bf16 v[92:95], a[124:127], v[220:223], v[92:95]
    s_waitcnt lgkmcnt(0)
    v_mfma_f32_16x16x32_bf16 v[36:39], a[64:67], v[192:195], v[36:39]
    ds_read_b64_tr_b16 v[208:209], v241 offset:49408
    v_mfma_f32_16x16x32_bf16 v[36:39], a[68:71], v[196:199], v[36:39]
    ds_read_b128 a[20:23], v237 offset:4096
    ds_read_b64_tr_b16 v[210:211], v241 offset:49920
    v_mfma_f32_16x16x32_bf16 v[36:39], a[96:99], v[200:203], v[36:39]
    buffer_load_dwordx4 v245, s[24:27], s64 offen offset:3072 lds
    v_mfma_f32_16x16x32_bf16 v[36:39], a[100:103], v[204:207], v[36:39]
    ds_read_b64_tr_b16 v[212:213], v241 offset:53504
    v_mfma_f32_16x16x32_bf16 v[44:47], a[72:75], v[192:195], v[44:47]
    buffer_store_dwordx4 v[56:59], v255, s[4:7], s60 offen offset:3072 sc1
    v_mfma_f32_16x16x32_bf16 v[44:47], a[76:79], v[196:199], v[44:47]
    ds_read_b128 a[24:27], v236 offset:6144
    ds_read_b64_tr_b16 v[214:215], v241 offset:54016
    v_mfma_f32_16x16x32_bf16 v[44:47], a[104:107], v[200:203], v[44:47]
    ds_read_b64_tr_b16 v[216:217], v241 offset:57600
    v_mfma_f32_16x16x32_bf16 v[44:47], a[108:111], v[204:207], v[44:47]
    ds_read_b128 a[28:31], v237 offset:6144
    ds_read_b64_tr_b16 v[218:219], v241 offset:58112
    v_mfma_f32_16x16x32_bf16 v[100:103], a[80:83], v[192:195], v[100:103]
    v_mfma_f32_16x16x32_bf16 v[100:103], a[84:87], v[196:199], v[100:103]
    ds_read_b64_tr_b16 v[220:221], v241 offset:61696
    v_mfma_f32_16x16x32_bf16 v[100:103], a[112:115], v[200:203], v[100:103]
    ds_read_b64_tr_b16 v[222:223], v241 offset:62208
    v_mfma_f32_16x16x32_bf16 v[100:103], a[116:119], v[204:207], v[100:103]
    v_mfma_f32_16x16x32_bf16 v[108:111], a[88:91], v[192:195], v[108:111]
    v_mfma_f32_16x16x32_bf16 v[108:111], a[92:95], v[196:199], v[108:111]
    v_mfma_f32_16x16x32_bf16 v[108:111], a[120:123], v[200:203], v[108:111]
    v_mfma_f32_16x16x32_bf16 v[108:111], a[124:127], v[204:207], v[108:111]
    s_waitcnt vmcnt(20) lgkmcnt(0)
    s_barrier
    v_mfma_f32_16x16x32_bf16 v[52:55], a[64:67], v[208:211], v[52:55]
    ds_read_b64_tr_b16 v[192:193], v240 offset:0
    v_mfma_f32_16x16x32_bf16 v[52:55], a[68:71], v[212:215], v[52:55]
    ds_read_b64_tr_b16 v[194:195], v240 offset:512
    v_mfma_f32_16x16x32_bf16 v[52:55], a[96:99], v[216:219], v[52:55]
    v_mfma_f32_16x16x32_bf16 v[52:55], a[100:103], v[220:223], v[52:55]
    ds_read_b64_tr_b16 v[196:197], v240 offset:4096
    v_mfma_f32_16x16x32_bf16 v[60:63], a[72:75], v[208:211], v[60:63]
    ds_read_b64_tr_b16 v[198:199], v240 offset:4608
    v_mfma_f32_16x16x32_bf16 v[60:63], a[76:79], v[212:215], v[60:63]
    v_mfma_f32_16x16x32_bf16 v[60:63], a[104:107], v[216:219], v[60:63]
    ds_read_b64_tr_b16 v[200:201], v240 offset:8192
    v_mfma_f32_16x16x32_bf16 v[60:63], a[108:111], v[220:223], v[60:63]
    ds_read_b64_tr_b16 v[202:203], v240 offset:8704
    v_mfma_f32_16x16x32_bf16 v[116:119], a[80:83], v[208:211], v[116:119]
    v_mfma_f32_16x16x32_bf16 v[116:119], a[84:87], v[212:215], v[116:119]
    ds_read_b64_tr_b16 v[204:205], v240 offset:12288
    v_mfma_f32_16x16x32_bf16 v[116:119], a[112:115], v[216:219], v[116:119]
    ds_read_b64_tr_b16 v[206:207], v240 offset:12800
    v_mfma_f32_16x16x32_bf16 v[116:119], a[116:119], v[220:223], v[116:119]
    v_mfma_f32_16x16x32_bf16 v[124:127], a[88:91], v[208:211], v[124:127]
    v_mfma_f32_16x16x32_bf16 v[124:127], a[92:95], v[212:215], v[124:127]
    v_mfma_f32_16x16x32_bf16 v[124:127], a[120:123], v[216:219], v[124:127]
    v_mfma_f32_16x16x32_bf16 v[124:127], a[124:127], v[220:223], v[124:127]
    s_waitcnt lgkmcnt(0)
    s_add_u32 s60, s88, 16384
    v_mfma_f32_16x16x32_bf16 v[128:131], a[128:131], v[192:195], v[128:131]
    s_add_u32 m0, s86, 65536
    ds_read_b64_tr_b16 v[208:209], v241 offset:0
    v_mfma_f32_16x16x32_bf16 v[128:131], a[132:135], v[196:199], v[128:131]
    buffer_store_dwordx4 v[64:67], v255, s[4:7], s60 offen offset:0 sc1
    v_mfma_f32_16x16x32_bf16 v[128:131], a[160:163], v[200:203], v[128:131]
    s_add_u32 s64, s84, 256
    ds_read_b64_tr_b16 v[210:211], v241 offset:512
    v_mfma_f32_16x16x32_bf16 v[128:131], a[164:167], v[204:207], v[128:131]
    ds_read_b64_tr_b16 v[212:213], v241 offset:4096
    v_mfma_f32_16x16x32_bf16 v[132:135], a[136:139], v[192:195], v[132:135]
    ds_read_b64_tr_b16 v[214:215], v241 offset:4608
    v_mfma_f32_16x16x32_bf16 v[132:135], a[140:143], v[196:199], v[132:135]
    buffer_load_dwordx4 v232, s[4:7], s64 offen offset:0 sc1 lds
    v_mfma_f32_16x16x32_bf16 v[132:135], a[168:171], v[200:203], v[132:135]
    ds_read_b64_tr_b16 v[216:217], v241 offset:8192
    v_mfma_f32_16x16x32_bf16 v[132:135], a[172:175], v[204:207], v[132:135]
    ds_read_b64_tr_b16 v[218:219], v241 offset:8704
    v_mfma_f32_16x16x32_bf16 v[160:163], a[144:147], v[192:195], v[160:163]
    buffer_load_dwordx4 v233, s[4:7], s64 offen offset:1024 sc1 lds
    v_mfma_f32_16x16x32_bf16 v[160:163], a[148:151], v[196:199], v[160:163]
    ds_read_b64_tr_b16 v[220:221], v241 offset:12288
    v_mfma_f32_16x16x32_bf16 v[160:163], a[176:179], v[200:203], v[160:163]
    buffer_load_dwordx4 v234, s[4:7], s64 offen offset:2048 sc1 lds
    v_mfma_f32_16x16x32_bf16 v[160:163], a[180:183], v[204:207], v[160:163]
    ds_read_b64_tr_b16 v[222:223], v241 offset:12800
    v_mfma_f32_16x16x32_bf16 v[164:167], a[152:155], v[192:195], v[164:167]
    buffer_load_dwordx4 v235, s[4:7], s64 offen offset:3072 sc1 lds
    v_mfma_f32_16x16x32_bf16 v[164:167], a[156:159], v[196:199], v[164:167]
    v_mfma_f32_16x16x32_bf16 v[164:167], a[184:187], v[200:203], v[164:167]
    v_mfma_f32_16x16x32_bf16 v[164:167], a[188:191], v[204:207], v[164:167]
    s_waitcnt lgkmcnt(0)
    s_add_u32 m0, s86, 69632
    v_mfma_f32_16x16x32_bf16 v[136:139], a[128:131], v[208:211], v[136:139]
    ds_read_b64_tr_b16 v[192:193], v240 offset:256
    v_mfma_f32_16x16x32_bf16 v[136:139], a[132:135], v[212:215], v[136:139]
    s_waitcnt vmcnt(16)
    s_add_u32 s64, s84, 33024
    ds_read_b64_tr_b16 v[194:195], v240 offset:768
    v_mfma_f32_16x16x32_bf16 v[136:139], a[160:163], v[216:219], v[136:139]
    ds_read_b128 a[32:35], v236 offset:32768
    v_mfma_f32_16x16x32_bf16 v[136:139], a[164:167], v[220:223], v[136:139]
    ds_read_b64_tr_b16 v[196:197], v240 offset:4352
    v_mfma_f32_16x16x32_bf16 v[140:143], a[136:139], v[208:211], v[140:143]
    buffer_load_dwordx4 v232, s[4:7], s64 offen offset:0 sc1 lds
    v_mfma_f32_16x16x32_bf16 v[140:143], a[140:143], v[212:215], v[140:143]
    ds_read_b64_tr_b16 v[198:199], v240 offset:4864
    ds_read_b128 a[36:39], v237 offset:32768
    v_mfma_f32_16x16x32_bf16 v[140:143], a[168:171], v[216:219], v[140:143]
    ds_read_b64_tr_b16 v[200:201], v240 offset:8448
    v_mfma_f32_16x16x32_bf16 v[140:143], a[172:175], v[220:223], v[140:143]
    buffer_load_dwordx4 v233, s[4:7], s64 offen offset:1024 sc1 lds
    v_mfma_f32_16x16x32_bf16 v[168:171], a[144:147], v[208:211], v[168:171]
    ds_read_b64_tr_b16 v[202:203], v240 offset:8960
    ds_read_b128 a[40:43], v236 offset:34816
    v_mfma_f32_16x16x32_bf16 v[168:171], a[148:151], v[212:215], v[168:171]
    ds_read_b64_tr_b16 v[204:205], v240 offset:12544
    v_mfma_f32_16x16x32_bf16 v[168:171], a[176:179], v[216:219], v[168:171]
    buffer_load_dwordx4 v234, s[4:7], s64 offen offset:2048 sc1 lds
    v_mfma_f32_16x16x32_bf16 v[168:171], a[180:183], v[220:223], v[168:171]
    ds_read_b64_tr_b16 v[206:207], v240 offset:13056
    ds_read_b128 a[44:47], v237 offset:34816
    v_mfma_f32_16x16x32_bf16 v[172:175], a[152:155], v[208:211], v[172:175]
    buffer_load_dwordx4 v235, s[4:7], s64 offen offset:3072 sc1 lds
    v_mfma_f32_16x16x32_bf16 v[172:175], a[156:159], v[212:215], v[172:175]
    buffer_store_dwordx4 v[72:75], v255, s[4:7], s60 offen offset:1024 sc1
    v_mfma_f32_16x16x32_bf16 v[172:175], a[184:187], v[216:219], v[172:175]
    ds_read_b128 a[48:51], v236 offset:36864
    v_mfma_f32_16x16x32_bf16 v[172:175], a[188:191], v[220:223], v[172:175]
    s_waitcnt lgkmcnt(0)
    v_mfma_f32_16x16x32_bf16 v[144:147], a[128:131], v[192:195], v[144:147]
    s_add_u32 m0, s68, 147456
    ds_read_b64_tr_b16 v[208:209], v241 offset:256
    v_mfma_f32_16x16x32_bf16 v[144:147], a[132:135], v[196:199], v[144:147]
    ds_read_b128 a[52:55], v237 offset:36864
    ds_read_b64_tr_b16 v[210:211], v241 offset:768
    v_mfma_f32_16x16x32_bf16 v[144:147], a[160:163], v[200:203], v[144:147]
    v_mfma_f32_16x16x32_bf16 v[144:147], a[164:167], v[204:207], v[144:147]
    ds_read_b64_tr_b16 v[212:213], v241 offset:4352
    v_mfma_f32_16x16x32_bf16 v[148:151], a[136:139], v[192:195], v[148:151]
    ds_read_b128 a[56:59], v236 offset:38912
    ds_read_b64_tr_b16 v[214:215], v241 offset:4864
    v_mfma_f32_16x16x32_bf16 v[148:151], a[140:143], v[196:199], v[148:151]
    s_add_u32 s64, s87, 3145856
    v_mfma_f32_16x16x32_bf16 v[148:151], a[168:171], v[200:203], v[148:151]
    ds_read_b64_tr_b16 v[216:217], v241 offset:8448
    v_mfma_f32_16x16x32_bf16 v[148:151], a[172:175], v[204:207], v[148:151]
    ds_read_b128 a[60:63], v237 offset:38912
    ds_read_b64_tr_b16 v[218:219], v241 offset:8960
    v_mfma_f32_16x16x32_bf16 v[176:179], a[144:147], v[192:195], v[176:179]
    v_mfma_f32_16x16x32_bf16 v[176:179], a[148:151], v[196:199], v[176:179]
    ds_read_b64_tr_b16 v[220:221], v241 offset:12544
    v_mfma_f32_16x16x32_bf16 v[176:179], a[176:179], v[200:203], v[176:179]
    buffer_load_dwordx4 v242, s[24:27], s64 offen offset:0 lds
    v_mfma_f32_16x16x32_bf16 v[176:179], a[180:183], v[204:207], v[176:179]
    ds_read_b64_tr_b16 v[222:223], v241 offset:13056
    v_mfma_f32_16x16x32_bf16 v[180:183], a[152:155], v[192:195], v[180:183]
    v_mfma_f32_16x16x32_bf16 v[180:183], a[156:159], v[196:199], v[180:183]
    v_mfma_f32_16x16x32_bf16 v[180:183], a[184:187], v[200:203], v[180:183]
    v_mfma_f32_16x16x32_bf16 v[180:183], a[188:191], v[204:207], v[180:183]
    s_waitcnt vmcnt(17) lgkmcnt(0)
    s_barrier
    v_mfma_f32_16x16x32_bf16 v[152:155], a[128:131], v[208:211], v[152:155]
    buffer_load_dwordx4 v243, s[24:27], s64 offen offset:1024 lds
    v_mfma_f32_16x16x32_bf16 v[152:155], a[132:135], v[212:215], v[152:155]
    ds_read_b64_tr_b16 v[192:193], v240 offset:16384
    ds_read_b64_tr_b16 v[194:195], v240 offset:16896
    v_mfma_f32_16x16x32_bf16 v[152:155], a[160:163], v[216:219], v[152:155]
    v_mfma_f32_16x16x32_bf16 v[152:155], a[164:167], v[220:223], v[152:155]
    ds_read_b64_tr_b16 v[196:197], v240 offset:20480
    v_mfma_f32_16x16x32_bf16 v[156:159], a[136:139], v[208:211], v[156:159]
    ds_read_b64_tr_b16 v[198:199], v240 offset:20992
    v_mfma_f32_16x16x32_bf16 v[156:159], a[140:143], v[212:215], v[156:159]
    buffer_load_dwordx4 v244, s[24:27], s64 offen offset:2048 lds
    v_mfma_f32_16x16x32_bf16 v[156:159], a[168:171], v[216:219], v[156:159]
    ds_read_b64_tr_b16 v[200:201], v240 offset:24576
    v_mfma_f32_16x16x32_bf16 v[156:159], a[172:175], v[220:223], v[156:159]
    ds_read_b64_tr_b16 v[202:203], v240 offset:25088
    v_mfma_f32_16x16x32_bf16 v[184:187], a[144:147], v[208:211], v[184:187]
    v_mfma_f32_16x16x32_bf16 v[184:187], a[148:151], v[212:215], v[184:187]
    ds_read_b64_tr_b16 v[204:205], v240 offset:28672
    v_mfma_f32_16x16x32_bf16 v[184:187], a[176:179], v[216:219], v[184:187]
    buffer_load_dwordx4 v245, s[24:27], s64 offen offset:3072 lds
    v_mfma_f32_16x16x32_bf16 v[184:187], a[180:183], v[220:223], v[184:187]
    buffer_store_dwordx4 v[80:83], v255, s[4:7], s60 offen offset:2048 sc1
    v_mfma_f32_16x16x32_bf16 v[188:191], a[152:155], v[208:211], v[188:191]
    ds_read_b64_tr_b16 v[206:207], v240 offset:29184
    v_mfma_f32_16x16x32_bf16 v[188:191], a[156:159], v[212:215], v[188:191]
    v_mfma_f32_16x16x32_bf16 v[188:191], a[184:187], v[216:219], v[188:191]
    v_mfma_f32_16x16x32_bf16 v[188:191], a[188:191], v[220:223], v[188:191]
    s_waitcnt lgkmcnt(0)
    v_mfma_f32_16x16x32_bf16 v[4:7], a[128:131], v[192:195], v[4:7]
    s_add_u32 m0, s86, 0
    ds_read_b64_tr_b16 v[208:209], v241 offset:16384
    v_mfma_f32_16x16x32_bf16 v[4:7], a[132:135], v[196:199], v[4:7]
    ds_read_b64_tr_b16 v[210:211], v241 offset:16896
    v_mfma_f32_16x16x32_bf16 v[4:7], a[160:163], v[200:203], v[4:7]
    s_add_u32 s64, s84, 384
    v_mfma_f32_16x16x32_bf16 v[4:7], a[164:167], v[204:207], v[4:7]
    ds_read_b64_tr_b16 v[212:213], v241 offset:20480
    v_mfma_f32_16x16x32_bf16 v[12:15], a[136:139], v[192:195], v[12:15]
    ds_read_b64_tr_b16 v[214:215], v241 offset:20992
    v_mfma_f32_16x16x32_bf16 v[12:15], a[140:143], v[196:199], v[12:15]
    buffer_load_dwordx4 v232, s[4:7], s64 offen offset:0 sc1 lds
    v_mfma_f32_16x16x32_bf16 v[12:15], a[168:171], v[200:203], v[12:15]
    ds_read_b64_tr_b16 v[216:217], v241 offset:24576
    v_mfma_f32_16x16x32_bf16 v[12:15], a[172:175], v[204:207], v[12:15]
    ds_read_b64_tr_b16 v[218:219], v241 offset:25088
    v_mfma_f32_16x16x32_bf16 v[68:71], a[144:147], v[192:195], v[68:71]
    buffer_load_dwordx4 v233, s[4:7], s64 offen offset:1024 sc1 lds
    v_mfma_f32_16x16x32_bf16 v[68:71], a[148:151], v[196:199], v[68:71]
    ds_read_b64_tr_b16 v[220:221], v241 offset:28672
    v_mfma_f32_16x16x32_bf16 v[68:71], a[176:179], v[200:203], v[68:71]
    buffer_load_dwordx4 v234, s[4:7], s64 offen offset:2048 sc1 lds
    v_mfma_f32_16x16x32_bf16 v[68:71], a[180:183], v[204:207], v[68:71]
    ds_read_b64_tr_b16 v[222:223], v241 offset:29184
    v_mfma_f32_16x16x32_bf16 v[76:79], a[152:155], v[192:195], v[76:79]
    buffer_load_dwordx4 v235, s[4:7], s64 offen offset:3072 sc1 lds
    v_mfma_f32_16x16x32_bf16 v[76:79], a[156:159], v[196:199], v[76:79]
    v_mfma_f32_16x16x32_bf16 v[76:79], a[184:187], v[200:203], v[76:79]
    v_mfma_f32_16x16x32_bf16 v[76:79], a[188:191], v[204:207], v[76:79]
    s_waitcnt lgkmcnt(0)
    s_add_u32 m0, s86, 4096
    v_mfma_f32_16x16x32_bf16 v[20:23], a[128:131], v[208:211], v[20:23]
    ds_read_b64_tr_b16 v[192:193], v240 offset:16640
    v_mfma_f32_16x16x32_bf16 v[20:23], a[132:135], v[212:215], v[20:23]
    s_add_u32 s64, s84, 33152
    ds_read_b64_tr_b16 v[194:195], v240 offset:17152
    v_mfma_f32_16x16x32_bf16 v[20:23], a[160:163], v[216:219], v[20:23]
    v_mfma_f32_16x16x32_bf16 v[20:23], a[164:167], v[220:223], v[20:23]
    ds_read_b64_tr_b16 v[196:197], v240 offset:20736
    v_mfma_f32_16x16x32_bf16 v[28:31], a[136:139], v[208:211], v[28:31]
    buffer_load_dwordx4 v232, s[4:7], s64 offen offset:0 sc1 lds
    v_mfma_f32_16x16x32_bf16 v[28:31], a[140:143], v[212:215], v[28:31]
    ds_read_b64_tr_b16 v[198:199], v240 offset:21248
    v_mfma_f32_16x16x32_bf16 v[28:31], a[168:171], v[216:219], v[28:31]
    ds_read_b64_tr_b16 v[200:201], v240 offset:24832
    v_mfma_f32_16x16x32_bf16 v[28:31], a[172:175], v[220:223], v[28:31]
    buffer_load_dwordx4 v233, s[4:7], s64 offen offset:1024 sc1 lds
    v_mfma_f32_16x16x32_bf16 v[84:87], a[144:147], v[208:211], v[84:87]
    buffer_store_dwordx4 v[88:91], v255, s[4:7], s60 offen offset:3072 sc1
    v_mfma_f32_16x16x32_bf16 v[84:87], a[148:151], v[212:215], v[84:87]
    ds_read_b64_tr_b16 v[202:203], v240 offset:25344
    ds_read_b64_tr_b16 v[204:205], v240 offset:28928
    v_mfma_f32_16x16x32_bf16 v[84:87], a[176:179], v[216:219], v[84:87]
    buffer_load_dwordx4 v234, s[4:7], s64 offen offset:2048 sc1 lds
    v_mfma_f32_16x16x32_bf16 v[84:87], a[180:183], v[220:223], v[84:87]
    ds_read_b64_tr_b16 v[206:207], v240 offset:29440
    v_mfma_f32_16x16x32_bf16 v[92:95], a[152:155], v[208:211], v[92:95]
    buffer_load_dwordx4 v235, s[4:7], s64 offen offset:3072 sc1 lds
    v_mfma_f32_16x16x32_bf16 v[92:95], a[156:159], v[212:215], v[92:95]
    v_mfma_f32_16x16x32_bf16 v[92:95], a[184:187], v[216:219], v[92:95]
    v_mfma_f32_16x16x32_bf16 v[92:95], a[188:191], v[220:223], v[92:95]
    s_waitcnt lgkmcnt(0)
    v_mfma_f32_16x16x32_bf16 v[36:39], a[128:131], v[192:195], v[36:39]
    s_add_u32 m0, s68, 98304
    ds_read_b64_tr_b16 v[208:209], v241 offset:16640
    v_mfma_f32_16x16x32_bf16 v[36:39], a[132:135], v[196:199], v[36:39]
    ds_read_b64_tr_b16 v[210:211], v241 offset:17152
    v_mfma_f32_16x16x32_bf16 v[36:39], a[160:163], v[200:203], v[36:39]
    v_mfma_f32_16x16x32_bf16 v[36:39], a[164:167], v[204:207], v[36:39]
    ds_read_b64_tr_b16 v[212:213], v241 offset:20736
    v_mfma_f32_16x16x32_bf16 v[44:47], a[136:139], v[192:195], v[44:47]
    ds_read_b64_tr_b16 v[214:215], v241 offset:21248
    v_mfma_f32_16x16x32_bf16 v[44:47], a[140:143], v[196:199], v[44:47]
    s_add_u32 s64, s85, 0
    v_mfma_f32_16x16x32_bf16 v[44:47], a[168:171], v[200:203], v[44:47]
    ds_read_b64_tr_b16 v[216:217], v241 offset:24832
    v_mfma_f32_16x16x32_bf16 v[44:47], a[172:175], v[204:207], v[44:47]
    ds_read_b64_tr_b16 v[218:219], v241 offset:25344
    v_mfma_f32_16x16x32_bf16 v[100:103], a[144:147], v[192:195], v[100:103]
    v_mfma_f32_16x16x32_bf16 v[100:103], a[148:151], v[196:199], v[100:103]
    ds_read_b64_tr_b16 v[220:221], v241 offset:28928
    v_mfma_f32_16x16x32_bf16 v[100:103], a[176:179], v[200:203], v[100:103]
    buffer_load_dwordx4 v228, s[32:35], s64 offen offset:0 lds
    v_mfma_f32_16x16x32_bf16 v[100:103], a[180:183], v[204:207], v[100:103]
    ds_read_b64_tr_b16 v[222:223], v241 offset:29440
    v_mfma_f32_16x16x32_bf16 v[108:111], a[152:155], v[192:195], v[108:111]
    v_mfma_f32_16x16x32_bf16 v[108:111], a[156:159], v[196:199], v[108:111]
    v_mfma_f32_16x16x32_bf16 v[108:111], a[184:187], v[200:203], v[108:111]
    v_mfma_f32_16x16x32_bf16 v[108:111], a[188:191], v[204:207], v[108:111]
    s_waitcnt vmcnt(26) lgkmcnt(0)
    s_barrier
    v_mfma_f32_16x16x32_bf16 v[52:55], a[128:131], v[208:211], v[52:55]
    buffer_load_dwordx4 v229, s[32:35], s64 offen offset:1024 lds
    v_mfma_f32_16x16x32_bf16 v[52:55], a[132:135], v[212:215], v[52:55]
    ds_read_b64_tr_b16 v[192:193], v240 offset:32768
    ds_read_b64_tr_b16 v[194:195], v240 offset:33280
    v_mfma_f32_16x16x32_bf16 v[52:55], a[160:163], v[216:219], v[52:55]
    v_mfma_f32_16x16x32_bf16 v[52:55], a[164:167], v[220:223], v[52:55]
    s_add_u32 s60, s88, 20480
    ds_read_b64_tr_b16 v[196:197], v240 offset:36864
    v_mfma_f32_16x16x32_bf16 v[60:63], a[136:139], v[208:211], v[60:63]
    buffer_store_dwordx4 v[96:99], v255, s[4:7], s60 offen offset:0 sc1
    v_mfma_f32_16x16x32_bf16 v[60:63], a[140:143], v[212:215], v[60:63]
    ds_read_b64_tr_b16 v[198:199], v240 offset:37376
    v_mfma_f32_16x16x32_bf16 v[60:63], a[168:171], v[216:219], v[60:63]
    buffer_load_dwordx4 v230, s[32:35], s64 offen offset:2048 lds
    v_mfma_f32_16x16x32_bf16 v[60:63], a[172:175], v[220:223], v[60:63]
    ds_read_b64_tr_b16 v[200:201], v240 offset:40960
    ds_read_b64_tr_b16 v[202:203], v240 offset:41472
    v_mfma_f32_16x16x32_bf16 v[116:119], a[144:147], v[208:211], v[116:119]
    v_mfma_f32_16x16x32_bf16 v[116:119], a[148:151], v[212:215], v[116:119]
    ds_read_b64_tr_b16 v[204:205], v240 offset:45056
    v_mfma_f32_16x16x32_bf16 v[116:119], a[176:179], v[216:219], v[116:119]
    buffer_load_dwordx4 v231, s[32:35], s64 offen offset:3072 lds
    v_mfma_f32_16x16x32_bf16 v[116:119], a[180:183], v[220:223], v[116:119]
    ds_read_b64_tr_b16 v[206:207], v240 offset:45568
    v_mfma_f32_16x16x32_bf16 v[124:127], a[152:155], v[208:211], v[124:127]
    v_mfma_f32_16x16x32_bf16 v[124:127], a[156:159], v[212:215], v[124:127]
    v_mfma_f32_16x16x32_bf16 v[124:127], a[184:187], v[216:219], v[124:127]
    v_mfma_f32_16x16x32_bf16 v[124:127], a[188:191], v[220:223], v[124:127]
    s_waitcnt lgkmcnt(0)
    v_mfma_f32_16x16x32_bf16 v[128:131], a[192:195], v[192:195], v[128:131]
    s_add_u32 m0, s68, 114688
    ds_read_b64_tr_b16 v[208:209], v241 offset:32768
    v_mfma_f32_16x16x32_bf16 v[128:131], a[196:199], v[196:199], v[128:131]
    ds_read_b64_tr_b16 v[210:211], v241 offset:33280
    v_mfma_f32_16x16x32_bf16 v[128:131], a[224:227], v[200:203], v[128:131]
    v_mfma_f32_16x16x32_bf16 v[128:131], a[228:231], v[204:207], v[128:131]
    ds_read_b64_tr_b16 v[212:213], v241 offset:36864
    v_mfma_f32_16x16x32_bf16 v[132:135], a[200:203], v[192:195], v[132:135]
    ds_read_b64_tr_b16 v[214:215], v241 offset:37376
    v_lshrrev_b32 v250, 4, v254
    v_mfma_f32_16x16x32_bf16 v[132:135], a[204:207], v[196:199], v[132:135]
    v_mfma_f32_16x16x32_bf16 v[132:135], a[232:235], v[200:203], v[132:135]
    s_add_u32 s64, s87, 0
    ds_read_b64_tr_b16 v[216:217], v241 offset:40960
    v_mfma_f32_16x16x32_bf16 v[132:135], a[236:239], v[204:207], v[132:135]
    ds_read_b64_tr_b16 v[218:219], v241 offset:41472
    v_lshlrev_b32 v250, 3, v250
    v_mfma_f32_16x16x32_bf16 v[160:163], a[208:211], v[192:195], v[160:163]
    v_mfma_f32_16x16x32_bf16 v[160:163], a[212:215], v[196:199], v[160:163]
    ds_read_b64_tr_b16 v[220:221], v241 offset:45056
    v_mfma_f32_16x16x32_bf16 v[160:163], a[240:243], v[200:203], v[160:163]
    ds_read_b64_tr_b16 v[222:223], v241 offset:45568
    v_mfma_f32_16x16x32_bf16 v[160:163], a[244:247], v[204:207], v[160:163]
    s_lshl_b32 s3, s57, 7
    v_mfma_f32_16x16x32_bf16 v[164:167], a[216:219], v[192:195], v[164:167]
    v_mfma_f32_16x16x32_bf16 v[164:167], a[220:223], v[196:199], v[164:167]
    buffer_load_dwordx4 v242, s[16:19], s64 offen offset:0 lds
    v_mfma_f32_16x16x32_bf16 v[164:167], a[248:251], v[200:203], v[164:167]
    v_add_u32 v236, 65536, v236
    v_mfma_f32_16x16x32_bf16 v[164:167], a[252:255], v[204:207], v[164:167]
    s_waitcnt lgkmcnt(0)
    v_add_u32 v237, 65536, v237
    v_mfma_f32_16x16x32_bf16 v[136:139], a[192:195], v[208:211], v[136:139]
    buffer_load_dwordx2 v[246:247], v250, s[44:47], s3 offen offset:0
    v_mfma_f32_16x16x32_bf16 v[136:139], a[196:199], v[212:215], v[136:139]
    s_waitcnt vmcnt(22)
    ds_read_b64_tr_b16 v[192:193], v240 offset:33024
    ds_read_b64_tr_b16 v[194:195], v240 offset:33536
    v_mfma_f32_16x16x32_bf16 v[136:139], a[224:227], v[216:219], v[136:139]
    buffer_store_dwordx4 v[104:107], v255, s[4:7], s60 offen offset:1024 sc1
    v_mfma_f32_16x16x32_bf16 v[136:139], a[228:231], v[220:223], v[136:139]
    ds_read_b128 a[64:67], v236 offset:0
    ds_read_b64_tr_b16 v[196:197], v240 offset:37120
    v_mfma_f32_16x16x32_bf16 v[140:143], a[200:203], v[208:211], v[140:143]
    buffer_load_dwordx2 v[248:249], v250, s[44:47], s3 offen offset:32
    v_mfma_f32_16x16x32_bf16 v[140:143], a[204:207], v[212:215], v[140:143]
    buffer_load_dwordx4 v243, s[16:19], s64 offen offset:1024 lds
    v_mfma_f32_16x16x32_bf16 v[140:143], a[232:235], v[216:219], v[140:143]
    ds_read_b64_tr_b16 v[198:199], v240 offset:37632
    v_cvt_pk_bf16_f32 v128, v128, v129
    v_mfma_f32_16x16x32_bf16 v[140:143], a[236:239], v[220:223], v[140:143]
    ds_read_b128 a[68:71], v237 offset:0
    v_cvt_pk_bf16_f32 v129, v130, v131
    v_mfma_f32_16x16x32_bf16 v[168:171], a[208:211], v[208:211], v[168:171]
    ds_read_b64_tr_b16 v[200:201], v240 offset:41216
    v_cvt_pk_bf16_f32 v130, v132, v133
    v_mfma_f32_16x16x32_bf16 v[168:171], a[212:215], v[212:215], v[168:171]
    buffer_load_dwordx2 v[224:225], v250, s[44:47], s3 offen offset:64
    v_mfma_f32_16x16x32_bf16 v[168:171], a[240:243], v[216:219], v[168:171]
    ds_read_b64_tr_b16 v[202:203], v240 offset:41728
    ds_read_b128 a[72:75], v236 offset:2048
    v_mfma_f32_16x16x32_bf16 v[168:171], a[244:247], v[220:223], v[168:171]
    ds_read_b64_tr_b16 v[204:205], v240 offset:45312
    v_cvt_pk_bf16_f32 v131, v134, v135
    v_mfma_f32_16x16x32_bf16 v[172:175], a[216:219], v[208:211], v[172:175]
    ds_read_b64_tr_b16 v[206:207], v240 offset:45824
    v_cvt_pk_bf16_f32 v160, v160, v161
    v_mfma_f32_16x16x32_bf16 v[172:175], a[220:223], v[212:215], v[172:175]
    buffer_load_dwordx2 v[0:1], v250, s[44:47], s3 offen offset:96
    v_mfma_f32_16x16x32_bf16 v[172:175], a[248:251], v[216:219], v[172:175]
    buffer_load_dwordx4 v244, s[16:19], s64 offen offset:2048 lds
    v_mfma_f32_16x16x32_bf16 v[172:175], a[252:255], v[220:223], v[172:175]
    s_waitcnt lgkmcnt(0)
    ds_read_b128 a[76:79], v237 offset:2048
    v_cvt_pk_bf16_f32 v161, v162, v163
    v_mfma_f32_16x16x32_bf16 v[144:147], a[192:195], v[192:195], v[144:147]
    ds_read_b128 a[80:83], v236 offset:4096
    v_cvt_pk_bf16_f32 v162, v164, v165
    v_mfma_f32_16x16x32_bf16 v[144:147], a[196:199], v[196:199], v[144:147]
    ds_read_b64_tr_b16 v[208:209], v241 offset:33024
    v_cvt_pk_bf16_f32 v163, v166, v167
    v_mfma_f32_16x16x32_bf16 v[144:147], a[224:227], v[200:203], v[144:147]
    ds_read_b128 a[84:87], v237 offset:4096
    ds_read_b64_tr_b16 v[210:211], v241 offset:33536
    v_mfma_f32_16x16x32_bf16 v[144:147], a[228:231], v[204:207], v[144:147]
    buffer_load_dwordx4 v245, s[16:19], s64 offen offset:3072 lds
    v_mfma_f32_16x16x32_bf16 v[148:151], a[200:203], v[192:195], v[148:151]
    ds_read_b64_tr_b16 v[212:213], v241 offset:37120
    ds_read_b128 a[88:91], v236 offset:6144
    v_mfma_f32_16x16x32_bf16 v[148:151], a[204:207], v[196:199], v[148:151]
    ds_read_b64_tr_b16 v[214:215], v241 offset:37632
    v_cvt_pk_bf16_f32 v136, v136, v137
    v_mfma_f32_16x16x32_bf16 v[148:151], a[232:235], v[200:203], v[148:151]
    ds_read_b64_tr_b16 v[216:217], v241 offset:41216
    v_cvt_pk_bf16_f32 v137, v138, v139
    v_mfma_f32_16x16x32_bf16 v[148:151], a[236:239], v[204:207], v[148:151]
    ds_read_b128 a[92:95], v237 offset:6144
    v_cvt_pk_bf16_f32 v138, v140, v141
    v_mfma_f32_16x16x32_bf16 v[176:179], a[208:211], v[192:195], v[176:179]
    ds_read_b64_tr_b16 v[218:219], v241 offset:41728
    v_cvt_pk_bf16_f32 v139, v142, v143
    v_mfma_f32_16x16x32_bf16 v[176:179], a[212:215], v[196:199], v[176:179]
    ds_read_b64_tr_b16 v[220:221], v241 offset:45312
    v_mfma_f32_16x16x32_bf16 v[176:179], a[240:243], v[200:203], v[176:179]
    ds_read_b64_tr_b16 v[222:223], v241 offset:45824
    v_cvt_pk_bf16_f32 v168, v168, v169
    v_mfma_f32_16x16x32_bf16 v[176:179], a[244:247], v[204:207], v[176:179]
    v_cvt_pk_bf16_f32 v169, v170, v171
    v_mfma_f32_16x16x32_bf16 v[180:183], a[216:219], v[192:195], v[180:183]
    v_mfma_f32_16x16x32_bf16 v[180:183], a[220:223], v[196:199], v[180:183]
    v_cvt_pk_bf16_f32 v170, v172, v173
    v_mfma_f32_16x16x32_bf16 v[180:183], a[248:251], v[200:203], v[180:183]
    buffer_store_dwordx4 v[112:115], v255, s[4:7], s60 offen offset:2048 sc1
    v_mfma_f32_16x16x32_bf16 v[180:183], a[252:255], v[204:207], v[180:183]
    s_waitcnt vmcnt(25) lgkmcnt(0)
    s_barrier
    v_mfma_f32_16x16x32_bf16 v[152:155], a[192:195], v[208:211], v[152:155]
    ds_read_b64_tr_b16 v[192:193], v240 offset:49152
    v_cvt_pk_bf16_f32 v171, v174, v175
    v_mfma_f32_16x16x32_bf16 v[152:155], a[196:199], v[212:215], v[152:155]
    ds_read_b64_tr_b16 v[194:195], v240 offset:49664
    v_mfma_f32_16x16x32_bf16 v[152:155], a[224:227], v[216:219], v[152:155]
    v_mfma_f32_16x16x32_bf16 v[152:155], a[228:231], v[220:223], v[152:155]
    ds_read_b64_tr_b16 v[196:197], v240 offset:53248
    v_mfma_f32_16x16x32_bf16 v[156:159], a[200:203], v[208:211], v[156:159]
    ds_read_b64_tr_b16 v[198:199], v240 offset:53760
    v_cvt_pk_bf16_f32 v144, v144, v145
    v_mfma_f32_16x16x32_bf16 v[156:159], a[204:207], v[212:215], v[156:159]
    v_cvt_pk_bf16_f32 v145, v146, v147
    v_mfma_f32_16x16x32_bf16 v[156:159], a[232:235], v[216:219], v[156:159]
    ds_read_b64_tr_b16 v[200:201], v240 offset:57344
    v_mfma_f32_16x16x32_bf16 v[156:159], a[236:239], v[220:223], v[156:159]
    ds_read_b64_tr_b16 v[202:203], v240 offset:57856
    v_cvt_pk_bf16_f32 v146, v148, v149
    v_mfma_f32_16x16x32_bf16 v[184:187], a[208:211], v[208:211], v[184:187]
    v_cvt_pk_bf16_f32 v147, v150, v151
    v_mfma_f32_16x16x32_bf16 v[184:187], a[212:215], v[212:215], v[184:187]
    ds_read_b64_tr_b16 v[204:205], v240 offset:61440
    v_mfma_f32_16x16x32_bf16 v[184:187], a[240:243], v[216:219], v[184:187]
    ds_read_b64_tr_b16 v[206:207], v240 offset:61952
    v_cvt_pk_bf16_f32 v176, v176, v177
    v_mfma_f32_16x16x32_bf16 v[184:187], a[244:247], v[220:223], v[184:187]
    v_cvt_pk_bf16_f32 v177, v178, v179
    v_mfma_f32_16x16x32_bf16 v[188:191], a[216:219], v[208:211], v[188:191]
    v_mfma_f32_16x16x32_bf16 v[188:191], a[220:223], v[212:215], v[188:191]
    v_cvt_pk_bf16_f32 v178, v180, v181
    v_mfma_f32_16x16x32_bf16 v[188:191], a[248:251], v[216:219], v[188:191]
    v_cvt_pk_bf16_f32 v179, v182, v183
    v_mfma_f32_16x16x32_bf16 v[188:191], a[252:255], v[220:223], v[188:191]
    s_waitcnt lgkmcnt(0)
    v_mfma_f32_16x16x32_bf16 v[4:7], a[192:195], v[192:195], v[4:7]
    s_add_u32 m0, s86, 32768
    ds_read_b64_tr_b16 v[208:209], v241 offset:49152
    v_mfma_f32_16x16x32_bf16 v[4:7], a[196:199], v[196:199], v[4:7]
    ds_read_b64_tr_b16 v[210:211], v241 offset:49664
    v_mfma_f32_16x16x32_bf16 v[4:7], a[224:227], v[200:203], v[4:7]
    s_add_u32 s64, s84, 512
    v_mfma_f32_16x16x32_bf16 v[4:7], a[228:231], v[204:207], v[4:7]
    ds_read_b64_tr_b16 v[212:213], v241 offset:53248
    v_mfma_f32_16x16x32_bf16 v[12:15], a[200:203], v[192:195], v[12:15]
    ds_read_b64_tr_b16 v[214:215], v241 offset:53760
    v_cvt_pk_bf16_f32 v152, v152, v153
    v_mfma_f32_16x16x32_bf16 v[12:15], a[204:207], v[196:199], v[12:15]
    buffer_load_dwordx4 v232, s[4:7], s64 offen offset:0 sc1 lds
    v_mfma_f32_16x16x32_bf16 v[12:15], a[232:235], v[200:203], v[12:15]
    ds_read_b64_tr_b16 v[216:217], v241 offset:57344
    v_cvt_pk_bf16_f32 v153, v154, v155
    v_mfma_f32_16x16x32_bf16 v[12:15], a[236:239], v[204:207], v[12:15]
    ds_read_b64_tr_b16 v[218:219], v241 offset:57856
    v_cvt_pk_bf16_f32 v154, v156, v157
    v_mfma_f32_16x16x32_bf16 v[68:71], a[208:211], v[192:195], v[68:71]
    buffer_load_dwordx4 v233, s[4:7], s64 offen offset:1024 sc1 lds
    v_mfma_f32_16x16x32_bf16 v[68:71], a[212:215], v[196:199], v[68:71]
    ds_read_b64_tr_b16 v[220:221], v241 offset:61440
    v_cvt_pk_bf16_f32 v155, v158, v159
    v_mfma_f32_16x16x32_bf16 v[68:71], a[240:243], v[200:203], v[68:71]
    buffer_load_dwordx4 v234, s[4:7], s64 offen offset:2048 sc1 lds
    v_mfma_f32_16x16x32_bf16 v[68:71], a[244:247], v[204:207], v[68:71]
    ds_read_b64_tr_b16 v[222:223], v241 offset:61952
    v_cvt_pk_bf16_f32 v184, v184, v185
    v_mfma_f32_16x16x32_bf16 v[76:79], a[216:219], v[192:195], v[76:79]
    buffer_store_dwordx4 v[120:123], v255, s[4:7], s60 offen offset:3072 sc1
    v_mfma_f32_16x16x32_bf16 v[76:79], a[220:223], v[196:199], v[76:79]
    v_cvt_pk_bf16_f32 v185, v186, v187
    v_cvt_pk_bf16_f32 v186, v188, v189
    v_mfma_f32_16x16x32_bf16 v[76:79], a[248:251], v[200:203], v[76:79]
    buffer_load_dwordx4 v235, s[4:7], s64 offen offset:3072 sc1 lds
    v_mfma_f32_16x16x32_bf16 v[76:79], a[252:255], v[204:207], v[76:79]
    s_waitcnt lgkmcnt(0)
    v_subrev_u32 v236, 65536, v236
    v_cvt_pk_bf16_f32 v187, v190, v191
    v_mfma_f32_16x16x32_bf16 v[20:23], a[192:195], v[208:211], v[20:23]
    s_add_u32 m0, s86, 36864
    ds_read_b64_tr_b16 v[192:193], v240 offset:49408
    v_subrev_u32 v237, 65536, v237
    v_mfma_f32_16x16x32_bf16 v[20:23], a[196:199], v[212:215], v[20:23]
    s_waitcnt vmcnt(20)
    s_add_u32 s64, s84, 33280
    ds_read_b64_tr_b16 v[194:195], v240 offset:49920
    v_mfma_f32_16x16x32_bf16 v[20:23], a[224:227], v[216:219], v[20:23]
    ds_read_b128 a[96:99], v236 offset:0
    v_mfma_f32_16x16x32_bf16 v[20:23], a[228:231], v[220:223], v[20:23]
    ds_read_b64_tr_b16 v[196:197], v240 offset:53504
    v_mfma_f32_16x16x32_bf16 v[28:31], a[200:203], v[208:211], v[28:31]
    buffer_load_dwordx4 v232, s[4:7], s64 offen offset:0 sc1 lds
    v_mfma_f32_16x16x32_bf16 v[28:31], a[204:207], v[212:215], v[28:31]
    ds_read_b64_tr_b16 v[198:199], v240 offset:54016
    v_cvt_pk_bf16_f32 v4, v4, v5
    v_mfma_f32_16x16x32_bf16 v[28:31], a[232:235], v[216:219], v[28:31]
    ds_read_b128 a[100:103], v237 offset:0
    v_cvt_pk_bf16_f32 v5, v6, v7
    v_mfma_f32_16x16x32_bf16 v[28:31], a[236:239], v[220:223], v[28:31]
    ds_read_b64_tr_b16 v[200:201], v240 offset:57600
    v_cvt_pk_bf16_f32 v6, v12, v13
    v_mfma_f32_16x16x32_bf16 v[84:87], a[208:211], v[208:211], v[84:87]
    buffer_load_dwordx4 v233, s[4:7], s64 offen offset:1024 sc1 lds
    v_mfma_f32_16x16x32_bf16 v[84:87], a[212:215], v[212:215], v[84:87]
    ds_read_b64_tr_b16 v[202:203], v240 offset:58112
    ds_read_b128 a[104:107], v236 offset:2048
    v_mfma_f32_16x16x32_bf16 v[84:87], a[240:243], v[216:219], v[84:87]
    s_waitcnt vmcnt(10)
    v_mfma_f32_16x16x32_bf16 v[84:87], a[244:247], v[220:223], v[84:87]
    ds_read_b64_tr_b16 v[204:205], v240 offset:61696
    ds_read_b64_tr_b16 v[206:207], v240 offset:62208
    v_cvt_pk_bf16_f32 v7, v14, v15
    v_mfma_f32_16x16x32_bf16 v[92:95], a[216:219], v[208:211], v[92:95]
    buffer_load_dwordx4 v234, s[4:7], s64 offen offset:2048 sc1 lds
    v_mfma_f32_16x16x32_bf16 v[92:95], a[220:223], v[212:215], v[92:95]
    v_lshlrev_b32 v132, 16, v246
    v_cvt_pk_bf16_f32 v68, v68, v69
    v_mfma_f32_16x16x32_bf16 v[92:95], a[248:251], v[216:219], v[92:95]
    ds_read_b128 a[108:111], v237 offset:2048
    v_and_b32 v133, 0xffff0000, v246
    v_mfma_f32_16x16x32_bf16 v[92:95], a[252:255], v[220:223], v[92:95]
    s_waitcnt lgkmcnt(0)
    v_cvt_pk_bf16_f32 v69, v70, v71
    v_lshlrev_b32 v134, 16, v247
    v_mfma_f32_16x16x32_bf16 v[36:39], a[192:195], v[192:195], v[36:39]
    buffer_load_dwordx4 v235, s[4:7], s64 offen offset:3072 sc1 lds
    v_mfma_f32_16x16x32_bf16 v[36:39], a[196:199], v[196:199], v[36:39]
    s_add_u32 m0, s68, 131072
    v_and_b32 v135, 0xffff0000, v247
    v_cvt_pk_bf16_f32 v70, v76, v77
    v_mfma_f32_16x16x32_bf16 v[36:39], a[224:227], v[200:203], v[36:39]
    ds_read_b128 a[112:115], v236 offset:4096
    v_lshlrev_b32 v140, 16, v248
    v_mfma_f32_16x16x32_bf16 v[36:39], a[228:231], v[204:207], v[36:39]
    v_cvt_pk_bf16_f32 v71, v78, v79
    v_and_b32 v141, 0xffff0000, v248
    v_mfma_f32_16x16x32_bf16 v[44:47], a[200:203], v[192:195], v[44:47]
    ds_read_b64_tr_b16 v[208:209], v241 offset:49408
    v_lshlrev_b32 v142, 16, v249
    v_mfma_f32_16x16x32_bf16 v[44:47], a[204:207], v[196:199], v[44:47]
    s_add_u32 s64, s85, 458752
    ds_read_b128 a[116:119], v237 offset:4096
    v_and_b32 v143, 0xffff0000, v249
    v_mfma_f32_16x16x32_bf16 v[44:47], a[232:235], v[200:203], v[44:47]
    ds_read_b64_tr_b16 v[210:211], v241 offset:49920
    v_lshlrev_b32 v148, 16, v224
    v_mfma_f32_16x16x32_bf16 v[44:47], a[236:239], v[204:207], v[44:47]
    s_add_u32 s60, s88, 8192
    ds_read_b64_tr_b16 v[212:213], v241 offset:53504
    v_and_b32 v149, 0xffff0000, v224
    v_mfma_f32_16x16x32_bf16 v[100:103], a[208:211], v[192:195], v[100:103]
    ds_read_b128 a[120:123], v236 offset:6144
    v_cvt_pk_bf16_f32 v20, v20, v21
    v_mfma_f32_16x16x32_bf16 v[100:103], a[212:215], v[196:199], v[100:103]
    ds_read_b64_tr_b16 v[214:215], v241 offset:54016
    v_lshlrev_b32 v150, 16, v225
    v_mfma_f32_16x16x32_bf16 v[100:103], a[240:243], v[200:203], v[100:103]
    ds_read_b64_tr_b16 v[216:217], v241 offset:57600
    v_cvt_pk_bf16_f32 v21, v22, v23
    v_mfma_f32_16x16x32_bf16 v[100:103], a[244:247], v[204:207], v[100:103]
    ds_read_b128 a[124:127], v237 offset:6144
    v_and_b32 v151, 0xffff0000, v225
    v_mfma_f32_16x16x32_bf16 v[108:111], a[216:219], v[192:195], v[108:111]
    v_cvt_pk_bf16_f32 v22, v28, v29
    v_lshlrev_b32 v156, 16, v0
    v_mfma_f32_16x16x32_bf16 v[108:111], a[220:223], v[196:199], v[108:111]
    ds_read_b64_tr_b16 v[218:219], v241 offset:58112
    ds_read_b64_tr_b16 v[220:221], v241 offset:61696
    ds_read_b64_tr_b16 v[222:223], v241 offset:62208
    v_and_b32 v157, 0xffff0000, v0
    v_mfma_f32_16x16x32_bf16 v[108:111], a[248:251], v[200:203], v[108:111]
    buffer_store_dwordx4 v[128:131], v255, s[4:7], s60 offen offset:0 sc1
    v_mfma_f32_16x16x32_bf16 v[108:111], a[252:255], v[204:207], v[108:111]
    s_waitcnt lgkmcnt(0)
    s_barrier
    v_mfma_f32_16x16x32_bf16 v[52:55], a[192:195], v[208:211], v[52:55]
    v_cvt_pk_bf16_f32 v23, v30, v31
    v_lshlrev_b32 v158, 16, v1
    v_mfma_f32_16x16x32_bf16 v[52:55], a[196:199], v[212:215], v[52:55]
    v_cvt_pk_bf16_f32 v84, v84, v85
    v_and_b32 v159, 0xffff0000, v1
    v_mfma_f32_16x16x32_bf16 v[52:55], a[224:227], v[216:219], v[52:55]
    buffer_load_dwordx4 v228, s[32:35], s64 offen offset:0 lds
    v_mfma_f32_16x16x32_bf16 v[52:55], a[228:231], v[220:223], v[52:55]
    v_cvt_pk_bf16_f32 v85, v86, v87
    v_cvt_pk_bf16_f32 v86, v92, v93
    v_mfma_f32_16x16x32_bf16 v[60:63], a[200:203], v[208:211], v[60:63]
    ds_read_b64_tr_b16 v[192:193], v240 offset:0
    v_cvt_pk_bf16_f32 v87, v94, v95
    v_mfma_f32_16x16x32_bf16 v[60:63], a[204:207], v[212:215], v[60:63]
    buffer_load_dwordx4 v229, s[32:35], s64 offen offset:1024 lds
    v_mfma_f32_16x16x32_bf16 v[60:63], a[232:235], v[216:219], v[60:63]
    ds_read_b64_tr_b16 v[194:195], v240 offset:512
    ds_read_b64_tr_b16 v[196:197], v240 offset:4096
    v_mfma_f32_16x16x32_bf16 v[60:63], a[236:239], v[220:223], v[60:63]
    ds_read_b64_tr_b16 v[198:199], v240 offset:4608
    v_cvt_pk_bf16_f32 v36, v36, v37
    v_mfma_f32_16x16x32_bf16 v[116:119], a[208:211], v[208:211], v[116:119]
    buffer_load_dwordx4 v230, s[32:35], s64 offen offset:2048 lds
    v_mfma_f32_16x16x32_bf16 v[116:119], a[212:215], v[212:215], v[116:119]
    ds_read_b64_tr_b16 v[200:201], v240 offset:8192
    v_cvt_pk_bf16_f32 v37, v38, v39
    v_mfma_f32_16x16x32_bf16 v[116:119], a[240:243], v[216:219], v[116:119]
    ds_read_b64_tr_b16 v[202:203], v240 offset:8704
    v_cvt_pk_bf16_f32 v38, v44, v45
    v_mfma_f32_16x16x32_bf16 v[116:119], a[244:247], v[220:223], v[116:119]
    ds_read_b64_tr_b16 v[204:205], v240 offset:12288
    v_cvt_pk_bf16_f32 v39, v46, v47
    v_mfma_f32_16x16x32_bf16 v[124:127], a[216:219], v[208:211], v[124:127]
    buffer_load_dwordx4 v231, s[32:35], s64 offen offset:3072 lds
    v_mfma_f32_16x16x32_bf16 v[124:127], a[220:223], v[212:215], v[124:127]
    ds_read_b64_tr_b16 v[206:207], v240 offset:12800
    v_cvt_pk_bf16_f32 v100, v100, v101
    v_mfma_f32_16x16x32_bf16 v[124:127], a[248:251], v[216:219], v[124:127]
    v_cvt_pk_bf16_f32 v101, v102, v103
    v_cvt_pk_bf16_f32 v102, v108, v109
    v_mfma_f32_16x16x32_bf16 v[124:127], a[252:255], v[220:223], v[124:127]
    s_waitcnt lgkmcnt(0)
    v_cvt_pk_bf16_f32 v103, v110, v111
    v_mfma_f32_16x16x32_bf16 v[0:3], v[192:195], a[0:3], v[132:135]
    buffer_store_dwordx4 v[136:139], v255, s[4:7], s60 offen offset:1024 sc1
    v_mfma_f32_16x16x32_bf16 v[0:3], v[196:199], a[4:7], v[0:3]
    s_add_u32 m0, s86, 65536
    ds_read_b64_tr_b16 v[208:209], v241 offset:0
    ds_read_b64_tr_b16 v[210:211], v241 offset:512
    v_mfma_f32_16x16x32_bf16 v[0:3], v[200:203], a[32:35], v[0:3]
    s_add_u32 s64, s84, 640
    v_mfma_f32_16x16x32_bf16 v[0:3], v[204:207], a[36:39], v[0:3]
    ds_read_b64_tr_b16 v[212:213], v241 offset:4096
    v_mfma_f32_16x16x32_bf16 v[32:35], v[192:195], a[8:11], v[132:135]
    ds_read_b64_tr_b16 v[214:215], v241 offset:4608
    v_cvt_pk_bf16_f32 v52, v52, v53
    v_mfma_f32_16x16x32_bf16 v[32:35], v[196:199], a[12:15], v[32:35]
    buffer_load_dwordx4 v232, s[4:7], s64 offen offset:0 sc1 lds
    v_mfma_f32_16x16x32_bf16 v[32:35], v[200:203], a[40:43], v[32:35]
    ds_read_b64_tr_b16 v[216:217], v241 offset:8192
    v_cvt_pk_bf16_f32 v53, v54, v55
    v_mfma_f32_16x16x32_bf16 v[32:35], v[204:207], a[44:47], v[32:35]
    ds_read_b64_tr_b16 v[218:219], v241 offset:8704
    v_cvt_pk_bf16_f32 v54, v60, v61
    v_mfma_f32_16x16x32_bf16 v[64:67], v[192:195], a[16:19], v[132:135]
    buffer_load_dwordx4 v233, s[4:7], s64 offen offset:1024 sc1 lds
    v_mfma_f32_16x16x32_bf16 v[64:67], v[196:199], a[20:23], v[64:67]
    ds_read_b64_tr_b16 v[220:221], v241 offset:12288
    v_cvt_pk_bf16_f32 v55, v62, v63
    v_mfma_f32_16x16x32_bf16 v[64:67], v[200:203], a[48:51], v[64:67]
    buffer_load_dwordx4 v234, s[4:7], s64 offen offset:2048 sc1 lds
    v_mfma_f32_16x16x32_bf16 v[64:67], v[204:207], a[52:55], v[64:67]
    ds_read_b64_tr_b16 v[222:223], v241 offset:12800
    v_cvt_pk_bf16_f32 v116, v116, v117
    v_mfma_f32_16x16x32_bf16 v[96:99], v[192:195], a[24:27], v[132:135]
    v_cvt_pk_bf16_f32 v117, v118, v119
    v_mfma_f32_16x16x32_bf16 v[96:99], v[196:199], a[28:31], v[96:99]
    buffer_load_dwordx4 v235, s[4:7], s64 offen offset:3072 sc1 lds
    v_mfma_f32_16x16x32_bf16 v[96:99], v[200:203], a[56:59], v[96:99]
    v_cvt_pk_bf16_f32 v118, v124, v125
    v_cvt_pk_bf16_f32 v119, v126, v127
    v_mfma_f32_16x16x32_bf16 v[96:99], v[204:207], a[60:63], v[96:99]
    s_waitcnt lgkmcnt(0)
    s_add_u32 m0, s86, 69632
    v_mfma_f32_16x16x32_bf16 v[8:11], v[208:211], a[0:3], v[140:143]
    ds_read_b64_tr_b16 v[192:193], v240 offset:256
    v_mfma_f32_16x16x32_bf16 v[8:11], v[212:215], a[4:7], v[8:11]
    s_add_u32 s64, s84, 33408
    ds_read_b64_tr_b16 v[194:195], v240 offset:768
    v_mfma_f32_16x16x32_bf16 v[8:11], v[216:219], a[32:35], v[8:11]
    v_mfma_f32_16x16x32_bf16 v[8:11], v[220:223], a[36:39], v[8:11]
    ds_read_b64_tr_b16 v[196:197], v240 offset:4352
    v_mfma_f32_16x16x32_bf16 v[40:43], v[208:211], a[8:11], v[140:143]
    buffer_load_dwordx4 v232, s[4:7], s64 offen offset:0 sc1 lds
    v_mfma_f32_16x16x32_bf16 v[40:43], v[212:215], a[12:15], v[40:43]
    buffer_store_dwordx4 v[144:147], v255, s[4:7], s60 offen offset:2048 sc1
    v_mfma_f32_16x16x32_bf16 v[40:43], v[216:219], a[40:43], v[40:43]
    ds_read_b64_tr_b16 v[198:199], v240 offset:4864
    ds_read_b64_tr_b16 v[200:201], v240 offset:8448
    v_mfma_f32_16x16x32_bf16 v[40:43], v[220:223], a[44:47], v[40:43]
    buffer_load_dwordx4 v233, s[4:7], s64 offen offset:1024 sc1 lds
    v_mfma_f32_16x16x32_bf16 v[72:75], v[208:211], a[16:19], v[140:143]
    ds_read_b64_tr_b16 v[202:203], v240 offset:8960
    v_mfma_f32_16x16x32_bf16 v[72:75], v[212:215], a[20:23], v[72:75]
    ds_read_b64_tr_b16 v[204:205], v240 offset:12544
    v_mfma_f32_16x16x32_bf16 v[72:75], v[216:219], a[48:51], v[72:75]
    buffer_load_dwordx4 v234, s[4:7], s64 offen offset:2048 sc1 lds
    v_mfma_f32_16x16x32_bf16 v[72:75], v[220:223], a[52:55], v[72:75]
    ds_read_b64_tr_b16 v[206:207], v240 offset:13056
    v_mfma_f32_16x16x32_bf16 v[104:107], v[208:211], a[24:27], v[140:143]
    buffer_load_dwordx4 v235, s[4:7], s64 offen offset:3072 sc1 lds
    v_mfma_f32_16x16x32_bf16 v[104:107], v[212:215], a[28:31], v[104:107]
    v_mfma_f32_16x16x32_bf16 v[104:107], v[216:219], a[56:59], v[104:107]
    v_mfma_f32_16x16x32_bf16 v[104:107], v[220:223], a[60:63], v[104:107]
    s_waitcnt lgkmcnt(0)
    v_mfma_f32_16x16x32_bf16 v[16:19], v[192:195], a[0:3], v[148:151]
    s_add_u32 m0, s68, 147456
    ds_read_b64_tr_b16 v[208:209], v241 offset:256
    v_mfma_f32_16x16x32_bf16 v[16:19], v[196:199], a[4:7], v[16:19]
    ds_read_b64_tr_b16 v[210:211], v241 offset:768
    v_mfma_f32_16x16x32_bf16 v[16:19], v[200:203], a[32:35], v[16:19]
    v_mfma_f32_16x16x32_bf16 v[16:19], v[204:207], a[36:39], v[16:19]
    ds_read_b64_tr_b16 v[212:213], v241 offset:4352
    v_mfma_f32_16x16x32_bf16 v[48:51], v[192:195], a[8:11], v[148:151]
    ds_read_b64_tr_b16 v[214:215], v241 offset:4864
    v_mfma_f32_16x16x32_bf16 v[48:51], v[196:199], a[12:15], v[48:51]
    s_add_u32 s64, s87, 1048576
    v_mfma_f32_16x16x32_bf16 v[48:51], v[200:203], a[40:43], v[48:51]
    ds_read_b64_tr_b16 v[216:217], v241 offset:8448
    v_mfma_f32_16x16x32_bf16 v[48:51], v[204:207], a[44:47], v[48:51]
    ds_read_b64_tr_b16 v[218:219], v241 offset:8960
    v_mfma_f32_16x16x32_bf16 v[80:83], v[192:195], a[16:19], v[148:151]
    v_mfma_f32_16x16x32_bf16 v[80:83], v[196:199], a[20:23], v[80:83]
    ds_read_b64_tr_b16 v[220:221], v241 offset:12544
    v_mfma_f32_16x16x32_bf16 v[80:83], v[200:203], a[48:51], v[80:83]
    buffer_store_dwordx4 v[152:155], v255, s[4:7], s60 offen offset:3072 sc1
    v_mfma_f32_16x16x32_bf16 v[80:83], v[204:207], a[52:55], v[80:83]
    buffer_load_dwordx4 v242, s[16:19], s64 offen offset:0 lds
    v_mfma_f32_16x16x32_bf16 v[112:115], v[192:195], a[24:27], v[148:151]
    ds_read_b64_tr_b16 v[222:223], v241 offset:13056
    v_mfma_f32_16x16x32_bf16 v[112:115], v[196:199], a[28:31], v[112:115]
    v_mfma_f32_16x16x32_bf16 v[112:115], v[200:203], a[56:59], v[112:115]
    v_mfma_f32_16x16x32_bf16 v[112:115], v[204:207], a[60:63], v[112:115]
    s_waitcnt vmcnt(27) lgkmcnt(0)
    s_barrier
    v_mfma_f32_16x16x32_bf16 v[24:27], v[208:211], a[0:3], v[156:159]
    buffer_load_dwordx4 v243, s[16:19], s64 offen offset:1024 lds
    v_mfma_f32_16x16x32_bf16 v[24:27], v[212:215], a[4:7], v[24:27]
    ds_read_b64_tr_b16 v[192:193], v240 offset:16384
    ds_read_b64_tr_b16 v[194:195], v240 offset:16896
    v_mfma_f32_16x16x32_bf16 v[24:27], v[216:219], a[32:35], v[24:27]
    v_mfma_f32_16x16x32_bf16 v[24:27], v[220:223], a[36:39], v[24:27]
    ds_read_b64_tr_b16 v[196:197], v240 offset:20480
    v_mfma_f32_16x16x32_bf16 v[56:59], v[208:211], a[8:11], v[156:159]
    ds_read_b64_tr_b16 v[198:199], v240 offset:20992
    v_mfma_f32_16x16x32_bf16 v[56:59], v[212:215], a[12:15], v[56:59]
    buffer_load_dwordx4 v244, s[16:19], s64 offen offset:2048 lds
    v_mfma_f32_16x16x32_bf16 v[56:59], v[216:219], a[40:43], v[56:59]
    ds_read_b64_tr_b16 v[200:201], v240 offset:24576
    v_mfma_f32_16x16x32_bf16 v[56:59], v[220:223], a[44:47], v[56:59]
    ds_read_b64_tr_b16 v[202:203], v240 offset:25088
    v_mfma_f32_16x16x32_bf16 v[88:91], v[208:211], a[16:19], v[156:159]
    v_mfma_f32_16x16x32_bf16 v[88:91], v[212:215], a[20:23], v[88:91]
    ds_read_b64_tr_b16 v[204:205], v240 offset:28672
    v_mfma_f32_16x16x32_bf16 v[88:91], v[216:219], a[48:51], v[88:91]
    buffer_load_dwordx4 v245, s[16:19], s64 offen offset:3072 lds
    v_mfma_f32_16x16x32_bf16 v[88:91], v[220:223], a[52:55], v[88:91]
    ds_read_b64_tr_b16 v[206:207], v240 offset:29184
    v_mfma_f32_16x16x32_bf16 v[120:123], v[208:211], a[24:27], v[156:159]
    v_mfma_f32_16x16x32_bf16 v[120:123], v[212:215], a[28:31], v[120:123]
    v_mfma_f32_16x16x32_bf16 v[120:123], v[216:219], a[56:59], v[120:123]
    v_mfma_f32_16x16x32_bf16 v[120:123], v[220:223], a[60:63], v[120:123]
    s_waitcnt lgkmcnt(0)
    s_add_u32 s60, s88, 24576
L_q_start:
    v_mfma_f32_16x16x32_bf16 v[132:135], v[192:195], a[0:3], 0
    s_add_u32 m0, s68, 98304
    ds_read_b64_tr_b16 v[208:209], v241 offset:16384
    v_mfma_f32_16x16x32_bf16 v[132:135], v[196:199], a[4:7], v[132:135]
    buffer_store_dwordx4 v[160:163], v255, s[4:7], s60 offen offset:0 sc1
    v_mfma_f32_16x16x32_bf16 v[132:135], v[200:203], a[32:35], v[132:135]
    ds_read_b64_tr_b16 v[210:211], v241 offset:16896
    v_mfma_f32_16x16x32_bf16 v[132:135], v[204:207], a[36:39], v[132:135]
    ds_read_b64_tr_b16 v[212:213], v241 offset:20480
    v_mfma_f32_16x16x32_bf16 v[148:151], v[192:195], a[8:11], 0
    ds_read_b64_tr_b16 v[214:215], v241 offset:20992
    v_mfma_f32_16x16x32_bf16 v[148:151], v[196:199], a[12:15], v[148:151]
    v_mfma_f32_16x16x32_bf16 v[148:151], v[200:203], a[40:43], v[148:151]
    s_add_u32 s64, s85, 917504
    ds_read_b64_tr_b16 v[216:217], v241 offset:24576
    v_mfma_f32_16x16x32_bf16 v[148:151], v[204:207], a[44:47], v[148:151]
    ds_read_b64_tr_b16 v[218:219], v241 offset:25088
    v_mfma_f32_16x16x32_bf16 v[164:167], v[192:195], a[16:19], 0
    v_mfma_f32_16x16x32_bf16 v[164:167], v[196:199], a[20:23], v[164:167]
    ds_read_b64_tr_b16 v[220:221], v241 offset:28672
    v_mfma_f32_16x16x32_bf16 v[164:167], v[200:203], a[48:51], v[164:167]
    ds_read_b64_tr_b16 v[222:223], v241 offset:29184
    v_mfma_f32_16x16x32_bf16 v[164:167], v[204:207], a[52:55], v[164:167]
    v_mfma_f32_16x16x32_bf16 v[180:183], v[192:195], a[24:27], 0
    v_mfma_f32_16x16x32_bf16 v[180:183], v[196:199], a[28:31], v[180:183]
    buffer_load_dwordx4 v228, s[32:35], s64 offen offset:0 lds
    v_mfma_f32_16x16x32_bf16 v[180:183], v[200:203], a[56:59], v[180:183]
    v_mfma_f32_16x16x32_bf16 v[180:183], v[204:207], a[60:63], v[180:183]
    s_waitcnt lgkmcnt(0)
    v_mfma_f32_16x16x32_bf16 v[12:15], v[208:211], a[0:3], 0
    ds_read_b64_tr_b16 v[192:193], v240 offset:16640
    v_mfma_f32_16x16x32_bf16 v[12:15], v[212:215], a[4:7], v[12:15]
    s_waitcnt vmcnt(22)
    ds_read_b64_tr_b16 v[194:195], v240 offset:17152
    v_mfma_f32_16x16x32_bf16 v[12:15], v[216:219], a[32:35], v[12:15]
    ds_read_b128 a[128:131], v236 offset:32768
    v_mfma_f32_16x16x32_bf16 v[12:15], v[220:223], a[36:39], v[12:15]
    ds_read_b64_tr_b16 v[196:197], v240 offset:20736
    v_mfma_f32_16x16x32_bf16 v[44:47], v[208:211], a[8:11], 0
    buffer_load_dwordx4 v229, s[32:35], s64 offen offset:1024 lds
    v_mfma_f32_16x16x32_bf16 v[44:47], v[212:215], a[12:15], v[44:47]
    ds_read_b64_tr_b16 v[198:199], v240 offset:21248
    ds_read_b128 a[132:135], v237 offset:32768
    v_mfma_f32_16x16x32_bf16 v[44:47], v[216:219], a[40:43], v[44:47]
    ds_read_b64_tr_b16 v[200:201], v240 offset:24832
    v_mfma_f32_16x16x32_bf16 v[44:47], v[220:223], a[44:47], v[44:47]
    buffer_store_dwordx4 v[168:171], v255, s[4:7], s60 offen offset:1024 sc1
    v_mfma_f32_16x16x32_bf16 v[76:79], v[208:211], a[16:19], 0
    ds_read_b64_tr_b16 v[202:203], v240 offset:25344
    ds_read_b128 a[136:139], v236 offset:34816
    v_mfma_f32_16x16x32_bf16 v[76:79], v[212:215], a[20:23], v[76:79]
    ds_read_b64_tr_b16 v[204:205], v240 offset:28928
    v_mfma_f32_16x16x32_bf16 v[76:79], v[216:219], a[48:51], v[76:79]
    ds_read_b64_tr_b16 v[206:207], v240 offset:29440
    v_mfma_f32_16x16x32_bf16 v[76:79], v[220:223], a[52:55], v[76:79]
    buffer_load_dwordx4 v230, s[32:35], s64 offen offset:2048 lds
    v_mfma_f32_16x16x32_bf16 v[108:111], v[208:211], a[24:27], 0
    ds_read_b128 a[140:143], v237 offset:34816
    v_mfma_f32_16x16x32_bf16 v[108:111], v[212:215], a[28:31], v[108:111]
    v_mfma_f32_16x16x32_bf16 v[108:111], v[216:219], a[56:59], v[108:111]
    ds_read_b128 a[144:147], v236 offset:36864
    v_mfma_f32_16x16x32_bf16 v[108:111], v[220:223], a[60:63], v[108:111]
    s_waitcnt lgkmcnt(0)
    v_mfma_f32_16x16x32_bf16 v[140:143], v[192:195], a[0:3], 0
    ds_read_b64_tr_b16 v[208:209], v241 offset:16640
    v_mfma_f32_16x16x32_bf16 v[140:143], v[196:199], a[4:7], v[140:143]
    ds_read_b128 a[148:151], v237 offset:36864
    ds_read_b64_tr_b16 v[210:211], v241 offset:17152
    v_mfma_f32_16x16x32_bf16 v[140:143], v[200:203], a[32:35], v[140:143]
    buffer_load_dwordx4 v231, s[32:35], s64 offen offset:3072 lds
    v_mfma_f32_16x16x32_bf16 v[140:143], v[204:207], a[36:39], v[140:143]
    ds_read_b64_tr_b16 v[212:213], v241 offset:20736
    v_mfma_f32_16x16x32_bf16 v[156:159], v[192:195], a[8:11], 0
    ds_read_b128 a[152:155], v236 offset:38912
    ds_read_b64_tr_b16 v[214:215], v241 offset:21248
    v_mfma_f32_16x16x32_bf16 v[156:159], v[196:199], a[12:15], v[156:159]
    v_mfma_f32_16x16x32_bf16 v[156:159], v[200:203], a[40:43], v[156:159]
    ds_read_b64_tr_b16 v[216:217], v241 offset:24832
    v_mfma_f32_16x16x32_bf16 v[156:159], v[204:207], a[44:47], v[156:159]
    ds_read_b128 a[156:159], v237 offset:38912
    ds_read_b64_tr_b16 v[218:219], v241 offset:25344
    v_mfma_f32_16x16x32_bf16 v[172:175], v[192:195], a[16:19], 0
    v_mfma_f32_16x16x32_bf16 v[172:175], v[196:199], a[20:23], v[172:175]
    ds_read_b64_tr_b16 v[220:221], v241 offset:28928
    v_mfma_f32_16x16x32_bf16 v[172:175], v[200:203], a[48:51], v[172:175]
    ds_read_b64_tr_b16 v[222:223], v241 offset:29440
    v_mfma_f32_16x16x32_bf16 v[172:175], v[204:207], a[52:55], v[172:175]
    v_mfma_f32_16x16x32_bf16 v[188:191], v[192:195], a[24:27], 0
    buffer_store_dwordx4 v[176:179], v255, s[4:7], s60 offen offset:2048 sc1
    v_mfma_f32_16x16x32_bf16 v[188:191], v[196:199], a[28:31], v[188:191]
    v_mfma_f32_16x16x32_bf16 v[188:191], v[200:203], a[56:59], v[188:191]
    v_mfma_f32_16x16x32_bf16 v[188:191], v[204:207], a[60:63], v[188:191]
    s_waitcnt vmcnt(22) lgkmcnt(0)
    s_barrier
    v_mfma_f32_16x16x32_bf16 v[28:31], v[208:211], a[0:3], 0
    ds_read_b64_tr_b16 v[192:193], v240 offset:32768
    v_mfma_f32_16x16x32_bf16 v[28:31], v[212:215], a[4:7], v[28:31]
    ds_read_b64_tr_b16 v[194:195], v240 offset:33280
    v_mfma_f32_16x16x32_bf16 v[28:31], v[216:219], a[32:35], v[28:31]
    v_mfma_f32_16x16x32_bf16 v[28:31], v[220:223], a[36:39], v[28:31]
    ds_read_b64_tr_b16 v[196:197], v240 offset:36864
    v_mfma_f32_16x16x32_bf16 v[60:63], v[208:211], a[8:11], 0
    ds_read_b64_tr_b16 v[198:199], v240 offset:37376
    v_mfma_f32_16x16x32_bf16 v[60:63], v[212:215], a[12:15], v[60:63]
    v_mfma_f32_16x16x32_bf16 v[60:63], v[216:219], a[40:43], v[60:63]
    ds_read_b64_tr_b16 v[200:201], v240 offset:40960
    v_mfma_f32_16x16x32_bf16 v[60:63], v[220:223], a[44:47], v[60:63]
    ds_read_b64_tr_b16 v[202:203], v240 offset:41472
    v_mfma_f32_16x16x32_bf16 v[92:95], v[208:211], a[16:19], 0
    v_mfma_f32_16x16x32_bf16 v[92:95], v[212:215], a[20:23], v[92:95]
    ds_read_b64_tr_b16 v[204:205], v240 offset:45056
    v_mfma_f32_16x16x32_bf16 v[92:95], v[216:219], a[48:51], v[92:95]
    ds_read_b64_tr_b16 v[206:207], v240 offset:45568
    v_mfma_f32_16x16x32_bf16 v[92:95], v[220:223], a[52:55], v[92:95]
    v_mfma_f32_16x16x32_bf16 v[124:127], v[208:211], a[24:27], 0
    v_mfma_f32_16x16x32_bf16 v[124:127], v[212:215], a[28:31], v[124:127]
    v_mfma_f32_16x16x32_bf16 v[124:127], v[216:219], a[56:59], v[124:127]
    v_mfma_f32_16x16x32_bf16 v[124:127], v[220:223], a[60:63], v[124:127]
    s_waitcnt lgkmcnt(0)
    v_mfma_f32_16x16x32_bf16 v[0:3], v[192:195], a[64:67], v[0:3]
    s_add_u32 m0, s86, 0
    ds_read_b64_tr_b16 v[208:209], v241 offset:32768
    v_mfma_f32_16x16x32_bf16 v[0:3], v[196:199], a[68:71], v[0:3]
    ds_read_b64_tr_b16 v[210:211], v241 offset:33280
    v_mfma_f32_16x16x32_bf16 v[0:3], v[200:203], a[96:99], v[0:3]
    buffer_store_dwordx4 v[184:187], v255, s[4:7], s60 offen offset:3072 sc1
    v_mfma_f32_16x16x32_bf16 v[0:3], v[204:207], a[100:103], v[0:3]
    s_add_u32 s64, s84, 768
    ds_read_b64_tr_b16 v[212:213], v241 offset:36864
    v_mfma_f32_16x16x32_bf16 v[32:35], v[192:195], a[72:75], v[32:35]
    ds_read_b64_tr_b16 v[214:215], v241 offset:37376
    v_mfma_f32_16x16x32_bf16 v[32:35], v[196:199], a[76:79], v[32:35]
    buffer_load_dwordx4 v232, s[4:7], s64 offen offset:0 sc1 lds
    v_mfma_f32_16x16x32_bf16 v[32:35], v[200:203], a[104:107], v[32:35]
    ds_read_b64_tr_b16 v[216:217], v241 offset:40960
    v_mfma_f32_16x16x32_bf16 v[32:35], v[204:207], a[108:111], v[32:35]
    ds_read_b64_tr_b16 v[218:219], v241 offset:41472
    v_mfma_f32_16x16x32_bf16 v[64:67], v[192:195], a[80:83], v[64:67]
    buffer_load_dwordx4 v233, s[4:7], s64 offen offset:1024 sc1 lds
    v_mfma_f32_16x16x32_bf16 v[64:67], v[196:199], a[84:87], v[64:67]
    ds_read_b64_tr_b16 v[220:221], v241 offset:45056
    v_mfma_f32_16x16x32_bf16 v[64:67], v[200:203], a[112:115], v[64:67]
    buffer_load_dwordx4 v234, s[4:7], s64 offen offset:2048 sc1 lds
    v_mfma_f32_16x16x32_bf16 v[64:67], v[204:207], a[116:119], v[64:67]
    ds_read_b64_tr_b16 v[222:223], v241 offset:45568
    v_mfma_f32_16x16x32_bf16 v[96:99], v[192:195], a[88:91], v[96:99]
    buffer_load_dwordx4 v235, s[4:7], s64 offen offset:3072 sc1 lds
    v_mfma_f32_16x16x32_bf16 v[96:99], v[196:199], a[92:95], v[96:99]
    v_mfma_f32_16x16x32_bf16 v[96:99], v[200:203], a[120:123], v[96:99]
    v_add_u32 v236, 65536, v236
    v_mfma_f32_16x16x32_bf16 v[96:99], v[204:207], a[124:127], v[96:99]
    s_waitcnt lgkmcnt(0)
    s_add_u32 m0, s86, 4096
    v_add_u32 v237, 65536, v237
    v_mfma_f32_16x16x32_bf16 v[8:11], v[208:211], a[64:67], v[8:11]
    ds_read_b64_tr_b16 v[192:193], v240 offset:33024
    v_mfma_f32_16x16x32_bf16 v[8:11], v[212:215], a[68:71], v[8:11]
    s_waitcnt vmcnt(17)
    s_add_u32 s64, s84, 33536
    ds_read_b64_tr_b16 v[194:195], v240 offset:33536
    v_mfma_f32_16x16x32_bf16 v[8:11], v[216:219], a[96:99], v[8:11]
    ds_read_b128 a[160:163], v236 offset:0
    v_mfma_f32_16x16x32_bf16 v[8:11], v[220:223], a[100:103], v[8:11]
    ds_read_b64_tr_b16 v[196:197], v240 offset:37120
    v_mfma_f32_16x16x32_bf16 v[40:43], v[208:211], a[72:75], v[40:43]
    buffer_load_dwordx4 v232, s[4:7], s64 offen offset:0 sc1 lds
    v_mfma_f32_16x16x32_bf16 v[40:43], v[212:215], a[76:79], v[40:43]
    ds_read_b64_tr_b16 v[198:199], v240 offset:37632
    ds_read_b128 a[164:167], v237 offset:0
    v_mfma_f32_16x16x32_bf16 v[40:43], v[216:219], a[104:107], v[40:43]
    ds_read_b64_tr_b16 v[200:201], v240 offset:41216
    v_mfma_f32_16x16x32_bf16 v[40:43], v[220:223], a[108:111], v[40:43]
    buffer_load_dwordx4 v233, s[4:7], s64 offen offset:1024 sc1 lds
    v_mfma_f32_16x16x32_bf16 v[72:75], v[208:211], a[80:83], v[72:75]
    s_add_u32 s60, s88, 12288
    ds_read_b64_tr_b16 v[202:203], v240 offset:41728
    ds_read_b128 a[168:171], v236 offset:2048
    v_mfma_f32_16x16x32_bf16 v[72:75], v[212:215], a[84:87], v[72:75]
    buffer_store_dwordx4 v[4:7], v255, s[4:7], s60 offen offset:0 sc1
    v_mfma_f32_16x16x32_bf16 v[72:75], v[216:219], a[112:115], v[72:75]
    ds_read_b64_tr_b16 v[204:205], v240 offset:45312
    ds_read_b64_tr_b16 v[206:207], v240 offset:45824
    v_mfma_f32_16x16x32_bf16 v[72:75], v[220:223], a[116:119], v[72:75]
    buffer_load_dwordx4 v234, s[4:7], s64 offen offset:2048 sc1 lds
    v_mfma_f32_16x16x32_bf16 v[104:107], v[208:211], a[88:91], v[104:107]
    ds_read_b128 a[172:175], v237 offset:2048
    v_mfma_f32_16x16x32_bf16 v[104:107], v[212:215], a[92:95], v[104:107]
    buffer_load_dwordx4 v235, s[4:7], s64 offen offset:3072 sc1 lds
    v_mfma_f32_16x16x32_bf16 v[104:107], v[216:219], a[120:123], v[104:107]
    ds_read_b128 a[176:179], v236 offset:4096
    v_mfma_f32_16x16x32_bf16 v[104:107], v[220:223], a[124:127], v[104:107]
    s_waitcnt lgkmcnt(0)
    v_mfma_f32_16x16x32_bf16 v[16:19], v[192:195], a[64:67], v[16:19]
    s_add_u32 m0, s68, 114688
    ds_read_b64_tr_b16 v[208:209], v241 offset:33024
    v_mfma_f32_16x16x32_bf16 v[16:19], v[196:199], a[68:71], v[16:19]
    ds_read_b128 a[180:183], v237 offset:4096
    ds_read_b64_tr_b16 v[210:211], v241 offset:33536
    v_mfma_f32_16x16x32_bf16 v[16:19], v[200:203], a[96:99], v[16:19]
    v_mfma_f32_16x16x32_bf16 v[16:19], v[204:207], a[100:103], v[16:19]
    ds_read_b64_tr_b16 v[212:213], v241 offset:37120
    v_mfma_f32_16x16x32_bf16 v[48:51], v[192:195], a[72:75], v[48:51]
    ds_read_b128 a[184:187], v236 offset:6144
    ds_read_b64_tr_b16 v[214:215], v241 offset:37632
    v_mfma_f32_16x16x32_bf16 v[48:51], v[196:199], a[76:79], v[48:51]
    s_add_u32 s64, s87, 2097152
    v_mfma_f32_16x16x32_bf16 v[48:51], v[200:203], a[104:107], v[48:51]
    ds_read_b64_tr_b16 v[216:217], v241 offset:41216
    v_mfma_f32_16x16x32_bf16 v[48:51], v[204:207], a[108:111], v[48:51]
    ds_read_b128 a[188:191], v237 offset:6144
    ds_read_b64_tr_b16 v[218:219], v241 offset:41728
    v_mfma_f32_16x16x32_bf16 v[80:83], v[192:195], a[80:83], v[80:83]
    v_mfma_f32_16x16x32_bf16 v[80:83], v[196:199], a[84:87], v[80:83]
    ds_read_b64_tr_b16 v[220:221], v241 offset:45312
    v_mfma_f32_16x16x32_bf16 v[80:83], v[200:203], a[112:115], v[80:83]
    buffer_load_dwordx4 v242, s[16:19], s64 offen offset:0 lds
    v_mfma_f32_16x16x32_bf16 v[80:83], v[204:207], a[116:119], v[80:83]
    ds_read_b64_tr_b16 v[222:223], v241 offset:45824
    v_mfma_f32_16x16x32_bf16 v[112:115], v[192:195], a[88:91], v[112:115]
    v_mfma_f32_16x16x32_bf16 v[112:115], v[196:199], a[92:95], v[112:115]
    v_mfma_f32_16x16x32_bf16 v[112:115], v[200:203], a[120:123], v[112:115]
    buffer_store_dwordx4 v[20:23], v255, s[4:7], s60 offen offset:1024 sc1
    v_mfma_f32_16x16x32_bf16 v[112:115], v[204:207], a[124:127], v[112:115]
    s_waitcnt vmcnt(19) lgkmcnt(0)
    s_barrier
    v_mfma_f32_16x16x32_bf16 v[24:27], v[208:211], a[64:67], v[24:27]
    buffer_load_dwordx4 v243, s[16:19], s64 offen offset:1024 lds
    v_mfma_f32_16x16x32_bf16 v[24:27], v[212:215], a[68:71], v[24:27]
    ds_read_b64_tr_b16 v[192:193], v240 offset:49152
    ds_read_b64_tr_b16 v[194:195], v240 offset:49664
    v_mfma_f32_16x16x32_bf16 v[24:27], v[216:219], a[96:99], v[24:27]
    v_mfma_f32_16x16x32_bf16 v[24:27], v[220:223], a[100:103], v[24:27]
    ds_read_b64_tr_b16 v[196:197], v240 offset:53248
    v_mfma_f32_16x16x32_bf16 v[56:59], v[208:211], a[72:75], v[56:59]
    ds_read_b64_tr_b16 v[198:199], v240 offset:53760
    v_mfma_f32_16x16x32_bf16 v[56:59], v[212:215], a[76:79], v[56:59]
    buffer_load_dwordx4 v244, s[16:19], s64 offen offset:2048 lds
    v_mfma_f32_16x16x32_bf16 v[56:59], v[216:219], a[104:107], v[56:59]
    ds_read_b64_tr_b16 v[200:201], v240 offset:57344
    v_mfma_f32_16x16x32_bf16 v[56:59], v[220:223], a[108:111], v[56:59]
    ds_read_b64_tr_b16 v[202:203], v240 offset:57856
    v_mfma_f32_16x16x32_bf16 v[88:91], v[208:211], a[80:83], v[88:91]
    v_mfma_f32_16x16x32_bf16 v[88:91], v[212:215], a[84:87], v[88:91]
    ds_read_b64_tr_b16 v[204:205], v240 offset:61440
    v_mfma_f32_16x16x32_bf16 v[88:91], v[216:219], a[112:115], v[88:91]
    buffer_load_dwordx4 v245, s[16:19], s64 offen offset:3072 lds
    v_mfma_f32_16x16x32_bf16 v[88:91], v[220:223], a[116:119], v[88:91]
    ds_read_b64_tr_b16 v[206:207], v240 offset:61952
    v_mfma_f32_16x16x32_bf16 v[120:123], v[208:211], a[88:91], v[120:123]
    v_mfma_f32_16x16x32_bf16 v[120:123], v[212:215], a[92:95], v[120:123]
    v_mfma_f32_16x16x32_bf16 v[120:123], v[216:219], a[120:123], v[120:123]
    v_mfma_f32_16x16x32_bf16 v[120:123], v[220:223], a[124:127], v[120:123]
    s_waitcnt lgkmcnt(0)
    v_mfma_f32_16x16x32_bf16 v[132:135], v[192:195], a[64:67], v[132:135]
    s_add_u32 m0, s86, 32768
    ds_read_b64_tr_b16 v[208:209], v241 offset:49152
    v_mfma_f32_16x16x32_bf16 v[132:135], v[196:199], a[68:71], v[132:135]
    ds_read_b64_tr_b16 v[210:211], v241 offset:49664
    v_mfma_f32_16x16x32_bf16 v[132:135], v[200:203], a[96:99], v[132:135]
    s_add_u32 s64, s84, 896
    v_mfma_f32_16x16x32_bf16 v[132:135], v[204:207], a[100:103], v[132:135]
    ds_read_b64_tr_b16 v[212:213], v241 offset:53248
    v_mfma_f32_16x16x32_bf16 v[148:151], v[192:195], a[72:75], v[148:151]
    buffer_store_dwordx4 v[36:39], v255, s[4:7], s60 offen offset:2048 sc1
    v_mfma_f32_16x16x32_bf16 v[148:151], v[196:199], a[76:79], v[148:151]
    ds_read_b64_tr_b16 v[214:215], v241 offset:53760
    v_mfma_f32_16x16x32_bf16 v[148:151], v[200:203], a[104:107], v[148:151]
    buffer_load_dwordx4 v232, s[4:7], s64 offen offset:0 sc1 lds
    v_mfma_f32_16x16x32_bf16 v[148:151], v[204:207], a[108:111], v[148:151]
    ds_read_b64_tr_b16 v[216:217], v241 offset:57344
    ds_read_b64_tr_b16 v[218:219], v241 offset:57856
    v_mfma_f32_16x16x32_bf16 v[164:167], v[192:195], a[80:83], v[164:167]
    buffer_load_dwordx4 v233, s[4:7], s64 offen offset:1024 sc1 lds
    v_mfma_f32_16x16x32_bf16 v[164:167], v[196:199], a[84:87], v[164:167]
    ds_read_b64_tr_b16 v[220:221], v241 offset:61440
    v_mfma_f32_16x16x32_bf16 v[164:167], v[200:203], a[112:115], v[164:167]
    buffer_load_dwordx4 v234, s[4:7], s64 offen offset:2048 sc1 lds
    v_mfma_f32_16x16x32_bf16 v[164:167], v[204:207], a[116:119], v[164:167]
    ds_read_b64_tr_b16 v[222:223], v241 offset:61952
    v_mfma_f32_16x16x32_bf16 v[180:183], v[192:195], a[88:91], v[180:183]
    buffer_load_dwordx4 v235, s[4:7], s64 offen offset:3072 sc1 lds
    v_mfma_f32_16x16x32_bf16 v[180:183], v[196:199], a[92:95], v[180:183]
    v_mfma_f32_16x16x32_bf16 v[180:183], v[200:203], a[120:123], v[180:183]
    v_mfma_f32_16x16x32_bf16 v[180:183], v[204:207], a[124:127], v[180:183]
    s_waitcnt lgkmcnt(0)
    s_add_u32 m0, s86, 36864
    v_mfma_f32_16x16x32_bf16 v[12:15], v[208:211], a[64:67], v[12:15]
    ds_read_b64_tr_b16 v[192:193], v240 offset:49408
    v_mfma_f32_16x16x32_bf16 v[12:15], v[212:215], a[68:71], v[12:15]
    s_add_u32 s64, s84, 33664
    ds_read_b64_tr_b16 v[194:195], v240 offset:49920
    v_mfma_f32_16x16x32_bf16 v[12:15], v[216:219], a[96:99], v[12:15]
    v_mfma_f32_16x16x32_bf16 v[12:15], v[220:223], a[100:103], v[12:15]
    ds_read_b64_tr_b16 v[196:197], v240 offset:53504
    v_mfma_f32_16x16x32_bf16 v[44:47], v[208:211], a[72:75], v[44:47]
    buffer_load_dwordx4 v232, s[4:7], s64 offen offset:0 sc1 lds
    v_mfma_f32_16x16x32_bf16 v[44:47], v[212:215], a[76:79], v[44:47]
    ds_read_b64_tr_b16 v[198:199], v240 offset:54016
    v_mfma_f32_16x16x32_bf16 v[44:47], v[216:219], a[104:107], v[44:47]
    ds_read_b64_tr_b16 v[200:201], v240 offset:57600
    v_mfma_f32_16x16x32_bf16 v[44:47], v[220:223], a[108:111], v[44:47]
    buffer_load_dwordx4 v233, s[4:7], s64 offen offset:1024 sc1 lds
    v_mfma_f32_16x16x32_bf16 v[76:79], v[208:211], a[80:83], v[76:79]
    ds_read_b64_tr_b16 v[202:203], v240 offset:58112
    v_mfma_f32_16x16x32_bf16 v[76:79], v[212:215], a[84:87], v[76:79]
    ds_read_b64_tr_b16 v[204:205], v240 offset:61696
    v_mfma_f32_16x16x32_bf16 v[76:79], v[216:219], a[112:115], v[76:79]
    buffer_load_dwordx4 v234, s[4:7], s64 offen offset:2048 sc1 lds
    v_mfma_f32_16x16x32_bf16 v[76:79], v[220:223], a[116:119], v[76:79]
    buffer_store_dwordx4 v[52:55], v255, s[4:7], s60 offen offset:3072 sc1
    v_mfma_f32_16x16x32_bf16 v[108:111], v[208:211], a[88:91], v[108:111]
    ds_read_b64_tr_b16 v[206:207], v240 offset:62208
    v_mfma_f32_16x16x32_bf16 v[108:111], v[212:215], a[92:95], v[108:111]
    buffer_load_dwordx4 v235, s[4:7], s64 offen offset:3072 sc1 lds
    v_mfma_f32_16x16x32_bf16 v[108:111], v[216:219], a[120:123], v[108:111]
    v_mfma_f32_16x16x32_bf16 v[108:111], v[220:223], a[124:127], v[108:111]
    s_waitcnt lgkmcnt(0)
    v_mfma_f32_16x16x32_bf16 v[140:143], v[192:195], a[64:67], v[140:143]
    s_add_u32 m0, s68, 131072
    ds_read_b64_tr_b16 v[208:209], v241 offset:49408
    v_mfma_f32_16x16x32_bf16 v[140:143], v[196:199], a[68:71], v[140:143]
    ds_read_b64_tr_b16 v[210:211], v241 offset:49920
    v_mfma_f32_16x16x32_bf16 v[140:143], v[200:203], a[96:99], v[140:143]
    v_mfma_f32_16x16x32_bf16 v[140:143], v[204:207], a[100:103], v[140:143]
    ds_read_b64_tr_b16 v[212:213], v241 offset:53504
    v_mfma_f32_16x16x32_bf16 v[156:159], v[192:195], a[72:75], v[156:159]
    ds_read_b64_tr_b16 v[214:215], v241 offset:54016
    v_mfma_f32_16x16x32_bf16 v[156:159], v[196:199], a[76:79], v[156:159]
    s_add_u32 s64, s85, 1376256
    v_mfma_f32_16x16x32_bf16 v[156:159], v[200:203], a[104:107], v[156:159]
    ds_read_b64_tr_b16 v[216:217], v241 offset:57600
    v_mfma_f32_16x16x32_bf16 v[156:159], v[204:207], a[108:111], v[156:159]
    ds_read_b64_tr_b16 v[218:219], v241 offset:58112
    v_mfma_f32_16x16x32_bf16 v[172:175], v[192:195], a[80:83], v[172:175]
    v_mfma_f32_16x16x32_bf16 v[172:175], v[196:199], a[84:87], v[172:175]
    ds_read_b64_tr_b16 v[220:221], v241 offset:61696
    v_mfma_f32_16x16x32_bf16 v[172:175], v[200:203], a[112:115], v[172:175]
    buffer_load_dwordx4 v228, s[32:35], s64 offen offset:0 lds
    v_mfma_f32_16x16x32_bf16 v[172:175], v[204:207], a[116:119], v[172:175]
    ds_read_b64_tr_b16 v[222:223], v241 offset:62208
    v_mfma_f32_16x16x32_bf16 v[188:191], v[192:195], a[88:91], v[188:191]
    v_mfma_f32_16x16x32_bf16 v[188:191], v[196:199], a[92:95], v[188:191]
    v_mfma_f32_16x16x32_bf16 v[188:191], v[200:203], a[120:123], v[188:191]
    v_mfma_f32_16x16x32_bf16 v[188:191], v[204:207], a[124:127], v[188:191]
    s_waitcnt vmcnt(27) lgkmcnt(0)
    s_barrier
    v_mfma_f32_16x16x32_bf16 v[28:31], v[208:211], a[64:67], v[28:31]
    s_add_u32 s60, s88, 28672
    ds_read_b64_tr_b16 v[192:193], v240 offset:0
    v_mfma_f32_16x16x32_bf16 v[28:31], v[212:215], a[68:71], v[28:31]
    buffer_load_dwordx4 v229, s[32:35], s64 offen offset:1024 lds
    v_mfma_f32_16x16x32_bf16 v[28:31], v[216:219], a[96:99], v[28:31]
    buffer_store_dwordx4 v[68:71], v255, s[4:7], s60 offen offset:0 sc1
    v_mfma_f32_16x16x32_bf16 v[28:31], v[220:223], a[100:103], v[28:31]
    ds_read_b64_tr_b16 v[194:195], v240 offset:512
    ds_read_b64_tr_b16 v[196:197], v240 offset:4096
    v_mfma_f32_16x16x32_bf16 v[60:63], v[208:211], a[72:75], v[60:63]
    ds_read_b64_tr_b16 v[198:199], v240 offset:4608
    v_mfma_f32_16x16x32_bf16 v[60:63], v[212:215], a[76:79], v[60:63]
    buffer_load_dwordx4 v230, s[32:35], s64 offen offset:2048 lds
    v_mfma_f32_16x16x32_bf16 v[60:63], v[216:219], a[104:107], v[60:63]
    ds_read_b64_tr_b16 v[200:201], v240 offset:8192
    v_mfma_f32_16x16x32_bf16 v[60:63], v[220:223], a[108:111], v[60:63]
    ds_read_b64_tr_b16 v[202:203], v240 offset:8704
    v_mfma_f32_16x16x32_bf16 v[92:95], v[208:211], a[80:83], v[92:95]
    v_mfma_f32_16x16x32_bf16 v[92:95], v[212:215], a[84:87], v[92:95]
    ds_read_b64_tr_b16 v[204:205], v240 offset:12288
    v_mfma_f32_16x16x32_bf16 v[92:95], v[216:219], a[112:115], v[92:95]
    buffer_load_dwordx4 v231, s[32:35], s64 offen offset:3072 lds
    v_mfma_f32_16x16x32_bf16 v[92:95], v[220:223], a[116:119], v[92:95]
    ds_read_b64_tr_b16 v[206:207], v240 offset:12800
    v_mfma_f32_16x16x32_bf16 v[124:127], v[208:211], a[88:91], v[124:127]
    v_mfma_f32_16x16x32_bf16 v[124:127], v[212:215], a[92:95], v[124:127]
    v_mfma_f32_16x16x32_bf16 v[124:127], v[216:219], a[120:123], v[124:127]
    v_mfma_f32_16x16x32_bf16 v[124:127], v[220:223], a[124:127], v[124:127]
    s_waitcnt lgkmcnt(0)
    v_mfma_f32_16x16x32_bf16 v[0:3], v[192:195], a[128:131], v[0:3]
    s_add_u32 m0, s68, 147456
    s_bfe_u32 s91, s2, 0x30003
    ds_read_b64_tr_b16 v[208:209], v241 offset:0
    v_mfma_f32_16x16x32_bf16 v[0:3], v[196:199], a[132:135], v[0:3]
    ds_read_b64_tr_b16 v[210:211], v241 offset:512
    v_mfma_f32_16x16x32_bf16 v[0:3], v[200:203], a[160:163], v[0:3]
    s_and_b32 s3, s2, 1
    v_mfma_f32_16x16x32_bf16 v[0:3], v[204:207], a[164:167], v[0:3]
    ds_read_b64_tr_b16 v[212:213], v241 offset:4096
    v_mfma_f32_16x16x32_bf16 v[32:35], v[192:195], a[136:139], v[32:35]
    s_getpc_b64 s[0:1]
L_pf2:
    s_add_u32 s0, s0, L_st_late-L_pf2
    s_addc_u32 s1, s1, 0
    s_bfe_u32 s89, s2, 0x50003
    s_lshl_b32 s89, s89, 2
    s_add_u32 s89, s89, s56
    s_lshl_b32 s89, s89, 13
    v_lshl_add_u32 v246, v254, 7, s89
    v_min_u32 v246, L_code_end-L_st_late-4, v246
    v_mov_b32 v247, s1
    v_add_co_u32 v246, vcc, s0, v246
    s_nop 1
    v_addc_co_u32 v247, vcc, 0, v247, vcc
    v_mfma_f32_16x16x32_bf16 v[32:35], v[196:199], a[140:143], v[32:35]
    s_lshl_b32 s3, s3, 3
    ds_read_b64_tr_b16 v[214:215], v241 offset:4608
    v_mfma_f32_16x16x32_bf16 v[32:35], v[200:203], a[168:171], v[32:35]
    global_load_dword v248, v[246:247], off
    v_mfma_f32_16x16x32_bf16 v[32:35], v[204:207], a[172:175], v[32:35]
    s_add_u32 s64, s87, 3145728
    s_add_u32 s91, s91, s3
    ds_read_b64_tr_b16 v[216:217], v241 offset:8192
    v_mfma_f32_16x16x32_bf16 v[64:67], v[192:195], a[144:147], v[64:67]
    buffer_store_dwordx4 v[84:87], v255, s[4:7], s60 offen offset:1024 sc1
    v_mfma_f32_16x16x32_bf16 v[64:67], v[196:199], a[148:151], v[64:67]
    s_lshl_b32 s91, s91, 2
    ds_read_b64_tr_b16 v[218:219], v241 offset:8704
    ds_read_b64_tr_b16 v[220:221], v241 offset:12288
    v_mfma_f32_16x16x32_bf16 v[64:67], v[200:203], a[176:179], v[64:67]
    ds_read_b64_tr_b16 v[222:223], v241 offset:12800
    v_mfma_f32_16x16x32_bf16 v[64:67], v[204:207], a[180:183], v[64:67]
    s_lshr_b32 s3, s2, 6
    v_mfma_f32_16x16x32_bf16 v[96:99], v[192:195], a[152:155], v[96:99]
    v_mfma_f32_16x16x32_bf16 v[96:99], v[196:199], a[156:159], v[96:99]
    buffer_load_dwordx4 v242, s[16:19], s64 offen offset:0 lds
    v_mfma_f32_16x16x32_bf16 v[96:99], v[200:203], a[184:187], v[96:99]
    s_add_u32 s91, s91, s3
    v_subrev_u32 v236, 65536, v236
    v_mfma_f32_16x16x32_bf16 v[96:99], v[204:207], a[188:191], v[96:99]
    s_waitcnt lgkmcnt(0)
    v_subrev_u32 v237, 65536, v237
    v_mfma_f32_16x16x32_bf16 v[8:11], v[208:211], a[128:131], v[8:11]
    s_lshl_b32 s91, s91, 2
    ds_read_b64_tr_b16 v[192:193], v240 offset:256
    v_mfma_f32_16x16x32_bf16 v[8:11], v[212:215], a[132:135], v[8:11]
    s_waitcnt vmcnt(23)
    ds_read_b64_tr_b16 v[194:195], v240 offset:768
    v_mfma_f32_16x16x32_bf16 v[8:11], v[216:219], a[160:163], v[8:11]
    s_add_u32 s91, s91, s56
    ds_read_b128 a[192:195], v236 offset:0
    v_mfma_f32_16x16x32_bf16 v[8:11], v[220:223], a[164:167], v[8:11]
    ds_read_b64_tr_b16 v[196:197], v240 offset:4352
    v_mfma_f32_16x16x32_bf16 v[40:43], v[208:211], a[136:139], v[40:43]
    buffer_load_dwordx4 v243, s[16:19], s64 offen offset:1024 lds
    v_mfma_f32_16x16x32_bf16 v[40:43], v[212:215], a[140:143], v[40:43]
    s_lshl_b32 s91, s91, 3
    ds_read_b64_tr_b16 v[198:199], v240 offset:4864
    ds_read_b128 a[196:199], v237 offset:0
    v_mfma_f32_16x16x32_bf16 v[40:43], v[216:219], a[168:171], v[40:43]
    ds_read_b64_tr_b16 v[200:201], v240 offset:8448
    v_mfma_f32_16x16x32_bf16 v[40:43], v[220:223], a[172:175], v[40:43]
    s_bfe_u32 s3, s2, 0x20001
    ds_read_b64_tr_b16 v[202:203], v240 offset:8960
    v_mfma_f32_16x16x32_bf16 v[72:75], v[208:211], a[144:147], v[72:75]
    ds_read_b128 a[200:203], v236 offset:2048
    v_mfma_f32_16x16x32_bf16 v[72:75], v[212:215], a[148:151], v[72:75]
    s_add_u32 s91, s91, s3
    ds_read_b64_tr_b16 v[204:205], v240 offset:12544
    v_mfma_f32_16x16x32_bf16 v[72:75], v[216:219], a[176:179], v[72:75]
    ds_read_b64_tr_b16 v[206:207], v240 offset:13056
    v_mfma_f32_16x16x32_bf16 v[72:75], v[220:223], a[180:183], v[72:75]
    buffer_load_dwordx4 v244, s[16:19], s64 offen offset:2048 lds
    v_mfma_f32_16x16x32_bf16 v[104:107], v[208:211], a[152:155], v[104:107]
    s_lshl_b32 s91, s91, 13
    ds_read_b128 a[204:207], v237 offset:2048
    v_mfma_f32_16x16x32_bf16 v[104:107], v[212:215], a[156:159], v[104:107]
    buffer_store_dwordx4 v[100:103], v255, s[4:7], s60 offen offset:2048 sc1
    v_mfma_f32_16x16x32_bf16 v[104:107], v[216:219], a[184:187], v[104:107]
    s_add_u32 s91, s91, 62914560
    ds_read_b128 a[208:211], v236 offset:4096
    v_mfma_f32_16x16x32_bf16 v[104:107], v[220:223], a[188:191], v[104:107]
    s_waitcnt lgkmcnt(0)
    v_mfma_f32_16x16x32_bf16 v[16:19], v[192:195], a[128:131], v[16:19]
    s_cmp_eq_u32 s3, s56
    s_cselect_b32 s14, 0, 8192
    ds_read_b64_tr_b16 v[208:209], v241 offset:256
    v_mfma_f32_16x16x32_bf16 v[16:19], v[196:199], a[132:135], v[16:19]
    ds_read_b128 a[212:215], v237 offset:4096
    ds_read_b64_tr_b16 v[210:211], v241 offset:768
    v_mfma_f32_16x16x32_bf16 v[16:19], v[200:203], a[160:163], v[16:19]
    buffer_load_dwordx4 v245, s[16:19], s64 offen offset:3072 lds
    v_mfma_f32_16x16x32_bf16 v[16:19], v[204:207], a[164:167], v[16:19]
    s_add_u32 s12, s4, s91
    s_addc_u32 s13, s5, 0
    ds_read_b64_tr_b16 v[212:213], v241 offset:4352
    v_mfma_f32_16x16x32_bf16 v[48:51], v[192:195], a[136:139], v[48:51]
    ds_read_b128 a[216:219], v236 offset:6144
    ds_read_b64_tr_b16 v[214:215], v241 offset:4864
    v_mfma_f32_16x16x32_bf16 v[48:51], v[196:199], a[140:143], v[48:51]
    s_mov_b32 s99, 0
    v_mfma_f32_16x16x32_bf16 v[48:51], v[200:203], a[168:171], v[48:51]
    ds_read_b64_tr_b16 v[216:217], v241 offset:8448
    v_mfma_f32_16x16x32_bf16 v[48:51], v[204:207], a[172:175], v[48:51]
    ds_read_b128 a[220:223], v237 offset:6144
    ds_read_b64_tr_b16 v[218:219], v241 offset:8960
    v_mfma_f32_16x16x32_bf16 v[80:83], v[192:195], a[144:147], v[80:83]
    v_mfma_f32_16x16x32_bf16 v[80:83], v[196:199], a[148:151], v[80:83]
    ds_read_b64_tr_b16 v[220:221], v241 offset:12544
    v_mfma_f32_16x16x32_bf16 v[80:83], v[200:203], a[176:179], v[80:83]
    ds_read_b64_tr_b16 v[222:223], v241 offset:13056
    v_mfma_f32_16x16x32_bf16 v[80:83], v[204:207], a[180:183], v[80:83]
    v_mfma_f32_16x16x32_bf16 v[112:115], v[192:195], a[152:155], v[112:115]
    v_mfma_f32_16x16x32_bf16 v[112:115], v[196:199], a[156:159], v[112:115]
    v_mfma_f32_16x16x32_bf16 v[112:115], v[200:203], a[184:187], v[112:115]
    v_mfma_f32_16x16x32_bf16 v[112:115], v[204:207], a[188:191], v[112:115]
    s_waitcnt vmcnt(22) lgkmcnt(0)
    s_barrier
    v_mfma_f32_16x16x32_bf16 v[24:27], v[208:211], a[128:131], v[24:27]
    ds_read_b64_tr_b16 v[192:193], v240 offset:16384
    v_mfma_f32_16x16x32_bf16 v[24:27], v[212:215], a[132:135], v[24:27]
    ds_read_b64_tr_b16 v[194:195], v240 offset:16896
    v_mfma_f32_16x16x32_bf16 v[24:27], v[216:219], a[160:163], v[24:27]
    buffer_store_dwordx4 v[116:119], v255, s[4:7], s60 offen offset:3072 sc1
    v_mfma_f32_16x16x32_bf16 v[24:27], v[220:223], a[164:167], v[24:27]
    ds_read_b64_tr_b16 v[196:197], v240 offset:20480
    v_mfma_f32_16x16x32_bf16 v[56:59], v[208:211], a[136:139], v[56:59]
    ds_read_b64_tr_b16 v[198:199], v240 offset:20992
    v_mfma_f32_16x16x32_bf16 v[56:59], v[212:215], a[140:143], v[56:59]
    v_mfma_f32_16x16x32_bf16 v[56:59], v[216:219], a[168:171], v[56:59]
    ds_read_b64_tr_b16 v[200:201], v240 offset:24576
    v_mfma_f32_16x16x32_bf16 v[56:59], v[220:223], a[172:175], v[56:59]
    ds_read_b64_tr_b16 v[202:203], v240 offset:25088
    v_mfma_f32_16x16x32_bf16 v[88:91], v[208:211], a[144:147], v[88:91]
    v_mfma_f32_16x16x32_bf16 v[88:91], v[212:215], a[148:151], v[88:91]
    ds_read_b64_tr_b16 v[204:205], v240 offset:28672
    v_mfma_f32_16x16x32_bf16 v[88:91], v[216:219], a[176:179], v[88:91]
    ds_read_b64_tr_b16 v[206:207], v240 offset:29184
    v_mfma_f32_16x16x32_bf16 v[88:91], v[220:223], a[180:183], v[88:91]
    v_mfma_f32_16x16x32_bf16 v[120:123], v[208:211], a[152:155], v[120:123]
    v_mfma_f32_16x16x32_bf16 v[120:123], v[212:215], a[156:159], v[120:123]
    v_mfma_f32_16x16x32_bf16 v[120:123], v[216:219], a[184:187], v[120:123]
    v_mfma_f32_16x16x32_bf16 v[120:123], v[220:223], a[188:191], v[120:123]
    s_waitcnt lgkmcnt(0)
    v_mfma_f32_16x16x32_bf16 v[132:135], v[192:195], a[128:131], v[132:135]
    s_add_u32 m0, s68, 98304
    ds_read_b64_tr_b16 v[208:209], v241 offset:16384
    v_mfma_f32_16x16x32_bf16 v[132:135], v[196:199], a[132:135], v[132:135]
    ds_read_b64_tr_b16 v[210:211], v241 offset:16896
    v_mfma_f32_16x16x32_bf16 v[132:135], v[200:203], a[160:163], v[132:135]
    v_mfma_f32_16x16x32_bf16 v[132:135], v[204:207], a[164:167], v[132:135]
    ds_read_b64_tr_b16 v[212:213], v241 offset:20480
    v_mfma_f32_16x16x32_bf16 v[148:151], v[192:195], a[136:139], v[148:151]
    ds_read_b64_tr_b16 v[214:215], v241 offset:20992
    v_mfma_f32_16x16x32_bf16 v[148:151], v[196:199], a[140:143], v[148:151]
    v_mfma_f32_16x16x32_bf16 v[148:151], v[200:203], a[168:171], v[148:151]
    s_add_u32 s64, s87, 128
    ds_read_b64_tr_b16 v[216:217], v241 offset:24576
    v_mfma_f32_16x16x32_bf16 v[148:151], v[204:207], a[172:175], v[148:151]
    ds_read_b64_tr_b16 v[218:219], v241 offset:25088
    v_mfma_f32_16x16x32_bf16 v[164:167], v[192:195], a[144:147], v[164:167]
    v_mfma_f32_16x16x32_bf16 v[164:167], v[196:199], a[148:151], v[164:167]
    ds_read_b64_tr_b16 v[220:221], v241 offset:28672
    v_mfma_f32_16x16x32_bf16 v[164:167], v[200:203], a[176:179], v[164:167]
    ds_read_b64_tr_b16 v[222:223], v241 offset:29184
    v_mfma_f32_16x16x32_bf16 v[164:167], v[204:207], a[180:183], v[164:167]
    v_mfma_f32_16x16x32_bf16 v[180:183], v[192:195], a[152:155], v[180:183]
    v_mfma_f32_16x16x32_bf16 v[180:183], v[196:199], a[156:159], v[180:183]
    buffer_load_dwordx4 v242, s[16:19], s64 offen offset:0 lds
    v_mfma_f32_16x16x32_bf16 v[180:183], v[200:203], a[184:187], v[180:183]
    v_mfma_f32_16x16x32_bf16 v[180:183], v[204:207], a[188:191], v[180:183]
    s_waitcnt lgkmcnt(0)
    v_mfma_f32_16x16x32_bf16 v[12:15], v[208:211], a[128:131], v[12:15]
    ds_read_b64_tr_b16 v[192:193], v240 offset:16640
    v_mfma_f32_16x16x32_bf16 v[12:15], v[212:215], a[132:135], v[12:15]
    s_waitcnt vmcnt(14)
    ds_read_b64_tr_b16 v[194:195], v240 offset:17152
    v_mfma_f32_16x16x32_bf16 v[12:15], v[216:219], a[160:163], v[12:15]
    ds_read_b128 a[224:227], v236 offset:32768
    v_mfma_f32_16x16x32_bf16 v[12:15], v[220:223], a[164:167], v[12:15]
    ds_read_b64_tr_b16 v[196:197], v240 offset:20736
    v_mfma_f32_16x16x32_bf16 v[44:47], v[208:211], a[136:139], v[44:47]
    buffer_load_dwordx4 v243, s[16:19], s64 offen offset:1024 lds
    v_mfma_f32_16x16x32_bf16 v[44:47], v[212:215], a[140:143], v[44:47]
    ds_read_b64_tr_b16 v[198:199], v240 offset:21248
    ds_read_b128 a[228:231], v237 offset:32768
    v_mfma_f32_16x16x32_bf16 v[44:47], v[216:219], a[168:171], v[44:47]
    ds_read_b64_tr_b16 v[200:201], v240 offset:24832
    v_mfma_f32_16x16x32_bf16 v[44:47], v[220:223], a[172:175], v[44:47]
    ds_read_b64_tr_b16 v[202:203], v240 offset:25344
    v_mfma_f32_16x16x32_bf16 v[76:79], v[208:211], a[144:147], v[76:79]
    ds_read_b128 a[232:235], v236 offset:34816
    v_mfma_f32_16x16x32_bf16 v[76:79], v[212:215], a[148:151], v[76:79]
    ds_read_b64_tr_b16 v[204:205], v240 offset:28928
    v_mfma_f32_16x16x32_bf16 v[76:79], v[216:219], a[176:179], v[76:79]
    ds_read_b64_tr_b16 v[206:207], v240 offset:29440
    v_mfma_f32_16x16x32_bf16 v[76:79], v[220:223], a[180:183], v[76:79]
    buffer_load_dwordx4 v244, s[16:19], s64 offen offset:2048 lds
    v_mfma_f32_16x16x32_bf16 v[108:111], v[208:211], a[152:155], v[108:111]
    ds_read_b128 a[236:239], v237 offset:34816
    v_mfma_f32_16x16x32_bf16 v[108:111], v[212:215], a[156:159], v[108:111]
    v_mfma_f32_16x16x32_bf16 v[108:111], v[216:219], a[184:187], v[108:111]
    ds_read_b128 a[240:243], v236 offset:36864
    v_mfma_f32_16x16x32_bf16 v[108:111], v[220:223], a[188:191], v[108:111]
    s_waitcnt lgkmcnt(0)
    v_mfma_f32_16x16x32_bf16 v[140:143], v[192:195], a[128:131], v[140:143]
    ds_read_b64_tr_b16 v[208:209], v241 offset:16640
    v_mfma_f32_16x16x32_bf16 v[140:143], v[196:199], a[132:135], v[140:143]
    ds_read_b128 a[244:247], v237 offset:36864
    ds_read_b64_tr_b16 v[210:211], v241 offset:17152
    v_mfma_f32_16x16x32_bf16 v[140:143], v[200:203], a[160:163], v[140:143]
    buffer_load_dwordx4 v245, s[16:19], s64 offen offset:3072 lds
    v_mfma_f32_16x16x32_bf16 v[140:143], v[204:207], a[164:167], v[140:143]
    ds_read_b64_tr_b16 v[212:213], v241 offset:20736
    v_mfma_f32_16x16x32_bf16 v[156:159], v[192:195], a[136:139], v[156:159]
    ds_read_b128 a[248:251], v236 offset:38912
    ds_read_b64_tr_b16 v[214:215], v241 offset:21248
    v_mfma_f32_16x16x32_bf16 v[156:159], v[196:199], a[140:143], v[156:159]
    v_mfma_f32_16x16x32_bf16 v[156:159], v[200:203], a[168:171], v[156:159]
    ds_read_b64_tr_b16 v[216:217], v241 offset:24832
    v_mfma_f32_16x16x32_bf16 v[156:159], v[204:207], a[172:175], v[156:159]
    ds_read_b128 a[252:255], v237 offset:38912
    ds_read_b64_tr_b16 v[218:219], v241 offset:25344
    v_mfma_f32_16x16x32_bf16 v[172:175], v[192:195], a[144:147], v[172:175]
    v_mfma_f32_16x16x32_bf16 v[172:175], v[196:199], a[148:151], v[172:175]
    ds_read_b64_tr_b16 v[220:221], v241 offset:28928
    v_mfma_f32_16x16x32_bf16 v[172:175], v[200:203], a[176:179], v[172:175]
    ds_read_b64_tr_b16 v[222:223], v241 offset:29440
    v_mfma_f32_16x16x32_bf16 v[172:175], v[204:207], a[180:183], v[172:175]
    v_mfma_f32_16x16x32_bf16 v[188:191], v[192:195], a[152:155], v[188:191]
    v_mfma_f32_16x16x32_bf16 v[188:191], v[196:199], a[156:159], v[188:191]
    v_mfma_f32_16x16x32_bf16 v[188:191], v[200:203], a[184:187], v[188:191]
    v_mfma_f32_16x16x32_bf16 v[188:191], v[204:207], a[188:191], v[188:191]
    s_waitcnt vmcnt(12) lgkmcnt(0)
    s_barrier
    v_mfma_f32_16x16x32_bf16 v[28:31], v[208:211], a[128:131], v[28:31]
    ds_read_b64_tr_b16 v[192:193], v240 offset:32768
    v_mfma_f32_16x16x32_bf16 v[28:31], v[212:215], a[132:135], v[28:31]
    ds_read_b64_tr_b16 v[194:195], v240 offset:33280
    v_mfma_f32_16x16x32_bf16 v[28:31], v[216:219], a[160:163], v[28:31]
    v_mfma_f32_16x16x32_bf16 v[28:31], v[220:223], a[164:167], v[28:31]
    ds_read_b64_tr_b16 v[196:197], v240 offset:36864
    v_mfma_f32_16x16x32_bf16 v[60:63], v[208:211], a[136:139], v[60:63]
    ds_read_b64_tr_b16 v[198:199], v240 offset:37376
    v_mfma_f32_16x16x32_bf16 v[60:63], v[212:215], a[140:143], v[60:63]
    v_mfma_f32_16x16x32_bf16 v[60:63], v[216:219], a[168:171], v[60:63]
    ds_read_b64_tr_b16 v[200:201], v240 offset:40960
    v_mfma_f32_16x16x32_bf16 v[60:63], v[220:223], a[172:175], v[60:63]
    ds_read_b64_tr_b16 v[202:203], v240 offset:41472
    v_mfma_f32_16x16x32_bf16 v[92:95], v[208:211], a[144:147], v[92:95]
    v_mfma_f32_16x16x32_bf16 v[92:95], v[212:215], a[148:151], v[92:95]
    ds_read_b64_tr_b16 v[204:205], v240 offset:45056
    v_mfma_f32_16x16x32_bf16 v[92:95], v[216:219], a[176:179], v[92:95]
    ds_read_b64_tr_b16 v[206:207], v240 offset:45568
    v_mfma_f32_16x16x32_bf16 v[92:95], v[220:223], a[180:183], v[92:95]
    v_mfma_f32_16x16x32_bf16 v[124:127], v[208:211], a[152:155], v[124:127]
    v_mfma_f32_16x16x32_bf16 v[124:127], v[212:215], a[156:159], v[124:127]
    v_mfma_f32_16x16x32_bf16 v[124:127], v[216:219], a[184:187], v[124:127]
    v_mfma_f32_16x16x32_bf16 v[124:127], v[220:223], a[188:191], v[124:127]
    s_waitcnt lgkmcnt(0)
L_st_late:
    v_mfma_f32_16x16x32_bf16 v[0:3], v[192:195], a[192:195], v[0:3]
    s_add_u32 m0, s68, 114688
    ds_read_b64_tr_b16 v[208:209], v241 offset:32768
    v_mfma_f32_16x16x32_bf16 v[0:3], v[196:199], a[196:199], v[0:3]
    ds_read_b64_tr_b16 v[210:211], v241 offset:33280
    v_mfma_f32_16x16x32_bf16 v[0:3], v[200:203], a[224:227], v[0:3]
    v_mfma_f32_16x16x32_bf16 v[0:3], v[204:207], a[228:231], v[0:3]
    ds_read_b64_tr_b16 v[212:213], v241 offset:36864
    v_mfma_f32_16x16x32_bf16 v[32:35], v[192:195], a[200:203], v[32:35]
    ds_read_b64_tr_b16 v[214:215], v241 offset:37376
    v_mfma_f32_16x16x32_bf16 v[32:35], v[196:199], a[204:207], v[32:35]
    v_mfma_f32_16x16x32_bf16 v[32:35], v[200:203], a[232:235], v[32:35]
    s_add_u32 s64, s87, 1048704
    ds_read_b64_tr_b16 v[216:217], v241 offset:40960
    v_mfma_f32_16x16x32_bf16 v[32:35], v[204:207], a[236:239], v[32:35]
    ds_read_b64_tr_b16 v[218:219], v241 offset:41472
    v_mfma_f32_16x16x32_bf16 v[64:67], v[192:195], a[208:211], v[64:67]
    v_mfma_f32_16x16x32_bf16 v[64:67], v[196:199], a[212:215], v[64:67]
    ds_read_b64_tr_b16 v[220:221], v241 offset:45056
    v_mfma_f32_16x16x32_bf16 v[64:67], v[200:203], a[240:243], v[64:67]
    ds_read_b64_tr_b16 v[222:223], v241 offset:45568
    v_mfma_f32_16x16x32_bf16 v[64:67], v[204:207], a[244:247], v[64:67]
    v_mfma_f32_16x16x32_bf16 v[96:99], v[192:195], a[216:219], v[96:99]
    v_mfma_f32_16x16x32_bf16 v[96:99], v[196:199], a[220:223], v[96:99]
    buffer_load_dwordx4 v242, s[16:19], s64 offen offset:0 lds
    v_mfma_f32_16x16x32_bf16 v[96:99], v[200:203], a[248:251], v[96:99]
    s_waitcnt vmcnt(5)
    s_lshl_b32 s89, s57, 7
    s_lshl_b32 s90, s58, 4
    s_add_u32 s89, s89, s90
    s_lshl_b32 s90, s56, 2
    s_add_u32 s89, s89, s90
    v_mov_b32 v250, s89
    v_mfma_f32_16x16x32_bf16 v[96:99], v[204:207], a[252:255], v[96:99]
    s_waitcnt lgkmcnt(0)
    v_mfma_f32_16x16x32_bf16 v[8:11], v[208:211], a[192:195], v[8:11]
    ds_read_b64_tr_b16 v[192:193], v240 offset:33024
    v_mfma_f32_16x16x32_bf16 v[8:11], v[212:215], a[196:199], v[8:11]
    buffer_store_dword v251, v250, s[4:7], 0 offen sc1
    v_mfma_f32_16x16x32_bf16 v[8:11], v[216:219], a[224:227], v[8:11]
    ds_read_b64_tr_b16 v[194:195], v240 offset:33536
    v_mfma_f32_16x16x32_bf16 v[8:11], v[220:223], a[228:231], v[8:11]
    ds_read_b64_tr_b16 v[196:197], v240 offset:37120
    v_mfma_f32_16x16x32_bf16 v[40:43], v[208:211], a[200:203], v[40:43]
    buffer_load_dwordx4 v243, s[16:19], s64 offen offset:1024 lds
    v_mfma_f32_16x16x32_bf16 v[40:43], v[212:215], a[204:207], v[40:43]
    ds_read_b64_tr_b16 v[198:199], v240 offset:37632
    v_mfma_f32_16x16x32_bf16 v[40:43], v[216:219], a[232:235], v[40:43]
    ds_read_b64_tr_b16 v[200:201], v240 offset:41216
    v_mfma_f32_16x16x32_bf16 v[40:43], v[220:223], a[236:239], v[40:43]
    ds_read_b64_tr_b16 v[202:203], v240 offset:41728
    v_mfma_f32_16x16x32_bf16 v[72:75], v[208:211], a[208:211], v[72:75]
    v_mfma_f32_16x16x32_bf16 v[72:75], v[212:215], a[212:215], v[72:75]
    ds_read_b64_tr_b16 v[204:205], v240 offset:45312
    v_mfma_f32_16x16x32_bf16 v[72:75], v[216:219], a[240:243], v[72:75]
    ds_read_b64_tr_b16 v[206:207], v240 offset:45824
    v_mfma_f32_16x16x32_bf16 v[72:75], v[220:223], a[244:247], v[72:75]
    buffer_load_dwordx4 v244, s[16:19], s64 offen offset:2048 lds
    v_mfma_f32_16x16x32_bf16 v[104:107], v[208:211], a[216:219], v[104:107]
    v_mfma_f32_16x16x32_bf16 v[104:107], v[212:215], a[220:223], v[104:107]
    v_mfma_f32_16x16x32_bf16 v[104:107], v[216:219], a[248:251], v[104:107]
    v_mfma_f32_16x16x32_bf16 v[104:107], v[220:223], a[252:255], v[104:107]
    s_waitcnt lgkmcnt(0)
    v_mfma_f32_16x16x32_bf16 v[16:19], v[192:195], a[192:195], v[16:19]
    ds_read_b64_tr_b16 v[208:209], v241 offset:33024
    v_mfma_f32_16x16x32_bf16 v[16:19], v[196:199], a[196:199], v[16:19]
    buffer_load_dwordx4 v245, s[16:19], s64 offen offset:3072 lds
    v_mfma_f32_16x16x32_bf16 v[16:19], v[200:203], a[224:227], v[16:19]
    ds_read_b64_tr_b16 v[210:211], v241 offset:33536
    v_mfma_f32_16x16x32_bf16 v[16:19], v[204:207], a[228:231], v[16:19]
    ds_read_b64_tr_b16 v[212:213], v241 offset:37120
    v_mfma_f32_16x16x32_bf16 v[48:51], v[192:195], a[200:203], v[48:51]
    ds_read_b64_tr_b16 v[214:215], v241 offset:37632
    v_mfma_f32_16x16x32_bf16 v[48:51], v[196:199], a[204:207], v[48:51]
    v_mfma_f32_16x16x32_bf16 v[48:51], v[200:203], a[232:235], v[48:51]
    ds_read_b64_tr_b16 v[216:217], v241 offset:41216
    v_max_f32 v0, 0, v0
    v_mfma_f32_16x16x32_bf16 v[48:51], v[204:207], a[236:239], v[48:51]
    ds_read_b64_tr_b16 v[218:219], v241 offset:41728
    v_max_f32 v1, 0, v1
    v_mfma_f32_16x16x32_bf16 v[80:83], v[192:195], a[208:211], v[80:83]
    v_max_f32 v2, 0, v2
    v_max_f32 v3, 0, v3
    v_mfma_f32_16x16x32_bf16 v[80:83], v[196:199], a[212:215], v[80:83]
    ds_read_b64_tr_b16 v[220:221], v241 offset:45312
    v_max_f32 v8, 0, v8
    v_mfma_f32_16x16x32_bf16 v[80:83], v[200:203], a[240:243], v[80:83]
    ds_read_b64_tr_b16 v[222:223], v241 offset:45824
    v_max_f32 v9, 0, v9
    v_mfma_f32_16x16x32_bf16 v[80:83], v[204:207], a[244:247], v[80:83]
    v_max_f32 v10, 0, v10
    v_max_f32 v11, 0, v11
    v_mfma_f32_16x16x32_bf16 v[112:115], v[192:195], a[216:219], v[112:115]
    v_mul_f32 v0, v0, v0
    v_mfma_f32_16x16x32_bf16 v[112:115], v[196:199], a[220:223], v[112:115]
    v_mul_f32 v1, v1, v1
    v_mfma_f32_16x16x32_bf16 v[112:115], v[200:203], a[248:251], v[112:115]
    v_mul_f32 v2, v2, v2
    v_mul_f32 v3, v3, v3
    v_mfma_f32_16x16x32_bf16 v[112:115], v[204:207], a[252:255], v[112:115]
    s_waitcnt lgkmcnt(0)
    s_barrier
    v_mfma_f32_16x16x32_bf16 v[24:27], v[208:211], a[192:195], v[24:27]
    ds_read_b64_tr_b16 v[192:193], v240 offset:49152
    v_mul_f32 v8, v8, v8
    v_mfma_f32_16x16x32_bf16 v[24:27], v[212:215], a[196:199], v[24:27]
    v_mul_f32 v9, v9, v9
    v_mul_f32 v10, v10, v10
    v_mfma_f32_16x16x32_bf16 v[24:27], v[216:219], a[224:227], v[24:27]
    ds_read_b64_tr_b16 v[194:195], v240 offset:49664
    v_mul_f32 v11, v11, v11
    v_mfma_f32_16x16x32_bf16 v[24:27], v[220:223], a[228:231], v[24:27]
    ds_read_b64_tr_b16 v[196:197], v240 offset:53248
    v_cvt_pk_bf16_f32 v0, v0, v1
    v_mfma_f32_16x16x32_bf16 v[56:59], v[208:211], a[200:203], v[56:59]
    v_cvt_pk_bf16_f32 v1, v2, v3
    v_cvt_pk_bf16_f32 v2, v8, v9
    v_mfma_f32_16x16x32_bf16 v[56:59], v[212:215], a[204:207], v[56:59]
    ds_read_b64_tr_b16 v[198:199], v240 offset:53760
    v_cvt_pk_bf16_f32 v3, v10, v11
    v_mfma_f32_16x16x32_bf16 v[56:59], v[216:219], a[232:235], v[56:59]
    s_add_u32 s60, s61, 0
    ds_read_b64_tr_b16 v[200:201], v240 offset:57344
    v_max_f32 v32, 0, v32
    v_mfma_f32_16x16x32_bf16 v[56:59], v[220:223], a[236:239], v[56:59]
    ds_read_b64_tr_b16 v[202:203], v240 offset:57856
    v_max_f32 v33, 0, v33
    v_mfma_f32_16x16x32_bf16 v[88:91], v[208:211], a[208:211], v[88:91]
    buffer_store_dwordx4 v[0:3], v255, s[4:7], s60 offen offset:0 sc1
    v_mfma_f32_16x16x32_bf16 v[88:91], v[212:215], a[212:215], v[88:91]
    v_max_f32 v34, 0, v34
    v_max_f32 v35, 0, v35
    v_mfma_f32_16x16x32_bf16 v[88:91], v[216:219], a[240:243], v[88:91]
    ds_read_b64_tr_b16 v[204:205], v240 offset:61440
    v_max_f32 v40, 0, v40
    v_mfma_f32_16x16x32_bf16 v[88:91], v[220:223], a[244:247], v[88:91]
    ds_read_b64_tr_b16 v[206:207], v240 offset:61952
    v_max_f32 v41, 0, v41
    v_mfma_f32_16x16x32_bf16 v[120:123], v[208:211], a[216:219], v[120:123]
    v_max_f32 v42, 0, v42
    v_max_f32 v43, 0, v43
    v_mfma_f32_16x16x32_bf16 v[120:123], v[212:215], a[220:223], v[120:123]
    v_mul_f32 v32, v32, v32
    v_mul_f32 v33, v33, v33
    v_mfma_f32_16x16x32_bf16 v[120:123], v[216:219], a[248:251], v[120:123]
    v_mul_f32 v34, v34, v34
    v_mul_f32 v35, v35, v35
    v_mfma_f32_16x16x32_bf16 v[120:123], v[220:223], a[252:255], v[120:123]
    s_waitcnt lgkmcnt(0)
    v_mul_f32 v40, v40, v40
    v_mfma_f32_16x16x32_bf16 v[132:135], v[192:195], a[192:195], v[132:135]
    s_add_u32 m0, s68, 131072
    ds_read_b64_tr_b16 v[208:209], v241 offset:49152
    v_mul_f32 v41, v41, v41
    v_mfma_f32_16x16x32_bf16 v[132:135], v[196:199], a[196:199], v[132:135]
    ds_read_b64_tr_b16 v[210:211], v241 offset:49664
    v_mul_f32 v42, v42, v42
    v_mfma_f32_16x16x32_bf16 v[132:135], v[200:203], a[224:227], v[132:135]
    v_mul_f32 v43, v43, v43
    v_cvt_pk_bf16_f32 v32, v32, v33
    v_mfma_f32_16x16x32_bf16 v[132:135], v[204:207], a[228:231], v[132:135]
    ds_read_b64_tr_b16 v[212:213], v241 offset:53248
    v_cvt_pk_bf16_f32 v33, v34, v35
    v_mfma_f32_16x16x32_bf16 v[148:151], v[192:195], a[200:203], v[148:151]
    ds_read_b64_tr_b16 v[214:215], v241 offset:53760
    v_cvt_pk_bf16_f32 v34, v40, v41
    v_mfma_f32_16x16x32_bf16 v[148:151], v[196:199], a[204:207], v[148:151]
    v_cvt_pk_bf16_f32 v35, v42, v43
    v_mfma_f32_16x16x32_bf16 v[148:151], v[200:203], a[232:235], v[148:151]
    s_add_u32 s64, s87, 2097280
    ds_read_b64_tr_b16 v[216:217], v241 offset:57344
    v_max_f32 v64, 0, v64
    v_mfma_f32_16x16x32_bf16 v[148:151], v[204:207], a[236:239], v[148:151]
    ds_read_b64_tr_b16 v[218:219], v241 offset:57856
    v_max_f32 v65, 0, v65
    v_mfma_f32_16x16x32_bf16 v[164:167], v[192:195], a[208:211], v[164:167]
    buffer_store_dwordx4 v[32:35], v255, s[4:7], s60 offen offset:2048 sc1
    v_mfma_f32_16x16x32_bf16 v[164:167], v[196:199], a[212:215], v[164:167]
    v_max_f32 v66, 0, v66
    v_max_f32 v67, 0, v67
    v_mfma_f32_16x16x32_bf16 v[164:167], v[200:203], a[240:243], v[164:167]
    ds_read_b64_tr_b16 v[220:221], v241 offset:61440
    v_max_f32 v72, 0, v72
    v_mfma_f32_16x16x32_bf16 v[164:167], v[204:207], a[244:247], v[164:167]
    ds_read_b64_tr_b16 v[222:223], v241 offset:61952
    v_max_f32 v73, 0, v73
    v_mfma_f32_16x16x32_bf16 v[180:183], v[192:195], a[216:219], v[180:183]
    v_max_f32 v74, 0, v74
    v_max_f32 v75, 0, v75
    v_mfma_f32_16x16x32_bf16 v[180:183], v[196:199], a[220:223], v[180:183]
    v_mul_f32 v64, v64, v64
    v_mul_f32 v65, v65, v65
    v_mfma_f32_16x16x32_bf16 v[180:183], v[200:203], a[248:251], v[180:183]
    buffer_load_dwordx4 v242, s[16:19], s64 offen offset:0 lds
    v_mfma_f32_16x16x32_bf16 v[180:183], v[204:207], a[252:255], v[180:183]
    s_waitcnt lgkmcnt(0)
    v_mul_f32 v66, v66, v66
    v_mul_f32 v67, v67, v67
    v_mfma_f32_16x16x32_bf16 v[12:15], v[208:211], a[192:195], v[12:15]
    ds_read_b64_tr_b16 v[192:193], v240 offset:49408
    v_mul_f32 v72, v72, v72
    v_mfma_f32_16x16x32_bf16 v[12:15], v[212:215], a[196:199], v[12:15]
    v_mul_f32 v73, v73, v73
    v_mul_f32 v74, v74, v74
    v_mfma_f32_16x16x32_bf16 v[12:15], v[216:219], a[224:227], v[12:15]
    ds_read_b64_tr_b16 v[194:195], v240 offset:49920
    v_mul_f32 v75, v75, v75
    v_mfma_f32_16x16x32_bf16 v[12:15], v[220:223], a[228:231], v[12:15]
    ds_read_b64_tr_b16 v[196:197], v240 offset:53504
    v_cvt_pk_bf16_f32 v64, v64, v65
    v_mfma_f32_16x16x32_bf16 v[44:47], v[208:211], a[200:203], v[44:47]
    v_cvt_pk_bf16_f32 v65, v66, v67
    v_cvt_pk_bf16_f32 v66, v72, v73
    v_mfma_f32_16x16x32_bf16 v[44:47], v[212:215], a[204:207], v[44:47]
    buffer_load_dwordx4 v243, s[16:19], s64 offen offset:1024 lds
    v_mfma_f32_16x16x32_bf16 v[44:47], v[216:219], a[232:235], v[44:47]
    s_add_u32 s60, s61, 4096
    ds_read_b64_tr_b16 v[198:199], v240 offset:54016
    v_cvt_pk_bf16_f32 v67, v74, v75
    v_mfma_f32_16x16x32_bf16 v[44:47], v[220:223], a[236:239], v[44:47]
    ds_read_b64_tr_b16 v[200:201], v240 offset:57600
    v_max_f32 v96, 0, v96
    v_mfma_f32_16x16x32_bf16 v[76:79], v[208:211], a[208:211], v[76:79]
    ds_read_b64_tr_b16 v[202:203], v240 offset:58112
    v_max_f32 v97, 0, v97
    v_mfma_f32_16x16x32_bf16 v[76:79], v[212:215], a[212:215], v[76:79]
    buffer_store_dwordx4 v[64:67], v255, s[4:7], s60 offen offset:0 sc1
    v_mfma_f32_16x16x32_bf16 v[76:79], v[216:219], a[240:243], v[76:79]
    v_max_f32 v98, 0, v98
    v_max_f32 v99, 0, v99
    v_mfma_f32_16x16x32_bf16 v[76:79], v[220:223], a[244:247], v[76:79]
    ds_read_b64_tr_b16 v[204:205], v240 offset:61696
    v_max_f32 v104, 0, v104
    v_mfma_f32_16x16x32_bf16 v[108:111], v[208:211], a[216:219], v[108:111]
    ds_read_b64_tr_b16 v[206:207], v240 offset:62208
    v_max_f32 v105, 0, v105
    v_mfma_f32_16x16x32_bf16 v[108:111], v[212:215], a[220:223], v[108:111]
    buffer_load_dwordx4 v244, s[16:19], s64 offen offset:2048 lds
    v_mfma_f32_16x16x32_bf16 v[108:111], v[216:219], a[248:251], v[108:111]
    v_max_f32 v106, 0, v106
    v_max_f32 v107, 0, v107
    v_mfma_f32_16x16x32_bf16 v[108:111], v[220:223], a[252:255], v[108:111]
    s_waitcnt lgkmcnt(0)
    v_mul_f32 v96, v96, v96
    v_mul_f32 v97, v97, v97
    v_mfma_f32_16x16x32_bf16 v[140:143], v[192:195], a[192:195], v[140:143]
    v_mul_f32 v98, v98, v98
    v_mul_f32 v99, v99, v99
    v_mfma_f32_16x16x32_bf16 v[140:143], v[196:199], a[196:199], v[140:143]
    ds_read_b64_tr_b16 v[208:209], v241 offset:49408
    v_mul_f32 v104, v104, v104
    v_mfma_f32_16x16x32_bf16 v[140:143], v[200:203], a[224:227], v[140:143]
    v_mul_f32 v105, v105, v105
    v_mul_f32 v106, v106, v106
    v_mfma_f32_16x16x32_bf16 v[140:143], v[204:207], a[228:231], v[140:143]
    buffer_load_dwordx4 v245, s[16:19], s64 offen offset:3072 lds
    v_mfma_f32_16x16x32_bf16 v[156:159], v[192:195], a[200:203], v[156:159]
    ds_read_b64_tr_b16 v[210:211], v241 offset:49920
    v_mul_f32 v107, v107, v107
    v_mfma_f32_16x16x32_bf16 v[156:159], v[196:199], a[204:207], v[156:159]
    ds_read_b64_tr_b16 v[212:213], v241 offset:53504
    v_cvt_pk_bf16_f32 v96, v96, v97
    v_mfma_f32_16x16x32_bf16 v[156:159], v[200:203], a[232:235], v[156:159]
    v_cvt_pk_bf16_f32 v97, v98, v99
    v_cvt_pk_bf16_f32 v98, v104, v105
    v_mfma_f32_16x16x32_bf16 v[156:159], v[204:207], a[236:239], v[156:159]
    ds_read_b64_tr_b16 v[214:215], v241 offset:54016
    v_cvt_pk_bf16_f32 v99, v106, v107
    v_mfma_f32_16x16x32_bf16 v[172:175], v[192:195], a[208:211], v[172:175]
    ds_read_b64_tr_b16 v[216:217], v241 offset:57600
    v_max_f32 v16, 0, v16
    v_mfma_f32_16x16x32_bf16 v[172:175], v[196:199], a[212:215], v[172:175]
    ds_read_b64_tr_b16 v[218:219], v241 offset:58112
    v_max_f32 v17, 0, v17
    v_mfma_f32_16x16x32_bf16 v[172:175], v[200:203], a[240:243], v[172:175]
    buffer_store_dwordx4 v[96:99], v255, s[4:7], s60 offen offset:2048 sc1
    v_mfma_f32_16x16x32_bf16 v[172:175], v[204:207], a[244:247], v[172:175]
    v_max_f32 v18, 0, v18
    v_max_f32 v19, 0, v19
    v_mfma_f32_16x16x32_bf16 v[188:191], v[192:195], a[216:219], v[188:191]
    ds_read_b64_tr_b16 v[220:221], v241 offset:61696
    v_max_f32 v24, 0, v24
    v_mfma_f32_16x16x32_bf16 v[188:191], v[196:199], a[220:223], v[188:191]
    ds_read_b64_tr_b16 v[222:223], v241 offset:62208
    v_max_f32 v25, 0, v25
    v_mfma_f32_16x16x32_bf16 v[188:191], v[200:203], a[248:251], v[188:191]
    v_max_f32 v26, 0, v26
    v_max_f32 v27, 0, v27
    v_mfma_f32_16x16x32_bf16 v[188:191], v[204:207], a[252:255], v[188:191]
    s_waitcnt vmcnt(13) lgkmcnt(0)
    s_barrier
    v_mfma_f32_16x16x32_bf16 v[28:31], v[208:211], a[192:195], v[28:31]
    v_mul_f32 v16, v16, v16
    v_mul_f32 v17, v17, v17
    v_mfma_f32_16x16x32_bf16 v[28:31], v[212:215], a[196:199], v[28:31]
    v_mul_f32 v18, v18, v18
    v_mul_f32 v19, v19, v19
    v_mfma_f32_16x16x32_bf16 v[28:31], v[216:219], a[224:227], v[28:31]
    ds_read_b64_tr_b16 v[192:193], v240 offset:0
    v_mul_f32 v24, v24, v24
    v_mfma_f32_16x16x32_bf16 v[28:31], v[220:223], a[228:231], v[28:31]
    v_mul_f32 v25, v25, v25
    v_mul_f32 v26, v26, v26
    v_mfma_f32_16x16x32_bf16 v[60:63], v[208:211], a[200:203], v[60:63]
    ds_read_b64_tr_b16 v[194:195], v240 offset:512
    v_mul_f32 v27, v27, v27
    v_mfma_f32_16x16x32_bf16 v[60:63], v[212:215], a[204:207], v[60:63]
    v_min_u32 v252, 31, v254
    v_cvt_pk_bf16_f32 v16, v16, v17
    v_mfma_f32_16x16x32_bf16 v[60:63], v[216:219], a[232:235], v[60:63]
    s_add_u32 s60, s61, 0
    ds_read_b64_tr_b16 v[196:197], v240 offset:4096
    v_cvt_pk_bf16_f32 v17, v18, v19
    v_mfma_f32_16x16x32_bf16 v[60:63], v[220:223], a[236:239], v[60:63]
    ds_read_b64_tr_b16 v[198:199], v240 offset:4608
    v_cvt_pk_bf16_f32 v18, v24, v25
    v_mfma_f32_16x16x32_bf16 v[92:95], v[208:211], a[208:211], v[92:95]
    v_lshlrev_b32 v252, 2, v252
    v_cvt_pk_bf16_f32 v19, v26, v27
    v_mfma_f32_16x16x32_bf16 v[92:95], v[212:215], a[212:215], v[92:95]
    ds_read_b64_tr_b16 v[200:201], v240 offset:8192
    v_max_f32 v48, 0, v48
    v_mfma_f32_16x16x32_bf16 v[92:95], v[216:219], a[240:243], v[92:95]
    ds_read_b64_tr_b16 v[202:203], v240 offset:8704
    ds_read_b64_tr_b16 v[204:205], v240 offset:12288
    v_max_f32 v49, 0, v49
    v_mfma_f32_16x16x32_bf16 v[92:95], v[220:223], a[244:247], v[92:95]
    s_lshl_b32 s89, s57, 7
    v_add_u32 v252, s89, v252
    v_mfma_f32_16x16x32_bf16 v[124:127], v[208:211], a[216:219], v[124:127]
    buffer_store_dwordx4 v[16:19], v255, s[4:7], s60 offen offset:1024 sc1
    v_mfma_f32_16x16x32_bf16 v[124:127], v[212:215], a[220:223], v[124:127]
    ds_read_b64_tr_b16 v[206:207], v240 offset:12800
    v_max_f32 v50, 0, v50
    v_max_f32 v51, 0, v51
    v_mfma_f32_16x16x32_bf16 v[124:127], v[216:219], a[248:251], v[124:127]
    v_max_f32 v56, 0, v56
    v_max_f32 v57, 0, v57
    v_mfma_f32_16x16x32_bf16 v[124:127], v[220:223], a[252:255], v[124:127]
    s_waitcnt lgkmcnt(0)
    v_max_f32 v58, 0, v58
    v_max_f32 v59, 0, v59
    v_mfma_f32_16x16x32_bf16 v[128:131], v[192:195], a[0:3], 0
    buffer_load_dword v253, v252, s[4:7], 0 offen sc1
    v_mfma_f32_16x16x32_bf16 v[128:131], v[196:199], a[4:7], v[128:131]
    s_add_u32 m0, s68, 147456
    v_mul_f32 v48, v48, v48
    v_mul_f32 v49, v49, v49
    v_mfma_f32_16x16x32_bf16 v[128:131], v[200:203], a[32:35], v[128:131]
    v_mul_f32 v50, v50, v50
    v_mul_f32 v51, v51, v51
    v_mfma_f32_16x16x32_bf16 v[128:131], v[204:207], a[36:39], v[128:131]
    ds_read_b64_tr_b16 v[208:209], v241 offset:0
    v_mul_f32 v56, v56, v56
    v_mfma_f32_16x16x32_bf16 v[144:147], v[192:195], a[8:11], 0
    v_mul_f32 v57, v57, v57
    v_mul_f32 v58, v58, v58
    v_mfma_f32_16x16x32_bf16 v[144:147], v[196:199], a[12:15], v[144:147]
    ds_read_b64_tr_b16 v[210:211], v241 offset:512
    v_mul_f32 v59, v59, v59
    v_mfma_f32_16x16x32_bf16 v[144:147], v[200:203], a[40:43], v[144:147]
    s_add_u32 s64, s87, 3145856
    ds_read_b64_tr_b16 v[212:213], v241 offset:4096
    v_cvt_pk_bf16_f32 v48, v48, v49
    v_mfma_f32_16x16x32_bf16 v[144:147], v[204:207], a[44:47], v[144:147]
    v_cvt_pk_bf16_f32 v49, v50, v51
    v_cvt_pk_bf16_f32 v50, v56, v57
    v_mfma_f32_16x16x32_bf16 v[160:163], v[192:195], a[16:19], 0
    ds_read_b64_tr_b16 v[214:215], v241 offset:4608
    v_cvt_pk_bf16_f32 v51, v58, v59
    v_mfma_f32_16x16x32_bf16 v[160:163], v[196:199], a[20:23], v[160:163]
    ds_read_b64_tr_b16 v[216:217], v241 offset:8192
    v_max_f32 v80, 0, v80
    v_mfma_f32_16x16x32_bf16 v[160:163], v[200:203], a[48:51], v[160:163]
    ds_read_b64_tr_b16 v[218:219], v241 offset:8704
    v_max_f32 v81, 0, v81
    v_mfma_f32_16x16x32_bf16 v[160:163], v[204:207], a[52:55], v[160:163]
    buffer_store_dwordx4 v[48:51], v255, s[4:7], s60 offen offset:3072 sc1
    v_mfma_f32_16x16x32_bf16 v[176:179], v[192:195], a[24:27], 0
    v_max_f32 v82, 0, v82
    v_max_f32 v83, 0, v83
    v_mfma_f32_16x16x32_bf16 v[176:179], v[196:199], a[28:31], v[176:179]
    ds_read_b64_tr_b16 v[220:221], v241 offset:12288
    ds_read_b64_tr_b16 v[222:223], v241 offset:12800
    v_max_f32 v88, 0, v88
    v_mfma_f32_16x16x32_bf16 v[176:179], v[200:203], a[56:59], v[176:179]
    v_max_f32 v89, 0, v89
    v_max_f32 v90, 0, v90
    v_mfma_f32_16x16x32_bf16 v[176:179], v[204:207], a[60:63], v[176:179]
    s_waitcnt lgkmcnt(0)
    v_max_f32 v91, 0, v91
    v_mul_f32 v80, v80, v80
    v_mfma_f32_16x16x32_bf16 v[4:7], v[208:211], a[0:3], 0
    v_mul_f32 v81, v81, v81
    v_mul_f32 v82, v82, v82
    v_mfma_f32_16x16x32_bf16 v[4:7], v[212:215], a[4:7], v[4:7]
    buffer_load_dwordx4 v242, s[16:19], s64 offen offset:0 lds
    v_mfma_f32_16x16x32_bf16 v[4:7], v[216:219], a[32:35], v[4:7]
    v_mul_f32 v83, v83, v83
    v_mul_f32 v88, v88, v88
    v_mfma_f32_16x16x32_bf16 v[4:7], v[220:223], a[36:39], v[4:7]
    ds_read_b64_tr_b16 v[192:193], v240 offset:256
    v_mul_f32 v89, v89, v89
    v_mfma_f32_16x16x32_bf16 v[36:39], v[208:211], a[8:11], 0
    ds_read_b64_tr_b16 v[194:195], v240 offset:768
    v_mul_f32 v90, v90, v90
    v_mfma_f32_16x16x32_bf16 v[36:39], v[212:215], a[12:15], v[36:39]
    v_mul_f32 v91, v91, v91
    v_cvt_pk_bf16_f32 v80, v80, v81
    v_mfma_f32_16x16x32_bf16 v[36:39], v[216:219], a[40:43], v[36:39]
    s_add_u32 s60, s61, 4096
    ds_read_b64_tr_b16 v[196:197], v240 offset:4352
    v_cvt_pk_bf16_f32 v81, v82, v83
    v_mfma_f32_16x16x32_bf16 v[36:39], v[220:223], a[44:47], v[36:39]
    buffer_load_dwordx4 v243, s[16:19], s64 offen offset:1024 lds
    v_mfma_f32_16x16x32_bf16 v[68:71], v[208:211], a[16:19], 0
    ds_read_b64_tr_b16 v[198:199], v240 offset:4864
    v_cvt_pk_bf16_f32 v82, v88, v89
    v_mfma_f32_16x16x32_bf16 v[68:71], v[212:215], a[20:23], v[68:71]
    ds_read_b64_tr_b16 v[200:201], v240 offset:8448
    v_cvt_pk_bf16_f32 v83, v90, v91
    v_mfma_f32_16x16x32_bf16 v[68:71], v[216:219], a[48:51], v[68:71]
    v_max_f32 v112, 0, v112
    v_max_f32 v113, 0, v113
    v_mfma_f32_16x16x32_bf16 v[68:71], v[220:223], a[52:55], v[68:71]
    buffer_store_dwordx4 v[80:83], v255, s[4:7], s60 offen offset:1024 sc1
    v_mfma_f32_16x16x32_bf16 v[100:103], v[208:211], a[24:27], 0
    ds_read_b64_tr_b16 v[202:203], v240 offset:8960
    v_max_f32 v114, 0, v114
    v_mfma_f32_16x16x32_bf16 v[100:103], v[212:215], a[28:31], v[100:103]
    ds_read_b64_tr_b16 v[204:205], v240 offset:12544
    ds_read_b64_tr_b16 v[206:207], v240 offset:13056
    v_max_f32 v115, 0, v115
    v_mfma_f32_16x16x32_bf16 v[100:103], v[216:219], a[56:59], v[100:103]
    v_max_f32 v120, 0, v120
    v_max_f32 v121, 0, v121
    v_mfma_f32_16x16x32_bf16 v[100:103], v[220:223], a[60:63], v[100:103]
    s_waitcnt lgkmcnt(0)
    v_max_f32 v122, 0, v122
    v_max_f32 v123, 0, v123
    v_mfma_f32_16x16x32_bf16 v[136:139], v[192:195], a[0:3], 0
    buffer_load_dwordx4 v244, s[16:19], s64 offen offset:2048 lds
    v_mfma_f32_16x16x32_bf16 v[136:139], v[196:199], a[4:7], v[136:139]
    v_mul_f32 v112, v112, v112
    v_mul_f32 v113, v113, v113
    v_mfma_f32_16x16x32_bf16 v[136:139], v[200:203], a[32:35], v[136:139]
    v_mul_f32 v114, v114, v114
    v_mul_f32 v115, v115, v115
    v_mfma_f32_16x16x32_bf16 v[136:139], v[204:207], a[36:39], v[136:139]
    ds_read_b64_tr_b16 v[208:209], v241 offset:256
    v_mul_f32 v120, v120, v120
    v_mfma_f32_16x16x32_bf16 v[152:155], v[192:195], a[8:11], 0
    v_mul_f32 v121, v121, v121
    v_mul_f32 v122, v122, v122
    v_mfma_f32_16x16x32_bf16 v[152:155], v[196:199], a[12:15], v[152:155]
    buffer_load_dwordx4 v245, s[16:19], s64 offen offset:3072 lds
    v_mfma_f32_16x16x32_bf16 v[152:155], v[200:203], a[40:43], v[152:155]
    ds_read_b64_tr_b16 v[210:211], v241 offset:768
    v_mul_f32 v123, v123, v123
    v_mfma_f32_16x16x32_bf16 v[152:155], v[204:207], a[44:47], v[152:155]
    ds_read_b64_tr_b16 v[212:213], v241 offset:4352
    v_cvt_pk_bf16_f32 v112, v112, v113
    v_mfma_f32_16x16x32_bf16 v[168:171], v[192:195], a[16:19], 0
    v_cvt_pk_bf16_f32 v113, v114, v115
    v_cvt_pk_bf16_f32 v114, v120, v121
    v_mfma_f32_16x16x32_bf16 v[168:171], v[196:199], a[20:23], v[168:171]
    ds_read_b64_tr_b16 v[214:215], v241 offset:4864
    v_cvt_pk_bf16_f32 v115, v122, v123
    v_mfma_f32_16x16x32_bf16 v[168:171], v[200:203], a[48:51], v[168:171]
    ds_read_b64_tr_b16 v[216:217], v241 offset:8448
    ds_read_b64_tr_b16 v[218:219], v241 offset:8960
    v_mfma_f32_16x16x32_bf16 v[168:171], v[204:207], a[52:55], v[168:171]
    buffer_store_dwordx4 v[112:115], v255, s[4:7], s60 offen offset:3072 sc1
    v_mfma_f32_16x16x32_bf16 v[184:187], v[192:195], a[24:27], 0
    v_mul_f32 v132, s97, v132
    v_mul_f32 v133, s97, v133
    v_mfma_f32_16x16x32_bf16 v[184:187], v[196:199], a[28:31], v[184:187]
    ds_read_b64_tr_b16 v[220:221], v241 offset:12544
    ds_read_b64_tr_b16 v[222:223], v241 offset:13056
    v_mul_f32 v134, s97, v134
    v_mfma_f32_16x16x32_bf16 v[184:187], v[200:203], a[56:59], v[184:187]
    v_mul_f32 v135, s97, v135
    v_mul_f32 v12, s97, v12
    v_mfma_f32_16x16x32_bf16 v[184:187], v[204:207], a[60:63], v[184:187]
    s_waitcnt vmcnt(17) lgkmcnt(0)
    s_barrier
    v_mfma_f32_16x16x32_bf16 v[20:23], v[208:211], a[0:3], 0
    v_mul_f32 v13, s97, v13
    v_mul_f32 v14, s97, v14
    v_mfma_f32_16x16x32_bf16 v[20:23], v[212:215], a[4:7], v[20:23]
    v_mul_f32 v15, s97, v15
    v_cvt_pk_bf16_f32 v132, v132, v133
    v_mfma_f32_16x16x32_bf16 v[20:23], v[216:219], a[32:35], v[20:23]
    v_cvt_pk_bf16_f32 v133, v134, v135
    v_cvt_pk_bf16_f32 v134, v12, v13
    v_mfma_f32_16x16x32_bf16 v[20:23], v[220:223], a[36:39], v[20:23]
    ds_read_b64_tr_b16 v[192:193], v240 offset:16384
    v_cvt_pk_bf16_f32 v135, v14, v15
    v_mfma_f32_16x16x32_bf16 v[52:55], v[208:211], a[8:11], 0
    ds_read_b64_tr_b16 v[194:195], v240 offset:16896
    v_mul_f32 v148, s97, v148
    v_mfma_f32_16x16x32_bf16 v[52:55], v[212:215], a[12:15], v[52:55]
    v_mul_f32 v149, s97, v149
    v_mul_f32 v150, s97, v150
    v_mfma_f32_16x16x32_bf16 v[52:55], v[216:219], a[40:43], v[52:55]
    ds_read_b64_tr_b16 v[196:197], v240 offset:20480
    v_mul_f32 v151, s97, v151
    v_mfma_f32_16x16x32_bf16 v[52:55], v[220:223], a[44:47], v[52:55]
    ds_read_b64_tr_b16 v[198:199], v240 offset:20992
    v_mul_f32 v44, s97, v44
    v_mfma_f32_16x16x32_bf16 v[84:87], v[208:211], a[16:19], 0
    v_mul_f32 v45, s97, v45
    v_mul_f32 v46, s97, v46
    v_mfma_f32_16x16x32_bf16 v[84:87], v[212:215], a[20:23], v[84:87]
    ds_read_b64_tr_b16 v[200:201], v240 offset:24576
    v_mul_f32 v47, s97, v47
    v_mfma_f32_16x16x32_bf16 v[84:87], v[216:219], a[48:51], v[84:87]
    ds_read_b64_tr_b16 v[202:203], v240 offset:25088
    v_cvt_pk_bf16_f32 v148, v148, v149
    v_mfma_f32_16x16x32_bf16 v[84:87], v[220:223], a[52:55], v[84:87]
    s_waitcnt vmcnt(7)
    v_cmp_gt_u32 vcc, 1, v253
    s_nop 0
    s_cbranch_vccnz L_spin_107
L_spinret_108:
    v_mfma_f32_16x16x32_bf16 v[116:119], v[208:211], a[24:27], 0
    v_cvt_pk_bf16_f32 v149, v150, v151
    v_cvt_pk_bf16_f32 v150, v44, v45
    v_mfma_f32_16x16x32_bf16 v[116:119], v[212:215], a[28:31], v[116:119]
    ds_read_b64_tr_b16 v[204:205], v240 offset:28672
    ds_read_b64_tr_b16 v[206:207], v240 offset:29184
    v_cvt_pk_bf16_f32 v151, v46, v47
    v_mfma_f32_16x16x32_bf16 v[116:119], v[216:219], a[56:59], v[116:119]
    v_mul_f32 v164, s97, v164
    v_mul_f32 v165, s97, v165
    v_mfma_f32_16x16x32_bf16 v[116:119], v[220:223], a[60:63], v[116:119]
    s_waitcnt lgkmcnt(0)
    v_mul_f32 v166, s97, v166
    v_mul_f32 v167, s97, v167
    v_mfma_f32_16x16x32_bf16 v[128:131], v[192:195], a[64:67], v[128:131]
    s_add_u32 m0, s68, 32768
    v_mul_f32 v76, s97, v76
    v_mul_f32 v77, s97, v77
    v_mfma_f32_16x16x32_bf16 v[128:131], v[196:199], a[68:71], v[128:131]
    v_mul_f32 v78, s97, v78
    v_mul_f32 v79, s97, v79
    v_mfma_f32_16x16x32_bf16 v[128:131], v[200:203], a[96:99], v[128:131]
    ds_read_b64_tr_b16 v[208:209], v241 offset:16384
    v_cvt_pk_bf16_f32 v164, v164, v165
    v_mfma_f32_16x16x32_bf16 v[128:131], v[204:207], a[100:103], v[128:131]
    s_sub_u32 s64, 0, s74
    ds_read_b64_tr_b16 v[210:211], v241 offset:16896
    v_cvt_pk_bf16_f32 v165, v166, v167
    v_mfma_f32_16x16x32_bf16 v[144:147], v[192:195], a[72:75], v[144:147]
    v_cvt_pk_bf16_f32 v166, v76, v77
    v_cvt_pk_bf16_f32 v167, v78, v79
    v_mfma_f32_16x16x32_bf16 v[144:147], v[196:199], a[76:79], v[144:147]
    ds_read_b64_tr_b16 v[212:213], v241 offset:20480
    v_mul_f32 v180, s97, v180
    v_mfma_f32_16x16x32_bf16 v[144:147], v[200:203], a[104:107], v[144:147]
    s_max_i32 s64, s64, 0
    ds_read_b64_tr_b16 v[214:215], v241 offset:20992
    v_mul_f32 v181, s97, v181
    v_mfma_f32_16x16x32_bf16 v[144:147], v[204:207], a[108:111], v[144:147]
    ds_read_b64_tr_b16 v[216:217], v241 offset:24576
    v_mul_f32 v182, s97, v182
    v_mfma_f32_16x16x32_bf16 v[160:163], v[192:195], a[80:83], v[160:163]
    v_mul_f32 v183, s97, v183
    v_mul_f32 v108, s97, v108
    v_mfma_f32_16x16x32_bf16 v[160:163], v[196:199], a[84:87], v[160:163]
    ds_read_b64_tr_b16 v[218:219], v241 offset:25088
    v_mul_f32 v109, s97, v109
    v_mfma_f32_16x16x32_bf16 v[160:163], v[200:203], a[112:115], v[160:163]
    s_lshl_b32 s64, s64, 14
    ds_read_b64_tr_b16 v[220:221], v241 offset:28672
    v_mul_f32 v110, s97, v110
    v_mfma_f32_16x16x32_bf16 v[160:163], v[204:207], a[116:119], v[160:163]
    v_mul_f32 v111, s97, v111
    v_cvt_pk_bf16_f32 v180, v180, v181
    v_mfma_f32_16x16x32_bf16 v[176:179], v[192:195], a[88:91], v[176:179]
    ds_read_b64_tr_b16 v[222:223], v241 offset:29184
    v_cvt_pk_bf16_f32 v181, v182, v183
    v_mfma_f32_16x16x32_bf16 v[176:179], v[196:199], a[92:95], v[176:179]
    s_add_u32 s64, s64, s69
    v_cvt_pk_bf16_f32 v182, v108, v109
    v_cvt_pk_bf16_f32 v183, v110, v111
    v_mfma_f32_16x16x32_bf16 v[176:179], v[200:203], a[120:123], v[176:179]
    v_mul_f32 v140, s97, v140
    v_mul_f32 v141, s97, v141
    v_mfma_f32_16x16x32_bf16 v[176:179], v[204:207], a[124:127], v[176:179]
    s_waitcnt lgkmcnt(0)
    v_mul_f32 v142, s97, v142
    v_mul_f32 v143, s97, v143
    v_mfma_f32_16x16x32_bf16 v[4:7], v[208:211], a[64:67], v[4:7]
    ds_read_b64_tr_b16 v[192:193], v240 offset:16640
    v_mul_f32 v28, s97, v28
    v_mfma_f32_16x16x32_bf16 v[4:7], v[212:215], a[68:71], v[4:7]
    buffer_load_dwordx4 v255, s[4:7], s64 offen offset:0 sc1 lds
    v_mfma_f32_16x16x32_bf16 v[4:7], v[216:219], a[96:99], v[4:7]
    ds_read_b64_tr_b16 v[194:195], v240 offset:17152
    v_mul_f32 v29, s97, v29
    v_mfma_f32_16x16x32_bf16 v[4:7], v[220:223], a[100:103], v[4:7]
    v_mul_f32 v30, s97, v30
    v_mul_f32 v31, s97, v31
    v_mfma_f32_16x16x32_bf16 v[36:39], v[208:211], a[72:75], v[36:39]
    ds_read_b64_tr_b16 v[196:197], v240 offset:20736
    v_cvt_pk_bf16_f32 v140, v140, v141
    v_mfma_f32_16x16x32_bf16 v[36:39], v[212:215], a[76:79], v[36:39]
    ds_read_b64_tr_b16 v[198:199], v240 offset:21248
    v_cvt_pk_bf16_f32 v141, v142, v143
    v_mfma_f32_16x16x32_bf16 v[36:39], v[216:219], a[104:107], v[36:39]
    buffer_load_dwordx4 v255, s[4:7], s64 offen offset:1024 sc1 lds
    v_mfma_f32_16x16x32_bf16 v[36:39], v[220:223], a[108:111], v[36:39]
    v_cvt_pk_bf16_f32 v142, v28, v29
    v_cvt_pk_bf16_f32 v143, v30, v31
    v_mfma_f32_16x16x32_bf16 v[68:71], v[208:211], a[80:83], v[68:71]
    ds_read_b64_tr_b16 v[200:201], v240 offset:24832
    v_mul_f32 v156, s97, v156
    v_mfma_f32_16x16x32_bf16 v[68:71], v[212:215], a[84:87], v[68:71]
    ds_read_b64_tr_b16 v[202:203], v240 offset:25344
    v_mul_f32 v157, s97, v157
    v_mfma_f32_16x16x32_bf16 v[68:71], v[216:219], a[112:115], v[68:71]
    buffer_load_dwordx4 v255, s[4:7], s64 offen offset:2048 sc1 lds
    v_mfma_f32_16x16x32_bf16 v[68:71], v[220:223], a[116:119], v[68:71]
    v_mul_f32 v158, s97, v158
    v_mul_f32 v159, s97, v159
    v_mfma_f32_16x16x32_bf16 v[100:103], v[208:211], a[88:91], v[100:103]
    ds_read_b64_tr_b16 v[204:205], v240 offset:28928
    v_mul_f32 v60, s97, v60
    v_mfma_f32_16x16x32_bf16 v[100:103], v[212:215], a[92:95], v[100:103]
    ds_read_b64_tr_b16 v[206:207], v240 offset:29440
    v_mul_f32 v61, s97, v61
    v_mfma_f32_16x16x32_bf16 v[100:103], v[216:219], a[120:123], v[100:103]
    buffer_load_dwordx4 v255, s[4:7], s64 offen offset:3072 sc1 lds
    v_mfma_f32_16x16x32_bf16 v[100:103], v[220:223], a[124:127], v[100:103]
    s_waitcnt lgkmcnt(0)
    v_mul_f32 v62, s97, v62
    v_mul_f32 v63, s97, v63
    v_mfma_f32_16x16x32_bf16 v[136:139], v[192:195], a[64:67], v[136:139]
    s_add_u32 m0, s68, 65536
    v_cvt_pk_bf16_f32 v156, v156, v157
    v_cvt_pk_bf16_f32 v157, v158, v159
    v_mfma_f32_16x16x32_bf16 v[136:139], v[196:199], a[68:71], v[136:139]
    s_sub_u32 s64, 1, s74
    v_cvt_pk_bf16_f32 v158, v60, v61
    v_cvt_pk_bf16_f32 v159, v62, v63
    v_mfma_f32_16x16x32_bf16 v[136:139], v[200:203], a[96:99], v[136:139]
    ds_read_b64_tr_b16 v[208:209], v241 offset:16640
    v_mul_f32 v172, s97, v172
    v_mfma_f32_16x16x32_bf16 v[136:139], v[204:207], a[100:103], v[136:139]
    v_mul_f32 v173, s97, v173
    v_mul_f32 v174, s97, v174
    v_mfma_f32_16x16x32_bf16 v[152:155], v[192:195], a[72:75], v[152:155]
    s_max_i32 s64, s64, 0
    ds_read_b64_tr_b16 v[210:211], v241 offset:17152
    v_mul_f32 v175, s97, v175
    v_mfma_f32_16x16x32_bf16 v[152:155], v[196:199], a[76:79], v[152:155]
    ds_read_b64_tr_b16 v[212:213], v241 offset:20736
    v_mul_f32 v92, s97, v92
    v_mfma_f32_16x16x32_bf16 v[152:155], v[200:203], a[104:107], v[152:155]
    v_mul_f32 v93, s97, v93
    v_mul_f32 v94, s97, v94
    v_mfma_f32_16x16x32_bf16 v[152:155], v[204:207], a[108:111], v[152:155]
    ds_read_b64_tr_b16 v[214:215], v241 offset:21248
    v_mul_f32 v95, s97, v95
    v_mfma_f32_16x16x32_bf16 v[168:171], v[192:195], a[80:83], v[168:171]
    s_lshl_b32 s64, s64, 14
    ds_read_b64_tr_b16 v[216:217], v241 offset:24832
    v_cvt_pk_bf16_f32 v172, v172, v173
    v_mfma_f32_16x16x32_bf16 v[168:171], v[196:199], a[84:87], v[168:171]
    v_cvt_pk_bf16_f32 v173, v174, v175
    v_cvt_pk_bf16_f32 v174, v92, v93
    v_mfma_f32_16x16x32_bf16 v[168:171], v[200:203], a[112:115], v[168:171]
    ds_read_b64_tr_b16 v[218:219], v241 offset:25344
    v_cvt_pk_bf16_f32 v175, v94, v95
    v_mfma_f32_16x16x32_bf16 v[168:171], v[204:207], a[116:119], v[168:171]
    s_add_u32 s64, s64, s69
    ds_read_b64_tr_b16 v[220:221], v241 offset:28928
    v_mul_f32 v188, s97, v188
    v_mfma_f32_16x16x32_bf16 v[184:187], v[192:195], a[88:91], v[184:187]
    v_mul_f32 v189, s97, v189
    v_mul_f32 v190, s97, v190
    v_mfma_f32_16x16x32_bf16 v[184:187], v[196:199], a[92:95], v[184:187]
    ds_read_b64_tr_b16 v[222:223], v241 offset:29440
    v_mul_f32 v191, s97, v191
    v_mfma_f32_16x16x32_bf16 v[184:187], v[200:203], a[120:123], v[184:187]
    v_mul_f32 v124, s97, v124
    v_mul_f32 v125, s97, v125
    v_mfma_f32_16x16x32_bf16 v[184:187], v[204:207], a[124:127], v[184:187]
    s_waitcnt lgkmcnt(0)
    s_barrier
    v_mfma_f32_16x16x32_bf16 v[20:23], v[208:211], a[64:67], v[20:23]
    v_mul_f32 v126, s97, v126
    v_mul_f32 v127, s97, v127
    v_mfma_f32_16x16x32_bf16 v[20:23], v[212:215], a[68:71], v[20:23]
    buffer_load_dwordx4 v255, s[4:7], s64 offen offset:0 sc1 lds
    v_mfma_f32_16x16x32_bf16 v[20:23], v[216:219], a[96:99], v[20:23]
    v_cvt_pk_bf16_f32 v188, v188, v189
    v_cvt_pk_bf16_f32 v189, v190, v191
    v_mfma_f32_16x16x32_bf16 v[20:23], v[220:223], a[100:103], v[20:23]
    ds_read_b64_tr_b16 v[192:193], v240 offset:32768
    v_cvt_pk_bf16_f32 v190, v124, v125
    v_mfma_f32_16x16x32_bf16 v[52:55], v[208:211], a[72:75], v[52:55]
    ds_read_b64_tr_b16 v[194:195], v240 offset:33280
    v_cvt_pk_bf16_f32 v191, v126, v127
    v_mfma_f32_16x16x32_bf16 v[52:55], v[212:215], a[76:79], v[52:55]
    buffer_load_dwordx4 v255, s[4:7], s64 offen offset:1024 sc1 lds
    v_mfma_f32_16x16x32_bf16 v[52:55], v[216:219], a[104:107], v[52:55]
    v_accvgpr_write_b32 a0, v132
    v_accvgpr_write_b32 a1, v133
    v_mfma_f32_16x16x32_bf16 v[52:55], v[220:223], a[108:111], v[52:55]
    ds_read_b64_tr_b16 v[196:197], v240 offset:36864
    v_accvgpr_write_b32 a2, v134
    v_mfma_f32_16x16x32_bf16 v[84:87], v[208:211], a[80:83], v[84:87]
    ds_read_b64_tr_b16 v[198:199], v240 offset:37376
    v_accvgpr_write_b32 a3, v135
    v_mfma_f32_16x16x32_bf16 v[84:87], v[212:215], a[84:87], v[84:87]
    v_accvgpr_write_b32 a16, v148
    v_accvgpr_write_b32 a17, v149
    v_mfma_f32_16x16x32_bf16 v[84:87], v[216:219], a[112:115], v[84:87]
    buffer_load_dwordx4 v255, s[4:7], s64 offen offset:2048 sc1 lds
    v_mfma_f32_16x16x32_bf16 v[84:87], v[220:223], a[116:119], v[84:87]
    ds_read_b64_tr_b16 v[200:201], v240 offset:40960
    v_accvgpr_write_b32 a18, v150
    v_mfma_f32_16x16x32_bf16 v[116:119], v[208:211], a[88:91], v[116:119]
    ds_read_b64_tr_b16 v[202:203], v240 offset:41472
    ds_read_b64_tr_b16 v[204:205], v240 offset:45056
    v_accvgpr_write_b32 a19, v151
    v_mfma_f32_16x16x32_bf16 v[116:119], v[212:215], a[92:95], v[116:119]
    ds_read_b64_tr_b16 v[206:207], v240 offset:45568
    v_accvgpr_write_b32 a32, v164
    v_accvgpr_write_b32 a33, v165
    v_mfma_f32_16x16x32_bf16 v[116:119], v[216:219], a[120:123], v[116:119]
    buffer_load_dwordx4 v255, s[4:7], s64 offen offset:3072 sc1 lds
    v_mfma_f32_16x16x32_bf16 v[116:119], v[220:223], a[124:127], v[116:119]
    s_waitcnt lgkmcnt(0)
    v_accvgpr_write_b32 a34, v166
    v_accvgpr_write_b32 a35, v167
    v_mfma_f32_16x16x32_bf16 v[128:131], v[192:195], a[128:131], v[128:131]
    s_add_u32 m0, s68, 98304
    v_accvgpr_write_b32 a48, v180
    v_accvgpr_write_b32 a49, v181
    v_mfma_f32_16x16x32_bf16 v[128:131], v[196:199], a[132:135], v[128:131]
    v_accvgpr_write_b32 a50, v182
    v_accvgpr_write_b32 a51, v183
    v_mfma_f32_16x16x32_bf16 v[128:131], v[200:203], a[160:163], v[128:131]
    v_accvgpr_write_b32 a4, v140
    v_accvgpr_write_b32 a5, v141
    v_mfma_f32_16x16x32_bf16 v[128:131], v[204:207], a[164:167], v[128:131]
    s_sub_u32 s64, 2, s74
    ds_read_b64_tr_b16 v[208:209], v241 offset:32768
    v_accvgpr_write_b32 a6, v142
    v_mfma_f32_16x16x32_bf16 v[144:147], v[192:195], a[136:139], v[144:147]
    v_accvgpr_write_b32 a7, v143
    v_accvgpr_write_b32 a20, v156
    v_mfma_f32_16x16x32_bf16 v[144:147], v[196:199], a[140:143], v[144:147]
    ds_read_b64_tr_b16 v[210:211], v241 offset:33280
    v_accvgpr_write_b32 a21, v157
    v_mfma_f32_16x16x32_bf16 v[144:147], v[200:203], a[168:171], v[144:147]
    ds_read_b64_tr_b16 v[212:213], v241 offset:36864
    v_accvgpr_write_b32 a22, v158
    v_mfma_f32_16x16x32_bf16 v[144:147], v[204:207], a[172:175], v[144:147]
    s_max_i32 s64, s64, 0
    v_accvgpr_write_b32 a23, v159
    v_accvgpr_write_b32 a36, v172
    v_mfma_f32_16x16x32_bf16 v[160:163], v[192:195], a[144:147], v[160:163]
    ds_read_b64_tr_b16 v[214:215], v241 offset:37376
    v_accvgpr_write_b32 a37, v173
    v_mfma_f32_16x16x32_bf16 v[160:163], v[196:199], a[148:151], v[160:163]
    ds_read_b64_tr_b16 v[216:217], v241 offset:40960
    v_accvgpr_write_b32 a38, v174
    v_mfma_f32_16x16x32_bf16 v[160:163], v[200:203], a[176:179], v[160:163]
    s_lshl_b32 s64, s64, 14
    v_accvgpr_write_b32 a39, v175
    v_accvgpr_write_b32 a52, v188
    v_mfma_f32_16x16x32_bf16 v[160:163], v[204:207], a[180:183], v[160:163]
    ds_read_b64_tr_b16 v[218:219], v241 offset:41472
    v_accvgpr_write_b32 a53, v189
    v_mfma_f32_16x16x32_bf16 v[176:179], v[192:195], a[152:155], v[176:179]
    ds_read_b64_tr_b16 v[220:221], v241 offset:45056
    v_accvgpr_write_b32 a54, v190
    v_mfma_f32_16x16x32_bf16 v[176:179], v[196:199], a[156:159], v[176:179]
    ds_read_b64_tr_b16 v[222:223], v241 offset:45568
    v_accvgpr_write_b32 a55, v191
    v_mfma_f32_16x16x32_bf16 v[176:179], v[200:203], a[184:187], v[176:179]
    s_add_u32 s64, s64, s69
    v_mfma_f32_16x16x32_bf16 v[176:179], v[204:207], a[188:191], v[176:179]
    s_waitcnt lgkmcnt(0)
    v_mfma_f32_16x16x32_bf16 v[4:7], v[208:211], a[128:131], v[4:7]
    ds_read_b64_tr_b16 v[192:193], v240 offset:33024
    v_mfma_f32_16x16x32_bf16 v[4:7], v[212:215], a[132:135], v[4:7]
    ds_read_b64_tr_b16 v[194:195], v240 offset:33536
    v_mfma_f32_16x16x32_bf16 v[4:7], v[216:219], a[160:163], v[4:7]
    buffer_load_dwordx4 v255, s[4:7], s64 offen offset:0 sc1 lds
    v_mfma_f32_16x16x32_bf16 v[4:7], v[220:223], a[164:167], v[4:7]
    ds_read_b64_tr_b16 v[196:197], v240 offset:37120
    v_mfma_f32_16x16x32_bf16 v[36:39], v[208:211], a[136:139], v[36:39]
    ds_read_b64_tr_b16 v[198:199], v240 offset:37632
    v_mfma_f32_16x16x32_bf16 v[36:39], v[212:215], a[140:143], v[36:39]
    buffer_load_dwordx4 v255, s[4:7], s64 offen offset:1024 sc1 lds
    v_mfma_f32_16x16x32_bf16 v[36:39], v[216:219], a[168:171], v[36:39]
    ds_read_b64_tr_b16 v[200:201], v240 offset:41216
    v_mfma_f32_16x16x32_bf16 v[36:39], v[220:223], a[172:175], v[36:39]
    ds_read_b64_tr_b16 v[202:203], v240 offset:41728
    v_mfma_f32_16x16x32_bf16 v[68:71], v[208:211], a[144:147], v[68:71]
    buffer_load_dwordx4 v255, s[4:7], s64 offen offset:2048 sc1 lds
    v_mfma_f32_16x16x32_bf16 v[68:71], v[212:215], a[148:151], v[68:71]
    ds_read_b64_tr_b16 v[204:205], v240 offset:45312
    v_mfma_f32_16x16x32_bf16 v[68:71], v[216:219], a[176:179], v[68:71]
    ds_read_b64_tr_b16 v[206:207], v240 offset:45824
    v_mfma_f32_16x16x32_bf16 v[68:71], v[220:223], a[180:183], v[68:71]
    v_mfma_f32_16x16x32_bf16 v[100:103], v[208:211], a[152:155], v[100:103]
    buffer_load_dwordx4 v255, s[4:7], s64 offen offset:3072 sc1 lds
    v_mfma_f32_16x16x32_bf16 v[100:103], v[212:215], a[156:159], v[100:103]
    v_mfma_f32_16x16x32_bf16 v[100:103], v[216:219], a[184:187], v[100:103]
    v_mfma_f32_16x16x32_bf16 v[100:103], v[220:223], a[188:191], v[100:103]
    s_waitcnt lgkmcnt(0)
    s_add_u32 m0, m0, 16384
    v_mfma_f32_16x16x32_bf16 v[136:139], v[192:195], a[128:131], v[136:139]
    ds_read_b64_tr_b16 v[208:209], v241 offset:33024
    v_mfma_f32_16x16x32_bf16 v[136:139], v[196:199], a[132:135], v[136:139]
    ds_read_b64_tr_b16 v[210:211], v241 offset:33536
    v_mfma_f32_16x16x32_bf16 v[136:139], v[200:203], a[160:163], v[136:139]
    v_mfma_f32_16x16x32_bf16 v[136:139], v[204:207], a[164:167], v[136:139]
    s_sub_u32 s98, 2, s74
    ds_read_b64_tr_b16 v[212:213], v241 offset:37120
    v_mfma_f32_16x16x32_bf16 v[152:155], v[192:195], a[136:139], v[152:155]
    ds_read_b64_tr_b16 v[214:215], v241 offset:37632
    v_mfma_f32_16x16x32_bf16 v[152:155], v[196:199], a[140:143], v[152:155]
    v_mfma_f32_16x16x32_bf16 v[152:155], v[200:203], a[168:171], v[152:155]
    s_add_u32 s64, s77, 32768
    ds_read_b64_tr_b16 v[216:217], v241 offset:41216
    v_mfma_f32_16x16x32_bf16 v[152:155], v[204:207], a[172:175], v[152:155]
    ds_read_b64_tr_b16 v[218:219], v241 offset:41728
    v_mfma_f32_16x16x32_bf16 v[168:171], v[192:195], a[144:147], v[168:171]
    v_mfma_f32_16x16x32_bf16 v[168:171], v[196:199], a[148:151], v[168:171]
    ds_read_b64_tr_b16 v[220:221], v241 offset:45312
    v_mfma_f32_16x16x32_bf16 v[168:171], v[200:203], a[176:179], v[168:171]
    s_cmp_ge_i32 s98, s73
    s_cselect_b32 s64, s64, 1073741824
    ds_read_b64_tr_b16 v[222:223], v241 offset:45824
    v_mfma_f32_16x16x32_bf16 v[168:171], v[204:207], a[180:183], v[168:171]
    v_mfma_f32_16x16x32_bf16 v[184:187], v[192:195], a[152:155], v[184:187]
    v_mfma_f32_16x16x32_bf16 v[184:187], v[196:199], a[156:159], v[184:187]
    buffer_load_dwordx4 v255, s[4:7], s64 offen offset:0 sc1 lds
    v_mfma_f32_16x16x32_bf16 v[184:187], v[200:203], a[184:187], v[184:187]
    v_mfma_f32_16x16x32_bf16 v[184:187], v[204:207], a[188:191], v[184:187]
    s_waitcnt vmcnt(14) lgkmcnt(0)
    s_barrier
    v_mfma_f32_16x16x32_bf16 v[20:23], v[208:211], a[128:131], v[20:23]
    ds_read_b64_tr_b16 v[192:193], v240 offset:49152
    v_mfma_f32_16x16x32_bf16 v[20:23], v[212:215], a[132:135], v[20:23]
    buffer_load_dwordx4 v255, s[4:7], s64 offen offset:1024 sc1 lds
    v_mfma_f32_16x16x32_bf16 v[20:23], v[216:219], a[160:163], v[20:23]
    ds_read_b64_tr_b16 v[194:195], v240 offset:49664
    v_accvgpr_write_b32 a116, -1
    v_mfma_f32_16x16x32_bf16 v[20:23], v[220:223], a[164:167], v[20:23]
    ds_read_b64_tr_b16 v[196:197], v240 offset:53248
    v_mfma_f32_16x16x32_bf16 v[52:55], v[208:211], a[136:139], v[52:55]
    ds_read_b64_tr_b16 v[198:199], v240 offset:53760
    v_accvgpr_write_b32 a117, -1
    v_mfma_f32_16x16x32_bf16 v[52:55], v[212:215], a[140:143], v[52:55]
    buffer_load_dwordx4 v255, s[4:7], s64 offen offset:2048 sc1 lds
    v_mfma_f32_16x16x32_bf16 v[52:55], v[216:219], a[168:171], v[52:55]
    ds_read_b64_tr_b16 v[200:201], v240 offset:57344
    v_mfma_f32_16x16x32_bf16 v[52:55], v[220:223], a[172:175], v[52:55]
    ds_read_b64_tr_b16 v[202:203], v240 offset:57856
    v_accvgpr_write_b32 a118, -1
    v_mfma_f32_16x16x32_bf16 v[84:87], v[208:211], a[144:147], v[84:87]
    v_accvgpr_write_b32 a124, 0
    v_mfma_f32_16x16x32_bf16 v[84:87], v[212:215], a[148:151], v[84:87]
    buffer_load_dwordx4 v255, s[4:7], s64 offen offset:3072 sc1 lds
    v_mfma_f32_16x16x32_bf16 v[84:87], v[216:219], a[176:179], v[84:87]
    ds_read_b64_tr_b16 v[204:205], v240 offset:61440
    v_accvgpr_write_b32 a125, 0
    v_mfma_f32_16x16x32_bf16 v[84:87], v[220:223], a[180:183], v[84:87]
    v_accvgpr_write_b32 a119, -1
    v_accvgpr_write_b32 a126, 0
    v_mfma_f32_16x16x32_bf16 v[116:119], v[208:211], a[152:155], v[116:119]
    ds_read_b64_tr_b16 v[206:207], v240 offset:61952
    v_accvgpr_write_b32 a127, 0
    v_mfma_f32_16x16x32_bf16 v[116:119], v[212:215], a[156:159], v[116:119]
    v_mfma_f32_16x16x32_bf16 v[116:119], v[216:219], a[184:187], v[116:119]
    v_mfma_f32_16x16x32_bf16 v[116:119], v[220:223], a[188:191], v[116:119]
    s_waitcnt lgkmcnt(0)
    v_mfma_f32_16x16x32_bf16 v[128:131], v[192:195], a[192:195], v[128:131]
    ds_read_b64_tr_b16 v[208:209], v241 offset:49152
    v_mov_b32 v235, 0xf149f2ca
    v_mfma_f32_16x16x32_bf16 v[128:131], v[196:199], a[196:199], v[128:131]
    ds_read_b64_tr_b16 v[210:211], v241 offset:49664
    v_and_b32 v224, 3, v254
    v_mfma_f32_16x16x32_bf16 v[128:131], v[200:203], a[224:227], v[128:131]
    v_sub_u32 v224, 0, v224
    v_ashrrev_i32 v224, 31, v224
    v_mfma_f32_16x16x32_bf16 v[128:131], v[204:207], a[228:231], v[128:131]
    ds_read_b64_tr_b16 v[212:213], v241 offset:53248
    v_not_b32 v224, v224
    v_mfma_f32_16x16x32_bf16 v[144:147], v[192:195], a[200:203], v[144:147]
    ds_read_b64_tr_b16 v[214:215], v241 offset:53760
    v_and_b32 v224, 0x3f803f80, v224
    v_mfma_f32_16x16x32_bf16 v[144:147], v[196:199], a[204:207], v[144:147]
    v_accvgpr_write_b32 a112, v224
    v_mfma_f32_16x16x32_bf16 v[144:147], v[200:203], a[232:235], v[144:147]
    ds_read_b64_tr_b16 v[216:217], v241 offset:57344
    v_accvgpr_write_b32 a113, v224
    v_mfma_f32_16x16x32_bf16 v[144:147], v[204:207], a[236:239], v[144:147]
    ds_read_b64_tr_b16 v[218:219], v241 offset:57856
    v_accvgpr_write_b32 a114, v224
    v_mfma_f32_16x16x32_bf16 v[160:163], v[192:195], a[208:211], v[160:163]
    v_accvgpr_write_b32 a115, v224
    v_mfma_f32_16x16x32_bf16 v[160:163], v[196:199], a[212:215], v[160:163]
    ds_read_b64_tr_b16 v[220:221], v241 offset:61440
    v_subrev_u32 v228, s68, v255
    v_mfma_f32_16x16x32_bf16 v[160:163], v[200:203], a[240:243], v[160:163]
    ds_read_b64_tr_b16 v[222:223], v241 offset:61952
    v_mov_b32 v229, v228
    v_mfma_f32_16x16x32_bf16 v[160:163], v[204:207], a[244:247], v[160:163]
    v_mov_b32 v230, v228
    v_mov_b32 v231, v255
    v_mfma_f32_16x16x32_bf16 v[176:179], v[192:195], a[216:219], v[176:179]
    v_lshrrev_b32 v224, 4, v254
    v_mfma_f32_16x16x32_bf16 v[176:179], v[196:199], a[220:223], v[176:179]
    v_lshlrev_b32 v224, 2, v224
    v_mfma_f32_16x16x32_bf16 v[176:179], v[200:203], a[248:251], v[176:179]
    v_and_b32 v225, 15, v254
    v_mfma_f32_16x16x32_bf16 v[176:179], v[204:207], a[252:255], v[176:179]
    s_waitcnt lgkmcnt(0)
    v_sub_u32 v224, v225, v224
    v_mfma_f32_16x16x32_bf16 v[4:7], v[208:211], a[192:195], v[4:7]
    s_and_b32 s91, s56, 1
    ds_read_b64_tr_b16 v[192:193], v240 offset:49408
    v_mfma_f32_16x16x32_bf16 v[4:7], v[212:215], a[196:199], v[4:7]
    s_lshl_b32 s91, s91, 14
    ds_read_b64_tr_b16 v[194:195], v240 offset:49920
    v_mfma_f32_16x16x32_bf16 v[4:7], v[216:219], a[224:227], v[4:7]
    v_add_u32 v236, s91, v255
    v_mfma_f32_16x16x32_bf16 v[4:7], v[220:223], a[228:231], v[4:7]
    ds_read_b64_tr_b16 v[196:197], v240 offset:53504
    v_cmp_le_i32 s[82:83], 0, v224
    v_mfma_f32_16x16x32_bf16 v[36:39], v[208:211], a[200:203], v[36:39]
    ds_read_b64_tr_b16 v[198:199], v240 offset:54016
    v_cmp_le_i32 s[84:85], 1, v224
    v_mfma_f32_16x16x32_bf16 v[36:39], v[212:215], a[204:207], v[36:39]
    v_cmp_le_i32 s[86:87], 2, v224
    v_cmp_le_i32 s[92:93], 3, v224
    v_mfma_f32_16x16x32_bf16 v[36:39], v[216:219], a[232:235], v[36:39]
    ds_read_b64_tr_b16 v[200:201], v240 offset:57600
    v_mov_b32 v242, 0
    v_mfma_f32_16x16x32_bf16 v[36:39], v[220:223], a[236:239], v[36:39]
    ds_read_b64_tr_b16 v[202:203], v240 offset:58112
    v_mov_b32 v243, 0
    v_mfma_f32_16x16x32_bf16 v[68:71], v[208:211], a[208:211], v[68:71]
    v_mov_b32 v244, 0
    v_mfma_f32_16x16x32_bf16 v[68:71], v[212:215], a[212:215], v[68:71]
    ds_read_b64_tr_b16 v[204:205], v240 offset:61696
    v_mov_b32 v245, 0
    v_mfma_f32_16x16x32_bf16 v[68:71], v[216:219], a[240:243], v[68:71]
    ds_read_b64_tr_b16 v[206:207], v240 offset:62208
    v_mov_b32 v246, 0
    v_mfma_f32_16x16x32_bf16 v[68:71], v[220:223], a[244:247], v[68:71]
    v_mov_b32 v247, 0
    v_mfma_f32_16x16x32_bf16 v[100:103], v[208:211], a[216:219], v[100:103]
    v_mov_b32 v248, 0
    v_mfma_f32_16x16x32_bf16 v[100:103], v[212:215], a[220:223], v[100:103]
    v_mov_b32 v249, 0
    v_mfma_f32_16x16x32_bf16 v[100:103], v[216:219], a[248:251], v[100:103]
    v_mfma_f32_16x16x32_bf16 v[100:103], v[220:223], a[252:255], v[100:103]
    s_waitcnt lgkmcnt(0)
    v_mfma_f32_16x16x32_bf16 v[136:139], v[192:195], a[192:195], v[136:139]
    ds_read_b64_tr_b16 v[208:209], v241 offset:49408
    v_mfma_f32_16x16x32_bf16 v[136:139], v[196:199], a[196:199], v[136:139]
    ds_read_b64_tr_b16 v[210:211], v241 offset:49920
    v_mfma_f32_16x16x32_bf16 v[136:139], v[200:203], a[224:227], v[136:139]
    v_mfma_f32_16x16x32_bf16 v[136:139], v[204:207], a[228:231], v[136:139]
    ds_read_b64_tr_b16 v[212:213], v241 offset:53504
    v_mfma_f32_16x16x32_bf16 v[152:155], v[192:195], a[200:203], v[152:155]
    ds_read_b64_tr_b16 v[214:215], v241 offset:54016
    v_mul_f32 v128, s97, v128
    v_mfma_f32_16x16x32_bf16 v[152:155], v[196:199], a[204:207], v[152:155]
    v_mul_f32 v129, s97, v129
    v_mul_f32 v130, s97, v130
    v_mfma_f32_16x16x32_bf16 v[152:155], v[200:203], a[232:235], v[152:155]
    ds_read_b64_tr_b16 v[216:217], v241 offset:57600
    v_mul_f32 v131, s97, v131
    v_mfma_f32_16x16x32_bf16 v[152:155], v[204:207], a[236:239], v[152:155]
    v_mul_f32 v4, s97, v4
    v_mul_f32 v5, s97, v5
    v_mfma_f32_16x16x32_bf16 v[168:171], v[192:195], a[208:211], v[168:171]
    ds_read_b64_tr_b16 v[218:219], v241 offset:58112
    v_mul_f32 v6, s97, v6
    v_mfma_f32_16x16x32_bf16 v[168:171], v[196:199], a[212:215], v[168:171]
    v_mul_f32 v7, s97, v7
    v_cvt_pk_bf16_f32 v128, v128, v129
    v_mfma_f32_16x16x32_bf16 v[168:171], v[200:203], a[240:243], v[168:171]
    ds_read_b64_tr_b16 v[220:221], v241 offset:61696
    v_cvt_pk_bf16_f32 v129, v130, v131
    v_mfma_f32_16x16x32_bf16 v[168:171], v[204:207], a[244:247], v[168:171]
    v_cvt_pk_bf16_f32 v130, v4, v5
    v_cvt_pk_bf16_f32 v131, v6, v7
    v_mfma_f32_16x16x32_bf16 v[184:187], v[192:195], a[216:219], v[184:187]
    ds_read_b64_tr_b16 v[222:223], v241 offset:62208
    v_mul_f32 v144, s97, v144
    v_mfma_f32_16x16x32_bf16 v[184:187], v[196:199], a[220:223], v[184:187]
    v_mul_f32 v145, s97, v145
    v_mul_f32 v146, s97, v146
    v_mfma_f32_16x16x32_bf16 v[184:187], v[200:203], a[248:251], v[184:187]
    v_mul_f32 v147, s97, v147
    v_mul_f32 v36, s97, v36
    v_mfma_f32_16x16x32_bf16 v[184:187], v[204:207], a[252:255], v[184:187]
    s_waitcnt vmcnt(12) lgkmcnt(0)
    s_barrier
    v_mfma_f32_16x16x32_bf16 v[20:23], v[208:211], a[192:195], v[20:23]
    v_mul_f32 v37, s97, v37
    v_mul_f32 v38, s97, v38
    v_mfma_f32_16x16x32_bf16 v[20:23], v[212:215], a[196:199], v[20:23]
    v_mul_f32 v39, s97, v39
    v_cvt_pk_bf16_f32 v144, v144, v145
    v_mfma_f32_16x16x32_bf16 v[20:23], v[216:219], a[224:227], v[20:23]
    v_cvt_pk_bf16_f32 v145, v146, v147
    v_cvt_pk_bf16_f32 v146, v36, v37
    v_mfma_f32_16x16x32_bf16 v[20:23], v[220:223], a[228:231], v[20:23]
    v_cvt_pk_bf16_f32 v147, v38, v39
    v_mul_f32 v160, s97, v160
    v_mfma_f32_16x16x32_bf16 v[52:55], v[208:211], a[200:203], v[52:55]
    v_mul_f32 v161, s97, v161
    v_mul_f32 v162, s97, v162
    v_mfma_f32_16x16x32_bf16 v[52:55], v[212:215], a[204:207], v[52:55]
    ds_read_b128 a[64:67], v231 offset:32768
    v_mul_f32 v163, s97, v163
    v_mfma_f32_16x16x32_bf16 v[52:55], v[216:219], a[232:235], v[52:55]
    v_mul_f32 v68, s97, v68
    v_mul_f32 v69, s97, v69
    v_mfma_f32_16x16x32_bf16 v[52:55], v[220:223], a[236:239], v[52:55]
    v_mul_f32 v70, s97, v70
    v_mul_f32 v71, s97, v71
    v_mfma_f32_16x16x32_bf16 v[84:87], v[208:211], a[208:211], v[84:87]
    ds_read_b128 a[68:71], v231 offset:33792
    v_cvt_pk_bf16_f32 v160, v160, v161
    v_mfma_f32_16x16x32_bf16 v[84:87], v[212:215], a[212:215], v[84:87]
    v_cvt_pk_bf16_f32 v161, v162, v163
    v_cvt_pk_bf16_f32 v162, v68, v69
    v_mfma_f32_16x16x32_bf16 v[84:87], v[216:219], a[240:243], v[84:87]
    v_cvt_pk_bf16_f32 v163, v70, v71
    v_mul_f32 v176, s97, v176
    v_mfma_f32_16x16x32_bf16 v[84:87], v[220:223], a[244:247], v[84:87]
    v_mul_f32 v177, s97, v177
    v_mul_f32 v178, s97, v178
    v_mfma_f32_16x16x32_bf16 v[116:119], v[208:211], a[216:219], v[116:119]
    ds_read_b128 a[72:75], v231 offset:34816
    v_mul_f32 v179, s97, v179
    v_mfma_f32_16x16x32_bf16 v[116:119], v[212:215], a[220:223], v[116:119]
    v_mul_f32 v100, s97, v100
    v_mul_f32 v101, s97, v101
    v_mfma_f32_16x16x32_bf16 v[116:119], v[216:219], a[248:251], v[116:119]
    v_mul_f32 v102, s97, v102
    v_mul_f32 v103, s97, v103
    v_mfma_f32_16x16x32_bf16 v[116:119], v[220:223], a[252:255], v[116:119]
    ds_read_b128 a[76:79], v231 offset:35840
    v_cvt_pk_bf16_f32 v176, v176, v177
    v_cvt_pk_bf16_f32 v177, v178, v179
    v_cvt_pk_bf16_f32 v178, v100, v101
    v_cvt_pk_bf16_f32 v179, v102, v103
    s_add_u32 s94, s74, 30
    s_add_u32 s60, s73, s74
    s_sub_u32 s60, s60, 3
    s_max_i32 s60, s60, 0
    s_sub_u32 s61, s94, s60
    v_mfma_f32_32x32x16_bf16 a[96:111], a[124:127], a[124:127], 0
    s_add_u32 m0, s68, 131072
    s_sub_u32 s64, 3, s74
    s_max_i32 s64, s64, 0
    s_lshl_b32 s64, s64, 14
    s_add_u32 s64, s64, s69
    v_accvgpr_write_b32 a8, v128
    v_accvgpr_write_b32 a9, v129
    v_accvgpr_write_b32 a10, v130
    v_accvgpr_write_b32 a11, v131
    v_accvgpr_write_b32 a24, v144
    v_accvgpr_write_b32 a25, v145
    v_mfma_f32_32x32x16_bf16 v[192:207], a[124:127], a[124:127], 0
    v_accvgpr_write_b32 a26, v146
    v_accvgpr_write_b32 a27, v147
    v_accvgpr_write_b32 a40, v160
    v_accvgpr_write_b32 a41, v161
    v_accvgpr_write_b32 a42, v162
    v_accvgpr_write_b32 a43, v163
    v_mfma_f32_32x32x16_bf16 v[208:223], a[124:127], a[124:127], 0
    v_accvgpr_write_b32 a56, v176
    v_accvgpr_write_b32 a57, v177
    v_accvgpr_write_b32 a58, v178
    v_accvgpr_write_b32 a59, v179
    v_mfma_f32_32x32x16_bf16 v[0:15], a[124:127], a[124:127], 0
    buffer_load_dwordx4 v255, s[4:7], s64 offen offset:0 sc1 lds
    v_mul_f32 v136, s97, v136
    v_mul_f32 v137, s97, v137
    v_mul_f32 v138, s97, v138
    v_mul_f32 v139, s97, v139
    v_mul_f32 v20, s97, v20
    v_mul_f32 v21, s97, v21
    buffer_load_dwordx4 v255, s[4:7], s64 offen offset:1024 sc1 lds
    v_mul_f32 v22, s97, v22
    v_mul_f32 v23, s97, v23
    v_cvt_pk_bf16_f32 v136, v136, v137
    v_cvt_pk_bf16_f32 v137, v138, v139
    v_cvt_pk_bf16_f32 v138, v20, v21
    v_cvt_pk_bf16_f32 v139, v22, v23
    v_accvgpr_write_b32 a12, v136
    v_accvgpr_write_b32 a13, v137
    v_accvgpr_write_b32 a14, v138
    v_accvgpr_write_b32 a15, v139
    v_mfma_f32_32x32x16_bf16 v[32:47], a[124:127], a[124:127], 0
    buffer_load_dwordx4 v255, s[4:7], s64 offen offset:2048 sc1 lds
    v_mul_f32 v152, s97, v152
    v_mul_f32 v153, s97, v153
    v_mul_f32 v154, s97, v154
    v_mul_f32 v155, s97, v155
    v_mul_f32 v52, s97, v52
    v_mul_f32 v53, s97, v53
    buffer_load_dwordx4 v255, s[4:7], s64 offen offset:3072 sc1 lds
    s_add_u32 m0, m0, 16384
    s_sub_u32 s98, 3, s74
    s_add_u32 s64, s77, 16384
    s_cmp_ge_i32 s98, s73
    s_cselect_b32 s64, s64, 1073741824
    v_mul_f32 v54, s97, v54
    v_mul_f32 v55, s97, v55
    v_cvt_pk_bf16_f32 v152, v152, v153
    v_cvt_pk_bf16_f32 v153, v154, v155
    v_cvt_pk_bf16_f32 v154, v52, v53
    v_cvt_pk_bf16_f32 v155, v54, v55
    v_mfma_f32_32x32x16_bf16 v[16:31], a[124:127], a[124:127], 0
    v_accvgpr_write_b32 a28, v152
    v_accvgpr_write_b32 a29, v153
    v_accvgpr_write_b32 a30, v154
    v_accvgpr_write_b32 a31, v155
    v_mfma_f32_32x32x16_bf16 v[64:79], a[124:127], a[124:127], 0
    buffer_load_dwordx4 v255, s[4:7], s64 offen offset:0 sc1 lds
    v_mul_f32 v168, s97, v168
    v_mul_f32 v169, s97, v169
    v_mul_f32 v170, s97, v170
    v_mul_f32 v171, s97, v171
    v_mul_f32 v84, s97, v84
    v_mul_f32 v85, s97, v85
    buffer_load_dwordx4 v255, s[4:7], s64 offen offset:1024 sc1 lds
    v_mul_f32 v86, s97, v86
    v_mul_f32 v87, s97, v87
    v_cvt_pk_bf16_f32 v168, v168, v169
    v_cvt_pk_bf16_f32 v169, v170, v171
    v_cvt_pk_bf16_f32 v170, v84, v85
    v_cvt_pk_bf16_f32 v171, v86, v87
    v_mfma_f32_32x32x16_bf16 v[48:63], a[124:127], a[124:127], 0
    v_accvgpr_write_b32 a44, v168
    v_accvgpr_write_b32 a45, v169
    v_accvgpr_write_b32 a46, v170
    v_accvgpr_write_b32 a47, v171
    v_mfma_f32_32x32x16_bf16 v[96:111], a[124:127], a[124:127], 0
    buffer_load_dwordx4 v255, s[4:7], s64 offen offset:2048 sc1 lds
    v_mul_f32 v184, s97, v184
    v_mul_f32 v185, s97, v185
    v_mul_f32 v186, s97, v186
    v_mul_f32 v187, s97, v187
    v_mul_f32 v116, s97, v116
    v_mul_f32 v117, s97, v117
    buffer_load_dwordx4 v255, s[4:7], s64 offen offset:3072 sc1 lds
    v_mul_f32 v118, s97, v118
    v_mul_f32 v119, s97, v119
    v_cvt_pk_bf16_f32 v184, v184, v185
    v_cvt_pk_bf16_f32 v185, v186, v187
    v_cvt_pk_bf16_f32 v186, v116, v117
    v_cvt_pk_bf16_f32 v187, v118, v119
    v_mfma_f32_32x32x16_bf16 v[80:95], a[124:127], a[124:127], 0
    v_accvgpr_write_b32 a60, v184
    v_accvgpr_write_b32 a61, v185
    v_accvgpr_write_b32 a62, v186
    v_accvgpr_write_b32 a63, v187
    v_mfma_f32_32x32x16_bf16 v[112:127], a[124:127], a[124:127], 0
    s_cmp_lg_u32 s59, 0
    s_cbranch_scc1 L_maxpass
L_maxret:
    s_cmp_eq_u32 s70, 2
    s_cbranch_scc1 L_pro_e1
L_pro_e1r:
    s_waitcnt lgkmcnt(0)
    s_cmp_ge_u32 s56, 2
    s_cbranch_scc1 L_pro_x
    v_mfma_f32_16x16x32_bf16 v[128:131], a[64:67], a[0:3], v[192:195]
    ds_read_b128 a[80:83], v231 offset:36864
    ds_read_b128 a[84:87], v231 offset:37888
    v_mfma_f32_16x16x32_bf16 v[128:131], a[68:71], a[4:7], v[128:131]
    ds_read_b128 a[88:91], v231 offset:38912
    ds_read_b128 a[92:95], v231 offset:39936
    v_mfma_f32_16x16x32_bf16 v[128:131], a[72:75], a[8:11], v[128:131]
    ds_write_b128 v236, a[0:3] offset:0
    v_mfma_f32_16x16x32_bf16 v[128:131], a[76:79], a[12:15], v[128:131]
    ds_write_b128 v236, a[4:7] offset:1024
    v_mfma_f32_16x16x32_bf16 v[132:135], a[64:67], a[16:19], v[196:199]
    ds_write_b128 v236, a[8:11] offset:2048
    v_mfma_f32_16x16x32_bf16 v[132:135], a[68:71], a[20:23], v[132:135]
    ds_write_b128 v236, a[12:15] offset:3072
    v_mfma_f32_16x16x32_bf16 v[132:135], a[72:75], a[24:27], v[132:135]
    ds_write_b128 v236, a[16:19] offset:4096
    v_mfma_f32_16x16x32_bf16 v[132:135], a[76:79], a[28:31], v[132:135]
    ds_write_b128 v236, a[20:23] offset:5120
    v_mfma_f32_16x16x32_bf16 v[136:139], a[64:67], a[32:35], v[200:203]
    ds_write_b128 v236, a[24:27] offset:6144
    v_mfma_f32_16x16x32_bf16 v[136:139], a[68:71], a[36:39], v[136:139]
    ds_write_b128 v236, a[28:31] offset:7168
    v_mfma_f32_16x16x32_bf16 v[136:139], a[72:75], a[40:43], v[136:139]
    ds_write_b128 v236, a[32:35] offset:8192
    v_mfma_f32_16x16x32_bf16 v[136:139], a[76:79], a[44:47], v[136:139]
    ds_write_b128 v236, a[36:39] offset:9216
    v_mfma_f32_16x16x32_bf16 v[140:143], a[64:67], a[48:51], v[204:207]
    v_exp_f32 v128, v128
    v_mfma_f32_16x16x32_bf16 v[140:143], a[68:71], a[52:55], v[140:143]
    v_exp_f32 v129, v129
    v_mfma_f32_16x16x32_bf16 v[140:143], a[72:75], a[56:59], v[140:143]
    v_exp_f32 v130, v130
    v_mfma_f32_16x16x32_bf16 v[140:143], a[76:79], a[60:63], v[140:143]
    s_waitcnt lgkmcnt(0)
    v_exp_f32 v131, v131
    v_mfma_f32_16x16x32_bf16 v[144:147], a[80:83], a[0:3], v[208:211]
    ds_write_b128 v236, a[40:43] offset:10240
    v_mfma_f32_16x16x32_bf16 v[144:147], a[84:87], a[4:7], v[144:147]
    v_cvt_pk_bf16_f32 v160, v128, v129
    v_mfma_f32_16x16x32_bf16 v[144:147], a[88:91], a[8:11], v[144:147]
    v_exp_f32 v132, v132
    v_mfma_f32_16x16x32_bf16 v[144:147], a[92:95], a[12:15], v[144:147]
    v_exp_f32 v133, v133
    v_mfma_f32_16x16x32_bf16 v[148:151], a[80:83], a[16:19], v[212:215]
    ds_write_b128 v236, a[44:47] offset:11264
    v_mfma_f32_16x16x32_bf16 v[148:151], a[84:87], a[20:23], v[148:151]
    v_cvt_pk_bf16_f32 v161, v130, v131
    v_mfma_f32_16x16x32_bf16 v[148:151], a[88:91], a[24:27], v[148:151]
    v_exp_f32 v134, v134
    v_mfma_f32_16x16x32_bf16 v[148:151], a[92:95], a[28:31], v[148:151]
    v_exp_f32 v135, v135
    v_mfma_f32_16x16x32_bf16 v[152:155], a[80:83], a[32:35], v[216:219]
    ds_write_b128 v236, a[48:51] offset:12288
    v_mfma_f32_16x16x32_bf16 v[152:155], a[84:87], a[36:39], v[152:155]
    v_cvt_pk_bf16_f32 v164, v132, v133
    v_mfma_f32_16x16x32_bf16 v[152:155], a[88:91], a[40:43], v[152:155]
    v_exp_f32 v136, v136
    v_mfma_f32_16x16x32_bf16 v[152:155], a[92:95], a[44:47], v[152:155]
    ds_write_b128 v236, a[52:55] offset:13312
    v_mfma_f32_16x16x32_bf16 v[156:159], a[80:83], a[48:51], v[220:223]
    v_exp_f32 v137, v137
    v_mfma_f32_16x16x32_bf16 v[156:159], a[84:87], a[52:55], v[156:159]
    ds_write_b128 v236, a[56:59] offset:14336
    ds_write_b128 v236, a[60:63] offset:15360
    v_cvt_pk_bf16_f32 v165, v134, v135
    v_mfma_f32_16x16x32_bf16 v[156:159], a[88:91], a[56:59], v[156:159]
    v_exp_f32 v138, v138
    v_exp_f32 v139, v139
    v_cvt_pk_bf16_f32 v168, v136, v137
    v_mfma_f32_16x16x32_bf16 v[156:159], a[92:95], a[60:63], v[156:159]
    s_waitcnt vmcnt(16)
    s_barrier
L_pro_xr:
    v_add_u32 v231, s80, v228
    v_add_u32 v233, s80, v229
    ds_read_b128 a[64:67], v231 offset:32768
    ds_read_b128 a[68:71], v231 offset:33792
    ds_read_b128 a[72:75], v231 offset:34816
    ds_read_b128 a[76:79], v231 offset:35840
    s_cmp_lt_u32 s79, s94
    s_cselect_b32 s76, s75, 1073741824
    v_exp_f32 v140, v140
    v_exp_f32 v141, v141
    s_add_u32 m0, s81, 32768
    v_cvt_pk_bf16_f32 v169, v138, v139
    v_exp_f32 v142, v142
    buffer_load_dwordx4 v255, s[4:7], s76 offen offset:0 sc1 lds
    v_exp_f32 v143, v143
    v_cvt_pk_bf16_f32 v172, v140, v141
    buffer_load_dwordx4 v255, s[4:7], s76 offen offset:1024 sc1 lds
    v_cvt_pk_bf16_f32 v173, v142, v143
    v_exp_f32 v144, v144
    buffer_load_dwordx4 v255, s[4:7], s76 offen offset:2048 sc1 lds
    v_exp_f32 v145, v145
    v_exp_f32 v146, v146
    buffer_load_dwordx4 v255, s[4:7], s76 offen offset:3072 sc1 lds
    v_exp_f32 v147, v147
    v_cvt_pk_bf16_f32 v162, v144, v145
    s_sub_u32 s78, s79, s60
    v_exp_f32 v148, v148
    v_exp_f32 v149, v149
    s_add_u32 s76, m0, 16384
    v_cvt_pk_bf16_f32 v163, v146, v147
    v_exp_f32 v150, v150
    s_cmp_lt_u32 s78, s61
    s_cselect_b32 s78, s77, 1073741824
    s_cselect_b32 m0, s76, 0x30000
    v_exp_f32 v151, v151
    v_cvt_pk_bf16_f32 v166, v148, v149
    s_add_u32 s75, s75, 16384
    v_exp_f32 v152, v152
    v_exp_f32 v153, v153
    s_sub_u32 s77, s77, 16384
    s_lshl_b32 s89, s58, 9
    s_lshl_b32 s90, s57, 4
    s_add_u32 s89, s89, s90
    s_lshl_b32 s90, s56, 2
    s_add_u32 s89, s89, s90
    s_add_u32 s89, s89, 4096
    v_mov_b32 v250, s89
    buffer_store_dword v251, v250, s[4:7], 0 offen sc1
    s_mov_b32 s79, 2
    s_waitcnt lgkmcnt(0)
    s_cmp_eq_u32 s65, 2
    s_cbranch_scc1 L_special
    .p2align 6
L_att_loop:
    v_mfma_f32_16x16x32_bf16 v[128:131], a[64:67], a[0:3], v[192:195]
    ds_read_b128 a[80:83], v231 offset:36864
    v_cvt_pk_bf16_f32 v167, v150, v151
    v_mfma_f32_16x16x32_bf16 v[128:131], a[68:71], a[4:7], v[128:131]
    v_exp_f32 v154, v154
    v_mfma_f32_16x16x32_bf16 v[128:131], a[72:75], a[8:11], v[128:131]
    v_exp_f32 v155, v155
    v_mfma_f32_16x16x32_bf16 v[128:131], a[76:79], a[12:15], v[128:131]
    ds_read_b128 a[84:87], v231 offset:37888
    v_cvt_pk_bf16_f32 v170, v152, v153
    v_mfma_f32_16x16x32_bf16 v[132:135], a[64:67], a[16:19], v[196:199]
    buffer_load_dwordx4 v255, s[4:7], s78 offen offset:0 sc1 lds
    v_mfma_f32_16x16x32_bf16 v[132:135], a[68:71], a[20:23], v[132:135]
    v_exp_f32 v156, v156
    v_mfma_f32_16x16x32_bf16 v[132:135], a[72:75], a[24:27], v[132:135]
    ds_read_b128 a[88:91], v231 offset:38912
    ds_read_b128 a[92:95], v231 offset:39936
    v_mfma_f32_16x16x32_bf16 v[132:135], a[76:79], a[28:31], v[132:135]
    v_exp_f32 v157, v157
    v_mfma_f32_16x16x32_bf16 v[136:139], a[64:67], a[32:35], v[200:203]
    v_cvt_pk_bf16_f32 v171, v154, v155
    v_mfma_f32_16x16x32_bf16 v[136:139], a[68:71], a[36:39], v[136:139]
    v_exp_f32 v158, v158
    v_mfma_f32_16x16x32_bf16 v[136:139], a[72:75], a[40:43], v[136:139]
    buffer_load_dwordx4 v255, s[4:7], s78 offen offset:1024 sc1 lds
    v_mfma_f32_16x16x32_bf16 v[136:139], a[76:79], a[44:47], v[136:139]
    s_add_u32 s81, s80, 32768
    v_exp_f32 v159, v159
    v_mfma_f32_16x16x32_bf16 v[140:143], a[64:67], a[48:51], v[204:207]
    s_and_b32 s81, s81, 0x1ffff
    v_cvt_pk_bf16_f32 v174, v156, v157
    v_cvt_pk_bf16_f32 v175, v158, v159
    v_mfma_f32_16x16x32_bf16 v[140:143], a[68:71], a[52:55], v[140:143]
    v_exp_f32 v128, v128
    v_mfma_f32_16x16x32_bf16 v[140:143], a[72:75], a[56:59], v[140:143]
    v_add_u32 v234, s81, v230
    v_mfma_f32_16x16x32_bf16 v[140:143], a[76:79], a[60:63], v[140:143]
    s_waitcnt lgkmcnt(0)
    v_exp_f32 v129, v129
    v_mfma_f32_16x16x32_bf16 v[144:147], a[80:83], a[0:3], v[208:211]
    buffer_load_dwordx4 v255, s[4:7], s78 offen offset:2048 sc1 lds
    v_mfma_f32_16x16x32_bf16 v[144:147], a[84:87], a[4:7], v[144:147]
    v_exp_f32 v130, v130
    v_mfma_f32_16x16x32_bf16 v[144:147], a[88:91], a[8:11], v[144:147]
    ds_read_b128 a[64:67], v233 offset:40960
    ds_read_b128 a[68:71], v233 offset:41984
    v_mfma_f32_16x16x32_bf16 v[144:147], a[92:95], a[12:15], v[144:147]
    v_exp_f32 v131, v131
    v_mfma_f32_16x16x32_bf16 v[148:151], a[80:83], a[16:19], v[212:215]
    buffer_load_dwordx4 v255, s[4:7], s78 offen offset:3072 sc1 lds
    v_mfma_f32_16x16x32_bf16 v[148:151], a[84:87], a[20:23], v[148:151]
    ds_read_b128 a[72:75], v233 offset:43008
    v_cvt_pk_bf16_f32 v176, v128, v129
    v_mfma_f32_16x16x32_bf16 v[148:151], a[88:91], a[24:27], v[148:151]
    v_exp_f32 v132, v132
    v_mfma_f32_16x16x32_bf16 v[148:151], a[92:95], a[28:31], v[148:151]
    v_exp_f32 v133, v133
    v_mfma_f32_16x16x32_bf16 v[152:155], a[80:83], a[32:35], v[216:219]
    ds_read_b128 a[76:79], v233 offset:44032
    v_cvt_pk_bf16_f32 v177, v130, v131
    v_mfma_f32_16x16x32_bf16 v[152:155], a[84:87], a[36:39], v[152:155]
    v_exp_f32 v134, v134
    v_mfma_f32_16x16x32_bf16 v[152:155], a[88:91], a[40:43], v[152:155]
    v_exp_f32 v135, v135
    v_mfma_f32_16x16x32_bf16 v[152:155], a[92:95], a[44:47], v[152:155]
    s_cmp_lt_u32 s79, s94
    s_cselect_b32 s76, s75, 1073741824
    v_cvt_pk_bf16_f32 v180, v132, v133
    v_mfma_f32_16x16x32_bf16 v[156:159], a[80:83], a[48:51], v[220:223]
    v_exp_f32 v136, v136
    v_mfma_f32_16x16x32_bf16 v[156:159], a[84:87], a[52:55], v[156:159]
    v_exp_f32 v137, v137
    v_mfma_f32_16x16x32_bf16 v[156:159], a[88:91], a[56:59], v[156:159]
    s_bitcmp1_b64 s[62:63], s79
    v_cvt_pk_bf16_f32 v181, v134, v135
    v_mfma_f32_16x16x32_bf16 v[156:159], a[92:95], a[60:63], v[156:159]
    s_waitcnt vmcnt(17) lgkmcnt(0)
    s_cbranch_scc1 L_ev_even
L_ev_even_r:
    s_barrier
    v_mfma_f32_16x16x32_bf16 v[0:3], a[64:67], v[160:163], v[0:3]
    s_add_u32 m0, s80, 32768
    v_exp_f32 v138, v138
    v_mfma_f32_16x16x32_bf16 v[32:35], a[64:67], v[164:167], v[32:35]
    ds_read_b128 a[80:83], v234 offset:45056
    v_mfma_f32_16x16x32_bf16 v[64:67], a[64:67], v[168:171], v[64:67]
    buffer_load_dwordx4 v255, s[4:7], s76 offen offset:0 sc1 lds
    v_mfma_f32_16x16x32_bf16 v[96:99], a[64:67], v[172:175], v[96:99]
    v_exp_f32 v139, v139
    v_mfma_f32_16x16x32_bf16 v[4:7], a[68:71], v[160:163], v[4:7]
    ds_read_b128 a[84:87], v234 offset:46080
    v_cvt_pk_bf16_f32 v184, v136, v137
    v_mfma_f32_16x16x32_bf16 v[36:39], a[68:71], v[164:167], v[36:39]
    v_exp_f32 v140, v140
    v_mfma_f32_16x16x32_bf16 v[68:71], a[68:71], v[168:171], v[68:71]
    ds_read_b128 a[88:91], v234 offset:47104
    ds_read_b128 a[92:95], v234 offset:48128
    v_mfma_f32_16x16x32_bf16 v[100:103], a[68:71], v[172:175], v[100:103]
    v_exp_f32 v141, v141
    v_mfma_f32_16x16x32_bf16 v[8:11], a[72:75], v[160:163], v[8:11]
    v_add_u32 v231, s81, v228
    v_cvt_pk_bf16_f32 v185, v138, v139
    v_mfma_f32_16x16x32_bf16 v[40:43], a[72:75], v[164:167], v[40:43]
    buffer_load_dwordx4 v255, s[4:7], s76 offen offset:1024 sc1 lds
    v_mfma_f32_16x16x32_bf16 v[72:75], a[72:75], v[168:171], v[72:75]
    v_exp_f32 v142, v142
    v_mfma_f32_16x16x32_bf16 v[104:107], a[72:75], v[172:175], v[104:107]
    v_exp_f32 v143, v143
    v_mfma_f32_16x16x32_bf16 v[12:15], a[76:79], v[160:163], v[12:15]
    v_add_u32 v233, s81, v229
    v_cvt_pk_bf16_f32 v188, v140, v141
    v_mfma_f32_16x16x32_bf16 v[44:47], a[76:79], v[164:167], v[44:47]
    v_cvt_pk_bf16_f32 v189, v142, v143
    v_mfma_f32_16x16x32_bf16 v[76:79], a[76:79], v[168:171], v[76:79]
    v_exp_f32 v144, v144
    v_mfma_f32_16x16x32_bf16 v[108:111], a[76:79], v[172:175], v[108:111]
    s_waitcnt lgkmcnt(0)
    v_exp_f32 v145, v145
    v_mfma_f32_16x16x32_bf16 v[16:19], a[80:83], v[160:163], v[16:19]
    buffer_load_dwordx4 v255, s[4:7], s76 offen offset:2048 sc1 lds
    v_mfma_f32_16x16x32_bf16 v[48:51], a[80:83], v[164:167], v[48:51]
    ds_read_b128 a[64:67], v231 offset:32768
    v_mfma_f32_16x16x32_bf16 v[80:83], a[80:83], v[168:171], v[80:83]
    v_exp_f32 v146, v146
    v_mfma_f32_16x16x32_bf16 v[112:115], a[80:83], v[172:175], v[112:115]
    v_exp_f32 v147, v147
    v_mfma_f32_16x16x32_bf16 v[20:23], a[84:87], v[160:163], v[20:23]
    ds_read_b128 a[68:71], v231 offset:33792
    v_cvt_pk_bf16_f32 v178, v144, v145
    v_mfma_f32_16x16x32_bf16 v[52:55], a[84:87], v[164:167], v[52:55]
    v_exp_f32 v148, v148
    v_mfma_f32_16x16x32_bf16 v[84:87], a[84:87], v[168:171], v[84:87]
    v_exp_f32 v149, v149
    v_mfma_f32_16x16x32_bf16 v[116:119], a[84:87], v[172:175], v[116:119]
    ds_read_b128 a[72:75], v231 offset:34816
    v_cvt_pk_bf16_f32 v179, v146, v147
    v_mfma_f32_16x16x32_bf16 v[24:27], a[88:91], v[160:163], v[24:27]
    v_exp_f32 v150, v150
    v_mfma_f32_16x16x32_bf16 v[56:59], a[88:91], v[164:167], v[56:59]
    ds_read_b128 a[76:79], v231 offset:35840
    v_mfma_f32_16x16x32_bf16 v[88:91], a[88:91], v[168:171], v[88:91]
    buffer_load_dwordx4 v255, s[4:7], s76 offen offset:3072 sc1 lds
    v_mfma_f32_16x16x32_bf16 v[120:123], a[88:91], v[172:175], v[120:123]
    s_sub_u32 s78, s79, s60
    v_exp_f32 v151, v151
    v_mfma_f32_16x16x32_bf16 v[28:31], a[92:95], v[160:163], v[28:31]
    s_add_u32 s79, s79, 1
    s_add_u32 s76, m0, 16384
    v_cvt_pk_bf16_f32 v182, v148, v149
    v_mfma_f32_16x16x32_bf16 v[60:63], a[92:95], v[164:167], v[60:63]
    v_exp_f32 v152, v152
    v_mfma_f32_16x16x32_bf16 v[92:95], a[92:95], v[168:171], v[92:95]
    v_exp_f32 v153, v153
    v_mfma_f32_16x16x32_bf16 v[124:127], a[92:95], v[172:175], v[124:127]
    s_cmp_lt_u32 s78, s61
    s_cselect_b32 s78, s77, 1073741824
    s_cselect_b32 m0, s76, 0x30000
    v_mfma_f32_16x16x32_bf16 a[96:99], a[112:115], v[160:163], a[96:99]
    s_add_u32 s75, s75, 16384
    s_sub_u32 s77, s77, 16384
    v_mfma_f32_16x16x32_bf16 a[100:103], a[112:115], v[164:167], a[100:103]
    buffer_store_dwordx4 a[116:119], v255, s[12:15], s99 offen sc1
    v_mfma_f32_16x16x32_bf16 a[104:107], a[112:115], v[168:171], a[104:107]
    s_add_u32 s99, s99, 1024
    v_mfma_f32_16x16x32_bf16 a[108:111], a[112:115], v[172:175], a[108:111]
    s_waitcnt lgkmcnt(0)
L_step_odd:
    v_mfma_f32_16x16x32_bf16 v[128:131], a[64:67], a[0:3], v[192:195]
    ds_read_b128 a[80:83], v231 offset:36864
    v_cvt_pk_bf16_f32 v183, v150, v151
    v_mfma_f32_16x16x32_bf16 v[128:131], a[68:71], a[4:7], v[128:131]
    v_exp_f32 v154, v154
    v_mfma_f32_16x16x32_bf16 v[128:131], a[72:75], a[8:11], v[128:131]
    v_exp_f32 v155, v155
    v_mfma_f32_16x16x32_bf16 v[128:131], a[76:79], a[12:15], v[128:131]
    ds_read_b128 a[84:87], v231 offset:37888
    v_cvt_pk_bf16_f32 v186, v152, v153
    v_mfma_f32_16x16x32_bf16 v[132:135], a[64:67], a[16:19], v[196:199]
    buffer_load_dwordx4 v255, s[4:7], s78 offen offset:0 sc1 lds
    v_mfma_f32_16x16x32_bf16 v[132:135], a[68:71], a[20:23], v[132:135]
    v_exp_f32 v156, v156
    v_mfma_f32_16x16x32_bf16 v[132:135], a[72:75], a[24:27], v[132:135]
    ds_read_b128 a[88:91], v231 offset:38912
    ds_read_b128 a[92:95], v231 offset:39936
    v_mfma_f32_16x16x32_bf16 v[132:135], a[76:79], a[28:31], v[132:135]
    v_exp_f32 v157, v157
    v_mfma_f32_16x16x32_bf16 v[136:139], a[64:67], a[32:35], v[200:203]
    v_cvt_pk_bf16_f32 v187, v154, v155
    v_mfma_f32_16x16x32_bf16 v[136:139], a[68:71], a[36:39], v[136:139]
    v_exp_f32 v158, v158
    v_mfma_f32_16x16x32_bf16 v[136:139], a[72:75], a[40:43], v[136:139]
    buffer_load_dwordx4 v255, s[4:7], s78 offen offset:1024 sc1 lds
    v_mfma_f32_16x16x32_bf16 v[136:139], a[76:79], a[44:47], v[136:139]
    s_add_u32 s80, s81, 32768
    v_exp_f32 v159, v159
    v_mfma_f32_16x16x32_bf16 v[140:143], a[64:67], a[48:51], v[204:207]
    s_and_b32 s80, s80, 0x1ffff
    v_cvt_pk_bf16_f32 v190, v156, v157
    v_cvt_pk_bf16_f32 v191, v158, v159
    v_mfma_f32_16x16x32_bf16 v[140:143], a[68:71], a[52:55], v[140:143]
    v_exp_f32 v128, v128
    v_mfma_f32_16x16x32_bf16 v[140:143], a[72:75], a[56:59], v[140:143]
    v_add_u32 v234, s80, v230
    v_mfma_f32_16x16x32_bf16 v[140:143], a[76:79], a[60:63], v[140:143]
    s_waitcnt lgkmcnt(0)
    v_exp_f32 v129, v129
    v_mfma_f32_16x16x32_bf16 v[144:147], a[80:83], a[0:3], v[208:211]
    buffer_load_dwordx4 v255, s[4:7], s78 offen offset:2048 sc1 lds
    v_mfma_f32_16x16x32_bf16 v[144:147], a[84:87], a[4:7], v[144:147]
    v_exp_f32 v130, v130
    v_mfma_f32_16x16x32_bf16 v[144:147], a[88:91], a[8:11], v[144:147]
    ds_read_b128 a[64:67], v233 offset:40960
    ds_read_b128 a[68:71], v233 offset:41984
    v_mfma_f32_16x16x32_bf16 v[144:147], a[92:95], a[12:15], v[144:147]
    v_exp_f32 v131, v131
    v_mfma_f32_16x16x32_bf16 v[148:151], a[80:83], a[16:19], v[212:215]
    buffer_load_dwordx4 v255, s[4:7], s78 offen offset:3072 sc1 lds
    v_mfma_f32_16x16x32_bf16 v[148:151], a[84:87], a[20:23], v[148:151]
    ds_read_b128 a[72:75], v233 offset:43008
    v_cvt_pk_bf16_f32 v160, v128, v129
    v_mfma_f32_16x16x32_bf16 v[148:151], a[88:91], a[24:27], v[148:151]
    v_exp_f32 v132, v132
    v_mfma_f32_16x16x32_bf16 v[148:151], a[92:95], a[28:31], v[148:151]
    v_exp_f32 v133, v133
    v_mfma_f32_16x16x32_bf16 v[152:155], a[80:83], a[32:35], v[216:219]
    ds_read_b128 a[76:79], v233 offset:44032
    v_cvt_pk_bf16_f32 v161, v130, v131
    v_mfma_f32_16x16x32_bf16 v[152:155], a[84:87], a[36:39], v[152:155]
    v_exp_f32 v134, v134
    v_mfma_f32_16x16x32_bf16 v[152:155], a[88:91], a[40:43], v[152:155]
    v_exp_f32 v135, v135
    v_mfma_f32_16x16x32_bf16 v[152:155], a[92:95], a[44:47], v[152:155]
    s_cmp_lt_u32 s79, s94
    s_cselect_b32 s76, s75, 1073741824
    v_cvt_pk_bf16_f32 v164, v132, v133
    v_mfma_f32_16x16x32_bf16 v[156:159], a[80:83], a[48:51], v[220:223]
    v_exp_f32 v136, v136
    v_mfma_f32_16x16x32_bf16 v[156:159], a[84:87], a[52:55], v[156:159]
    v_exp_f32 v137, v137
    v_mfma_f32_16x16x32_bf16 v[156:159], a[88:91], a[56:59], v[156:159]
    s_bitcmp1_b64 s[62:63], s79
    v_cvt_pk_bf16_f32 v165, v134, v135
    v_mfma_f32_16x16x32_bf16 v[156:159], a[92:95], a[60:63], v[156:159]
    s_waitcnt vmcnt(17) lgkmcnt(0)
    s_cbranch_scc1 L_ev_odd
L_ev_odd_r:
    s_barrier
    v_mfma_f32_16x16x32_bf16 v[0:3], a[64:67], v[176:179], v[0:3]
    s_add_u32 m0, s81, 32768
    v_exp_f32 v138, v138
    v_mfma_f32_16x16x32_bf16 v[32:35], a[64:67], v[180:183], v[32:35]
    ds_read_b128 a[80:83], v234 offset:45056
    v_mfma_f32_16x16x32_bf16 v[64:67], a[64:67], v[184:187], v[64:67]
    buffer_load_dwordx4 v255, s[4:7], s76 offen offset:0 sc1 lds
    v_mfma_f32_16x16x32_bf16 v[96:99], a[64:67], v[188:191], v[96:99]
    v_exp_f32 v139, v139
    v_mfma_f32_16x16x32_bf16 v[4:7], a[68:71], v[176:179], v[4:7]
    ds_read_b128 a[84:87], v234 offset:46080
    v_cvt_pk_bf16_f32 v168, v136, v137
    v_mfma_f32_16x16x32_bf16 v[36:39], a[68:71], v[180:183], v[36:39]
    v_exp_f32 v140, v140
    v_mfma_f32_16x16x32_bf16 v[68:71], a[68:71], v[184:187], v[68:71]
    ds_read_b128 a[88:91], v234 offset:47104
    ds_read_b128 a[92:95], v234 offset:48128
    v_mfma_f32_16x16x32_bf16 v[100:103], a[68:71], v[188:191], v[100:103]
    v_exp_f32 v141, v141
    v_mfma_f32_16x16x32_bf16 v[8:11], a[72:75], v[176:179], v[8:11]
    v_add_u32 v231, s80, v228
    v_cvt_pk_bf16_f32 v169, v138, v139
    v_mfma_f32_16x16x32_bf16 v[40:43], a[72:75], v[180:183], v[40:43]
    buffer_load_dwordx4 v255, s[4:7], s76 offen offset:1024 sc1 lds
    v_mfma_f32_16x16x32_bf16 v[72:75], a[72:75], v[184:187], v[72:75]
    v_exp_f32 v142, v142
    v_mfma_f32_16x16x32_bf16 v[104:107], a[72:75], v[188:191], v[104:107]
    v_exp_f32 v143, v143
    v_mfma_f32_16x16x32_bf16 v[12:15], a[76:79], v[176:179], v[12:15]
    v_add_u32 v233, s80, v229
    v_cvt_pk_bf16_f32 v172, v140, v141
    v_mfma_f32_16x16x32_bf16 v[44:47], a[76:79], v[180:183], v[44:47]
    v_cvt_pk_bf16_f32 v173, v142, v143
    v_mfma_f32_16x16x32_bf16 v[76:79], a[76:79], v[184:187], v[76:79]
    v_exp_f32 v144, v144
    v_mfma_f32_16x16x32_bf16 v[108:111], a[76:79], v[188:191], v[108:111]
    s_waitcnt lgkmcnt(0)
    v_exp_f32 v145, v145
    v_mfma_f32_16x16x32_bf16 v[16:19], a[80:83], v[176:179], v[16:19]
    buffer_load_dwordx4 v255, s[4:7], s76 offen offset:2048 sc1 lds
    v_mfma_f32_16x16x32_bf16 v[48:51], a[80:83], v[180:183], v[48:51]
    ds_read_b128 a[64:67], v231 offset:32768
    v_mfma_f32_16x16x32_bf16 v[80:83], a[80:83], v[184:187], v[80:83]
    v_exp_f32 v146, v146
    v_mfma_f32_16x16x32_bf16 v[112:115], a[80:83], v[188:191], v[112:115]
    v_exp_f32 v147, v147
    v_mfma_f32_16x16x32_bf16 v[20:23], a[84:87], v[176:179], v[20:23]
    ds_read_b128 a[68:71], v231 offset:33792
    v_cvt_pk_bf16_f32 v162, v144, v145
    v_mfma_f32_16x16x32_bf16 v[52:55], a[84:87], v[180:183], v[52:55]
    v_exp_f32 v148, v148
    v_mfma_f32_16x16x32_bf16 v[84:87], a[84:87], v[184:187], v[84:87]
    v_exp_f32 v149, v149
    v_mfma_f32_16x16x32_bf16 v[116:119], a[84:87], v[188:191], v[116:119]
    ds_read_b128 a[72:75], v231 offset:34816
    v_cvt_pk_bf16_f32 v163, v146, v147
    v_mfma_f32_16x16x32_bf16 v[24:27], a[88:91], v[176:179], v[24:27]
    v_exp_f32 v150, v150
    v_mfma_f32_16x16x32_bf16 v[56:59], a[88:91], v[180:183], v[56:59]
    ds_read_b128 a[76:79], v231 offset:35840
    v_mfma_f32_16x16x32_bf16 v[88:91], a[88:91], v[184:187], v[88:91]
    buffer_load_dwordx4 v255, s[4:7], s76 offen offset:3072 sc1 lds
    v_mfma_f32_16x16x32_bf16 v[120:123], a[88:91], v[188:191], v[120:123]
    s_sub_u32 s78, s79, s60
    v_exp_f32 v151, v151
    v_mfma_f32_16x16x32_bf16 v[28:31], a[92:95], v[176:179], v[28:31]
    s_add_u32 s79, s79, 1
    s_add_u32 s76, m0, 16384
    v_cvt_pk_bf16_f32 v166, v148, v149
    v_mfma_f32_16x16x32_bf16 v[60:63], a[92:95], v[180:183], v[60:63]
    v_exp_f32 v152, v152
    v_mfma_f32_16x16x32_bf16 v[92:95], a[92:95], v[184:187], v[92:95]
    v_exp_f32 v153, v153
    v_mfma_f32_16x16x32_bf16 v[124:127], a[92:95], v[188:191], v[124:127]
    s_cmp_lt_u32 s78, s61
    s_cselect_b32 s78, s77, 1073741824
    s_cselect_b32 m0, s76, 0x30000
    v_mfma_f32_16x16x32_bf16 a[96:99], a[112:115], v[176:179], a[96:99]
    s_add_u32 s75, s75, 16384
    s_sub_u32 s77, s77, 16384
    v_mfma_f32_16x16x32_bf16 a[100:103], a[112:115], v[180:183], a[100:103]
    v_mfma_f32_16x16x32_bf16 a[104:107], a[112:115], v[184:187], a[104:107]
    v_mfma_f32_16x16x32_bf16 a[108:111], a[112:115], v[188:191], a[108:111]
    s_waitcnt lgkmcnt(0)
    s_cmp_lt_u32 s79, s65
    s_cbranch_scc1 L_att_loop
    s_cmp_lt_u32 s79, 34
    s_cbranch_scc1 L_special
L_final:
    ds_read_b128 a[64:67], v233 offset:40960
    ds_read_b128 a[68:71], v233 offset:41984
    ds_read_b128 a[72:75], v233 offset:43008
    ds_read_b128 a[76:79], v233 offset:44032
    s_add_u32 s81, s80, 32768
    s_and_b32 s81, s81, 0x1ffff
    v_add_u32 v234, s81, v230
    v_cvt_pk_bf16_f32 v167, v150, v151
    s_bfe_u32 s85, s2, 0x20001
    s_bfe_u32 s83, s2, 0x30003
    v_bfe_u32 v221, v254, 2, 2
    v_exp_f32 v154, v154
    s_and_b32 s89, s2, 1
    s_lshl_b32 s89, s89, 3
    v_lshlrev_b32 v220, 10, v221
    v_exp_f32 v155, v155
    s_add_u32 s83, s83, s89
    s_lshr_b32 s84, s2, 6
    v_lshrrev_b32 v222, 4, v254
    v_cvt_pk_bf16_f32 v170, v152, v153
    s_lshl_b32 s90, s83, 14
    s_add_u32 s90, s90, s68
    v_lshl_add_u32 v220, v222, 6, v220
    v_exp_f32 v156, v156
    s_mul_i32 s89, s85, 1835008
    s_add_u32 s75, s89, s90
    v_and_b32 v222, 3, v254
    v_exp_f32 v157, v157
    s_add_u32 s75, s75, 37748736
    s_lshl_b32 s89, s85, 22
    v_lshl_add_u32 v200, v222, 4, v220
    v_cvt_pk_bf16_f32 v171, v154, v155
    s_add_u32 s77, s89, s90
    s_add_u32 s77, s77, 46137344
    v_xor_b32 v222, 32, v200
    v_exp_f32 v158, v158
    s_lshl_b32 s90, s84, 8
    s_lshl_b32 s89, s56, 14
    v_add_u32 v201, 3072, v222
    v_exp_f32 v159, v159
    s_add_u32 s90, s90, s89
    s_mul_i32 s89, s85, 458752
    v_add_u32 v202, 6144, v200
    v_cvt_pk_bf16_f32 v174, v156, v157
    s_add_u32 s76, s89, s90
    s_lshl_b32 s89, s85, 20
    v_add_u32 v203, 9216, v222
    v_cvt_pk_bf16_f32 v175, v158, v159
    s_add_u32 s78, s89, s90
    s_cmp_eq_u32 s70, 32
    s_waitcnt vmcnt(0) lgkmcnt(0)
    s_cbranch_scc1 L_ev_fin
L_ev_fin_r:
    s_barrier
    ds_read_b128 a[80:83], v234 offset:45056
    ds_read_b128 a[84:87], v234 offset:46080
    ds_read_b128 a[88:91], v234 offset:47104
    ds_read_b128 a[92:95], v234 offset:48128
    v_cmp_gt_u32 vcc, 1, v253
    s_nop 0
    s_cbranch_vccnz L_spin_136
L_spinret_137:
    s_cmp_ge_u32 s56, 2
    s_cbranch_scc1 L_fin_y
    v_mfma_f32_16x16x32_bf16 a[96:99], a[112:115], v[160:163], a[96:99]
    s_lshl_b32 s89, s56, 14
    v_add_u32 v228, s89, v255
    s_xor_b32 s89, s89, 32768
    v_add_u32 v229, s89, v255
    v_mfma_f32_16x16x32_bf16 a[100:103], a[112:115], v[164:167], a[100:103]
    s_mov_b32 s92, 0x6c800000
    s_mov_b32 s93, 0x17800000
    v_mfma_f32_16x16x32_bf16 a[104:107], a[112:115], v[168:171], a[104:107]
    s_lshl_b32 s89, s56, 10
    s_add_u32 s89, s89, 98304
    v_add_u32 v230, s89, v255
    s_xor_b32 s89, s89, 2048
    v_add_u32 v231, s89, v255
    v_mfma_f32_16x16x32_bf16 a[108:111], a[112:115], v[172:175], a[108:111]
    v_mov_b32 v236, 98312
    v_mfma_f32_16x16x32_bf16 v[64:67], a[64:67], v[168:171], v[64:67]
    s_lshl_b32 s94, s57, 6
    s_add_u32 s94, s94, s72
    s_lshl_b32 s94, s94, 13
    v_mfma_f32_16x16x32_bf16 v[96:99], a[64:67], v[172:175], v[96:99]
    s_add_u32 s94, s94, 46137344
    v_mfma_f32_16x16x32_bf16 v[68:71], a[68:71], v[168:171], v[68:71]
    s_add_u32 m0, s68, 65536
    v_mfma_f32_16x16x32_bf16 v[100:103], a[68:71], v[172:175], v[100:103]
    s_add_u32 s64, s76, 0
    v_mfma_f32_16x16x32_bf16 v[72:75], a[72:75], v[168:171], v[72:75]
    buffer_load_dwordx4 v200, s[36:39], s64 offen offset:0 lds
    v_mfma_f32_16x16x32_bf16 v[104:107], a[72:75], v[172:175], v[104:107]
    v_mfma_f32_16x16x32_bf16 v[76:79], a[76:79], v[168:171], v[76:79]
    buffer_load_dwordx4 v201, s[36:39], s64 offen offset:1024 lds
    v_mfma_f32_16x16x32_bf16 v[108:111], a[76:79], v[172:175], v[108:111]
    s_waitcnt lgkmcnt(0)
    v_mfma_f32_16x16x32_bf16 v[80:83], a[80:83], v[168:171], v[80:83]
    buffer_load_dwordx4 v202, s[36:39], s64 offen offset:2048 lds
    v_mfma_f32_16x16x32_bf16 v[112:115], a[80:83], v[172:175], v[112:115]
    buffer_load_dwordx4 v203, s[36:39], s64 offen offset:3072 lds
    v_mfma_f32_16x16x32_bf16 v[84:87], a[84:87], v[168:171], v[84:87]
    v_mfma_f32_16x16x32_bf16 v[116:119], a[84:87], v[172:175], v[116:119]
    v_mfma_f32_16x16x32_bf16 v[88:91], a[88:91], v[168:171], v[88:91]
    v_mfma_f32_16x16x32_bf16 v[120:123], a[88:91], v[172:175], v[120:123]
    v_mfma_f32_16x16x32_bf16 v[92:95], a[92:95], v[168:171], v[92:95]
    v_mfma_f32_16x16x32_bf16 v[124:127], a[92:95], v[172:175], v[124:127]
    ds_write_b128 v228, v[64:67] offset:0
    v_mfma_f32_16x16x32_bf16 v[0:3], a[64:67], v[160:163], v[0:3]
    ds_write_b128 v228, v[96:99] offset:8192
    v_mfma_f32_16x16x32_bf16 v[32:35], a[64:67], v[164:167], v[32:35]
    ds_write_b128 v228, v[68:71] offset:1024
    v_mfma_f32_16x16x32_bf16 v[4:7], a[68:71], v[160:163], v[4:7]
    ds_write_b128 v228, v[100:103] offset:9216
    v_mfma_f32_16x16x32_bf16 v[36:39], a[68:71], v[164:167], v[36:39]
    ds_write_b128 v228, v[72:75] offset:2048
    v_mfma_f32_16x16x32_bf16 v[8:11], a[72:75], v[160:163], v[8:11]
    ds_write_b128 v228, v[104:107] offset:10240
    v_mfma_f32_16x16x32_bf16 v[40:43], a[72:75], v[164:167], v[40:43]
    ds_write_b128 v228, v[76:79] offset:3072
    v_mfma_f32_16x16x32_bf16 v[12:15], a[76:79], v[160:163], v[12:15]
    ds_write_b128 v228, v[108:111] offset:11264
    v_mfma_f32_16x16x32_bf16 v[44:47], a[76:79], v[164:167], v[44:47]
    ds_write_b128 v228, v[80:83] offset:4096
    v_mfma_f32_16x16x32_bf16 v[16:19], a[80:83], v[160:163], v[16:19]
    ds_write_b128 v228, v[112:115] offset:12288
    v_mfma_f32_16x16x32_bf16 v[48:51], a[80:83], v[164:167], v[48:51]
    ds_write_b128 v228, v[84:87] offset:5120
    v_mfma_f32_16x16x32_bf16 v[20:23], a[84:87], v[160:163], v[20:23]
    s_waitcnt lgkmcnt(4)
    v_mfma_f32_16x16x32_bf16 v[52:55], a[84:87], v[164:167], v[52:55]
    ds_write_b128 v228, v[116:119] offset:13312
    v_mfma_f32_16x16x32_bf16 v[24:27], a[88:91], v[160:163], v[24:27]
    ds_write_b128 v228, v[88:91] offset:6144
    v_mfma_f32_16x16x32_bf16 v[56:59], a[88:91], v[164:167], v[56:59]
    ds_write_b128 v228, v[120:123] offset:14336
    v_mfma_f32_16x16x32_bf16 v[28:31], a[92:95], v[160:163], v[28:31]
    ds_write_b128 v228, v[92:95] offset:7168
    v_mfma_f32_16x16x32_bf16 v[60:63], a[92:95], v[164:167], v[60:63]
    ds_write_b128 v228, v[124:127] offset:15360
    v_accvgpr_read_b32 v128, a96
    v_accvgpr_read_b32 v129, a100
    v_accvgpr_read_b32 v130, a104
    v_accvgpr_read_b32 v131, a108
    v_cmp_nge_f32 vcc, s92, v128
    s_sub_u32 s89, s75, s68
    s_lshr_b32 s91, s56, 1
    s_lshl_b32 s91, s91, 13
    s_add_u32 s65, s89, s91
    s_or_b64 s[66:67], s[66:67], vcc
    v_cmp_nle_f32 vcc, s93, v128
    buffer_load_dwordx4 a[128:131], v255, s[4:7], s65 offen offset:0 sc1
    s_or_b64 s[66:67], s[66:67], vcc
    v_cmp_nge_f32 vcc, s92, v129
    buffer_load_dwordx4 a[132:135], v255, s[4:7], s65 offen offset:1024 sc1
    s_or_b64 s[66:67], s[66:67], vcc
    v_cmp_nle_f32 vcc, s93, v129
    buffer_load_dwordx4 a[136:139], v255, s[4:7], s65 offen offset:2048 sc1
    s_or_b64 s[66:67], s[66:67], vcc
    v_cmp_nge_f32 vcc, s92, v130
    buffer_load_dwordx4 a[140:143], v255, s[4:7], s65 offen offset:3072 sc1
    s_or_b64 s[66:67], s[66:67], vcc
    v_cmp_nle_f32 vcc, s93, v130
    s_add_u32 s65, s65, 4096
    s_or_b64 s[66:67], s[66:67], vcc
    v_cmp_nge_f32 vcc, s92, v131
    buffer_load_dwordx4 a[144:147], v255, s[4:7], s65 offen offset:0 sc1
    s_or_b64 s[66:67], s[66:67], vcc
    v_cmp_nle_f32 vcc, s93, v131
    buffer_load_dwordx4 a[148:151], v255, s[4:7], s65 offen offset:1024 sc1
    s_or_b64 s[66:67], s[66:67], vcc
    v_mov_b32 v132, v130
    v_mov_b32 v133, v131
    v_mov_b32 v135, 0
    s_cmp_lg_u64 s[66:67], 0
    s_cselect_b32 s90, 1, 0
    v_mov_b32 v134, s90
    ds_write_b128 v230, v[132:135]
    buffer_load_dwordx4 a[152:155], v255, s[4:7], s65 offen offset:2048 sc1
    buffer_load_dwordx4 a[156:159], v255, s[4:7], s65 offen offset:3072 sc1
    v_bfe_u32 v222, v254, 2, 2
    v_lshlrev_b32 v222, 6, v222
    v_and_b32 v223, 3, v254
    v_lshl_add_u32 v222, v223, 3, v222
    v_bfe_u32 v223, v254, 4, 1
    v_lshl_add_u32 v222, v223, 5, v222
    v_lshrrev_b32 v223, 4, v254
    v_lshl_add_u32 v220, v223, 10, v222
    v_xor_b32 v221, 32, v220
    s_and_b32 s89, s56, 1
    s_lshl_b32 s89, s89, 9
    v_add_u32 v204, s89, v220
    v_add_u32 v205, s89, v221
    v_add_u32 v206, 65536, v204
    v_add_u32 v207, 65536, v205
    s_lshr_b32 s89, s56, 1
    s_lshl_b32 s89, s89, 13
    s_add_u32 s89, s89, 98304
    v_add_u32 v208, s89, v255
    v_subrev_u32 v213, 65536, v208
    s_add_u32 m0, s68, 131072
    s_add_u32 s64, s75, 262144
    buffer_load_dwordx4 v255, s[4:7], s64 offen offset:0 sc1 lds
    buffer_load_dwordx4 v255, s[4:7], s64 offen offset:1024 sc1 lds
    buffer_load_dwordx4 v255, s[4:7], s64 offen offset:2048 sc1 lds
    buffer_load_dwordx4 v255, s[4:7], s64 offen offset:3072 sc1 lds
    s_add_u32 m0, s68, 81920
    s_add_u32 s64, s76, 65536
    buffer_load_dwordx4 v200, s[36:39], s64 offen offset:0 lds
    buffer_load_dwordx4 v201, s[36:39], s64 offen offset:1024 lds
    buffer_load_dwordx4 v202, s[36:39], s64 offen offset:2048 lds
    buffer_load_dwordx4 v203, s[36:39], s64 offen offset:3072 lds
    s_add_u32 m0, s68, 147456
    s_add_u32 s64, s75, 524288
    buffer_load_dwordx4 v255, s[4:7], s64 offen offset:0 sc1 lds
    buffer_load_dwordx4 v255, s[4:7], s64 offen offset:1024 sc1 lds
    buffer_load_dwordx4 v255, s[4:7], s64 offen offset:2048 sc1 lds
    buffer_load_dwordx4 v255, s[4:7], s64 offen offset:3072 sc1 lds
    s_waitcnt lgkmcnt(0)
    s_barrier
    ds_read_b32 v136, v236 offset:0
    ds_read_b32 v137, v236 offset:1024
    ds_read_b32 v138, v236 offset:2048
    ds_read_b32 v139, v236 offset:3072
    ds_read_b128 v[140:143], v231
    ds_read_b128 v[64:67], v229 offset:0
    ds_read_b128 v[68:71], v229 offset:1024
    ds_read_b128 v[72:75], v229 offset:2048
    ds_read_b128 v[76:79], v229 offset:3072
    ds_read_b128 v[80:83], v229 offset:4096
    ds_read_b128 v[84:87], v229 offset:5120
    ds_read_b128 v[88:91], v229 offset:6144
    ds_read_b128 v[92:95], v229 offset:7168
    ds_read_b128 v[96:99], v229 offset:8192
    ds_read_b128 v[100:103], v229 offset:9216
    s_waitcnt lgkmcnt(10)
    v_or_b32 v136, v136, v137
    v_or3_b32 v136, v136, v138, v139
    ds_read_b128 v[104:107], v229 offset:10240
    ds_read_b128 v[108:111], v229 offset:11264
    ds_read_b128 v[112:115], v229 offset:12288
    ds_read_b128 v[116:119], v229 offset:13312
    ds_read_b128 v[120:123], v229 offset:14336
    v_readfirstlane_b32 s90, v136
    v_add_f32 v144, v128, v140
    v_add_f32 v146, v129, v141
    s_andn2_b32 s90, s90, s59
    s_cmp_lg_u32 s90, 0
    s_cbranch_scc1 L_redo
    v_rcp_f32 v144, v144
    v_rcp_f32 v146, v146
    s_add_u32 s90, s94, 262144
    s_waitcnt lgkmcnt(11)
    ds_read_b128 v[124:127], v229 offset:15360
    v_pk_add_f32 v[0:1], v[0:1], v[64:65]
    v_pk_add_f32 v[2:3], v[2:3], v[66:67]
    v_pk_add_f32 v[4:5], v[4:5], v[68:69]
    v_pk_add_f32 v[6:7], v[6:7], v[70:71]
    v_pk_mul_f32 v[0:1], v[0:1], v[144:145] op_sel_hi:[1,0]
    v_pk_mul_f32 v[2:3], v[2:3], v[144:145] op_sel_hi:[1,0]
    v_pk_mul_f32 v[4:5], v[4:5], v[144:145] op_sel_hi:[1,0]
    v_pk_mul_f32 v[6:7], v[6:7], v[144:145] op_sel_hi:[1,0]
    v_cvt_pk_bf16_f32 v0, v0, v1
    v_cvt_pk_bf16_f32 v1, v2, v3
    v_cvt_pk_bf16_f32 v2, v4, v5
    v_cvt_pk_bf16_f32 v3, v6, v7
    buffer_store_dwordx4 v[0:3], v255, s[4:7], s94 offen offset:0 sc1
    v_pk_add_f32 v[8:9], v[8:9], v[72:73]
    v_pk_add_f32 v[10:11], v[10:11], v[74:75]
    v_pk_add_f32 v[12:13], v[12:13], v[76:77]
    v_pk_add_f32 v[14:15], v[14:15], v[78:79]
    v_pk_mul_f32 v[8:9], v[8:9], v[144:145] op_sel_hi:[1,0]
    v_pk_mul_f32 v[10:11], v[10:11], v[144:145] op_sel_hi:[1,0]
    v_pk_mul_f32 v[12:13], v[12:13], v[144:145] op_sel_hi:[1,0]
    v_pk_mul_f32 v[14:15], v[14:15], v[144:145] op_sel_hi:[1,0]
    v_cvt_pk_bf16_f32 v8, v8, v9
    v_cvt_pk_bf16_f32 v9, v10, v11
    v_cvt_pk_bf16_f32 v10, v12, v13
    v_cvt_pk_bf16_f32 v11, v14, v15
    buffer_store_dwordx4 v[8:11], v255, s[4:7], s94 offen offset:1024 sc1
    s_waitcnt lgkmcnt(8)
    v_pk_add_f32 v[16:17], v[16:17], v[80:81]
    v_pk_add_f32 v[18:19], v[18:19], v[82:83]
    v_pk_add_f32 v[20:21], v[20:21], v[84:85]
    v_pk_add_f32 v[22:23], v[22:23], v[86:87]
    v_pk_mul_f32 v[16:17], v[16:17], v[144:145] op_sel_hi:[1,0]
    v_pk_mul_f32 v[18:19], v[18:19], v[144:145] op_sel_hi:[1,0]
    v_pk_mul_f32 v[20:21], v[20:21], v[144:145] op_sel_hi:[1,0]
    v_pk_mul_f32 v[22:23], v[22:23], v[144:145] op_sel_hi:[1,0]
    v_cvt_pk_bf16_f32 v16, v16, v17
    v_cvt_pk_bf16_f32 v17, v18, v19
    v_cvt_pk_bf16_f32 v18, v20, v21
    v_cvt_pk_bf16_f32 v19, v22, v23
    buffer_store_dwordx4 v[16:19], v255, s[4:7], s90 offen offset:0 sc1
    v_pk_add_f32 v[24:25], v[24:25], v[88:89]
    v_pk_add_f32 v[26:27], v[26:27], v[90:91]
    v_pk_add_f32 v[28:29], v[28:29], v[92:93]
    v_pk_add_f32 v[30:31], v[30:31], v[94:95]
    v_pk_mul_f32 v[24:25], v[24:25], v[144:145] op_sel_hi:[1,0]
    v_pk_mul_f32 v[26:27], v[26:27], v[144:145] op_sel_hi:[1,0]
    v_pk_mul_f32 v[28:29], v[28:29], v[144:145] op_sel_hi:[1,0]
    v_pk_mul_f32 v[30:31], v[30:31], v[144:145] op_sel_hi:[1,0]
    v_cvt_pk_bf16_f32 v24, v24, v25
    v_cvt_pk_bf16_f32 v25, v26, v27
    v_cvt_pk_bf16_f32 v26, v28, v29
    v_cvt_pk_bf16_f32 v27, v30, v31
    buffer_store_dwordx4 v[24:27], v255, s[4:7], s90 offen offset:1024 sc1
    s_waitcnt lgkmcnt(0)
    v_pk_add_f32 v[32:33], v[32:33], v[96:97]
    v_pk_add_f32 v[34:35], v[34:35], v[98:99]
    v_pk_add_f32 v[36:37], v[36:37], v[100:101]
    v_pk_add_f32 v[38:39], v[38:39], v[102:103]
    v_pk_mul_f32 v[32:33], v[32:33], v[146:147] op_sel_hi:[1,0]
    v_pk_mul_f32 v[34:35], v[34:35], v[146:147] op_sel_hi:[1,0]
    v_pk_mul_f32 v[36:37], v[36:37], v[146:147] op_sel_hi:[1,0]
    v_pk_mul_f32 v[38:39], v[38:39], v[146:147] op_sel_hi:[1,0]
    v_cvt_pk_bf16_f32 v32, v32, v33
    v_cvt_pk_bf16_f32 v33, v34, v35
    v_cvt_pk_bf16_f32 v34, v36, v37
    v_cvt_pk_bf16_f32 v35, v38, v39
    buffer_store_dwordx4 v[32:35], v255, s[4:7], s94 offen offset:2048 sc1
    v_pk_add_f32 v[40:41], v[40:41], v[104:105]
    v_pk_add_f32 v[42:43], v[42:43], v[106:107]
    v_pk_add_f32 v[44:45], v[44:45], v[108:109]
    v_pk_add_f32 v[46:47], v[46:47], v[110:111]
    v_pk_mul_f32 v[40:41], v[40:41], v[146:147] op_sel_hi:[1,0]
    v_pk_mul_f32 v[42:43], v[42:43], v[146:147] op_sel_hi:[1,0]
    v_pk_mul_f32 v[44:45], v[44:45], v[146:147] op_sel_hi:[1,0]
    v_pk_mul_f32 v[46:47], v[46:47], v[146:147] op_sel_hi:[1,0]
    v_cvt_pk_bf16_f32 v40, v40, v41
    v_cvt_pk_bf16_f32 v41, v42, v43
    v_cvt_pk_bf16_f32 v42, v44, v45
    v_cvt_pk_bf16_f32 v43, v46, v47
    buffer_store_dwordx4 v[40:43], v255, s[4:7], s94 offen offset:3072 sc1
    v_pk_add_f32 v[48:49], v[48:49], v[112:113]
    v_pk_add_f32 v[50:51], v[50:51], v[114:115]
    v_pk_add_f32 v[52:53], v[52:53], v[116:117]
    v_pk_add_f32 v[54:55], v[54:55], v[118:119]
    v_pk_mul_f32 v[48:49], v[48:49], v[146:147] op_sel_hi:[1,0]
    v_pk_mul_f32 v[50:51], v[50:51], v[146:147] op_sel_hi:[1,0]
    v_pk_mul_f32 v[52:53], v[52:53], v[146:147] op_sel_hi:[1,0]
    v_pk_mul_f32 v[54:55], v[54:55], v[146:147] op_sel_hi:[1,0]
    v_cvt_pk_bf16_f32 v48, v48, v49
    v_cvt_pk_bf16_f32 v49, v50, v51
    v_cvt_pk_bf16_f32 v50, v52, v53
    v_cvt_pk_bf16_f32 v51, v54, v55
    buffer_store_dwordx4 v[48:51], v255, s[4:7], s90 offen offset:2048 sc1
    v_pk_add_f32 v[56:57], v[56:57], v[120:121]
    v_pk_add_f32 v[58:59], v[58:59], v[122:123]
    v_pk_add_f32 v[60:61], v[60:61], v[124:125]
    v_pk_add_f32 v[62:63], v[62:63], v[126:127]
    v_pk_mul_f32 v[56:57], v[56:57], v[146:147] op_sel_hi:[1,0]
    v_pk_mul_f32 v[58:59], v[58:59], v[146:147] op_sel_hi:[1,0]
    v_pk_mul_f32 v[60:61], v[60:61], v[146:147] op_sel_hi:[1,0]
    v_pk_mul_f32 v[62:63], v[62:63], v[146:147] op_sel_hi:[1,0]
    v_cvt_pk_bf16_f32 v56, v56, v57
    v_cvt_pk_bf16_f32 v57, v58, v59
    v_cvt_pk_bf16_f32 v58, v60, v61
    v_cvt_pk_bf16_f32 v59, v62, v63
    buffer_store_dwordx4 v[56:59], v255, s[4:7], s90 offen offset:3072 sc1
    s_branch L_fin_done
L_fin_y:
    v_mfma_f32_16x16x32_bf16 a[96:99], a[112:115], v[160:163], a[96:99]
    s_lshl_b32 s89, s56, 14
    v_add_u32 v228, s89, v255
    s_xor_b32 s89, s89, 32768
    v_add_u32 v229, s89, v255
    v_mfma_f32_16x16x32_bf16 a[100:103], a[112:115], v[164:167], a[100:103]
    s_mov_b32 s92, 0x6c800000
    s_mov_b32 s93, 0x17800000
    v_bfe_u32 v222, v254, 2, 2
    v_mfma_f32_16x16x32_bf16 a[104:107], a[112:115], v[168:171], a[104:107]
    v_lshlrev_b32 v222, 6, v222
    v_and_b32 v223, 3, v254
    v_mfma_f32_16x16x32_bf16 a[108:111], a[112:115], v[172:175], a[108:111]
    s_lshl_b32 s89, s56, 10
    s_add_u32 s89, s89, 98304
    v_add_u32 v230, s89, v255
    s_xor_b32 s89, s89, 2048
    v_add_u32 v231, s89, v255
    v_mfma_f32_16x16x32_bf16 v[0:3], a[64:67], v[160:163], v[0:3]
    s_add_u32 m0, s68, 65536
    v_mov_b32 v236, 98312
    v_lshl_add_u32 v222, v223, 3, v222
    v_mfma_f32_16x16x32_bf16 v[32:35], a[64:67], v[164:167], v[32:35]
    s_lshl_b32 s94, s57, 6
    s_add_u32 s94, s94, s72
    v_bfe_u32 v223, v254, 4, 1
    v_mfma_f32_16x16x32_bf16 v[4:7], a[68:71], v[160:163], v[4:7]
    s_lshl_b32 s94, s94, 13
    s_add_u32 s94, s94, 46141440
    v_lshl_add_u32 v222, v223, 5, v222
    v_mfma_f32_16x16x32_bf16 v[36:39], a[68:71], v[164:167], v[36:39]
    s_add_u32 s64, s76, 0
    v_lshrrev_b32 v223, 4, v254
    v_lshl_add_u32 v220, v223, 10, v222
    v_mfma_f32_16x16x32_bf16 v[8:11], a[72:75], v[160:163], v[8:11]
    buffer_load_dwordx4 v200, s[36:39], s64 offen offset:0 lds
    v_mfma_f32_16x16x32_bf16 v[40:43], a[72:75], v[164:167], v[40:43]
    v_xor_b32 v221, 32, v220
    v_mfma_f32_16x16x32_bf16 v[12:15], a[76:79], v[160:163], v[12:15]
    s_and_b32 s89, s56, 1
    s_lshl_b32 s89, s89, 9
    v_add_u32 v204, s89, v220
    v_add_u32 v205, s89, v221
    v_mfma_f32_16x16x32_bf16 v[44:47], a[76:79], v[164:167], v[44:47]
    buffer_load_dwordx4 v201, s[36:39], s64 offen offset:1024 lds
    v_mfma_f32_16x16x32_bf16 v[64:67], a[64:67], v[168:171], v[64:67]
    v_add_u32 v206, 65536, v204
    v_add_u32 v207, 65536, v205
    v_mfma_f32_16x16x32_bf16 v[96:99], a[64:67], v[172:175], v[96:99]
    buffer_load_dwordx4 v202, s[36:39], s64 offen offset:2048 lds
    v_mfma_f32_16x16x32_bf16 v[68:71], a[68:71], v[168:171], v[68:71]
    s_lshr_b32 s89, s56, 1
    s_lshl_b32 s89, s89, 13
    s_add_u32 s89, s89, 98304
    v_add_u32 v208, s89, v255
    v_mfma_f32_16x16x32_bf16 v[100:103], a[68:71], v[172:175], v[100:103]
    buffer_load_dwordx4 v203, s[36:39], s64 offen offset:3072 lds
    v_mfma_f32_16x16x32_bf16 v[72:75], a[72:75], v[168:171], v[72:75]
    v_subrev_u32 v213, 65536, v208
    v_accvgpr_read_b32 v128, a96
    v_mfma_f32_16x16x32_bf16 v[104:107], a[72:75], v[172:175], v[104:107]
    s_sub_u32 s89, s75, s68
    s_lshr_b32 s91, s56, 1
    s_lshl_b32 s91, s91, 13
    s_add_u32 s65, s89, s91
    v_mfma_f32_16x16x32_bf16 v[76:79], a[76:79], v[168:171], v[76:79]
    v_accvgpr_read_b32 v129, a100
    v_accvgpr_read_b32 v130, a104
    v_mfma_f32_16x16x32_bf16 v[108:111], a[76:79], v[172:175], v[108:111]
    s_waitcnt lgkmcnt(0)
    v_accvgpr_read_b32 v131, a108
    v_cmp_nge_f32 vcc, s92, v128
    v_mfma_f32_16x16x32_bf16 v[16:19], a[80:83], v[160:163], v[16:19]
    buffer_load_dwordx4 a[128:131], v255, s[4:7], s65 offen offset:0 sc1
    v_mfma_f32_16x16x32_bf16 v[48:51], a[80:83], v[164:167], v[48:51]
    buffer_load_dwordx4 a[132:135], v255, s[4:7], s65 offen offset:1024 sc1
    v_mfma_f32_16x16x32_bf16 v[20:23], a[84:87], v[160:163], v[20:23]
    s_or_b64 s[66:67], s[66:67], vcc
    v_cmp_nge_f32 vcc, s92, v129
    v_mfma_f32_16x16x32_bf16 v[52:55], a[84:87], v[164:167], v[52:55]
    buffer_load_dwordx4 a[136:139], v255, s[4:7], s65 offen offset:2048 sc1
    v_mfma_f32_16x16x32_bf16 v[24:27], a[88:91], v[160:163], v[24:27]
    s_or_b64 s[66:67], s[66:67], vcc
    v_cmp_nge_f32 vcc, s92, v130
    v_mfma_f32_16x16x32_bf16 v[56:59], a[88:91], v[164:167], v[56:59]
    buffer_load_dwordx4 a[140:143], v255, s[4:7], s65 offen offset:3072 sc1
    v_mfma_f32_16x16x32_bf16 v[28:31], a[92:95], v[160:163], v[28:31]
    s_add_u32 s65, s65, 4096
    s_or_b64 s[66:67], s[66:67], vcc
    v_cmp_nge_f32 vcc, s92, v131
    v_mfma_f32_16x16x32_bf16 v[60:63], a[92:95], v[164:167], v[60:63]
    buffer_load_dwordx4 a[144:147], v255, s[4:7], s65 offen offset:0 sc1
    v_mfma_f32_16x16x32_bf16 v[80:83], a[80:83], v[168:171], v[80:83]
    s_or_b64 s[66:67], s[66:67], vcc
    v_mov_b32 v132, v128
    v_mov_b32 v133, v129
    v_mfma_f32_16x16x32_bf16 v[112:115], a[80:83], v[172:175], v[112:115]
    buffer_load_dwordx4 a[148:151], v255, s[4:7], s65 offen offset:1024 sc1
    v_mfma_f32_16x16x32_bf16 v[84:87], a[84:87], v[168:171], v[84:87]
    buffer_load_dwordx4 a[152:155], v255, s[4:7], s65 offen offset:2048 sc1
    v_mfma_f32_16x16x32_bf16 v[116:119], a[84:87], v[172:175], v[116:119]
    v_mov_b32 v135, 0
    v_mfma_f32_16x16x32_bf16 v[88:91], a[88:91], v[168:171], v[88:91]
    buffer_load_dwordx4 a[156:159], v255, s[4:7], s65 offen offset:3072 sc1
    v_mfma_f32_16x16x32_bf16 v[120:123], a[88:91], v[172:175], v[120:123]
    s_add_u32 m0, s68, 131072
    s_add_u32 s64, s75, 262144
    v_mfma_f32_16x16x32_bf16 v[92:95], a[92:95], v[168:171], v[92:95]
    buffer_load_dwordx4 v255, s[4:7], s64 offen offset:0 sc1 lds
    v_mfma_f32_16x16x32_bf16 v[124:127], a[92:95], v[172:175], v[124:127]
    buffer_load_dwordx4 v255, s[4:7], s64 offen offset:1024 sc1 lds
    buffer_load_dwordx4 v255, s[4:7], s64 offen offset:2048 sc1 lds
    buffer_load_dwordx4 v255, s[4:7], s64 offen offset:3072 sc1 lds
    ds_write_b128 v228, v[0:3] offset:0
    s_add_u32 m0, s68, 81920
    ds_write_b128 v228, v[32:35] offset:8192
    s_add_u32 s64, s76, 65536
    ds_write_b128 v228, v[4:7] offset:1024
    buffer_load_dwordx4 v200, s[36:39], s64 offen offset:0 lds
    ds_write_b128 v228, v[36:39] offset:9216
    buffer_load_dwordx4 v201, s[36:39], s64 offen offset:1024 lds
    ds_write_b128 v228, v[8:11] offset:2048
    buffer_load_dwordx4 v202, s[36:39], s64 offen offset:2048 lds
    ds_write_b128 v228, v[40:43] offset:10240
    buffer_load_dwordx4 v203, s[36:39], s64 offen offset:3072 lds
    ds_write_b128 v228, v[12:15] offset:3072
    s_add_u32 m0, s68, 147456
    ds_write_b128 v228, v[44:47] offset:11264
    s_add_u32 s64, s75, 524288
    ds_write_b128 v228, v[16:19] offset:4096
    buffer_load_dwordx4 v255, s[4:7], s64 offen offset:0 sc1 lds
    ds_write_b128 v228, v[48:51] offset:12288
    buffer_load_dwordx4 v255, s[4:7], s64 offen offset:1024 sc1 lds
    s_waitcnt lgkmcnt(6)
    ds_write_b128 v228, v[20:23] offset:5120
    buffer_load_dwordx4 v255, s[4:7], s64 offen offset:2048 sc1 lds
    ds_write_b128 v228, v[52:55] offset:13312
    buffer_load_dwordx4 v255, s[4:7], s64 offen offset:3072 sc1 lds
    ds_write_b128 v228, v[24:27] offset:6144
    ds_write_b128 v228, v[56:59] offset:14336
    ds_write_b128 v228, v[28:31] offset:7168
    ds_write_b128 v228, v[60:63] offset:15360
    s_cmp_lg_u64 s[66:67], 0
    s_cselect_b32 s90, 1, 0
    v_mov_b32 v134, s90
    ds_write_b128 v230, v[132:135]
    s_waitcnt lgkmcnt(0)
    s_barrier
    ds_read_b32 v136, v236 offset:0
    ds_read_b32 v137, v236 offset:1024
    ds_read_b32 v138, v236 offset:2048
    ds_read_b32 v139, v236 offset:3072
    ds_read_b128 v[140:143], v231
    ds_read_b128 v[0:3], v229 offset:0
    ds_read_b128 v[4:7], v229 offset:1024
    ds_read_b128 v[8:11], v229 offset:2048
    ds_read_b128 v[12:15], v229 offset:3072
    ds_read_b128 v[16:19], v229 offset:4096
    ds_read_b128 v[20:23], v229 offset:5120
    ds_read_b128 v[24:27], v229 offset:6144
    ds_read_b128 v[28:31], v229 offset:7168
    ds_read_b128 v[32:35], v229 offset:8192
    ds_read_b128 v[36:39], v229 offset:9216
    s_waitcnt lgkmcnt(10)
    v_or_b32 v136, v136, v137
    v_or3_b32 v136, v136, v138, v139
    ds_read_b128 v[40:43], v229 offset:10240
    ds_read_b128 v[44:47], v229 offset:11264
    ds_read_b128 v[48:51], v229 offset:12288
    ds_read_b128 v[52:55], v229 offset:13312
    ds_read_b128 v[56:59], v229 offset:14336
    v_readfirstlane_b32 s90, v136
    v_add_f32 v144, v130, v140
    v_add_f32 v146, v131, v141
    s_andn2_b32 s90, s90, s59
    s_cmp_lg_u32 s90, 0
    s_cbranch_scc1 L_redo
    v_rcp_f32 v144, v144
    v_rcp_f32 v146, v146
    s_add_u32 s90, s94, 262144
    s_waitcnt lgkmcnt(11)
    ds_read_b128 v[60:63], v229 offset:15360
    v_pk_add_f32 v[64:65], v[64:65], v[0:1]
    v_pk_add_f32 v[66:67], v[66:67], v[2:3]
    v_pk_add_f32 v[68:69], v[68:69], v[4:5]
    v_pk_add_f32 v[70:71], v[70:71], v[6:7]
    v_pk_mul_f32 v[64:65], v[64:65], v[144:145] op_sel_hi:[1,0]
    v_pk_mul_f32 v[66:67], v[66:67], v[144:145] op_sel_hi:[1,0]
    v_pk_mul_f32 v[68:69], v[68:69], v[144:145] op_sel_hi:[1,0]
    v_pk_mul_f32 v[70:71], v[70:71], v[144:145] op_sel_hi:[1,0]
    v_cvt_pk_bf16_f32 v64, v64, v65
    v_cvt_pk_bf16_f32 v65, v66, v67
    v_cvt_pk_bf16_f32 v66, v68, v69
    v_cvt_pk_bf16_f32 v67, v70, v71
    buffer_store_dwordx4 v[64:67], v255, s[4:7], s94 offen offset:0 sc1
    v_pk_add_f32 v[72:73], v[72:73], v[8:9]
    v_pk_add_f32 v[74:75], v[74:75], v[10:11]
    v_pk_add_f32 v[76:77], v[76:77], v[12:13]
    v_pk_add_f32 v[78:79], v[78:79], v[14:15]
    v_pk_mul_f32 v[72:73], v[72:73], v[144:145] op_sel_hi:[1,0]
    v_pk_mul_f32 v[74:75], v[74:75], v[144:145] op_sel_hi:[1,0]
    v_pk_mul_f32 v[76:77], v[76:77], v[144:145] op_sel_hi:[1,0]
    v_pk_mul_f32 v[78:79], v[78:79], v[144:145] op_sel_hi:[1,0]
    v_cvt_pk_bf16_f32 v72, v72, v73
    v_cvt_pk_bf16_f32 v73, v74, v75
    v_cvt_pk_bf16_f32 v74, v76, v77
    v_cvt_pk_bf16_f32 v75, v78, v79
    buffer_store_dwordx4 v[72:75], v255, s[4:7], s94 offen offset:1024 sc1
    s_waitcnt lgkmcnt(8)
    v_pk_add_f32 v[80:81], v[80:81], v[16:17]
    v_pk_add_f32 v[82:83], v[82:83], v[18:19]
    v_pk_add_f32 v[84:85], v[84:85], v[20:21]
    v_pk_add_f32 v[86:87], v[86:87], v[22:23]
    v_pk_mul_f32 v[80:81], v[80:81], v[144:145] op_sel_hi:[1,0]
    v_pk_mul_f32 v[82:83], v[82:83], v[144:145] op_sel_hi:[1,0]
    v_pk_mul_f32 v[84:85], v[84:85], v[144:145] op_sel_hi:[1,0]
    v_pk_mul_f32 v[86:87], v[86:87], v[144:145] op_sel_hi:[1,0]
    v_cvt_pk_bf16_f32 v80, v80, v81
    v_cvt_pk_bf16_f32 v81, v82, v83
    v_cvt_pk_bf16_f32 v82, v84, v85
    v_cvt_pk_bf16_f32 v83, v86, v87
    buffer_store_dwordx4 v[80:83], v255, s[4:7], s90 offen offset:0 sc1
    v_pk_add_f32 v[88:89], v[88:89], v[24:25]
    v_pk_add_f32 v[90:91], v[90:91], v[26:27]
    v_pk_add_f32 v[92:93], v[92:93], v[28:29]
    v_pk_add_f32 v[94:95], v[94:95], v[30:31]
    v_pk_mul_f32 v[88:89], v[88:89], v[144:145] op_sel_hi:[1,0]
    v_pk_mul_f32 v[90:91], v[90:91], v[144:145] op_sel_hi:[1,0]
    v_pk_mul_f32 v[92:93], v[92:93], v[144:145] op_sel_hi:[1,0]
    v_pk_mul_f32 v[94:95], v[94:95], v[144:145] op_sel_hi:[1,0]
    v_cvt_pk_bf16_f32 v88, v88, v89
    v_cvt_pk_bf16_f32 v89, v90, v91
    v_cvt_pk_bf16_f32 v90, v92, v93
    v_cvt_pk_bf16_f32 v91, v94, v95
    buffer_store_dwordx4 v[88:91], v255, s[4:7], s90 offen offset:1024 sc1
    s_waitcnt lgkmcnt(0)
    v_pk_add_f32 v[96:97], v[96:97], v[32:33]
    v_pk_add_f32 v[98:99], v[98:99], v[34:35]
    v_pk_add_f32 v[100:101], v[100:101], v[36:37]
    v_pk_add_f32 v[102:103], v[102:103], v[38:39]
    v_pk_mul_f32 v[96:97], v[96:97], v[146:147] op_sel_hi:[1,0]
    v_pk_mul_f32 v[98:99], v[98:99], v[146:147] op_sel_hi:[1,0]
    v_pk_mul_f32 v[100:101], v[100:101], v[146:147] op_sel_hi:[1,0]
    v_pk_mul_f32 v[102:103], v[102:103], v[146:147] op_sel_hi:[1,0]
    v_cvt_pk_bf16_f32 v96, v96, v97
    v_cvt_pk_bf16_f32 v97, v98, v99
    v_cvt_pk_bf16_f32 v98, v100, v101
    v_cvt_pk_bf16_f32 v99, v102, v103
    buffer_store_dwordx4 v[96:99], v255, s[4:7], s94 offen offset:2048 sc1
    v_pk_add_f32 v[104:105], v[104:105], v[40:41]
    v_pk_add_f32 v[106:107], v[106:107], v[42:43]
    v_pk_add_f32 v[108:109], v[108:109], v[44:45]
    v_pk_add_f32 v[110:111], v[110:111], v[46:47]
    v_pk_mul_f32 v[104:105], v[104:105], v[146:147] op_sel_hi:[1,0]
    v_pk_mul_f32 v[106:107], v[106:107], v[146:147] op_sel_hi:[1,0]
    v_pk_mul_f32 v[108:109], v[108:109], v[146:147] op_sel_hi:[1,0]
    v_pk_mul_f32 v[110:111], v[110:111], v[146:147] op_sel_hi:[1,0]
    v_cvt_pk_bf16_f32 v104, v104, v105
    v_cvt_pk_bf16_f32 v105, v106, v107
    v_cvt_pk_bf16_f32 v106, v108, v109
    v_cvt_pk_bf16_f32 v107, v110, v111
    buffer_store_dwordx4 v[104:107], v255, s[4:7], s94 offen offset:3072 sc1
    v_pk_add_f32 v[112:113], v[112:113], v[48:49]
    v_pk_add_f32 v[114:115], v[114:115], v[50:51]
    v_pk_add_f32 v[116:117], v[116:117], v[52:53]
    v_pk_add_f32 v[118:119], v[118:119], v[54:55]
    v_pk_mul_f32 v[112:113], v[112:113], v[146:147] op_sel_hi:[1,0]
    v_pk_mul_f32 v[114:115], v[114:115], v[146:147] op_sel_hi:[1,0]
    v_pk_mul_f32 v[116:117], v[116:117], v[146:147] op_sel_hi:[1,0]
    v_pk_mul_f32 v[118:119], v[118:119], v[146:147] op_sel_hi:[1,0]
    v_cvt_pk_bf16_f32 v112, v112, v113
    v_cvt_pk_bf16_f32 v113, v114, v115
    v_cvt_pk_bf16_f32 v114, v116, v117
    v_cvt_pk_bf16_f32 v115, v118, v119
    buffer_store_dwordx4 v[112:115], v255, s[4:7], s90 offen offset:2048 sc1
    v_pk_add_f32 v[120:121], v[120:121], v[56:57]
    v_pk_add_f32 v[122:123], v[122:123], v[58:59]
    v_pk_add_f32 v[124:125], v[124:125], v[60:61]
    v_pk_add_f32 v[126:127], v[126:127], v[62:63]
    v_pk_mul_f32 v[120:121], v[120:121], v[146:147] op_sel_hi:[1,0]
    v_pk_mul_f32 v[122:123], v[122:123], v[146:147] op_sel_hi:[1,0]
    v_pk_mul_f32 v[124:125], v[124:125], v[146:147] op_sel_hi:[1,0]
    v_pk_mul_f32 v[126:127], v[126:127], v[146:147] op_sel_hi:[1,0]
    v_cvt_pk_bf16_f32 v120, v120, v121
    v_cvt_pk_bf16_f32 v121, v122, v123
    v_cvt_pk_bf16_f32 v122, v124, v125
    v_cvt_pk_bf16_f32 v123, v126, v127
    buffer_store_dwordx4 v[120:123], v255, s[4:7], s90 offen offset:3072 sc1
L_fin_done:
    s_waitcnt vmcnt(16)
    s_barrier
    ds_read_b64_tr_b16 a[64:65], v206 offset:0
    ds_read_b64_tr_b16 a[66:67], v206 offset:4096
    ds_read_b64_tr_b16 a[68:69], v206 offset:8192
    ds_read_b64_tr_b16 a[70:71], v206 offset:12288
    ds_read_b64_tr_b16 a[72:73], v207 offset:0
    ds_read_b64_tr_b16 a[74:75], v207 offset:4096
    ds_read_b64_tr_b16 a[76:77], v207 offset:8192
    ds_read_b64_tr_b16 a[78:79], v207 offset:12288
    ds_read_b128 a[160:163], v208 offset:32768
    ds_read_b128 a[164:167], v208 offset:33792
    ds_read_b128 a[168:171], v208 offset:34816
    ds_read_b128 a[172:175], v208 offset:35840
    s_waitcnt lgkmcnt(0)
    v_mfma_f32_16x16x32_bf16 v[64:67], a[64:67], a[128:131], 0
    s_add_u32 m0, s68, 0
    s_add_u32 s64, s76, 131072
    ds_read_b64_tr_b16 a[80:81], v206 offset:256
    v_mfma_f32_16x16x32_bf16 v[64:67], a[68:71], a[132:135], v[64:67]
    ds_read_b64_tr_b16 a[82:83], v206 offset:4352
    v_mfma_f32_16x16x32_bf16 v[68:71], a[72:75], a[128:131], 0
    buffer_load_dwordx4 v200, s[36:39], s64 offen offset:0 lds
    v_mfma_f32_16x16x32_bf16 v[68:71], a[76:79], a[132:135], v[68:71]
    ds_read_b64_tr_b16 a[84:85], v206 offset:8448
    ds_read_b64_tr_b16 a[86:87], v206 offset:12544
    v_mfma_f32_16x16x32_bf16 v[80:83], a[64:67], a[136:139], 0
    buffer_load_dwordx4 v201, s[36:39], s64 offen offset:1024 lds
    v_mfma_f32_16x16x32_bf16 v[80:83], a[68:71], a[140:143], v[80:83]
    buffer_load_dwordx4 v202, s[36:39], s64 offen offset:2048 lds
    v_mfma_f32_16x16x32_bf16 v[84:87], a[72:75], a[136:139], 0
    ds_read_b64_tr_b16 a[88:89], v207 offset:256
    ds_read_b64_tr_b16 a[90:91], v207 offset:4352
    v_mfma_f32_16x16x32_bf16 v[84:87], a[76:79], a[140:143], v[84:87]
    buffer_load_dwordx4 v203, s[36:39], s64 offen offset:3072 lds
    v_mfma_f32_16x16x32_bf16 v[96:99], a[64:67], a[144:147], 0
    s_add_u32 m0, s68, 98304
    s_add_u32 s64, s75, 786432
    ds_read_b64_tr_b16 a[92:93], v207 offset:8448
    v_mfma_f32_16x16x32_bf16 v[96:99], a[68:71], a[148:151], v[96:99]
    buffer_load_dwordx4 v255, s[4:7], s64 offen offset:0 sc1 lds
    v_mfma_f32_16x16x32_bf16 v[100:103], a[72:75], a[144:147], 0
    ds_read_b64_tr_b16 a[94:95], v207 offset:12544
    ds_read_b128 a[176:179], v208 offset:36864
    v_mfma_f32_16x16x32_bf16 v[100:103], a[76:79], a[148:151], v[100:103]
    buffer_load_dwordx4 v255, s[4:7], s64 offen offset:1024 sc1 lds
    v_mfma_f32_16x16x32_bf16 v[112:115], a[64:67], a[152:155], 0
    buffer_load_dwordx4 v255, s[4:7], s64 offen offset:2048 sc1 lds
    v_mfma_f32_16x16x32_bf16 v[112:115], a[68:71], a[156:159], v[112:115]
    ds_read_b128 a[180:183], v208 offset:37888
    ds_read_b128 a[184:187], v208 offset:38912
    ds_read_b128 a[188:191], v208 offset:39936
    v_mfma_f32_16x16x32_bf16 v[116:119], a[72:75], a[152:155], 0
    buffer_load_dwordx4 v255, s[4:7], s64 offen offset:3072 sc1 lds
    v_mfma_f32_16x16x32_bf16 v[116:119], a[76:79], a[156:159], v[116:119]
    s_waitcnt vmcnt(16) lgkmcnt(0)
    s_barrier
    v_mfma_f32_16x16x32_bf16 v[72:75], a[80:83], a[128:131], 0
    ds_read_b64_tr_b16 a[64:65], v206 offset:16384
    v_mfma_f32_16x16x32_bf16 v[72:75], a[84:87], a[132:135], v[72:75]
    ds_read_b64_tr_b16 a[66:67], v206 offset:20480
    v_mfma_f32_16x16x32_bf16 v[76:79], a[88:91], a[128:131], 0
    s_sub_u32 s89, 15, s83
    s_min_u32 s87, s89, s83
    v_mfma_f32_16x16x32_bf16 v[76:79], a[92:95], a[132:135], v[76:79]
    ds_read_b64_tr_b16 a[68:69], v206 offset:24576
    ds_read_b64_tr_b16 a[70:71], v206 offset:28672
    v_mfma_f32_16x16x32_bf16 v[88:91], a[80:83], a[136:139], 0
    ds_read_b64_tr_b16 a[72:73], v207 offset:16384
    v_mfma_f32_16x16x32_bf16 v[88:91], a[84:87], a[140:143], v[88:91]
    ds_read_b64_tr_b16 a[74:75], v207 offset:20480
    v_mfma_f32_16x16x32_bf16 v[92:95], a[88:91], a[136:139], 0
    s_lshl_b32 s89, s83, 2
    s_add_u32 s89, s89, s84
    s_lshl_b32 s88, s89, 7
    v_mfma_f32_16x16x32_bf16 v[92:95], a[92:95], a[140:143], v[92:95]
    ds_read_b64_tr_b16 a[76:77], v207 offset:24576
    ds_read_b64_tr_b16 a[78:79], v207 offset:28672
    v_mfma_f32_16x16x32_bf16 v[104:107], a[80:83], a[144:147], 0
    ds_read_b128 a[192:195], v208 offset:49152
    v_mfma_f32_16x16x32_bf16 v[104:107], a[84:87], a[148:151], v[104:107]
    s_lshl_b32 s90, s88, 11
    s_lshl_b32 s89, s56, 16
    s_add_u32 s90, s90, s89
    s_lshl_b32 s89, s85, 13
    s_add_u32 s90, s90, s89
    s_add_u32 s90, s90, 62914560
    s_cmp_eq_u32 s56, s85
    s_cselect_b32 s80, 1073741824, s90
    s_cselect_b32 s89, 0, 0x30000
    v_add_u32 v211, s89, v255
    v_mfma_f32_16x16x32_bf16 v[108:111], a[88:91], a[144:147], 0
    ds_read_b128 a[196:199], v208 offset:50176
    ds_read_b128 a[200:203], v208 offset:51200
    v_mfma_f32_16x16x32_bf16 v[108:111], a[92:95], a[148:151], v[108:111]
    ds_read_b128 a[204:207], v208 offset:52224
    v_mfma_f32_16x16x32_bf16 v[120:123], a[80:83], a[152:155], 0
    v_add_u32 v212, s68, v255
    v_mfma_f32_16x16x32_bf16 v[120:123], a[84:87], a[156:159], v[120:123]
    v_mfma_f32_16x16x32_bf16 v[124:127], a[88:91], a[152:155], 0
    s_waitcnt vmcnt(8)
    s_lshr_b32 s89, s57, 3
    s_lshl_b32 s90, s58, 2
    s_add_u32 s89, s89, s90
    s_lshl_b32 s89, s89, 7
    s_and_b32 s90, s57, 7
    s_lshl_b32 s90, s90, 4
    s_add_u32 s89, s89, s90
    s_lshl_b32 s90, s56, 2
    s_add_u32 s89, s89, s90
    s_add_u32 s89, s89, 8192
    v_mov_b32 v250, s89
    v_mfma_f32_16x16x32_bf16 v[124:127], a[92:95], a[156:159], v[124:127]
    s_waitcnt lgkmcnt(0)
    v_mfma_f32_16x16x32_bf16 v[64:67], a[64:67], a[160:163], v[64:67]
    buffer_store_dword v251, v250, s[4:7], 0 offen sc1
    v_mfma_f32_16x16x32_bf16 v[64:67], a[68:71], a[164:167], v[64:67]
    s_and_b32 s89, s85, 1
    s_lshl_b32 s90, s84, 1
    s_add_u32 s89, s89, s90
    s_lshl_b32 s86, s89, 7
    v_mfma_f32_16x16x32_bf16 v[68:71], a[72:75], a[160:163], v[68:71]
    s_add_u32 m0, s68, 16384
    s_add_u32 s64, s76, 196608
    ds_read_b64_tr_b16 a[80:81], v206 offset:16640
    v_mfma_f32_16x16x32_bf16 v[68:71], a[76:79], a[164:167], v[68:71]
    buffer_load_dwordx4 v200, s[36:39], s64 offen offset:0 lds
    v_mfma_f32_16x16x32_bf16 v[80:83], a[64:67], a[168:171], v[80:83]
    buffer_load_dwordx4 v201, s[36:39], s64 offen offset:1024 lds
    v_mfma_f32_16x16x32_bf16 v[80:83], a[68:71], a[172:175], v[80:83]
    buffer_load_dwordx4 v202, s[36:39], s64 offen offset:2048 lds
    v_mfma_f32_16x16x32_bf16 v[84:87], a[72:75], a[168:171], v[84:87]
    buffer_load_dwordx4 v203, s[36:39], s64 offen offset:3072 lds
    v_mfma_f32_16x16x32_bf16 v[84:87], a[76:79], a[172:175], v[84:87]
    s_add_u32 m0, s68, 114688
    s_add_u32 s64, s75, 1048576
    ds_read_b64_tr_b16 a[82:83], v206 offset:20736
    v_mfma_f32_16x16x32_bf16 v[96:99], a[64:67], a[176:179], v[96:99]
    buffer_load_dwordx4 v255, s[4:7], s64 offen offset:0 sc1 lds
    v_mfma_f32_16x16x32_bf16 v[96:99], a[68:71], a[180:183], v[96:99]
    buffer_load_dwordx4 v255, s[4:7], s64 offen offset:1024 sc1 lds
    v_mfma_f32_16x16x32_bf16 v[100:103], a[72:75], a[176:179], v[100:103]
    buffer_load_dwordx4 v255, s[4:7], s64 offen offset:2048 sc1 lds
    v_mfma_f32_16x16x32_bf16 v[100:103], a[76:79], a[180:183], v[100:103]
    buffer_load_dwordx4 v255, s[4:7], s64 offen offset:3072 sc1 lds
    v_mfma_f32_16x16x32_bf16 v[112:115], a[64:67], a[184:187], v[112:115]
    s_add_u32 m0, s68, 32768
    s_add_u32 s64, s76, 262144
    ds_read_b64_tr_b16 a[84:85], v206 offset:24832
    ds_read_b64_tr_b16 a[86:87], v206 offset:28928
    v_mfma_f32_16x16x32_bf16 v[112:115], a[68:71], a[188:191], v[112:115]
    buffer_load_dwordx4 v200, s[36:39], s64 offen offset:0 lds
    ds_read_b64_tr_b16 a[88:89], v207 offset:16640
    ds_read_b64_tr_b16 a[90:91], v207 offset:20736
    ds_read_b64_tr_b16 a[92:93], v207 offset:24832
    ds_read_b64_tr_b16 a[94:95], v207 offset:28928
    ds_read_b128 a[208:211], v208 offset:53248
    ds_read_b128 a[212:215], v208 offset:54272
    ds_read_b128 a[216:219], v208 offset:55296
    ds_read_b128 a[220:223], v208 offset:56320
    v_mfma_f32_16x16x32_bf16 v[116:119], a[72:75], a[184:187], v[116:119]
    buffer_load_dwordx4 v201, s[36:39], s64 offen offset:1024 lds
    v_mfma_f32_16x16x32_bf16 v[116:119], a[76:79], a[188:191], v[116:119]
    s_waitcnt vmcnt(11) lgkmcnt(0)
    s_barrier
    v_mfma_f32_16x16x32_bf16 v[72:75], a[80:83], a[160:163], v[72:75]
    buffer_load_dwordx4 v202, s[36:39], s64 offen offset:2048 lds
    v_mfma_f32_16x16x32_bf16 v[72:75], a[84:87], a[164:167], v[72:75]
    buffer_load_dwordx4 v203, s[36:39], s64 offen offset:3072 lds
    v_mfma_f32_16x16x32_bf16 v[76:79], a[88:91], a[160:163], v[76:79]
    s_add_u32 m0, s68, 49152
    s_add_u32 s64, s76, 327680
    ds_read_b64_tr_b16 a[64:65], v204 offset:0
    v_mfma_f32_16x16x32_bf16 v[76:79], a[92:95], a[164:167], v[76:79]
    buffer_load_dwordx4 v200, s[36:39], s64 offen offset:0 lds
    v_mfma_f32_16x16x32_bf16 v[88:91], a[80:83], a[168:171], v[88:91]
    buffer_load_dwordx4 v201, s[36:39], s64 offen offset:1024 lds
    v_mfma_f32_16x16x32_bf16 v[88:91], a[84:87], a[172:175], v[88:91]
    buffer_load_dwordx4 v202, s[36:39], s64 offen offset:2048 lds
    v_mfma_f32_16x16x32_bf16 v[92:95], a[88:91], a[168:171], v[92:95]
    buffer_load_dwordx4 v203, s[36:39], s64 offen offset:3072 lds
    v_mfma_f32_16x16x32_bf16 v[92:95], a[92:95], a[172:175], v[92:95]
    s_add_u32 m0, s68, 65536
    s_add_u32 s64, s76, 393216
    ds_read_b64_tr_b16 a[66:67], v204 offset:4096
    v_mfma_f32_16x16x32_bf16 v[104:107], a[80:83], a[176:179], v[104:107]
    s_lshr_b32 s89, s85, 1
    s_lshl_b32 s90, s83, 1
    s_add_u32 s89, s89, s90
    s_lshl_b32 s89, s89, 16
    s_lshl_b32 s90, s56, 14
    s_add_u32 s89, s89, s90
    s_add_u32 s81, s89, s86
    v_mfma_f32_16x16x32_bf16 v[104:107], a[84:87], a[180:183], v[104:107]
    buffer_load_dwordx4 v200, s[36:39], s64 offen offset:0 lds
    v_mfma_f32_16x16x32_bf16 v[108:111], a[88:91], a[176:179], v[108:111]
    buffer_load_dwordx4 v201, s[36:39], s64 offen offset:1024 lds
    v_mfma_f32_16x16x32_bf16 v[108:111], a[92:95], a[180:183], v[108:111]
    buffer_load_dwordx4 v202, s[36:39], s64 offen offset:2048 lds
    v_mfma_f32_16x16x32_bf16 v[120:123], a[80:83], a[184:187], v[120:123]
    ds_read_b64_tr_b16 a[68:69], v204 offset:8192
    ds_read_b64_tr_b16 a[70:71], v204 offset:12288
    v_and_b32 v209, 15, v254
    v_lshlrev_b32 v209, 10, v209
    v_mfma_f32_16x16x32_bf16 v[120:123], a[84:87], a[188:191], v[120:123]
    buffer_load_dwordx4 v203, s[36:39], s64 offen offset:3072 lds
    ds_read_b64_tr_b16 a[72:73], v205 offset:0
    ds_read_b64_tr_b16 a[74:75], v205 offset:4096
    ds_read_b64_tr_b16 a[76:77], v205 offset:8192
    ds_read_b64_tr_b16 a[78:79], v205 offset:12288
    ds_read_b128 a[128:131], v208 offset:0
    ds_read_b128 a[132:135], v208 offset:1024
    ds_read_b128 a[136:139], v208 offset:2048
    ds_read_b128 a[140:143], v208 offset:3072
    v_mfma_f32_16x16x32_bf16 v[124:127], a[88:91], a[184:187], v[124:127]
    s_add_u32 m0, s68, 131072
    s_add_u32 s64, s75, 1310720
    v_lshrrev_b32 v210, 4, v254
    v_mfma_f32_16x16x32_bf16 v[124:127], a[92:95], a[188:191], v[124:127]
    s_waitcnt lgkmcnt(0)
    v_lshlrev_b32 v210, 3, v210
    v_add_u32 v209, v209, v210
    v_mfma_f32_16x16x32_bf16 v[64:67], a[64:67], a[192:195], v[64:67]
    buffer_load_dwordx4 v255, s[4:7], s64 offen offset:0 sc1 lds
    v_mfma_f32_16x16x32_bf16 v[64:67], a[68:71], a[196:199], v[64:67]
    buffer_load_dwordx4 v255, s[4:7], s64 offen offset:1024 sc1 lds
    v_mfma_f32_16x16x32_bf16 v[68:71], a[72:75], a[192:195], v[68:71]
    buffer_load_dwordx4 v255, s[4:7], s64 offen offset:2048 sc1 lds
    v_mfma_f32_16x16x32_bf16 v[68:71], a[76:79], a[196:199], v[68:71]
    buffer_load_dwordx4 v255, s[4:7], s64 offen offset:3072 sc1 lds
    v_mfma_f32_16x16x32_bf16 v[80:83], a[64:67], a[200:203], v[80:83]
    s_add_u32 m0, s68, 81920
    s_add_u32 s64, s78, 0
    ds_read_b64_tr_b16 a[80:81], v204 offset:256
    v_mfma_f32_16x16x32_bf16 v[80:83], a[68:71], a[204:207], v[80:83]
    buffer_load_dwordx4 v200, s[28:31], s64 offen offset:0 lds
    v_mfma_f32_16x16x32_bf16 v[84:87], a[72:75], a[200:203], v[84:87]
    buffer_load_dwordx4 v201, s[28:31], s64 offen offset:1024 lds
    v_mfma_f32_16x16x32_bf16 v[84:87], a[76:79], a[204:207], v[84:87]
    s_lshl_b32 s90, s88, 11
    s_lshl_b32 s89, s85, 16
    s_add_u32 s90, s90, s89
    s_lshr_b32 s89, s68, 1
    s_add_u32 s90, s90, s89
    s_add_u32 s3, s90, 62914560
    v_mfma_f32_16x16x32_bf16 v[96:99], a[64:67], a[208:211], v[96:99]
    buffer_load_dwordx4 v202, s[28:31], s64 offen offset:2048 lds
    v_mfma_f32_16x16x32_bf16 v[96:99], a[68:71], a[212:215], v[96:99]
    s_add_u32 s89, s85, 1
    s_and_b32 s89, s89, 3
    s_lshl_b32 s89, s89, 13
    s_add_u32 s92, s89, s3
    v_mfma_f32_16x16x32_bf16 v[100:103], a[72:75], a[208:211], v[100:103]
    buffer_load_dwordx4 v203, s[28:31], s64 offen offset:3072 lds
    v_mfma_f32_16x16x32_bf16 v[100:103], a[76:79], a[212:215], v[100:103]
    s_add_u32 m0, s68, 147456
    s_add_u32 s64, s75, 1572864
    ds_read_b64_tr_b16 a[82:83], v204 offset:4352
    v_mfma_f32_16x16x32_bf16 v[112:115], a[64:67], a[216:219], v[112:115]
    s_add_u32 s89, s85, 2
    s_and_b32 s89, s89, 3
    s_lshl_b32 s89, s89, 13
    s_add_u32 s93, s89, s3
    v_mfma_f32_16x16x32_bf16 v[112:115], a[68:71], a[220:223], v[112:115]
    ds_read_b64_tr_b16 a[84:85], v204 offset:8448
    ds_read_b64_tr_b16 a[86:87], v204 offset:12544
    ds_read_b64_tr_b16 a[88:89], v205 offset:256
    ds_read_b64_tr_b16 a[90:91], v205 offset:4352
    ds_read_b64_tr_b16 a[92:93], v205 offset:8448
    ds_read_b64_tr_b16 a[94:95], v205 offset:12544
    ds_read_b128 a[144:147], v208 offset:4096
    ds_read_b128 a[148:151], v208 offset:5120
    ds_read_b128 a[152:155], v208 offset:6144
    ds_read_b128 a[156:159], v208 offset:7168
    v_mfma_f32_16x16x32_bf16 v[116:119], a[72:75], a[216:219], v[116:119]
    s_add_u32 s89, s85, 3
    s_and_b32 s89, s89, 3
    s_lshl_b32 s89, s89, 13
    s_add_u32 s94, s89, s3
    v_mfma_f32_16x16x32_bf16 v[116:119], a[76:79], a[220:223], v[116:119]
    s_waitcnt vmcnt(20) lgkmcnt(0)
    s_barrier
    v_mfma_f32_16x16x32_bf16 v[72:75], a[80:83], a[192:195], v[72:75]
    buffer_load_dwordx4 v255, s[4:7], s64 offen offset:0 sc1 lds
    v_mfma_f32_16x16x32_bf16 v[72:75], a[84:87], a[196:199], v[72:75]
    buffer_load_dwordx4 v255, s[4:7], s64 offen offset:1024 sc1 lds
    v_mfma_f32_16x16x32_bf16 v[76:79], a[88:91], a[192:195], v[76:79]
    buffer_load_dwordx4 v255, s[4:7], s64 offen offset:2048 sc1 lds
    v_mfma_f32_16x16x32_bf16 v[76:79], a[92:95], a[196:199], v[76:79]
    buffer_load_dwordx4 v255, s[4:7], s64 offen offset:3072 sc1 lds
    v_mfma_f32_16x16x32_bf16 v[88:91], a[80:83], a[200:203], v[88:91]
    s_add_u32 m0, s68, 0
    ds_read_b64_tr_b16 a[64:65], v204 offset:16384
    ds_read_b64_tr_b16 a[66:67], v204 offset:20480
    v_mfma_f32_16x16x32_bf16 v[88:91], a[84:87], a[204:207], v[88:91]
    s_add_u32 s64, s78, 65536
    ds_read_b64_tr_b16 a[68:69], v204 offset:24576
    ds_read_b64_tr_b16 a[70:71], v204 offset:28672
    v_mfma_f32_16x16x32_bf16 v[92:95], a[88:91], a[200:203], v[92:95]
    ds_read_b64_tr_b16 a[72:73], v205 offset:16384
    ds_read_b64_tr_b16 a[74:75], v205 offset:20480
    v_mfma_f32_16x16x32_bf16 v[92:95], a[92:95], a[204:207], v[92:95]
    ds_read_b64_tr_b16 a[76:77], v205 offset:24576
    ds_read_b64_tr_b16 a[78:79], v205 offset:28672
    v_mfma_f32_16x16x32_bf16 v[104:107], a[80:83], a[208:211], v[104:107]
    ds_read_b128 a[160:163], v208 offset:16384
    v_mfma_f32_16x16x32_bf16 v[104:107], a[84:87], a[212:215], v[104:107]
    ds_read_b128 a[164:167], v208 offset:17408
    v_mfma_f32_16x16x32_bf16 v[108:111], a[88:91], a[208:211], v[108:111]
    ds_read_b128 a[168:171], v208 offset:18432
    v_mfma_f32_16x16x32_bf16 v[108:111], a[92:95], a[212:215], v[108:111]
    buffer_load_dwordx4 v200, s[28:31], s64 offen offset:0 lds
    v_mfma_f32_16x16x32_bf16 v[120:123], a[80:83], a[216:219], v[120:123]
    ds_read_b128 a[172:175], v208 offset:19456
    v_mfma_f32_16x16x32_bf16 v[120:123], a[84:87], a[220:223], v[120:123]
    v_mfma_f32_16x16x32_bf16 v[124:127], a[88:91], a[216:219], v[124:127]
    buffer_load_dwordx4 v201, s[28:31], s64 offen offset:1024 lds
    v_mfma_f32_16x16x32_bf16 v[124:127], a[92:95], a[220:223], v[124:127]
    s_waitcnt lgkmcnt(0)
    v_mfma_f32_16x16x32_bf16 v[64:67], a[64:67], a[128:131], v[64:67]
    ds_read_b64_tr_b16 a[80:81], v204 offset:16640
    v_mfma_f32_16x16x32_bf16 v[64:67], a[68:71], a[132:135], v[64:67]
    ds_read_b64_tr_b16 a[82:83], v204 offset:20736
    v_mfma_f32_16x16x32_bf16 v[68:71], a[72:75], a[128:131], v[68:71]
    ds_read_b64_tr_b16 a[84:85], v204 offset:24832
    v_mfma_f32_16x16x32_bf16 v[68:71], a[76:79], a[132:135], v[68:71]
    buffer_load_dwordx4 v202, s[28:31], s64 offen offset:2048 lds
    v_mfma_f32_16x16x32_bf16 v[80:83], a[64:67], a[136:139], v[80:83]
    ds_read_b64_tr_b16 a[86:87], v204 offset:28928
    ds_read_b64_tr_b16 a[88:89], v205 offset:16640
    v_mfma_f32_16x16x32_bf16 v[80:83], a[68:71], a[140:143], v[80:83]
    ds_read_b64_tr_b16 a[90:91], v205 offset:20736
    v_mfma_f32_16x16x32_bf16 v[84:87], a[72:75], a[136:139], v[84:87]
    ds_read_b64_tr_b16 a[92:93], v205 offset:24832
    v_mfma_f32_16x16x32_bf16 v[84:87], a[76:79], a[140:143], v[84:87]
    ds_read_b64_tr_b16 a[94:95], v205 offset:28928
    v_mfma_f32_16x16x32_bf16 v[96:99], a[64:67], a[144:147], v[96:99]
    buffer_load_dwordx4 v203, s[28:31], s64 offen offset:3072 lds
    v_mfma_f32_16x16x32_bf16 v[96:99], a[68:71], a[148:151], v[96:99]
    ds_read_b128 a[176:179], v208 offset:20480
    ds_read_b128 a[180:183], v208 offset:21504
    v_mfma_f32_16x16x32_bf16 v[100:103], a[72:75], a[144:147], v[100:103]
    ds_read_b128 a[184:187], v208 offset:22528
    v_mfma_f32_16x16x32_bf16 v[100:103], a[76:79], a[148:151], v[100:103]
    ds_read_b128 a[188:191], v208 offset:23552
    v_mfma_f32_16x16x32_bf16 v[112:115], a[64:67], a[152:155], v[112:115]
    v_mfma_f32_16x16x32_bf16 v[112:115], a[68:71], a[156:159], v[112:115]
    v_mfma_f32_16x16x32_bf16 v[116:119], a[72:75], a[152:155], v[116:119]
    v_mfma_f32_16x16x32_bf16 v[116:119], a[76:79], a[156:159], v[116:119]
    s_waitcnt vmcnt(12) lgkmcnt(0)
    s_barrier
    v_mfma_f32_16x16x32_bf16 v[72:75], a[80:83], a[128:131], v[72:75]
    ds_read_b64_tr_b16 a[64:65], v204 offset:32768
    v_mfma_f32_16x16x32_bf16 v[72:75], a[84:87], a[132:135], v[72:75]
    s_add_u32 m0, s68, 16384
    ds_read_b64_tr_b16 a[66:67], v204 offset:36864
    v_mfma_f32_16x16x32_bf16 v[76:79], a[88:91], a[128:131], v[76:79]
    ds_read_b64_tr_b16 a[68:69], v204 offset:40960
    v_min_u32 v252, 31, v254
    v_mfma_f32_16x16x32_bf16 v[76:79], a[92:95], a[132:135], v[76:79]
    ds_read_b64_tr_b16 a[70:71], v204 offset:45056
    v_mfma_f32_16x16x32_bf16 v[88:91], a[80:83], a[136:139], v[88:91]
    ds_read_b64_tr_b16 a[72:73], v205 offset:32768
    v_lshlrev_b32 v252, 2, v252
    v_mfma_f32_16x16x32_bf16 v[88:91], a[84:87], a[140:143], v[88:91]
    s_add_u32 s64, s78, 131072
    ds_read_b64_tr_b16 a[74:75], v205 offset:36864
    v_mfma_f32_16x16x32_bf16 v[92:95], a[88:91], a[136:139], v[92:95]
    s_lshl_b32 s89, s87, 2
    s_add_u32 s89, s89, s85
    s_lshl_b32 s89, s89, 7
    s_add_u32 s89, s89, 8192
    v_add_u32 v252, s89, v252
    v_mfma_f32_16x16x32_bf16 v[92:95], a[92:95], a[140:143], v[92:95]
    ds_read_b64_tr_b16 a[76:77], v205 offset:40960
    ds_read_b64_tr_b16 a[78:79], v205 offset:45056
    v_mfma_f32_16x16x32_bf16 v[104:107], a[80:83], a[144:147], v[104:107]
    buffer_load_dword v253, v252, s[4:7], 0 offen sc1
    v_mfma_f32_16x16x32_bf16 v[104:107], a[84:87], a[148:151], v[104:107]
    ds_read_b128 a[192:195], v208 offset:32768
    ds_read_b128 a[196:199], v208 offset:33792
    v_mfma_f32_16x16x32_bf16 v[108:111], a[88:91], a[144:147], v[108:111]
    ds_read_b128 a[200:203], v208 offset:34816
    v_mfma_f32_16x16x32_bf16 v[108:111], a[92:95], a[148:151], v[108:111]
    buffer_load_dwordx4 v200, s[28:31], s64 offen offset:0 lds
    v_mfma_f32_16x16x32_bf16 v[120:123], a[80:83], a[152:155], v[120:123]
    ds_read_b128 a[204:207], v208 offset:35840
    v_mfma_f32_16x16x32_bf16 v[120:123], a[84:87], a[156:159], v[120:123]
    v_mfma_f32_16x16x32_bf16 v[124:127], a[88:91], a[152:155], v[124:127]
    buffer_load_dwordx4 v201, s[28:31], s64 offen offset:1024 lds
    v_mfma_f32_16x16x32_bf16 v[124:127], a[92:95], a[156:159], v[124:127]
    s_waitcnt lgkmcnt(0)
    v_mfma_f32_16x16x32_bf16 v[64:67], a[64:67], a[160:163], v[64:67]
    ds_read_b64_tr_b16 a[80:81], v204 offset:33024
    v_mfma_f32_16x16x32_bf16 v[64:67], a[68:71], a[164:167], v[64:67]
    ds_read_b64_tr_b16 a[82:83], v204 offset:37120
    v_mfma_f32_16x16x32_bf16 v[68:71], a[72:75], a[160:163], v[68:71]
    ds_read_b64_tr_b16 a[84:85], v204 offset:41216
    v_mfma_f32_16x16x32_bf16 v[68:71], a[76:79], a[164:167], v[68:71]
    buffer_load_dwordx4 v202, s[28:31], s64 offen offset:2048 lds
    v_mfma_f32_16x16x32_bf16 v[80:83], a[64:67], a[168:171], v[80:83]
    ds_read_b64_tr_b16 a[86:87], v204 offset:45312
    ds_read_b64_tr_b16 a[88:89], v205 offset:33024
    v_mfma_f32_16x16x32_bf16 v[80:83], a[68:71], a[172:175], v[80:83]
    ds_read_b64_tr_b16 a[90:91], v205 offset:37120
    v_mfma_f32_16x16x32_bf16 v[84:87], a[72:75], a[168:171], v[84:87]
    ds_read_b64_tr_b16 a[92:93], v205 offset:41216
    v_mfma_f32_16x16x32_bf16 v[84:87], a[76:79], a[172:175], v[84:87]
    ds_read_b64_tr_b16 a[94:95], v205 offset:45312
    v_mfma_f32_16x16x32_bf16 v[96:99], a[64:67], a[176:179], v[96:99]
    buffer_load_dwordx4 v203, s[28:31], s64 offen offset:3072 lds
    v_mfma_f32_16x16x32_bf16 v[96:99], a[68:71], a[180:183], v[96:99]
    ds_read_b128 a[208:211], v208 offset:36864
    ds_read_b128 a[212:215], v208 offset:37888
    v_mfma_f32_16x16x32_bf16 v[100:103], a[72:75], a[176:179], v[100:103]
    ds_read_b128 a[216:219], v208 offset:38912
    v_mfma_f32_16x16x32_bf16 v[100:103], a[76:79], a[180:183], v[100:103]
    ds_read_b128 a[220:223], v208 offset:39936
    v_mfma_f32_16x16x32_bf16 v[112:115], a[64:67], a[184:187], v[112:115]
    v_mfma_f32_16x16x32_bf16 v[112:115], a[68:71], a[188:191], v[112:115]
    v_mfma_f32_16x16x32_bf16 v[116:119], a[72:75], a[184:187], v[116:119]
    v_mfma_f32_16x16x32_bf16 v[116:119], a[76:79], a[188:191], v[116:119]
    s_waitcnt vmcnt(9) lgkmcnt(0)
    s_barrier
    v_mfma_f32_16x16x32_bf16 v[72:75], a[80:83], a[160:163], v[72:75]
    s_waitcnt vmcnt(4)
    v_cmp_gt_u32 vcc, 1, v253
    s_nop 0
    s_cbranch_vccnz L_spin_178
L_spinret_179:
    v_mfma_f32_16x16x32_bf16 v[72:75], a[84:87], a[164:167], v[72:75]
    s_add_u32 m0, s68, 98304
    ds_read_b64_tr_b16 a[64:65], v204 offset:49152
    ds_read_b64_tr_b16 a[66:67], v204 offset:53248
    v_mfma_f32_16x16x32_bf16 v[76:79], a[88:91], a[160:163], v[76:79]
    s_add_u32 s64, s77, 0
    ds_read_b64_tr_b16 a[68:69], v204 offset:57344
    v_mfma_f32_16x16x32_bf16 v[76:79], a[92:95], a[164:167], v[76:79]
    ds_read_b64_tr_b16 a[70:71], v204 offset:61440
    v_mfma_f32_16x16x32_bf16 v[88:91], a[80:83], a[168:171], v[88:91]
    buffer_load_dwordx4 v255, s[4:7], s64 offen offset:0 sc1 lds
    v_mfma_f32_16x16x32_bf16 v[88:91], a[84:87], a[172:175], v[88:91]
    ds_read_b64_tr_b16 a[72:73], v205 offset:49152
    ds_read_b64_tr_b16 a[74:75], v205 offset:53248
    v_mfma_f32_16x16x32_bf16 v[92:95], a[88:91], a[168:171], v[92:95]
    buffer_load_dwordx4 v255, s[4:7], s64 offen offset:1024 sc1 lds
    v_mfma_f32_16x16x32_bf16 v[92:95], a[92:95], a[172:175], v[92:95]
    buffer_load_dwordx4 v255, s[4:7], s64 offen offset:2048 sc1 lds
    v_mfma_f32_16x16x32_bf16 v[104:107], a[80:83], a[176:179], v[104:107]
    ds_read_b64_tr_b16 a[76:77], v205 offset:57344
    ds_read_b64_tr_b16 a[78:79], v205 offset:61440
    v_mfma_f32_16x16x32_bf16 v[104:107], a[84:87], a[180:183], v[104:107]
    buffer_load_dwordx4 v255, s[4:7], s64 offen offset:3072 sc1 lds
    v_mfma_f32_16x16x32_bf16 v[108:111], a[88:91], a[176:179], v[108:111]
    s_add_u32 m0, s68, 32768
    s_add_u32 s64, s78, 196608
    ds_read_b128 a[128:131], v208 offset:49152
    v_mfma_f32_16x16x32_bf16 v[108:111], a[92:95], a[180:183], v[108:111]
    ds_read_b128 a[132:135], v208 offset:50176
    ds_read_b128 a[136:139], v208 offset:51200
    v_mfma_f32_16x16x32_bf16 v[120:123], a[80:83], a[184:187], v[120:123]
    buffer_load_dwordx4 v200, s[28:31], s64 offen offset:0 lds
    v_mfma_f32_16x16x32_bf16 v[120:123], a[84:87], a[188:191], v[120:123]
    ds_read_b128 a[140:143], v208 offset:52224
    v_mfma_f32_16x16x32_bf16 v[124:127], a[88:91], a[184:187], v[124:127]
    buffer_load_dwordx4 v201, s[28:31], s64 offen offset:1024 lds
    v_mfma_f32_16x16x32_bf16 v[124:127], a[92:95], a[188:191], v[124:127]
    s_waitcnt lgkmcnt(0)
    v_mfma_f32_16x16x32_bf16 v[64:67], a[64:67], a[192:195], v[64:67]
    buffer_load_dwordx4 v202, s[28:31], s64 offen offset:2048 lds
    v_mfma_f32_16x16x32_bf16 v[64:67], a[68:71], a[196:199], v[64:67]
    buffer_load_dwordx4 v203, s[28:31], s64 offen offset:3072 lds
    v_mfma_f32_16x16x32_bf16 v[68:71], a[72:75], a[192:195], v[68:71]
    s_add_u32 m0, s68, 114688
    s_add_u32 s64, s77, 262144
    ds_read_b64_tr_b16 a[80:81], v204 offset:49408
    v_mfma_f32_16x16x32_bf16 v[68:71], a[76:79], a[196:199], v[68:71]
    buffer_load_dwordx4 v255, s[4:7], s64 offen offset:0 sc1 lds
    v_mfma_f32_16x16x32_bf16 v[80:83], a[64:67], a[200:203], v[80:83]
    ds_read_b64_tr_b16 a[82:83], v204 offset:53504
    ds_read_b64_tr_b16 a[84:85], v204 offset:57600
    v_mfma_f32_16x16x32_bf16 v[80:83], a[68:71], a[204:207], v[80:83]
    buffer_load_dwordx4 v255, s[4:7], s64 offen offset:1024 sc1 lds
    v_mfma_f32_16x16x32_bf16 v[84:87], a[72:75], a[200:203], v[84:87]
    buffer_load_dwordx4 v255, s[4:7], s64 offen offset:2048 sc1 lds
    v_mfma_f32_16x16x32_bf16 v[84:87], a[76:79], a[204:207], v[84:87]
    ds_read_b64_tr_b16 a[86:87], v204 offset:61696
    ds_read_b64_tr_b16 a[88:89], v205 offset:49408
    v_mfma_f32_16x16x32_bf16 v[96:99], a[64:67], a[208:211], v[96:99]
    buffer_load_dwordx4 v255, s[4:7], s64 offen offset:3072 sc1 lds
    v_mfma_f32_16x16x32_bf16 v[96:99], a[68:71], a[212:215], v[96:99]
    s_add_u32 m0, s68, 131072
    ds_read_b64_tr_b16 a[90:91], v205 offset:53504
    ds_read_b64_tr_b16 a[92:93], v205 offset:57600
    v_mfma_f32_16x16x32_bf16 v[100:103], a[72:75], a[208:211], v[100:103]
    s_add_u32 s64, s77, 524288
    ds_read_b64_tr_b16 a[94:95], v205 offset:61696
    ds_read_b128 a[144:147], v208 offset:53248
    v_mfma_f32_16x16x32_bf16 v[100:103], a[76:79], a[212:215], v[100:103]
    buffer_load_dwordx4 v255, s[4:7], s64 offen offset:0 sc1 lds
    v_mfma_f32_16x16x32_bf16 v[112:115], a[64:67], a[216:219], v[112:115]
    buffer_load_dwordx4 v255, s[4:7], s64 offen offset:1024 sc1 lds
    v_mfma_f32_16x16x32_bf16 v[112:115], a[68:71], a[220:223], v[112:115]
    ds_read_b128 a[148:151], v208 offset:54272
    ds_read_b128 a[152:155], v208 offset:55296
    ds_read_b128 a[156:159], v208 offset:56320
    v_mfma_f32_16x16x32_bf16 v[116:119], a[72:75], a[216:219], v[116:119]
    buffer_load_dwordx4 v255, s[4:7], s64 offen offset:2048 sc1 lds
    v_mfma_f32_16x16x32_bf16 v[116:119], a[76:79], a[220:223], v[116:119]
    s_waitcnt vmcnt(11) lgkmcnt(0)
    s_barrier
    v_mfma_f32_16x16x32_bf16 v[72:75], a[80:83], a[192:195], v[72:75]
    buffer_load_dwordx4 v255, s[4:7], s64 offen offset:3072 sc1 lds
    v_mfma_f32_16x16x32_bf16 v[72:75], a[84:87], a[196:199], v[72:75]
    s_add_u32 m0, s68, 49152
    ds_read_b64_tr_b16 a[64:65], v206 offset:0
    ds_read_b64_tr_b16 a[66:67], v206 offset:4096
    v_mfma_f32_16x16x32_bf16 v[76:79], a[88:91], a[192:195], v[76:79]
    ds_read_b64_tr_b16 a[68:69], v206 offset:8192
    v_mfma_f32_16x16x32_bf16 v[76:79], a[92:95], a[196:199], v[76:79]
    s_add_u32 s64, s78, 262144
    ds_read_b64_tr_b16 a[70:71], v206 offset:12288
    v_mfma_f32_16x16x32_bf16 v[88:91], a[80:83], a[200:203], v[88:91]
    ds_read_b64_tr_b16 a[72:73], v207 offset:0
    v_mfma_f32_16x16x32_bf16 v[88:91], a[84:87], a[204:207], v[88:91]
    ds_read_b64_tr_b16 a[74:75], v207 offset:4096
    v_mfma_f32_16x16x32_bf16 v[92:95], a[88:91], a[200:203], v[92:95]
    buffer_load_dwordx4 v200, s[28:31], s64 offen offset:0 lds
    v_mfma_f32_16x16x32_bf16 v[92:95], a[92:95], a[204:207], v[92:95]
    ds_read_b64_tr_b16 a[76:77], v207 offset:8192
    ds_read_b64_tr_b16 a[78:79], v207 offset:12288
    v_mfma_f32_16x16x32_bf16 v[104:107], a[80:83], a[208:211], v[104:107]
    buffer_load_dwordx4 v201, s[28:31], s64 offen offset:1024 lds
    v_mfma_f32_16x16x32_bf16 v[104:107], a[84:87], a[212:215], v[104:107]
    ds_read_b128 a[160:163], v208 offset:0
    ds_read_b128 a[164:167], v208 offset:1024
    v_mfma_f32_16x16x32_bf16 v[108:111], a[88:91], a[208:211], v[108:111]
    ds_read_b128 a[168:171], v208 offset:2048
    v_mfma_f32_16x16x32_bf16 v[108:111], a[92:95], a[212:215], v[108:111]
    buffer_load_dwordx4 v202, s[28:31], s64 offen offset:2048 lds
    v_mfma_f32_16x16x32_bf16 v[120:123], a[80:83], a[216:219], v[120:123]
    ds_read_b128 a[172:175], v208 offset:3072
    v_mfma_f32_16x16x32_bf16 v[120:123], a[84:87], a[220:223], v[120:123]
    buffer_load_dwordx4 v203, s[28:31], s64 offen offset:3072 lds
    v_mfma_f32_16x16x32_bf16 v[124:127], a[88:91], a[216:219], v[124:127]
    s_add_u32 m0, s68, 147456
    v_mfma_f32_16x16x32_bf16 v[124:127], a[92:95], a[220:223], v[124:127]
    s_waitcnt lgkmcnt(0)
    v_mfma_f32_16x16x32_bf16 v[64:67], a[64:67], a[128:131], v[64:67]
    s_add_u32 s64, s77, 786432
    ds_read_b64_tr_b16 a[80:81], v206 offset:256
    v_mfma_f32_16x16x32_bf16 v[64:67], a[68:71], a[132:135], v[64:67]
    ds_read_b64_tr_b16 a[82:83], v206 offset:4352
    v_mfma_f32_16x16x32_bf16 v[68:71], a[72:75], a[128:131], v[68:71]
    ds_read_b64_tr_b16 a[84:85], v206 offset:8448
    v_mfma_f32_16x16x32_bf16 v[68:71], a[76:79], a[132:135], v[68:71]
    buffer_load_dwordx4 v255, s[4:7], s64 offen offset:0 sc1 lds
    v_mfma_f32_16x16x32_bf16 v[80:83], a[64:67], a[136:139], v[80:83]
    ds_read_b64_tr_b16 a[86:87], v206 offset:12544
    ds_read_b64_tr_b16 a[88:89], v207 offset:256
    v_mfma_f32_16x16x32_bf16 v[80:83], a[68:71], a[140:143], v[80:83]
    ds_read_b64_tr_b16 a[90:91], v207 offset:4352
    v_mfma_f32_16x16x32_bf16 v[84:87], a[72:75], a[136:139], v[84:87]
    buffer_load_dwordx4 v255, s[4:7], s64 offen offset:1024 sc1 lds
    v_mfma_f32_16x16x32_bf16 v[84:87], a[76:79], a[140:143], v[84:87]
    ds_read_b64_tr_b16 a[92:93], v207 offset:8448
    ds_read_b64_tr_b16 a[94:95], v207 offset:12544
    v_mfma_f32_16x16x32_bf16 v[96:99], a[64:67], a[144:147], v[96:99]
    buffer_load_dwordx4 v255, s[4:7], s64 offen offset:2048 sc1 lds
    v_mfma_f32_16x16x32_bf16 v[96:99], a[68:71], a[148:151], v[96:99]
    ds_read_b128 a[176:179], v208 offset:4096
    ds_read_b128 a[180:183], v208 offset:5120
    v_mfma_f32_16x16x32_bf16 v[100:103], a[72:75], a[144:147], v[100:103]
    buffer_load_dwordx4 v255, s[4:7], s64 offen offset:3072 sc1 lds
    v_mfma_f32_16x16x32_bf16 v[100:103], a[76:79], a[148:151], v[100:103]
    ds_read_b128 a[184:187], v208 offset:6144
    ds_read_b128 a[188:191], v208 offset:7168
    v_mfma_f32_16x16x32_bf16 v[112:115], a[64:67], a[152:155], v[112:115]
    v_mfma_f32_16x16x32_bf16 v[112:115], a[68:71], a[156:159], v[112:115]
    v_mfma_f32_16x16x32_bf16 v[116:119], a[72:75], a[152:155], v[116:119]
    v_mfma_f32_16x16x32_bf16 v[116:119], a[76:79], a[156:159], v[116:119]
    s_waitcnt vmcnt(12) lgkmcnt(0)
    s_barrier
    v_mfma_f32_16x16x32_bf16 v[72:75], a[80:83], a[128:131], v[72:75]
    ds_read_b64_tr_b16 a[64:65], v206 offset:16384
    v_mfma_f32_16x16x32_bf16 v[72:75], a[84:87], a[132:135], v[72:75]
    s_add_u32 m0, s68, 65536
    ds_read_b64_tr_b16 a[66:67], v206 offset:20480
    v_mfma_f32_16x16x32_bf16 v[76:79], a[88:91], a[128:131], v[76:79]
    ds_read_b64_tr_b16 a[68:69], v206 offset:24576
    v_mfma_f32_16x16x32_bf16 v[76:79], a[92:95], a[132:135], v[76:79]
    s_add_u32 s64, s78, 327680
    ds_read_b64_tr_b16 a[70:71], v206 offset:28672
    v_mfma_f32_16x16x32_bf16 v[88:91], a[80:83], a[136:139], v[88:91]
    ds_read_b64_tr_b16 a[72:73], v207 offset:16384
    v_mfma_f32_16x16x32_bf16 v[88:91], a[84:87], a[140:143], v[88:91]
    ds_read_b64_tr_b16 a[74:75], v207 offset:20480
    v_mfma_f32_16x16x32_bf16 v[92:95], a[88:91], a[136:139], v[92:95]
    buffer_load_dwordx4 v200, s[28:31], s64 offen offset:0 lds
    v_mfma_f32_16x16x32_bf16 v[92:95], a[92:95], a[140:143], v[92:95]
    ds_read_b64_tr_b16 a[76:77], v207 offset:24576
    ds_read_b64_tr_b16 a[78:79], v207 offset:28672
    v_mfma_f32_16x16x32_bf16 v[104:107], a[80:83], a[144:147], v[104:107]
    buffer_load_dwordx4 v201, s[28:31], s64 offen offset:1024 lds
    v_mfma_f32_16x16x32_bf16 v[104:107], a[84:87], a[148:151], v[104:107]
    ds_read_b128 a[192:195], v208 offset:16384
    ds_read_b128 a[196:199], v208 offset:17408
    v_mfma_f32_16x16x32_bf16 v[108:111], a[88:91], a[144:147], v[108:111]
    ds_read_b128 a[200:203], v208 offset:18432
    v_mfma_f32_16x16x32_bf16 v[108:111], a[92:95], a[148:151], v[108:111]
    buffer_load_dwordx4 v202, s[28:31], s64 offen offset:2048 lds
    v_mfma_f32_16x16x32_bf16 v[120:123], a[80:83], a[152:155], v[120:123]
    ds_read_b128 a[204:207], v208 offset:19456
    v_mfma_f32_16x16x32_bf16 v[120:123], a[84:87], a[156:159], v[120:123]
    buffer_load_dwordx4 v203, s[28:31], s64 offen offset:3072 lds
    v_mfma_f32_16x16x32_bf16 v[124:127], a[88:91], a[152:155], v[124:127]
    s_add_u32 m0, s68, 98304
    v_mfma_f32_16x16x32_bf16 v[124:127], a[92:95], a[156:159], v[124:127]
    s_waitcnt lgkmcnt(0)
    v_mfma_f32_16x16x32_bf16 v[0:3], a[64:67], a[160:163], 0
    s_add_u32 s64, s77, 1048576
    ds_read_b64_tr_b16 a[80:81], v206 offset:16640
    v_mfma_f32_16x16x32_bf16 v[0:3], a[68:71], a[164:167], v[0:3]
    ds_read_b64_tr_b16 a[82:83], v206 offset:20736
    v_mfma_f32_16x16x32_bf16 v[4:7], a[72:75], a[160:163], 0
    ds_read_b64_tr_b16 a[84:85], v206 offset:24832
    v_mfma_f32_16x16x32_bf16 v[4:7], a[76:79], a[164:167], v[4:7]
    buffer_load_dwordx4 v255, s[4:7], s64 offen offset:0 sc1 lds
    v_mfma_f32_16x16x32_bf16 v[16:19], a[64:67], a[168:171], 0
    ds_read_b64_tr_b16 a[86:87], v206 offset:28928
    v_cvt_pk_bf16_f32 v128, v64, v65
    v_mfma_f32_16x16x32_bf16 v[16:19], a[68:71], a[172:175], v[16:19]
    ds_read_b64_tr_b16 a[88:89], v207 offset:16640
    v_cvt_pk_bf16_f32 v129, v66, v67
    v_mfma_f32_16x16x32_bf16 v[20:23], a[72:75], a[168:171], 0
    ds_read_b64_tr_b16 a[90:91], v207 offset:20736
    v_cvt_pk_bf16_f32 v130, v68, v69
    v_mfma_f32_16x16x32_bf16 v[20:23], a[76:79], a[172:175], v[20:23]
    buffer_load_dwordx4 v255, s[4:7], s64 offen offset:1024 sc1 lds
    v_mfma_f32_16x16x32_bf16 v[32:35], a[64:67], a[176:179], 0
    ds_read_b64_tr_b16 a[92:93], v207 offset:24832
    v_cvt_pk_bf16_f32 v131, v70, v71
    v_mfma_f32_16x16x32_bf16 v[32:35], a[68:71], a[180:183], v[32:35]
    ds_read_b64_tr_b16 a[94:95], v207 offset:28928
    v_cvt_pk_bf16_f32 v132, v72, v73
    v_mfma_f32_16x16x32_bf16 v[36:39], a[72:75], a[176:179], 0
    buffer_load_dwordx4 v255, s[4:7], s64 offen offset:2048 sc1 lds
    v_mfma_f32_16x16x32_bf16 v[36:39], a[76:79], a[180:183], v[36:39]
    ds_read_b128 a[208:211], v208 offset:20480
    v_cvt_pk_bf16_f32 v133, v74, v75
    v_mfma_f32_16x16x32_bf16 v[48:51], a[64:67], a[184:187], 0
    ds_read_b128 a[212:215], v208 offset:21504
    ds_read_b128 a[216:219], v208 offset:22528
    ds_read_b128 a[220:223], v208 offset:23552
    v_cvt_pk_bf16_f32 v134, v76, v77
    v_mfma_f32_16x16x32_bf16 v[48:51], a[68:71], a[188:191], v[48:51]
    buffer_load_dwordx4 v255, s[4:7], s64 offen offset:3072 sc1 lds
    v_mfma_f32_16x16x32_bf16 v[52:55], a[72:75], a[184:187], 0
    v_cvt_pk_bf16_f32 v135, v78, v79
    v_cvt_pk_bf16_f32 v136, v80, v81
    v_mfma_f32_16x16x32_bf16 v[52:55], a[76:79], a[188:191], v[52:55]
    s_waitcnt vmcnt(16) lgkmcnt(0)
    s_barrier
    v_mfma_f32_16x16x32_bf16 v[8:11], a[80:83], a[160:163], 0
    v_cvt_pk_bf16_f32 v137, v82, v83
    v_cvt_pk_bf16_f32 v138, v84, v85
    v_mfma_f32_16x16x32_bf16 v[8:11], a[84:87], a[164:167], v[8:11]
    s_add_u32 m0, s68, 81920
    v_cvt_pk_bf16_f32 v139, v86, v87
    v_cvt_pk_bf16_f32 v140, v88, v89
    v_mfma_f32_16x16x32_bf16 v[12:15], a[88:91], a[160:163], 0
    ds_read_b64_tr_b16 a[64:65], v204 offset:0
    v_cvt_pk_bf16_f32 v141, v90, v91
    v_mfma_f32_16x16x32_bf16 v[12:15], a[92:95], a[164:167], v[12:15]
    s_add_u32 s64, s78, 393216
    ds_read_b64_tr_b16 a[66:67], v204 offset:4096
    v_cvt_pk_bf16_f32 v142, v92, v93
    v_mfma_f32_16x16x32_bf16 v[24:27], a[80:83], a[168:171], 0
    v_cvt_pk_bf16_f32 v143, v94, v95
    v_cvt_pk_bf16_f32 v144, v96, v97
    v_mfma_f32_16x16x32_bf16 v[24:27], a[84:87], a[172:175], v[24:27]
    ds_read_b64_tr_b16 a[68:69], v204 offset:8192
    v_cvt_pk_bf16_f32 v145, v98, v99
    v_mfma_f32_16x16x32_bf16 v[28:31], a[88:91], a[168:171], 0
    ds_read_b64_tr_b16 a[70:71], v204 offset:12288
    v_cvt_pk_bf16_f32 v146, v100, v101
    v_mfma_f32_16x16x32_bf16 v[28:31], a[92:95], a[172:175], v[28:31]
    ds_read_b64_tr_b16 a[72:73], v205 offset:0
    v_cvt_pk_bf16_f32 v147, v102, v103
    v_mfma_f32_16x16x32_bf16 v[40:43], a[80:83], a[176:179], 0
    ds_read_b64_tr_b16 a[74:75], v205 offset:4096
    v_cvt_pk_bf16_f32 v148, v104, v105
    v_mfma_f32_16x16x32_bf16 v[40:43], a[84:87], a[180:183], v[40:43]
    buffer_load_dwordx4 v200, s[28:31], s64 offen offset:0 lds
    v_mfma_f32_16x16x32_bf16 v[44:47], a[88:91], a[176:179], 0
    ds_read_b64_tr_b16 a[76:77], v205 offset:8192
    v_cvt_pk_bf16_f32 v149, v106, v107
    v_mfma_f32_16x16x32_bf16 v[44:47], a[92:95], a[180:183], v[44:47]
    ds_read_b64_tr_b16 a[78:79], v205 offset:12288
    v_cvt_pk_bf16_f32 v150, v108, v109
    v_mfma_f32_16x16x32_bf16 v[56:59], a[80:83], a[184:187], 0
    buffer_load_dwordx4 v201, s[28:31], s64 offen offset:1024 lds
    v_mfma_f32_16x16x32_bf16 v[56:59], a[84:87], a[188:191], v[56:59]
    ds_read_b128 a[128:131], v208 offset:32768
    ds_read_b128 a[132:135], v208 offset:33792
    ds_read_b128 a[136:139], v208 offset:34816
    ds_read_b128 a[140:143], v208 offset:35840
    v_cvt_pk_bf16_f32 v151, v110, v111
    v_mfma_f32_16x16x32_bf16 v[60:63], a[88:91], a[184:187], 0
    v_cvt_pk_bf16_f32 v152, v112, v113
    v_cvt_pk_bf16_f32 v153, v114, v115
    v_mfma_f32_16x16x32_bf16 v[60:63], a[92:95], a[188:191], v[60:63]
    s_waitcnt lgkmcnt(0)
    v_cvt_pk_bf16_f32 v154, v116, v117
    v_cvt_pk_bf16_f32 v155, v118, v119
    v_mfma_f32_16x16x32_bf16 v[0:3], a[64:67], a[192:195], v[0:3]
    buffer_load_dwordx4 v202, s[28:31], s64 offen offset:2048 lds
    v_mfma_f32_16x16x32_bf16 v[0:3], a[68:71], a[196:199], v[0:3]
    buffer_load_dwordx4 v203, s[28:31], s64 offen offset:3072 lds
    v_mfma_f32_16x16x32_bf16 v[4:7], a[72:75], a[192:195], v[4:7]
    s_add_u32 m0, s68, 114688
    v_cvt_pk_bf16_f32 v156, v120, v121
    v_cvt_pk_bf16_f32 v157, v122, v123
    v_mfma_f32_16x16x32_bf16 v[4:7], a[76:79], a[196:199], v[4:7]
    s_add_u32 s64, s77, 1310720
    v_cvt_pk_bf16_f32 v158, v124, v125
    v_cvt_pk_bf16_f32 v159, v126, v127
    v_mfma_f32_16x16x32_bf16 v[16:19], a[64:67], a[200:203], v[16:19]
    s_add_u32 s65, s80, 32768
    ds_read_b64_tr_b16 a[80:81], v204 offset:256
    ds_read_b64_tr_b16 a[82:83], v204 offset:4352
    v_mfma_f32_16x16x32_bf16 v[16:19], a[68:71], a[204:207], v[16:19]
    ds_read_b64_tr_b16 a[84:85], v204 offset:8448
    ds_read_b64_tr_b16 a[86:87], v204 offset:12544
    v_mfma_f32_16x16x32_bf16 v[20:23], a[72:75], a[200:203], v[20:23]
    buffer_load_dwordx4 v255, s[4:7], s64 offen offset:0 sc1 lds
    v_mfma_f32_16x16x32_bf16 v[20:23], a[76:79], a[204:207], v[20:23]
    ds_read_b64_tr_b16 a[88:89], v205 offset:256
    ds_read_b64_tr_b16 a[90:91], v205 offset:4352
    v_mfma_f32_16x16x32_bf16 v[32:35], a[64:67], a[208:211], v[32:35]
    buffer_load_dwordx4 v255, s[4:7], s64 offen offset:1024 sc1 lds
    v_mfma_f32_16x16x32_bf16 v[32:35], a[68:71], a[212:215], v[32:35]
    ds_read_b64_tr_b16 a[92:93], v205 offset:8448
    ds_read_b64_tr_b16 a[94:95], v205 offset:12544
    v_mfma_f32_16x16x32_bf16 v[36:39], a[72:75], a[208:211], v[36:39]
    buffer_load_dwordx4 v255, s[4:7], s64 offen offset:2048 sc1 lds
    v_mfma_f32_16x16x32_bf16 v[36:39], a[76:79], a[212:215], v[36:39]
    ds_read_b128 a[144:147], v208 offset:36864
    ds_read_b128 a[148:151], v208 offset:37888
    v_mfma_f32_16x16x32_bf16 v[48:51], a[64:67], a[216:219], v[48:51]
    buffer_load_dwordx4 v255, s[4:7], s64 offen offset:3072 sc1 lds
    v_mfma_f32_16x16x32_bf16 v[48:51], a[68:71], a[220:223], v[48:51]
    ds_read_b128 a[152:155], v208 offset:38912
    ds_read_b128 a[156:159], v208 offset:39936
    v_mfma_f32_16x16x32_bf16 v[52:55], a[72:75], a[216:219], v[52:55]
    v_mfma_f32_16x16x32_bf16 v[52:55], a[76:79], a[220:223], v[52:55]
    s_waitcnt vmcnt(16) lgkmcnt(0)
    s_barrier
    v_mfma_f32_16x16x32_bf16 v[8:11], a[80:83], a[192:195], v[8:11]
    ds_read_b64_tr_b16 a[64:65], v204 offset:16384
    v_mfma_f32_16x16x32_bf16 v[8:11], a[84:87], a[196:199], v[8:11]
    s_add_u32 m0, s68, 0
    ds_read_b64_tr_b16 a[66:67], v204 offset:20480
    v_mfma_f32_16x16x32_bf16 v[12:15], a[88:91], a[192:195], v[12:15]
    buffer_store_dwordx4 v[128:131], v255, s[4:7], s65 offen offset:0 sc1
    v_mfma_f32_16x16x32_bf16 v[12:15], a[92:95], a[196:199], v[12:15]
    s_add_u32 s64, s78, 458752
    ds_read_b64_tr_b16 a[68:69], v204 offset:24576
    ds_read_b64_tr_b16 a[70:71], v204 offset:28672
    v_mfma_f32_16x16x32_bf16 v[24:27], a[80:83], a[200:203], v[24:27]
    ds_read_b64_tr_b16 a[72:73], v205 offset:16384
    v_mfma_f32_16x16x32_bf16 v[24:27], a[84:87], a[204:207], v[24:27]
    ds_read_b64_tr_b16 a[74:75], v205 offset:20480
    v_mfma_f32_16x16x32_bf16 v[28:31], a[88:91], a[200:203], v[28:31]
    buffer_load_dwordx4 v200, s[28:31], s64 offen offset:0 lds
    v_mfma_f32_16x16x32_bf16 v[28:31], a[92:95], a[204:207], v[28:31]
    ds_read_b64_tr_b16 a[76:77], v205 offset:24576
    ds_read_b64_tr_b16 a[78:79], v205 offset:28672
    v_mfma_f32_16x16x32_bf16 v[40:43], a[80:83], a[208:211], v[40:43]
    buffer_load_dwordx4 v201, s[28:31], s64 offen offset:1024 lds
    v_mfma_f32_16x16x32_bf16 v[40:43], a[84:87], a[212:215], v[40:43]
    ds_read_b128 a[160:163], v208 offset:49152
    ds_read_b128 a[164:167], v208 offset:50176
    v_mfma_f32_16x16x32_bf16 v[44:47], a[88:91], a[208:211], v[44:47]
    ds_read_b128 a[168:171], v208 offset:51200
    v_mfma_f32_16x16x32_bf16 v[44:47], a[92:95], a[212:215], v[44:47]
    buffer_load_dwordx4 v202, s[28:31], s64 offen offset:2048 lds
    v_mfma_f32_16x16x32_bf16 v[56:59], a[80:83], a[216:219], v[56:59]
    ds_read_b128 a[172:175], v208 offset:52224
    v_mfma_f32_16x16x32_bf16 v[56:59], a[84:87], a[220:223], v[56:59]
    buffer_load_dwordx4 v203, s[28:31], s64 offen offset:3072 lds
    v_mfma_f32_16x16x32_bf16 v[60:63], a[88:91], a[216:219], v[60:63]
    s_add_u32 m0, s68, 131072
    v_mfma_f32_16x16x32_bf16 v[60:63], a[92:95], a[220:223], v[60:63]
    s_waitcnt lgkmcnt(0)
    v_mfma_f32_16x16x32_bf16 v[0:3], a[64:67], a[128:131], v[0:3]
    s_add_u32 s64, s77, 1572864
    ds_read_b64_tr_b16 a[80:81], v204 offset:16640
    v_mfma_f32_16x16x32_bf16 v[0:3], a[68:71], a[132:135], v[0:3]
    ds_read_b64_tr_b16 a[82:83], v204 offset:20736
    v_mfma_f32_16x16x32_bf16 v[4:7], a[72:75], a[128:131], v[4:7]
    buffer_store_dwordx4 v[132:135], v255, s[4:7], s65 offen offset:1024 sc1
    v_mfma_f32_16x16x32_bf16 v[4:7], a[76:79], a[132:135], v[4:7]
    ds_read_b64_tr_b16 a[84:85], v204 offset:24832
    ds_read_b64_tr_b16 a[86:87], v204 offset:28928
    v_mfma_f32_16x16x32_bf16 v[16:19], a[64:67], a[136:139], v[16:19]
    buffer_load_dwordx4 v255, s[4:7], s64 offen offset:0 sc1 lds
    v_mfma_f32_16x16x32_bf16 v[16:19], a[68:71], a[140:143], v[16:19]
    ds_read_b64_tr_b16 a[88:89], v205 offset:16640
    ds_read_b64_tr_b16 a[90:91], v205 offset:20736
    v_mfma_f32_16x16x32_bf16 v[20:23], a[72:75], a[136:139], v[20:23]
    buffer_load_dwordx4 v255, s[4:7], s64 offen offset:1024 sc1 lds
    v_mfma_f32_16x16x32_bf16 v[20:23], a[76:79], a[140:143], v[20:23]
    ds_read_b64_tr_b16 a[92:93], v205 offset:24832
    ds_read_b64_tr_b16 a[94:95], v205 offset:28928
    v_mfma_f32_16x16x32_bf16 v[32:35], a[64:67], a[144:147], v[32:35]
    buffer_load_dwordx4 v255, s[4:7], s64 offen offset:2048 sc1 lds
    v_mfma_f32_16x16x32_bf16 v[32:35], a[68:71], a[148:151], v[32:35]
    ds_read_b128 a[176:179], v208 offset:53248
    ds_read_b128 a[180:183], v208 offset:54272
    v_mfma_f32_16x16x32_bf16 v[36:39], a[72:75], a[144:147], v[36:39]
    buffer_load_dwordx4 v255, s[4:7], s64 offen offset:3072 sc1 lds
    v_mfma_f32_16x16x32_bf16 v[36:39], a[76:79], a[148:151], v[36:39]
    ds_read_b128 a[184:187], v208 offset:55296
    ds_read_b128 a[188:191], v208 offset:56320
    v_mfma_f32_16x16x32_bf16 v[48:51], a[64:67], a[152:155], v[48:51]
    v_mfma_f32_16x16x32_bf16 v[48:51], a[68:71], a[156:159], v[48:51]
    v_mfma_f32_16x16x32_bf16 v[52:55], a[72:75], a[152:155], v[52:55]
    v_mfma_f32_16x16x32_bf16 v[52:55], a[76:79], a[156:159], v[52:55]
    s_waitcnt vmcnt(18) lgkmcnt(0)
    s_barrier
    v_mfma_f32_16x16x32_bf16 v[8:11], a[80:83], a[128:131], v[8:11]
    ds_read_b64_tr_b16 a[64:65], v204 offset:32768
    v_mfma_f32_16x16x32_bf16 v[8:11], a[84:87], a[132:135], v[8:11]
    s_add_u32 m0, s68, 16384
    ds_read_b64_tr_b16 a[66:67], v204 offset:36864
    v_mfma_f32_16x16x32_bf16 v[12:15], a[88:91], a[128:131], v[12:15]
    buffer_store_dwordx4 v[136:139], v255, s[4:7], s65 offen offset:2048 sc1
    v_mfma_f32_16x16x32_bf16 v[12:15], a[92:95], a[132:135], v[12:15]
    s_add_u32 s64, s78, 524288
    ds_read_b64_tr_b16 a[68:69], v204 offset:40960
    ds_read_b64_tr_b16 a[70:71], v204 offset:45056
    v_mfma_f32_16x16x32_bf16 v[24:27], a[80:83], a[136:139], v[24:27]
    ds_read_b64_tr_b16 a[72:73], v205 offset:32768
    v_mfma_f32_16x16x32_bf16 v[24:27], a[84:87], a[140:143], v[24:27]
    ds_read_b64_tr_b16 a[74:75], v205 offset:36864
    v_mfma_f32_16x16x32_bf16 v[28:31], a[88:91], a[136:139], v[28:31]
    buffer_load_dwordx4 v200, s[28:31], s64 offen offset:0 lds
    v_mfma_f32_16x16x32_bf16 v[28:31], a[92:95], a[140:143], v[28:31]
    ds_read_b64_tr_b16 a[76:77], v205 offset:40960
    ds_read_b64_tr_b16 a[78:79], v205 offset:45056
    v_mfma_f32_16x16x32_bf16 v[40:43], a[80:83], a[144:147], v[40:43]
    buffer_load_dwordx4 v201, s[28:31], s64 offen offset:1024 lds
    v_mfma_f32_16x16x32_bf16 v[40:43], a[84:87], a[148:151], v[40:43]
    ds_read_b128 a[192:195], v208 offset:0
    ds_read_b128 a[196:199], v208 offset:1024
    v_mfma_f32_16x16x32_bf16 v[44:47], a[88:91], a[144:147], v[44:47]
    ds_read_b128 a[200:203], v208 offset:2048
    v_mfma_f32_16x16x32_bf16 v[44:47], a[92:95], a[148:151], v[44:47]
    buffer_load_dwordx4 v202, s[28:31], s64 offen offset:2048 lds
    v_mfma_f32_16x16x32_bf16 v[56:59], a[80:83], a[152:155], v[56:59]
    ds_read_b128 a[204:207], v208 offset:3072
    v_mfma_f32_16x16x32_bf16 v[56:59], a[84:87], a[156:159], v[56:59]
    buffer_load_dwordx4 v203, s[28:31], s64 offen offset:3072 lds
    v_mfma_f32_16x16x32_bf16 v[60:63], a[88:91], a[152:155], v[60:63]
    s_add_u32 m0, s68, 147456
    v_mfma_f32_16x16x32_bf16 v[60:63], a[92:95], a[156:159], v[60:63]
    s_waitcnt lgkmcnt(0)
    v_mfma_f32_16x16x32_bf16 v[0:3], a[64:67], a[160:163], v[0:3]
    s_add_u32 s64, s77, 1835008
    ds_read_b64_tr_b16 a[80:81], v204 offset:33024
    v_mfma_f32_16x16x32_bf16 v[0:3], a[68:71], a[164:167], v[0:3]
    ds_read_b64_tr_b16 a[82:83], v204 offset:37120
    v_mfma_f32_16x16x32_bf16 v[4:7], a[72:75], a[160:163], v[4:7]
    buffer_store_dwordx4 v[140:143], v255, s[4:7], s65 offen offset:3072 sc1
    v_mfma_f32_16x16x32_bf16 v[4:7], a[76:79], a[164:167], v[4:7]
    ds_read_b64_tr_b16 a[84:85], v204 offset:41216
    ds_read_b64_tr_b16 a[86:87], v204 offset:45312
    v_mfma_f32_16x16x32_bf16 v[16:19], a[64:67], a[168:171], v[16:19]
    buffer_load_dwordx4 v255, s[4:7], s64 offen offset:0 sc1 lds
    v_mfma_f32_16x16x32_bf16 v[16:19], a[68:71], a[172:175], v[16:19]
    ds_read_b64_tr_b16 a[88:89], v205 offset:33024
    ds_read_b64_tr_b16 a[90:91], v205 offset:37120
    v_mfma_f32_16x16x32_bf16 v[20:23], a[72:75], a[168:171], v[20:23]
    buffer_load_dwordx4 v255, s[4:7], s64 offen offset:1024 sc1 lds
    v_mfma_f32_16x16x32_bf16 v[20:23], a[76:79], a[172:175], v[20:23]
    ds_read_b64_tr_b16 a[92:93], v205 offset:41216
    ds_read_b64_tr_b16 a[94:95], v205 offset:45312
    v_mfma_f32_16x16x32_bf16 v[32:35], a[64:67], a[176:179], v[32:35]
    buffer_load_dwordx4 v255, s[4:7], s64 offen offset:2048 sc1 lds
    v_mfma_f32_16x16x32_bf16 v[32:35], a[68:71], a[180:183], v[32:35]
    ds_read_b128 a[208:211], v208 offset:4096
    ds_read_b128 a[212:215], v208 offset:5120
    v_mfma_f32_16x16x32_bf16 v[36:39], a[72:75], a[176:179], v[36:39]
    buffer_load_dwordx4 v255, s[4:7], s64 offen offset:3072 sc1 lds
    v_mfma_f32_16x16x32_bf16 v[36:39], a[76:79], a[180:183], v[36:39]
    ds_read_b128 a[216:219], v208 offset:6144
    ds_read_b128 a[220:223], v208 offset:7168
    v_mfma_f32_16x16x32_bf16 v[48:51], a[64:67], a[184:187], v[48:51]
    v_mfma_f32_16x16x32_bf16 v[48:51], a[68:71], a[188:191], v[48:51]
    v_mfma_f32_16x16x32_bf16 v[52:55], a[72:75], a[184:187], v[52:55]
    v_mfma_f32_16x16x32_bf16 v[52:55], a[76:79], a[188:191], v[52:55]
    s_waitcnt vmcnt(20) lgkmcnt(0)
    s_barrier
    v_mfma_f32_16x16x32_bf16 v[8:11], a[80:83], a[160:163], v[8:11]
    ds_read_b64_tr_b16 a[64:65], v204 offset:49152
    v_mfma_f32_16x16x32_bf16 v[8:11], a[84:87], a[164:167], v[8:11]
    s_add_u32 m0, s68, 32768
    ds_read_b64_tr_b16 a[66:67], v204 offset:53248
    v_mfma_f32_16x16x32_bf16 v[12:15], a[88:91], a[160:163], v[12:15]
    s_add_u32 s65, s80, 36864
    ds_read_b64_tr_b16 a[68:69], v204 offset:57344
    v_mfma_f32_16x16x32_bf16 v[12:15], a[92:95], a[164:167], v[12:15]
    s_add_u32 s64, s78, 589824
    ds_read_b64_tr_b16 a[70:71], v204 offset:61440
    v_mfma_f32_16x16x32_bf16 v[24:27], a[80:83], a[168:171], v[24:27]
    ds_read_b64_tr_b16 a[72:73], v205 offset:49152
    v_mfma_f32_16x16x32_bf16 v[24:27], a[84:87], a[172:175], v[24:27]
    ds_read_b64_tr_b16 a[74:75], v205 offset:53248
    v_mfma_f32_16x16x32_bf16 v[28:31], a[88:91], a[168:171], v[28:31]
    buffer_load_dwordx4 v200, s[28:31], s64 offen offset:0 lds
    v_mfma_f32_16x16x32_bf16 v[28:31], a[92:95], a[172:175], v[28:31]
    ds_read_b64_tr_b16 a[76:77], v205 offset:57344
    ds_read_b64_tr_b16 a[78:79], v205 offset:61440
    v_mfma_f32_16x16x32_bf16 v[40:43], a[80:83], a[176:179], v[40:43]
    buffer_load_dwordx4 v201, s[28:31], s64 offen offset:1024 lds
    v_mfma_f32_16x16x32_bf16 v[40:43], a[84:87], a[180:183], v[40:43]
    ds_read_b128 a[128:131], v208 offset:16384
    ds_read_b128 a[132:135], v208 offset:17408
    v_mfma_f32_16x16x32_bf16 v[44:47], a[88:91], a[176:179], v[44:47]
    ds_read_b128 a[136:139], v208 offset:18432
    v_mfma_f32_16x16x32_bf16 v[44:47], a[92:95], a[180:183], v[44:47]
    buffer_load_dwordx4 v202, s[28:31], s64 offen offset:2048 lds
    v_mfma_f32_16x16x32_bf16 v[56:59], a[80:83], a[184:187], v[56:59]
    ds_read_b128 a[140:143], v208 offset:19456
    v_mfma_f32_16x16x32_bf16 v[56:59], a[84:87], a[188:191], v[56:59]
    buffer_load_dwordx4 v203, s[28:31], s64 offen offset:3072 lds
    v_mfma_f32_16x16x32_bf16 v[60:63], a[88:91], a[184:187], v[60:63]
    s_add_u32 m0, s68, 98304
    v_mfma_f32_16x16x32_bf16 v[60:63], a[92:95], a[188:191], v[60:63]
    s_waitcnt lgkmcnt(0)
    v_mfma_f32_16x16x32_bf16 v[0:3], a[64:67], a[192:195], v[0:3]
    s_add_u32 s64, s77, 2097152
    ds_read_b64_tr_b16 a[80:81], v204 offset:49408
    v_mfma_f32_16x16x32_bf16 v[0:3], a[68:71], a[196:199], v[0:3]
    ds_read_b64_tr_b16 a[82:83], v204 offset:53504
    v_mfma_f32_16x16x32_bf16 v[4:7], a[72:75], a[192:195], v[4:7]
    buffer_store_dwordx4 v[144:147], v255, s[4:7], s65 offen offset:0 sc1
    v_mfma_f32_16x16x32_bf16 v[4:7], a[76:79], a[196:199], v[4:7]
    ds_read_b64_tr_b16 a[84:85], v204 offset:57600
    ds_read_b64_tr_b16 a[86:87], v204 offset:61696
    v_mfma_f32_16x16x32_bf16 v[16:19], a[64:67], a[200:203], v[16:19]
    buffer_load_dwordx4 v255, s[4:7], s64 offen offset:0 sc1 lds
    v_mfma_f32_16x16x32_bf16 v[16:19], a[68:71], a[204:207], v[16:19]
    ds_read_b64_tr_b16 a[88:89], v205 offset:49408
    ds_read_b64_tr_b16 a[90:91], v205 offset:53504
    v_mfma_f32_16x16x32_bf16 v[20:23], a[72:75], a[200:203], v[20:23]
    buffer_load_dwordx4 v255, s[4:7], s64 offen offset:1024 sc1 lds
    v_mfma_f32_16x16x32_bf16 v[20:23], a[76:79], a[204:207], v[20:23]
    ds_read_b64_tr_b16 a[92:93], v205 offset:57600
    ds_read_b64_tr_b16 a[94:95], v205 offset:61696
    v_mfma_f32_16x16x32_bf16 v[32:35], a[64:67], a[208:211], v[32:35]
    buffer_load_dwordx4 v255, s[4:7], s64 offen offset:2048 sc1 lds
    v_mfma_f32_16x16x32_bf16 v[32:35], a[68:71], a[212:215], v[32:35]
    ds_read_b128 a[144:147], v208 offset:20480
    ds_read_b128 a[148:151], v208 offset:21504
    v_mfma_f32_16x16x32_bf16 v[36:39], a[72:75], a[208:211], v[36:39]
    buffer_load_dwordx4 v255, s[4:7], s64 offen offset:3072 sc1 lds
    v_mfma_f32_16x16x32_bf16 v[36:39], a[76:79], a[212:215], v[36:39]
    ds_read_b128 a[152:155], v208 offset:22528
    ds_read_b128 a[156:159], v208 offset:23552
    v_mfma_f32_16x16x32_bf16 v[48:51], a[64:67], a[216:219], v[48:51]
    v_mfma_f32_16x16x32_bf16 v[48:51], a[68:71], a[220:223], v[48:51]
    v_mfma_f32_16x16x32_bf16 v[52:55], a[72:75], a[216:219], v[52:55]
    v_mfma_f32_16x16x32_bf16 v[52:55], a[76:79], a[220:223], v[52:55]
    s_waitcnt vmcnt(19) lgkmcnt(0)
    s_barrier
    v_mfma_f32_16x16x32_bf16 v[8:11], a[80:83], a[192:195], v[8:11]
    ds_read_b64_tr_b16 a[64:65], v206 offset:0
    v_mfma_f32_16x16x32_bf16 v[8:11], a[84:87], a[196:199], v[8:11]
    s_add_u32 m0, s68, 49152
    ds_read_b64_tr_b16 a[66:67], v206 offset:4096
    v_mfma_f32_16x16x32_bf16 v[12:15], a[88:91], a[192:195], v[12:15]
    buffer_store_dwordx4 v[148:151], v255, s[4:7], s65 offen offset:1024 sc1
    v_mfma_f32_16x16x32_bf16 v[12:15], a[92:95], a[196:199], v[12:15]
    s_add_u32 s64, s78, 655360
    ds_read_b64_tr_b16 a[68:69], v206 offset:8192
    ds_read_b64_tr_b16 a[70:71], v206 offset:12288
    v_mfma_f32_16x16x32_bf16 v[24:27], a[80:83], a[200:203], v[24:27]
    ds_read_b64_tr_b16 a[72:73], v207 offset:0
    v_mfma_f32_16x16x32_bf16 v[24:27], a[84:87], a[204:207], v[24:27]
    ds_read_b64_tr_b16 a[74:75], v207 offset:4096
    v_mfma_f32_16x16x32_bf16 v[28:31], a[88:91], a[200:203], v[28:31]
    buffer_load_dwordx4 v200, s[28:31], s64 offen offset:0 lds
    v_mfma_f32_16x16x32_bf16 v[28:31], a[92:95], a[204:207], v[28:31]
    ds_read_b64_tr_b16 a[76:77], v207 offset:8192
    ds_read_b64_tr_b16 a[78:79], v207 offset:12288
    v_mfma_f32_16x16x32_bf16 v[40:43], a[80:83], a[208:211], v[40:43]
    buffer_load_dwordx4 v201, s[28:31], s64 offen offset:1024 lds
    v_mfma_f32_16x16x32_bf16 v[40:43], a[84:87], a[212:215], v[40:43]
    ds_read_b128 a[160:163], v208 offset:32768
    ds_read_b128 a[164:167], v208 offset:33792
    v_mfma_f32_16x16x32_bf16 v[44:47], a[88:91], a[208:211], v[44:47]
    ds_read_b128 a[168:171], v208 offset:34816
    v_mfma_f32_16x16x32_bf16 v[44:47], a[92:95], a[212:215], v[44:47]
    buffer_load_dwordx4 v202, s[28:31], s64 offen offset:2048 lds
    v_mfma_f32_16x16x32_bf16 v[56:59], a[80:83], a[216:219], v[56:59]
    ds_read_b128 a[172:175], v208 offset:35840
    v_mfma_f32_16x16x32_bf16 v[56:59], a[84:87], a[220:223], v[56:59]
    buffer_load_dwordx4 v203, s[28:31], s64 offen offset:3072 lds
    v_mfma_f32_16x16x32_bf16 v[60:63], a[88:91], a[216:219], v[60:63]
    s_add_u32 m0, s68, 114688
    v_mfma_f32_16x16x32_bf16 v[60:63], a[92:95], a[220:223], v[60:63]
    s_waitcnt lgkmcnt(0)
    v_mfma_f32_16x16x32_bf16 v[0:3], a[64:67], a[128:131], v[0:3]
    s_add_u32 s64, s77, 2359296
    ds_read_b64_tr_b16 a[80:81], v206 offset:256
    v_mfma_f32_16x16x32_bf16 v[0:3], a[68:71], a[132:135], v[0:3]
    ds_read_b64_tr_b16 a[82:83], v206 offset:4352
    v_mfma_f32_16x16x32_bf16 v[4:7], a[72:75], a[128:131], v[4:7]
    buffer_store_dwordx4 v[152:155], v255, s[4:7], s65 offen offset:2048 sc1
    v_mfma_f32_16x16x32_bf16 v[4:7], a[76:79], a[132:135], v[4:7]
    ds_read_b64_tr_b16 a[84:85], v206 offset:8448
    ds_read_b64_tr_b16 a[86:87], v206 offset:12544
    v_mfma_f32_16x16x32_bf16 v[16:19], a[64:67], a[136:139], v[16:19]
    buffer_load_dwordx4 v255, s[4:7], s64 offen offset:0 sc1 lds
    v_mfma_f32_16x16x32_bf16 v[16:19], a[68:71], a[140:143], v[16:19]
    ds_read_b64_tr_b16 a[88:89], v207 offset:256
    ds_read_b64_tr_b16 a[90:91], v207 offset:4352
    v_mfma_f32_16x16x32_bf16 v[20:23], a[72:75], a[136:139], v[20:23]
    buffer_load_dwordx4 v255, s[4:7], s64 offen offset:1024 sc1 lds
    v_mfma_f32_16x16x32_bf16 v[20:23], a[76:79], a[140:143], v[20:23]
    ds_read_b64_tr_b16 a[92:93], v207 offset:8448
    ds_read_b64_tr_b16 a[94:95], v207 offset:12544
    v_mfma_f32_16x16x32_bf16 v[32:35], a[64:67], a[144:147], v[32:35]
    buffer_load_dwordx4 v255, s[4:7], s64 offen offset:2048 sc1 lds
    v_mfma_f32_16x16x32_bf16 v[32:35], a[68:71], a[148:151], v[32:35]
    ds_read_b128 a[176:179], v208 offset:36864
    ds_read_b128 a[180:183], v208 offset:37888
    v_mfma_f32_16x16x32_bf16 v[36:39], a[72:75], a[144:147], v[36:39]
    buffer_load_dwordx4 v255, s[4:7], s64 offen offset:3072 sc1 lds
    v_mfma_f32_16x16x32_bf16 v[36:39], a[76:79], a[148:151], v[36:39]
    ds_read_b128 a[184:187], v208 offset:38912
    ds_read_b128 a[188:191], v208 offset:39936
    v_mfma_f32_16x16x32_bf16 v[48:51], a[64:67], a[152:155], v[48:51]
    v_mfma_f32_16x16x32_bf16 v[48:51], a[68:71], a[156:159], v[48:51]
    v_mfma_f32_16x16x32_bf16 v[52:55], a[72:75], a[152:155], v[52:55]
    v_mfma_f32_16x16x32_bf16 v[52:55], a[76:79], a[156:159], v[52:55]
    s_waitcnt vmcnt(19) lgkmcnt(0)
    s_barrier
    v_mfma_f32_16x16x32_bf16 v[8:11], a[80:83], a[128:131], v[8:11]
    ds_read_b64_tr_b16 a[64:65], v206 offset:16384
    v_mfma_f32_16x16x32_bf16 v[8:11], a[84:87], a[132:135], v[8:11]
    s_add_u32 m0, s68, 65536
    ds_read_b64_tr_b16 a[66:67], v206 offset:20480
    v_mfma_f32_16x16x32_bf16 v[12:15], a[88:91], a[128:131], v[12:15]
    buffer_store_dwordx4 v[156:159], v255, s[4:7], s65 offen offset:3072 sc1
    v_mfma_f32_16x16x32_bf16 v[12:15], a[92:95], a[132:135], v[12:15]
    s_add_u32 s64, s78, 720896
    ds_read_b64_tr_b16 a[68:69], v206 offset:24576
    ds_read_b64_tr_b16 a[70:71], v206 offset:28672
    v_mfma_f32_16x16x32_bf16 v[24:27], a[80:83], a[136:139], v[24:27]
    ds_read_b64_tr_b16 a[72:73], v207 offset:16384
    v_mfma_f32_16x16x32_bf16 v[24:27], a[84:87], a[140:143], v[24:27]
    ds_read_b64_tr_b16 a[74:75], v207 offset:20480
    v_mfma_f32_16x16x32_bf16 v[28:31], a[88:91], a[136:139], v[28:31]
    buffer_load_dwordx4 v200, s[28:31], s64 offen offset:0 lds
    v_mfma_f32_16x16x32_bf16 v[28:31], a[92:95], a[140:143], v[28:31]
    ds_read_b64_tr_b16 a[76:77], v207 offset:24576
    ds_read_b64_tr_b16 a[78:79], v207 offset:28672
    v_mfma_f32_16x16x32_bf16 v[40:43], a[80:83], a[144:147], v[40:43]
    buffer_load_dwordx4 v201, s[28:31], s64 offen offset:1024 lds
    v_mfma_f32_16x16x32_bf16 v[40:43], a[84:87], a[148:151], v[40:43]
    ds_read_b128 a[192:195], v208 offset:49152
    ds_read_b128 a[196:199], v208 offset:50176
    v_mfma_f32_16x16x32_bf16 v[44:47], a[88:91], a[144:147], v[44:47]
    ds_read_b128 a[200:203], v208 offset:51200
    v_mfma_f32_16x16x32_bf16 v[44:47], a[92:95], a[148:151], v[44:47]
    buffer_load_dwordx4 v202, s[28:31], s64 offen offset:2048 lds
    v_mfma_f32_16x16x32_bf16 v[56:59], a[80:83], a[152:155], v[56:59]
    ds_read_b128 a[204:207], v208 offset:52224
    v_mfma_f32_16x16x32_bf16 v[56:59], a[84:87], a[156:159], v[56:59]
    buffer_load_dwordx4 v203, s[28:31], s64 offen offset:3072 lds
    v_mfma_f32_16x16x32_bf16 v[60:63], a[88:91], a[152:155], v[60:63]
    s_add_u32 m0, s68, 131072
    v_mfma_f32_16x16x32_bf16 v[60:63], a[92:95], a[156:159], v[60:63]
    s_waitcnt lgkmcnt(0)
    v_mfma_f32_16x16x32_bf16 v[0:3], a[64:67], a[160:163], v[0:3]
    s_add_u32 s64, s77, 2621440
    ds_read_b64_tr_b16 a[80:81], v206 offset:16640
    v_mfma_f32_16x16x32_bf16 v[0:3], a[68:71], a[164:167], v[0:3]
    ds_read_b64_tr_b16 a[82:83], v206 offset:20736
    v_mfma_f32_16x16x32_bf16 v[4:7], a[72:75], a[160:163], v[4:7]
    ds_read_b64_tr_b16 a[84:85], v206 offset:24832
    v_mfma_f32_16x16x32_bf16 v[4:7], a[76:79], a[164:167], v[4:7]
    buffer_load_dwordx4 v255, s[4:7], s64 offen offset:0 sc1 lds
    v_mfma_f32_16x16x32_bf16 v[16:19], a[64:67], a[168:171], v[16:19]
    ds_read_b64_tr_b16 a[86:87], v206 offset:28928
    ds_read_b64_tr_b16 a[88:89], v207 offset:16640
    v_mfma_f32_16x16x32_bf16 v[16:19], a[68:71], a[172:175], v[16:19]
    ds_read_b64_tr_b16 a[90:91], v207 offset:20736
    v_mfma_f32_16x16x32_bf16 v[20:23], a[72:75], a[168:171], v[20:23]
    buffer_load_dwordx4 v255, s[4:7], s64 offen offset:1024 sc1 lds
    v_mfma_f32_16x16x32_bf16 v[20:23], a[76:79], a[172:175], v[20:23]
    ds_read_b64_tr_b16 a[92:93], v207 offset:24832
    ds_read_b64_tr_b16 a[94:95], v207 offset:28928
    v_mfma_f32_16x16x32_bf16 v[32:35], a[64:67], a[176:179], v[32:35]
    buffer_load_dwordx4 v255, s[4:7], s64 offen offset:2048 sc1 lds
    v_mfma_f32_16x16x32_bf16 v[32:35], a[68:71], a[180:183], v[32:35]
    ds_read_b128 a[208:211], v208 offset:53248
    ds_read_b128 a[212:215], v208 offset:54272
    v_mfma_f32_16x16x32_bf16 v[36:39], a[72:75], a[176:179], v[36:39]
    buffer_load_dwordx4 v255, s[4:7], s64 offen offset:3072 sc1 lds
    v_mfma_f32_16x16x32_bf16 v[36:39], a[76:79], a[180:183], v[36:39]
    ds_read_b128 a[216:219], v208 offset:55296
    ds_read_b128 a[220:223], v208 offset:56320
    v_mfma_f32_16x16x32_bf16 v[48:51], a[64:67], a[184:187], v[48:51]
    v_mfma_f32_16x16x32_bf16 v[48:51], a[68:71], a[188:191], v[48:51]
    v_mfma_f32_16x16x32_bf16 v[52:55], a[72:75], a[184:187], v[52:55]
    v_mfma_f32_16x16x32_bf16 v[52:55], a[76:79], a[188:191], v[52:55]
    s_waitcnt vmcnt(19) lgkmcnt(0)
    s_barrier
    v_mfma_f32_16x16x32_bf16 v[8:11], a[80:83], a[160:163], v[8:11]
    ds_read_b64_tr_b16 a[64:65], v204 offset:0
    v_mfma_f32_16x16x32_bf16 v[8:11], a[84:87], a[164:167], v[8:11]
    s_add_u32 m0, s68, 81920
    ds_read_b64_tr_b16 a[66:67], v204 offset:4096
    v_mfma_f32_16x16x32_bf16 v[12:15], a[88:91], a[160:163], v[12:15]
    ds_read_b64_tr_b16 a[68:69], v204 offset:8192
    v_mfma_f32_16x16x32_bf16 v[12:15], a[92:95], a[164:167], v[12:15]
    s_add_u32 s64, s78, 786432
    ds_read_b64_tr_b16 a[70:71], v204 offset:12288
    v_mfma_f32_16x16x32_bf16 v[24:27], a[80:83], a[168:171], v[24:27]
    ds_read_b64_tr_b16 a[72:73], v205 offset:0
    v_mfma_f32_16x16x32_bf16 v[24:27], a[84:87], a[172:175], v[24:27]
    ds_read_b64_tr_b16 a[74:75], v205 offset:4096
    v_mfma_f32_16x16x32_bf16 v[28:31], a[88:91], a[168:171], v[28:31]
    buffer_load_dwordx4 v200, s[28:31], s64 offen offset:0 lds
    v_mfma_f32_16x16x32_bf16 v[28:31], a[92:95], a[172:175], v[28:31]
    ds_read_b64_tr_b16 a[76:77], v205 offset:8192
    ds_read_b64_tr_b16 a[78:79], v205 offset:12288
    v_mfma_f32_16x16x32_bf16 v[40:43], a[80:83], a[176:179], v[40:43]
    buffer_load_dwordx4 v201, s[28:31], s64 offen offset:1024 lds
    v_mfma_f32_16x16x32_bf16 v[40:43], a[84:87], a[180:183], v[40:43]
    ds_read_b128 a[128:131], v208 offset:0
    ds_read_b128 a[132:135], v208 offset:1024
    v_mfma_f32_16x16x32_bf16 v[44:47], a[88:91], a[176:179], v[44:47]
    ds_read_b128 a[136:139], v208 offset:2048
    v_mfma_f32_16x16x32_bf16 v[44:47], a[92:95], a[180:183], v[44:47]
    buffer_load_dwordx4 v202, s[28:31], s64 offen offset:2048 lds
    v_mfma_f32_16x16x32_bf16 v[56:59], a[80:83], a[184:187], v[56:59]
    ds_read_b128 a[140:143], v208 offset:3072
    v_mfma_f32_16x16x32_bf16 v[56:59], a[84:87], a[188:191], v[56:59]
    buffer_load_dwordx4 v203, s[28:31], s64 offen offset:3072 lds
    v_mfma_f32_16x16x32_bf16 v[60:63], a[88:91], a[184:187], v[60:63]
    s_add_u32 m0, s68, 147456
    v_mfma_f32_16x16x32_bf16 v[60:63], a[92:95], a[188:191], v[60:63]
    s_waitcnt lgkmcnt(0)
    v_mfma_f32_16x16x32_bf16 v[0:3], a[64:67], a[192:195], v[0:3]
    s_add_u32 s64, s77, 2883584
    ds_read_b64_tr_b16 a[80:81], v204 offset:256
    v_mfma_f32_16x16x32_bf16 v[0:3], a[68:71], a[196:199], v[0:3]
    ds_read_b64_tr_b16 a[82:83], v204 offset:4352
    v_mfma_f32_16x16x32_bf16 v[4:7], a[72:75], a[192:195], v[4:7]
    ds_read_b64_tr_b16 a[84:85], v204 offset:8448
    v_mfma_f32_16x16x32_bf16 v[4:7], a[76:79], a[196:199], v[4:7]
    buffer_load_dwordx4 v255, s[4:7], s64 offen offset:0 sc1 lds
    v_mfma_f32_16x16x32_bf16 v[16:19], a[64:67], a[200:203], v[16:19]
    ds_read_b64_tr_b16 a[86:87], v204 offset:12544
    ds_read_b64_tr_b16 a[88:89], v205 offset:256
    v_mfma_f32_16x16x32_bf16 v[16:19], a[68:71], a[204:207], v[16:19]
    ds_read_b64_tr_b16 a[90:91], v205 offset:4352
    v_mfma_f32_16x16x32_bf16 v[20:23], a[72:75], a[200:203], v[20:23]
    buffer_load_dwordx4 v255, s[4:7], s64 offen offset:1024 sc1 lds
    v_mfma_f32_16x16x32_bf16 v[20:23], a[76:79], a[204:207], v[20:23]
    ds_read_b64_tr_b16 a[92:93], v205 offset:8448
    ds_read_b64_tr_b16 a[94:95], v205 offset:12544
    v_mfma_f32_16x16x32_bf16 v[32:35], a[64:67], a[208:211], v[32:35]
    buffer_load_dwordx4 v255, s[4:7], s64 offen offset:2048 sc1 lds
    v_mfma_f32_16x16x32_bf16 v[32:35], a[68:71], a[212:215], v[32:35]
    ds_read_b128 a[144:147], v208 offset:4096
    ds_read_b128 a[148:151], v208 offset:5120
    v_mfma_f32_16x16x32_bf16 v[36:39], a[72:75], a[208:211], v[36:39]
    buffer_load_dwordx4 v255, s[4:7], s64 offen offset:3072 sc1 lds
    v_mfma_f32_16x16x32_bf16 v[36:39], a[76:79], a[212:215], v[36:39]
    ds_read_b128 a[152:155], v208 offset:6144
    ds_read_b128 a[156:159], v208 offset:7168
    v_mfma_f32_16x16x32_bf16 v[48:51], a[64:67], a[216:219], v[48:51]
    v_mfma_f32_16x16x32_bf16 v[48:51], a[68:71], a[220:223], v[48:51]
    v_mfma_f32_16x16x32_bf16 v[52:55], a[72:75], a[216:219], v[52:55]
    v_mfma_f32_16x16x32_bf16 v[52:55], a[76:79], a[220:223], v[52:55]
    s_waitcnt vmcnt(17) lgkmcnt(0)
    s_barrier
    v_mfma_f32_16x16x32_bf16 v[8:11], a[80:83], a[192:195], v[8:11]
    ds_read_b64_tr_b16 a[64:65], v204 offset:16384
    v_mfma_f32_16x16x32_bf16 v[8:11], a[84:87], a[196:199], v[8:11]
    s_add_u32 m0, s68, 0
    ds_read_b64_tr_b16 a[66:67], v204 offset:20480
    v_mfma_f32_16x16x32_bf16 v[12:15], a[88:91], a[192:195], v[12:15]
    ds_read_b64_tr_b16 a[68:69], v204 offset:24576
    v_mfma_f32_16x16x32_bf16 v[12:15], a[92:95], a[196:199], v[12:15]
    s_add_u32 s64, s78, 851968
    ds_read_b64_tr_b16 a[70:71], v204 offset:28672
    v_mfma_f32_16x16x32_bf16 v[24:27], a[80:83], a[200:203], v[24:27]
    ds_read_b64_tr_b16 a[72:73], v205 offset:16384
    v_mfma_f32_16x16x32_bf16 v[24:27], a[84:87], a[204:207], v[24:27]
    ds_read_b64_tr_b16 a[74:75], v205 offset:20480
    v_mfma_f32_16x16x32_bf16 v[28:31], a[88:91], a[200:203], v[28:31]
    buffer_load_dwordx4 v200, s[28:31], s64 offen offset:0 lds
    v_mfma_f32_16x16x32_bf16 v[28:31], a[92:95], a[204:207], v[28:31]
    ds_read_b64_tr_b16 a[76:77], v205 offset:24576
    ds_read_b64_tr_b16 a[78:79], v205 offset:28672
    v_mfma_f32_16x16x32_bf16 v[40:43], a[80:83], a[208:211], v[40:43]
    buffer_load_dwordx4 v201, s[28:31], s64 offen offset:1024 lds
    v_mfma_f32_16x16x32_bf16 v[40:43], a[84:87], a[212:215], v[40:43]
    ds_read_b128 a[160:163], v208 offset:16384
    ds_read_b128 a[164:167], v208 offset:17408
    v_mfma_f32_16x16x32_bf16 v[44:47], a[88:91], a[208:211], v[44:47]
    ds_read_b128 a[168:171], v208 offset:18432
    v_mfma_f32_16x16x32_bf16 v[44:47], a[92:95], a[212:215], v[44:47]
    buffer_load_dwordx4 v202, s[28:31], s64 offen offset:2048 lds
    v_mfma_f32_16x16x32_bf16 v[56:59], a[80:83], a[216:219], v[56:59]
    ds_read_b128 a[172:175], v208 offset:19456
    v_mfma_f32_16x16x32_bf16 v[56:59], a[84:87], a[220:223], v[56:59]
    buffer_load_dwordx4 v203, s[28:31], s64 offen offset:3072 lds
    v_mfma_f32_16x16x32_bf16 v[60:63], a[88:91], a[216:219], v[60:63]
    s_add_u32 m0, s68, 98304
    v_mfma_f32_16x16x32_bf16 v[60:63], a[92:95], a[220:223], v[60:63]
    s_waitcnt lgkmcnt(0)
    v_mfma_f32_16x16x32_bf16 v[0:3], a[64:67], a[128:131], v[0:3]
    s_add_u32 s64, s77, 3145728
    ds_read_b64_tr_b16 a[80:81], v204 offset:16640
    v_mfma_f32_16x16x32_bf16 v[0:3], a[68:71], a[132:135], v[0:3]
    ds_read_b64_tr_b16 a[82:83], v204 offset:20736
    v_mfma_f32_16x16x32_bf16 v[4:7], a[72:75], a[128:131], v[4:7]
    s_waitcnt vmcnt(20)
    s_lshl_b32 s89, s85, 4
    s_lshl_b32 s90, s56, 2
    s_add_u32 s89, s89, s90
    s_add_u32 s89, s89, s88
    s_add_u32 s89, s89, 12352
    v_mov_b32 v250, s89
    v_mfma_f32_16x16x32_bf16 v[4:7], a[76:79], a[132:135], v[4:7]
    ds_read_b64_tr_b16 a[84:85], v204 offset:24832
    ds_read_b64_tr_b16 a[86:87], v204 offset:28928
    v_mfma_f32_16x16x32_bf16 v[16:19], a[64:67], a[136:139], v[16:19]
    buffer_load_dwordx4 v255, s[4:7], s64 offen offset:0 sc1 lds
    v_mfma_f32_16x16x32_bf16 v[16:19], a[68:71], a[140:143], v[16:19]
    buffer_store_dword v251, v250, s[4:7], 0 offen sc1
    v_mfma_f32_16x16x32_bf16 v[20:23], a[72:75], a[136:139], v[20:23]
    ds_read_b64_tr_b16 a[88:89], v205 offset:16640
    ds_read_b64_tr_b16 a[90:91], v205 offset:20736
    v_mfma_f32_16x16x32_bf16 v[20:23], a[76:79], a[140:143], v[20:23]
    buffer_load_dwordx4 v255, s[4:7], s64 offen offset:1024 sc1 lds
    v_mfma_f32_16x16x32_bf16 v[32:35], a[64:67], a[144:147], v[32:35]
    ds_read_b64_tr_b16 a[92:93], v205 offset:24832
    ds_read_b64_tr_b16 a[94:95], v205 offset:28928
    v_mfma_f32_16x16x32_bf16 v[32:35], a[68:71], a[148:151], v[32:35]
    buffer_load_dwordx4 v255, s[4:7], s64 offen offset:2048 sc1 lds
    v_mfma_f32_16x16x32_bf16 v[36:39], a[72:75], a[144:147], v[36:39]
    ds_read_b128 a[176:179], v208 offset:20480
    ds_read_b128 a[180:183], v208 offset:21504
    v_mfma_f32_16x16x32_bf16 v[36:39], a[76:79], a[148:151], v[36:39]
    buffer_load_dwordx4 v255, s[4:7], s64 offen offset:3072 sc1 lds
    v_mfma_f32_16x16x32_bf16 v[48:51], a[64:67], a[152:155], v[48:51]
    ds_read_b128 a[184:187], v208 offset:22528
    ds_read_b128 a[188:191], v208 offset:23552
    v_mfma_f32_16x16x32_bf16 v[48:51], a[68:71], a[156:159], v[48:51]
    v_mfma_f32_16x16x32_bf16 v[52:55], a[72:75], a[152:155], v[52:55]
    v_mfma_f32_16x16x32_bf16 v[52:55], a[76:79], a[156:159], v[52:55]
    s_waitcnt vmcnt(17) lgkmcnt(0)
    s_barrier
    v_mfma_f32_16x16x32_bf16 v[8:11], a[80:83], a[128:131], v[8:11]
    ds_read_b64_tr_b16 a[64:65], v204 offset:32768
    v_mfma_f32_16x16x32_bf16 v[8:11], a[84:87], a[132:135], v[8:11]
    s_add_u32 m0, s68, 16384
    ds_read_b64_tr_b16 a[66:67], v204 offset:36864
    v_mfma_f32_16x16x32_bf16 v[12:15], a[88:91], a[128:131], v[12:15]
    ds_read_b64_tr_b16 a[68:69], v204 offset:40960
    v_mfma_f32_16x16x32_bf16 v[12:15], a[92:95], a[132:135], v[12:15]
    s_add_u32 s64, s78, 917504
    ds_read_b64_tr_b16 a[70:71], v204 offset:45056
    v_mfma_f32_16x16x32_bf16 v[24:27], a[80:83], a[136:139], v[24:27]
    ds_read_b64_tr_b16 a[72:73], v205 offset:32768
    v_mfma_f32_16x16x32_bf16 v[24:27], a[84:87], a[140:143], v[24:27]
    ds_read_b64_tr_b16 a[74:75], v205 offset:36864
    v_mfma_f32_16x16x32_bf16 v[28:31], a[88:91], a[136:139], v[28:31]
    buffer_load_dwordx4 v200, s[28:31], s64 offen offset:0 lds
    v_mfma_f32_16x16x32_bf16 v[28:31], a[92:95], a[140:143], v[28:31]
    ds_read_b64_tr_b16 a[76:77], v205 offset:40960
    ds_read_b64_tr_b16 a[78:79], v205 offset:45056
    v_mfma_f32_16x16x32_bf16 v[40:43], a[80:83], a[144:147], v[40:43]
    buffer_load_dwordx4 v201, s[28:31], s64 offen offset:1024 lds
    v_mfma_f32_16x16x32_bf16 v[40:43], a[84:87], a[148:151], v[40:43]
    ds_read_b128 a[192:195], v208 offset:32768
    ds_read_b128 a[196:199], v208 offset:33792
    v_mfma_f32_16x16x32_bf16 v[44:47], a[88:91], a[144:147], v[44:47]
    ds_read_b128 a[200:203], v208 offset:34816
    v_mfma_f32_16x16x32_bf16 v[44:47], a[92:95], a[148:151], v[44:47]
    buffer_load_dwordx4 v202, s[28:31], s64 offen offset:2048 lds
    v_mfma_f32_16x16x32_bf16 v[56:59], a[80:83], a[152:155], v[56:59]
    ds_read_b128 a[204:207], v208 offset:35840
    v_mfma_f32_16x16x32_bf16 v[56:59], a[84:87], a[156:159], v[56:59]
    buffer_load_dwordx4 v203, s[28:31], s64 offen offset:3072 lds
    v_mfma_f32_16x16x32_bf16 v[60:63], a[88:91], a[152:155], v[60:63]
    s_add_u32 m0, s68, 114688
    v_mfma_f32_16x16x32_bf16 v[60:63], a[92:95], a[156:159], v[60:63]
    s_waitcnt lgkmcnt(0)
    v_mfma_f32_16x16x32_bf16 v[0:3], a[64:67], a[160:163], v[0:3]
    s_add_u32 s64, s77, 3407872
    ds_read_b64_tr_b16 a[80:81], v204 offset:33024
    v_mfma_f32_16x16x32_bf16 v[0:3], a[68:71], a[164:167], v[0:3]
    ds_read_b64_tr_b16 a[82:83], v204 offset:37120
    v_mfma_f32_16x16x32_bf16 v[4:7], a[72:75], a[160:163], v[4:7]
    ds_read_b64_tr_b16 a[84:85], v204 offset:41216
    v_mfma_f32_16x16x32_bf16 v[4:7], a[76:79], a[164:167], v[4:7]
    buffer_load_dwordx4 v255, s[4:7], s64 offen offset:0 sc1 lds
    v_mfma_f32_16x16x32_bf16 v[16:19], a[64:67], a[168:171], v[16:19]
    ds_read_b64_tr_b16 a[86:87], v204 offset:45312
    ds_read_b64_tr_b16 a[88:89], v205 offset:33024
    v_mfma_f32_16x16x32_bf16 v[16:19], a[68:71], a[172:175], v[16:19]
    ds_read_b64_tr_b16 a[90:91], v205 offset:37120
    v_mfma_f32_16x16x32_bf16 v[20:23], a[72:75], a[168:171], v[20:23]
    buffer_load_dwordx4 v255, s[4:7], s64 offen offset:1024 sc1 lds
    v_mfma_f32_16x16x32_bf16 v[20:23], a[76:79], a[172:175], v[20:23]
    ds_read_b64_tr_b16 a[92:93], v205 offset:41216
    ds_read_b64_tr_b16 a[94:95], v205 offset:45312
    v_mfma_f32_16x16x32_bf16 v[32:35], a[64:67], a[176:179], v[32:35]
    buffer_load_dwordx4 v255, s[4:7], s64 offen offset:2048 sc1 lds
    v_mfma_f32_16x16x32_bf16 v[32:35], a[68:71], a[180:183], v[32:35]
    ds_read_b128 a[208:211], v208 offset:36864
    ds_read_b128 a[212:215], v208 offset:37888
    v_mfma_f32_16x16x32_bf16 v[36:39], a[72:75], a[176:179], v[36:39]
    buffer_load_dwordx4 v255, s[4:7], s64 offen offset:3072 sc1 lds
    v_mfma_f32_16x16x32_bf16 v[36:39], a[76:79], a[180:183], v[36:39]
    ds_read_b128 a[216:219], v208 offset:38912
    ds_read_b128 a[220:223], v208 offset:39936
    v_mfma_f32_16x16x32_bf16 v[48:51], a[64:67], a[184:187], v[48:51]
    v_mfma_f32_16x16x32_bf16 v[48:51], a[68:71], a[188:191], v[48:51]
    v_mfma_f32_16x16x32_bf16 v[52:55], a[72:75], a[184:187], v[52:55]
    v_mfma_f32_16x16x32_bf16 v[52:55], a[76:79], a[188:191], v[52:55]
    s_waitcnt vmcnt(17) lgkmcnt(0)
    s_barrier
    v_mfma_f32_16x16x32_bf16 v[8:11], a[80:83], a[160:163], v[8:11]
    ds_read_b64_tr_b16 a[64:65], v204 offset:49152
    v_mfma_f32_16x16x32_bf16 v[8:11], a[84:87], a[164:167], v[8:11]
    s_add_u32 m0, s68, 32768
    ds_read_b64_tr_b16 a[66:67], v204 offset:53248
    v_mfma_f32_16x16x32_bf16 v[12:15], a[88:91], a[160:163], v[12:15]
    ds_read_b64_tr_b16 a[68:69], v204 offset:57344
    v_mfma_f32_16x16x32_bf16 v[12:15], a[92:95], a[164:167], v[12:15]
    s_add_u32 s64, s78, 983040
    ds_read_b64_tr_b16 a[70:71], v204 offset:61440
    v_mfma_f32_16x16x32_bf16 v[24:27], a[80:83], a[168:171], v[24:27]
    ds_read_b64_tr_b16 a[72:73], v205 offset:49152
    v_mfma_f32_16x16x32_bf16 v[24:27], a[84:87], a[172:175], v[24:27]
    ds_read_b64_tr_b16 a[74:75], v205 offset:53248
    v_mfma_f32_16x16x32_bf16 v[28:31], a[88:91], a[168:171], v[28:31]
    buffer_load_dwordx4 v200, s[28:31], s64 offen offset:0 lds
    v_mfma_f32_16x16x32_bf16 v[28:31], a[92:95], a[172:175], v[28:31]
    ds_read_b64_tr_b16 a[76:77], v205 offset:57344
    ds_read_b64_tr_b16 a[78:79], v205 offset:61440
    v_mfma_f32_16x16x32_bf16 v[40:43], a[80:83], a[176:179], v[40:43]
    buffer_load_dwordx4 v201, s[28:31], s64 offen offset:1024 lds
    v_mfma_f32_16x16x32_bf16 v[40:43], a[84:87], a[180:183], v[40:43]
    ds_read_b128 a[128:131], v208 offset:49152
    ds_read_b128 a[132:135], v208 offset:50176
    v_mfma_f32_16x16x32_bf16 v[44:47], a[88:91], a[176:179], v[44:47]
    ds_read_b128 a[136:139], v208 offset:51200
    v_mfma_f32_16x16x32_bf16 v[44:47], a[92:95], a[180:183], v[44:47]
    buffer_load_dwordx4 v202, s[28:31], s64 offen offset:2048 lds
    v_mfma_f32_16x16x32_bf16 v[56:59], a[80:83], a[184:187], v[56:59]
    ds_read_b128 a[140:143], v208 offset:52224
    v_min_u32 v252, 3, v254
    v_mfma_f32_16x16x32_bf16 v[56:59], a[84:87], a[188:191], v[56:59]
    buffer_load_dwordx4 v203, s[28:31], s64 offen offset:3072 lds
    v_mfma_f32_16x16x32_bf16 v[60:63], a[88:91], a[184:187], v[60:63]
    s_add_u32 m0, s68, 131072
    v_lshlrev_b32 v252, 4, v252
    v_mfma_f32_16x16x32_bf16 v[60:63], a[92:95], a[188:191], v[60:63]
    s_waitcnt lgkmcnt(0)
    v_mfma_f32_16x16x32_bf16 v[0:3], a[64:67], a[192:195], v[0:3]
    s_lshl_b32 s89, s85, 2
    s_add_u32 s89, s89, s88
    s_add_u32 s89, s89, 12352
    v_add_u32 v252, s89, v252
    v_mfma_f32_16x16x32_bf16 v[0:3], a[68:71], a[196:199], v[0:3]
    s_add_u32 s64, s77, 3670016
    ds_read_b64_tr_b16 a[80:81], v204 offset:49408
    ds_read_b64_tr_b16 a[82:83], v204 offset:53504
    v_mfma_f32_16x16x32_bf16 v[4:7], a[72:75], a[192:195], v[4:7]
    buffer_load_dword v253, v252, s[4:7], 0 offen sc1
    v_mfma_f32_16x16x32_bf16 v[4:7], a[76:79], a[196:199], v[4:7]
    ds_read_b64_tr_b16 a[84:85], v204 offset:57600
    ds_read_b64_tr_b16 a[86:87], v204 offset:61696
    v_mfma_f32_16x16x32_bf16 v[16:19], a[64:67], a[200:203], v[16:19]
    buffer_load_dwordx4 v255, s[4:7], s64 offen offset:0 sc1 lds
    v_mfma_f32_16x16x32_bf16 v[16:19], a[68:71], a[204:207], v[16:19]
    ds_read_b64_tr_b16 a[88:89], v205 offset:49408
    ds_read_b64_tr_b16 a[90:91], v205 offset:53504
    v_mfma_f32_16x16x32_bf16 v[20:23], a[72:75], a[200:203], v[20:23]
    buffer_load_dwordx4 v255, s[4:7], s64 offen offset:1024 sc1 lds
    v_mfma_f32_16x16x32_bf16 v[20:23], a[76:79], a[204:207], v[20:23]
    ds_read_b64_tr_b16 a[92:93], v205 offset:57600
    ds_read_b64_tr_b16 a[94:95], v205 offset:61696
    v_mfma_f32_16x16x32_bf16 v[32:35], a[64:67], a[208:211], v[32:35]
    buffer_load_dwordx4 v255, s[4:7], s64 offen offset:2048 sc1 lds
    v_mfma_f32_16x16x32_bf16 v[32:35], a[68:71], a[212:215], v[32:35]
    ds_read_b128 a[144:147], v208 offset:53248
    ds_read_b128 a[148:151], v208 offset:54272
    v_mfma_f32_16x16x32_bf16 v[36:39], a[72:75], a[208:211], v[36:39]
    buffer_load_dwordx4 v255, s[4:7], s64 offen offset:3072 sc1 lds
    v_mfma_f32_16x16x32_bf16 v[36:39], a[76:79], a[212:215], v[36:39]
    ds_read_b128 a[152:155], v208 offset:55296
    ds_read_b128 a[156:159], v208 offset:56320
    v_mfma_f32_16x16x32_bf16 v[48:51], a[64:67], a[216:219], v[48:51]
    v_mfma_f32_16x16x32_bf16 v[48:51], a[68:71], a[220:223], v[48:51]
    v_mfma_f32_16x16x32_bf16 v[52:55], a[72:75], a[216:219], v[52:55]
    v_mfma_f32_16x16x32_bf16 v[52:55], a[76:79], a[220:223], v[52:55]
    s_waitcnt vmcnt(17) lgkmcnt(0)
    s_barrier
    v_mfma_f32_16x16x32_bf16 v[8:11], a[80:83], a[192:195], v[8:11]
    ds_read_b64_tr_b16 a[64:65], v206 offset:0
    v_mfma_f32_16x16x32_bf16 v[8:11], a[84:87], a[196:199], v[8:11]
    s_add_u32 m0, s68, 147456
    ds_read_b64_tr_b16 a[66:67], v206 offset:4096
    v_mfma_f32_16x16x32_bf16 v[12:15], a[88:91], a[192:195], v[12:15]
    ds_read_b64_tr_b16 a[68:69], v206 offset:8192
    v_mfma_f32_16x16x32_bf16 v[12:15], a[92:95], a[196:199], v[12:15]
    ds_read_b64_tr_b16 a[70:71], v206 offset:12288
    v_mfma_f32_16x16x32_bf16 v[24:27], a[80:83], a[200:203], v[24:27]
    ds_read_b64_tr_b16 a[72:73], v207 offset:0
    v_mfma_f32_16x16x32_bf16 v[24:27], a[84:87], a[204:207], v[24:27]
    s_add_u32 s64, s77, 3932160
    ds_read_b64_tr_b16 a[74:75], v207 offset:4096
    v_mfma_f32_16x16x32_bf16 v[28:31], a[88:91], a[200:203], v[28:31]
    ds_read_b64_tr_b16 a[76:77], v207 offset:8192
    v_mfma_f32_16x16x32_bf16 v[28:31], a[92:95], a[204:207], v[28:31]
    ds_read_b64_tr_b16 a[78:79], v207 offset:12288
    v_mfma_f32_16x16x32_bf16 v[40:43], a[80:83], a[208:211], v[40:43]
    ds_read_b128 a[160:163], v208 offset:0
    v_mfma_f32_16x16x32_bf16 v[40:43], a[84:87], a[212:215], v[40:43]
    ds_read_b128 a[164:167], v208 offset:1024
    v_mfma_f32_16x16x32_bf16 v[44:47], a[88:91], a[208:211], v[44:47]
    ds_read_b128 a[168:171], v208 offset:2048
    v_mfma_f32_16x16x32_bf16 v[44:47], a[92:95], a[212:215], v[44:47]
    buffer_load_dwordx4 v255, s[4:7], s64 offen offset:0 sc1 lds
    v_mfma_f32_16x16x32_bf16 v[56:59], a[80:83], a[216:219], v[56:59]
    ds_read_b128 a[172:175], v208 offset:3072
    v_mfma_f32_16x16x32_bf16 v[56:59], a[84:87], a[220:223], v[56:59]
    v_mfma_f32_16x16x32_bf16 v[60:63], a[88:91], a[216:219], v[60:63]
    buffer_load_dwordx4 v255, s[4:7], s64 offen offset:1024 sc1 lds
    v_mfma_f32_16x16x32_bf16 v[60:63], a[92:95], a[220:223], v[60:63]
    s_waitcnt lgkmcnt(0)
    v_mfma_f32_16x16x32_bf16 v[0:3], a[64:67], a[128:131], v[0:3]
    ds_read_b64_tr_b16 a[80:81], v206 offset:256
    v_mfma_f32_16x16x32_bf16 v[0:3], a[68:71], a[132:135], v[0:3]
    ds_read_b64_tr_b16 a[82:83], v206 offset:4352
    v_mfma_f32_16x16x32_bf16 v[4:7], a[72:75], a[128:131], v[4:7]
    ds_read_b64_tr_b16 a[84:85], v206 offset:8448
    v_mfma_f32_16x16x32_bf16 v[4:7], a[76:79], a[132:135], v[4:7]
    buffer_load_dwordx4 v255, s[4:7], s64 offen offset:2048 sc1 lds
    v_mfma_f32_16x16x32_bf16 v[16:19], a[64:67], a[136:139], v[16:19]
    ds_read_b64_tr_b16 a[86:87], v206 offset:12544
    ds_read_b64_tr_b16 a[88:89], v207 offset:256
    v_mfma_f32_16x16x32_bf16 v[16:19], a[68:71], a[140:143], v[16:19]
    ds_read_b64_tr_b16 a[90:91], v207 offset:4352
    v_mfma_f32_16x16x32_bf16 v[20:23], a[72:75], a[136:139], v[20:23]
    ds_read_b64_tr_b16 a[92:93], v207 offset:8448
    v_mfma_f32_16x16x32_bf16 v[20:23], a[76:79], a[140:143], v[20:23]
    ds_read_b64_tr_b16 a[94:95], v207 offset:12544
    v_mfma_f32_16x16x32_bf16 v[32:35], a[64:67], a[144:147], v[32:35]
    buffer_load_dwordx4 v255, s[4:7], s64 offen offset:3072 sc1 lds
    v_mfma_f32_16x16x32_bf16 v[32:35], a[68:71], a[148:151], v[32:35]
    ds_read_b128 a[176:179], v208 offset:4096
    ds_read_b128 a[180:183], v208 offset:5120
    v_mfma_f32_16x16x32_bf16 v[36:39], a[72:75], a[144:147], v[36:39]
    ds_read_b128 a[184:187], v208 offset:6144
    v_mfma_f32_16x16x32_bf16 v[36:39], a[76:79], a[148:151], v[36:39]
    ds_read_b128 a[188:191], v208 offset:7168
    v_mfma_f32_16x16x32_bf16 v[48:51], a[64:67], a[152:155], v[48:51]
    v_mfma_f32_16x16x32_bf16 v[48:51], a[68:71], a[156:159], v[48:51]
    v_mfma_f32_16x16x32_bf16 v[52:55], a[72:75], a[152:155], v[52:55]
    s_waitcnt vmcnt(8)
    v_cmp_gt_u32 vcc, 1, v253
    s_nop 0
    s_cbranch_vccnz L_spin_180
L_spinret_181:
    v_mfma_f32_16x16x32_bf16 v[52:55], a[76:79], a[156:159], v[52:55]
    s_waitcnt lgkmcnt(0)
    s_barrier
    v_mfma_f32_16x16x32_bf16 v[8:11], a[80:83], a[128:131], v[8:11]
    buffer_load_dwordx2 v[240:241], v210, s[48:51], s86 offen offset:0
    v_mfma_f32_16x16x32_bf16 v[8:11], a[84:87], a[132:135], v[8:11]
    ds_read_b64_tr_b16 a[64:65], v206 offset:16384
    ds_read_b64_tr_b16 a[66:67], v206 offset:20480
    v_mfma_f32_16x16x32_bf16 v[12:15], a[88:91], a[128:131], v[12:15]
    buffer_load_dwordx2 v[242:243], v210, s[48:51], s86 offen offset:32
    v_mfma_f32_16x16x32_bf16 v[12:15], a[92:95], a[132:135], v[12:15]
    ds_read_b64_tr_b16 a[68:69], v206 offset:24576
    ds_read_b64_tr_b16 a[70:71], v206 offset:28672
    v_mfma_f32_16x16x32_bf16 v[24:27], a[80:83], a[136:139], v[24:27]
    buffer_load_dwordx2 v[244:245], v210, s[48:51], s86 offen offset:64
    v_mfma_f32_16x16x32_bf16 v[24:27], a[84:87], a[140:143], v[24:27]
    ds_read_b64_tr_b16 a[72:73], v207 offset:16384
    ds_read_b64_tr_b16 a[74:75], v207 offset:20480
    v_mfma_f32_16x16x32_bf16 v[28:31], a[88:91], a[136:139], v[28:31]
    buffer_load_dwordx2 v[246:247], v210, s[48:51], s86 offen offset:96
    v_mfma_f32_16x16x32_bf16 v[28:31], a[92:95], a[140:143], v[28:31]
    s_add_u32 s65, s92, 32768
    ds_read_b64_tr_b16 a[76:77], v207 offset:24576
    ds_read_b64_tr_b16 a[78:79], v207 offset:28672
    v_mfma_f32_16x16x32_bf16 v[40:43], a[80:83], a[144:147], v[40:43]
    buffer_load_dwordx4 v[160:163], v255, s[4:7], s65 offen offset:0 sc1
    v_mfma_f32_16x16x32_bf16 v[40:43], a[84:87], a[148:151], v[40:43]
    ds_read_b128 a[192:195], v208 offset:16384
    ds_read_b128 a[196:199], v208 offset:17408
    v_mfma_f32_16x16x32_bf16 v[44:47], a[88:91], a[144:147], v[44:47]
    buffer_load_dwordx4 v[164:167], v255, s[4:7], s65 offen offset:1024 sc1
    v_mfma_f32_16x16x32_bf16 v[44:47], a[92:95], a[148:151], v[44:47]
    s_add_u32 s65, s93, 32768
    ds_read_b128 a[200:203], v208 offset:18432
    ds_read_b128 a[204:207], v208 offset:19456
    v_mfma_f32_16x16x32_bf16 v[56:59], a[80:83], a[152:155], v[56:59]
    buffer_load_dwordx4 v[168:171], v255, s[4:7], s65 offen offset:0 sc1
    v_mfma_f32_16x16x32_bf16 v[56:59], a[84:87], a[156:159], v[56:59]
    v_mfma_f32_16x16x32_bf16 v[60:63], a[88:91], a[152:155], v[60:63]
    buffer_load_dwordx4 v[172:175], v255, s[4:7], s65 offen offset:1024 sc1
    v_mfma_f32_16x16x32_bf16 v[60:63], a[92:95], a[156:159], v[60:63]
    s_waitcnt lgkmcnt(0)
    v_mfma_f32_16x16x32_bf16 v[0:3], a[64:67], a[160:163], v[0:3]
    s_add_u32 s65, s94, 32768
    ds_read_b64_tr_b16 a[80:81], v206 offset:16640
    v_mfma_f32_16x16x32_bf16 v[0:3], a[68:71], a[164:167], v[0:3]
    ds_read_b64_tr_b16 a[82:83], v206 offset:20736
    v_mfma_f32_16x16x32_bf16 v[4:7], a[72:75], a[160:163], v[4:7]
    buffer_load_dwordx4 v[176:179], v255, s[4:7], s65 offen offset:0 sc1
    v_mfma_f32_16x16x32_bf16 v[4:7], a[76:79], a[164:167], v[4:7]
    ds_read_b64_tr_b16 a[84:85], v206 offset:24832
    ds_read_b64_tr_b16 a[86:87], v206 offset:28928
    v_mfma_f32_16x16x32_bf16 v[16:19], a[64:67], a[168:171], v[16:19]
    buffer_load_dwordx4 v[180:183], v255, s[4:7], s65 offen offset:1024 sc1
    v_mfma_f32_16x16x32_bf16 v[16:19], a[68:71], a[172:175], v[16:19]
    ds_read_b64_tr_b16 a[88:89], v207 offset:16640
    ds_read_b64_tr_b16 a[90:91], v207 offset:20736
    v_mfma_f32_16x16x32_bf16 v[20:23], a[72:75], a[168:171], v[20:23]
    buffer_load_dwordx2 v[232:233], v209, s[8:11], s81 offen offset:0
    v_mfma_f32_16x16x32_bf16 v[20:23], a[76:79], a[172:175], v[20:23]
    ds_read_b64_tr_b16 a[92:93], v207 offset:24832
    ds_read_b64_tr_b16 a[94:95], v207 offset:28928
    v_mfma_f32_16x16x32_bf16 v[32:35], a[64:67], a[176:179], v[32:35]
    buffer_load_dwordx2 v[234:235], v209, s[8:11], s81 offen offset:32
    v_mfma_f32_16x16x32_bf16 v[32:35], a[68:71], a[180:183], v[32:35]
    ds_read_b128 a[208:211], v208 offset:20480
    ds_read_b128 a[212:215], v208 offset:21504
    v_mfma_f32_16x16x32_bf16 v[36:39], a[72:75], a[176:179], v[36:39]
    buffer_load_dwordx2 v[236:237], v209, s[8:11], s81 offen offset:64
    v_mfma_f32_16x16x32_bf16 v[36:39], a[76:79], a[180:183], v[36:39]
    ds_read_b128 a[216:219], v208 offset:22528
    ds_read_b128 a[220:223], v208 offset:23552
    v_mfma_f32_16x16x32_bf16 v[48:51], a[64:67], a[184:187], v[48:51]
    buffer_load_dwordx2 v[238:239], v209, s[8:11], s81 offen offset:96
    v_mfma_f32_16x16x32_bf16 v[48:51], a[68:71], a[188:191], v[48:51]
    v_mfma_f32_16x16x32_bf16 v[52:55], a[72:75], a[184:187], v[52:55]
    v_mfma_f32_16x16x32_bf16 v[52:55], a[76:79], a[188:191], v[52:55]
    s_waitcnt vmcnt(18) lgkmcnt(0)
    s_barrier
    v_mfma_f32_16x16x32_bf16 v[8:11], a[80:83], a[160:163], v[8:11]
    ds_read_b64_tr_b16 a[64:65], v204 offset:0
    v_mfma_f32_16x16x32_bf16 v[8:11], a[84:87], a[164:167], v[8:11]
    ds_read_b64_tr_b16 a[66:67], v204 offset:4096
    v_mfma_f32_16x16x32_bf16 v[12:15], a[88:91], a[160:163], v[12:15]
    ds_read_b64_tr_b16 a[68:69], v204 offset:8192
    v_mfma_f32_16x16x32_bf16 v[12:15], a[92:95], a[164:167], v[12:15]
    ds_read_b64_tr_b16 a[70:71], v204 offset:12288
    v_mfma_f32_16x16x32_bf16 v[24:27], a[80:83], a[168:171], v[24:27]
    ds_read_b64_tr_b16 a[72:73], v205 offset:0
    v_mfma_f32_16x16x32_bf16 v[24:27], a[84:87], a[172:175], v[24:27]
    ds_read_b64_tr_b16 a[74:75], v205 offset:4096
    v_mfma_f32_16x16x32_bf16 v[28:31], a[88:91], a[168:171], v[28:31]
    ds_read_b64_tr_b16 a[76:77], v205 offset:8192
    v_mfma_f32_16x16x32_bf16 v[28:31], a[92:95], a[172:175], v[28:31]
    ds_read_b64_tr_b16 a[78:79], v205 offset:12288
    v_mfma_f32_16x16x32_bf16 v[40:43], a[80:83], a[176:179], v[40:43]
    ds_read_b128 a[128:131], v208 offset:32768
    v_mfma_f32_16x16x32_bf16 v[40:43], a[84:87], a[180:183], v[40:43]
    ds_read_b128 a[132:135], v208 offset:33792
    v_mfma_f32_16x16x32_bf16 v[44:47], a[88:91], a[176:179], v[44:47]
    ds_read_b128 a[136:139], v208 offset:34816
    v_mfma_f32_16x16x32_bf16 v[44:47], a[92:95], a[180:183], v[44:47]
    ds_read_b128 a[140:143], v208 offset:35840
    v_mfma_f32_16x16x32_bf16 v[56:59], a[80:83], a[184:187], v[56:59]
    v_mfma_f32_16x16x32_bf16 v[56:59], a[84:87], a[188:191], v[56:59]
    v_mfma_f32_16x16x32_bf16 v[60:63], a[88:91], a[184:187], v[60:63]
    v_mfma_f32_16x16x32_bf16 v[60:63], a[92:95], a[188:191], v[60:63]
    s_waitcnt lgkmcnt(0)
    v_mfma_f32_16x16x32_bf16 v[0:3], a[64:67], a[192:195], v[0:3]
    ds_read_b64_tr_b16 a[80:81], v204 offset:256
    v_mfma_f32_16x16x32_bf16 v[0:3], a[68:71], a[196:199], v[0:3]
    ds_read_b64_tr_b16 a[82:83], v204 offset:4352
    v_mfma_f32_16x16x32_bf16 v[4:7], a[72:75], a[192:195], v[4:7]
    ds_read_b64_tr_b16 a[84:85], v204 offset:8448
    v_mfma_f32_16x16x32_bf16 v[4:7], a[76:79], a[196:199], v[4:7]
    ds_read_b64_tr_b16 a[86:87], v204 offset:12544
    v_mfma_f32_16x16x32_bf16 v[16:19], a[64:67], a[200:203], v[16:19]
    ds_read_b64_tr_b16 a[88:89], v205 offset:256
    v_mfma_f32_16x16x32_bf16 v[16:19], a[68:71], a[204:207], v[16:19]
    ds_read_b64_tr_b16 a[90:91], v205 offset:4352
    v_mfma_f32_16x16x32_bf16 v[20:23], a[72:75], a[200:203], v[20:23]
    ds_read_b64_tr_b16 a[92:93], v205 offset:8448
    v_mfma_f32_16x16x32_bf16 v[20:23], a[76:79], a[204:207], v[20:23]
    ds_read_b64_tr_b16 a[94:95], v205 offset:12544
    v_mfma_f32_16x16x32_bf16 v[32:35], a[64:67], a[208:211], v[32:35]
    ds_read_b128 a[144:147], v208 offset:36864
    v_mfma_f32_16x16x32_bf16 v[32:35], a[68:71], a[212:215], v[32:35]
    ds_read_b128 a[148:151], v208 offset:37888
    v_mfma_f32_16x16x32_bf16 v[36:39], a[72:75], a[208:211], v[36:39]
    ds_read_b128 a[152:155], v208 offset:38912
    v_mfma_f32_16x16x32_bf16 v[36:39], a[76:79], a[212:215], v[36:39]
    ds_read_b128 a[156:159], v208 offset:39936
    v_mfma_f32_16x16x32_bf16 v[48:51], a[64:67], a[216:219], v[48:51]
    v_mfma_f32_16x16x32_bf16 v[48:51], a[68:71], a[220:223], v[48:51]
    v_mfma_f32_16x16x32_bf16 v[52:55], a[72:75], a[216:219], v[52:55]
    v_mfma_f32_16x16x32_bf16 v[52:55], a[76:79], a[220:223], v[52:55]
    s_waitcnt vmcnt(14) lgkmcnt(0)
    s_barrier
    v_mfma_f32_16x16x32_bf16 v[8:11], a[80:83], a[192:195], v[8:11]
    ds_read_b64_tr_b16 a[64:65], v204 offset:16384
    v_mfma_f32_16x16x32_bf16 v[8:11], a[84:87], a[196:199], v[8:11]
    ds_read_b64_tr_b16 a[66:67], v204 offset:20480
    v_mfma_f32_16x16x32_bf16 v[12:15], a[88:91], a[192:195], v[12:15]
    ds_read_b64_tr_b16 a[68:69], v204 offset:24576
    v_mfma_f32_16x16x32_bf16 v[12:15], a[92:95], a[196:199], v[12:15]
    ds_read_b64_tr_b16 a[70:71], v204 offset:28672
    v_mfma_f32_16x16x32_bf16 v[24:27], a[80:83], a[200:203], v[24:27]
    s_waitcnt vmcnt(8)
    v_mfma_f32_16x16x32_bf16 v[24:27], a[84:87], a[204:207], v[24:27]
    ds_read_b64_tr_b16 a[72:73], v205 offset:16384
    ds_read_b64_tr_b16 a[74:75], v205 offset:20480
    v_mfma_f32_16x16x32_bf16 v[28:31], a[88:91], a[200:203], v[28:31]
    ds_read_b64_tr_b16 a[76:77], v205 offset:24576
    v_lshlrev_b32 v184, 16, v240
    v_mfma_f32_16x16x32_bf16 v[28:31], a[92:95], a[204:207], v[28:31]
    ds_read_b64_tr_b16 a[78:79], v205 offset:28672
    v_and_b32 v185, 0xffff0000, v240
    v_mfma_f32_16x16x32_bf16 v[40:43], a[80:83], a[208:211], v[40:43]
    ds_read_b128 a[160:163], v208 offset:49152
    v_lshlrev_b32 v186, 16, v241
    v_mfma_f32_16x16x32_bf16 v[40:43], a[84:87], a[212:215], v[40:43]
    ds_read_b128 a[164:167], v208 offset:50176
    v_and_b32 v187, 0xffff0000, v241
    v_mfma_f32_16x16x32_bf16 v[44:47], a[88:91], a[208:211], v[44:47]
    ds_read_b128 a[168:171], v208 offset:51200
    v_lshlrev_b32 v188, 16, v242
    v_mfma_f32_16x16x32_bf16 v[44:47], a[92:95], a[212:215], v[44:47]
    ds_read_b128 a[172:175], v208 offset:52224
    v_and_b32 v189, 0xffff0000, v242
    v_mfma_f32_16x16x32_bf16 v[56:59], a[80:83], a[216:219], v[56:59]
    v_lshlrev_b32 v190, 16, v243
    v_mfma_f32_16x16x32_bf16 v[56:59], a[84:87], a[220:223], v[56:59]
    v_and_b32 v191, 0xffff0000, v243
    v_mfma_f32_16x16x32_bf16 v[60:63], a[88:91], a[216:219], v[60:63]
    v_lshlrev_b32 v192, 16, v244
    v_mfma_f32_16x16x32_bf16 v[60:63], a[92:95], a[220:223], v[60:63]
    s_waitcnt lgkmcnt(0)
    v_and_b32 v193, 0xffff0000, v244
    v_mfma_f32_16x16x32_bf16 v[0:3], a[64:67], a[128:131], v[0:3]
    ds_read_b64_tr_b16 a[80:81], v204 offset:16640
    v_lshlrev_b32 v194, 16, v245
    v_mfma_f32_16x16x32_bf16 v[0:3], a[68:71], a[132:135], v[0:3]
    ds_read_b64_tr_b16 a[82:83], v204 offset:20736
    v_and_b32 v195, 0xffff0000, v245
    v_mfma_f32_16x16x32_bf16 v[4:7], a[72:75], a[128:131], v[4:7]
    ds_read_b64_tr_b16 a[84:85], v204 offset:24832
    v_mfma_f32_16x16x32_bf16 v[4:7], a[76:79], a[132:135], v[4:7]
    ds_read_b64_tr_b16 a[86:87], v204 offset:28928
    v_lshlrev_b32 v196, 16, v246
    v_mfma_f32_16x16x32_bf16 v[16:19], a[64:67], a[136:139], v[16:19]
    ds_read_b64_tr_b16 a[88:89], v205 offset:16640
    v_and_b32 v197, 0xffff0000, v246
    v_mfma_f32_16x16x32_bf16 v[16:19], a[68:71], a[140:143], v[16:19]
    ds_read_b64_tr_b16 a[90:91], v205 offset:20736
    v_lshlrev_b32 v198, 16, v247
    v_mfma_f32_16x16x32_bf16 v[20:23], a[72:75], a[136:139], v[20:23]
    ds_read_b64_tr_b16 a[92:93], v205 offset:24832
    v_and_b32 v199, 0xffff0000, v247
    v_mfma_f32_16x16x32_bf16 v[20:23], a[76:79], a[140:143], v[20:23]
    ds_read_b64_tr_b16 a[94:95], v205 offset:28928
    v_lshlrev_b32 v248, 16, v160
    v_mfma_f32_16x16x32_bf16 v[32:35], a[64:67], a[144:147], v[32:35]
    ds_read_b128 a[176:179], v208 offset:53248
    v_and_b32 v249, 0xffff0000, v160
    v_mfma_f32_16x16x32_bf16 v[32:35], a[68:71], a[148:151], v[32:35]
    ds_read_b128 a[180:183], v208 offset:54272
    v_mfma_f32_16x16x32_bf16 v[36:39], a[72:75], a[144:147], v[36:39]
    ds_read_b128 a[184:187], v208 offset:55296
    v_add_f32 v184, v184, v248
    v_mfma_f32_16x16x32_bf16 v[36:39], a[76:79], a[148:151], v[36:39]
    ds_read_b128 a[188:191], v208 offset:56320
    v_add_f32 v185, v185, v249
    v_mfma_f32_16x16x32_bf16 v[48:51], a[64:67], a[152:155], v[48:51]
    v_lshlrev_b32 v248, 16, v161
    v_mfma_f32_16x16x32_bf16 v[48:51], a[68:71], a[156:159], v[48:51]
    v_and_b32 v249, 0xffff0000, v161
    v_mfma_f32_16x16x32_bf16 v[52:55], a[72:75], a[152:155], v[52:55]
    v_add_f32 v186, v186, v248
    v_mfma_f32_16x16x32_bf16 v[52:55], a[76:79], a[156:159], v[52:55]
    s_waitcnt lgkmcnt(0)
    s_barrier
    v_mfma_f32_16x16x32_bf16 v[8:11], a[80:83], a[128:131], v[8:11]
    ds_read_b64_tr_b16 a[64:65], v204 offset:32768
    v_add_f32 v187, v187, v249
    v_mfma_f32_16x16x32_bf16 v[8:11], a[84:87], a[132:135], v[8:11]
    ds_read_b64_tr_b16 a[66:67], v204 offset:36864
    v_lshlrev_b32 v248, 16, v162
    v_mfma_f32_16x16x32_bf16 v[12:15], a[88:91], a[128:131], v[12:15]
    ds_read_b64_tr_b16 a[68:69], v204 offset:40960
    v_and_b32 v249, 0xffff0000, v162
    v_mfma_f32_16x16x32_bf16 v[12:15], a[92:95], a[132:135], v[12:15]
    ds_read_b64_tr_b16 a[70:71], v204 offset:45056
    v_add_f32 v188, v188, v248
    v_mfma_f32_16x16x32_bf16 v[24:27], a[80:83], a[136:139], v[24:27]
    ds_read_b64_tr_b16 a[72:73], v205 offset:32768
    v_add_f32 v189, v189, v249
    v_mfma_f32_16x16x32_bf16 v[24:27], a[84:87], a[140:143], v[24:27]
    ds_read_b64_tr_b16 a[74:75], v205 offset:36864
    v_lshlrev_b32 v248, 16, v163
    v_mfma_f32_16x16x32_bf16 v[28:31], a[88:91], a[136:139], v[28:31]
    ds_read_b64_tr_b16 a[76:77], v205 offset:40960
    v_and_b32 v249, 0xffff0000, v163
    v_mfma_f32_16x16x32_bf16 v[28:31], a[92:95], a[140:143], v[28:31]
    ds_read_b64_tr_b16 a[78:79], v205 offset:45056
    v_add_f32 v190, v190, v248
    v_mfma_f32_16x16x32_bf16 v[40:43], a[80:83], a[144:147], v[40:43]
    v_mfma_f32_16x16x32_bf16 v[40:43], a[84:87], a[148:151], v[40:43]
    v_add_f32 v191, v191, v249
    v_mfma_f32_16x16x32_bf16 v[44:47], a[88:91], a[144:147], v[44:47]
    v_lshlrev_b32 v248, 16, v164
    v_mfma_f32_16x16x32_bf16 v[44:47], a[92:95], a[148:151], v[44:47]
    v_and_b32 v249, 0xffff0000, v164
    v_mfma_f32_16x16x32_bf16 v[56:59], a[80:83], a[152:155], v[56:59]
    v_add_f32 v192, v192, v248
    v_mfma_f32_16x16x32_bf16 v[56:59], a[84:87], a[156:159], v[56:59]
    v_add_f32 v193, v193, v249
    v_mfma_f32_16x16x32_bf16 v[60:63], a[88:91], a[152:155], v[60:63]
    v_lshlrev_b32 v248, 16, v165
    v_mfma_f32_16x16x32_bf16 v[60:63], a[92:95], a[156:159], v[60:63]
    s_waitcnt lgkmcnt(0)
    v_mfma_f32_16x16x32_bf16 v[0:3], a[64:67], a[160:163], v[0:3]
    ds_read_b64_tr_b16 a[80:81], v204 offset:33024
    v_and_b32 v249, 0xffff0000, v165
    v_mfma_f32_16x16x32_bf16 v[0:3], a[68:71], a[164:167], v[0:3]
    ds_read_b64_tr_b16 a[82:83], v204 offset:37120
    v_add_f32 v194, v194, v248
    v_mfma_f32_16x16x32_bf16 v[4:7], a[72:75], a[160:163], v[4:7]
    ds_read_b64_tr_b16 a[84:85], v204 offset:41216
    v_add_f32 v195, v195, v249
    v_mfma_f32_16x16x32_bf16 v[4:7], a[76:79], a[164:167], v[4:7]
    ds_read_b64_tr_b16 a[86:87], v204 offset:45312
    v_lshlrev_b32 v248, 16, v166
    v_mfma_f32_16x16x32_bf16 v[16:19], a[64:67], a[168:171], v[16:19]
    ds_read_b64_tr_b16 a[88:89], v205 offset:33024
    v_and_b32 v249, 0xffff0000, v166
    v_mfma_f32_16x16x32_bf16 v[16:19], a[68:71], a[172:175], v[16:19]
    ds_read_b64_tr_b16 a[90:91], v205 offset:37120
    v_add_f32 v196, v196, v248
    v_mfma_f32_16x16x32_bf16 v[20:23], a[72:75], a[168:171], v[20:23]
    ds_read_b64_tr_b16 a[92:93], v205 offset:41216
    v_mfma_f32_16x16x32_bf16 v[20:23], a[76:79], a[172:175], v[20:23]
    ds_read_b64_tr_b16 a[94:95], v205 offset:45312
    v_add_f32 v197, v197, v249
    v_mfma_f32_16x16x32_bf16 v[32:35], a[64:67], a[176:179], v[32:35]
    v_lshlrev_b32 v248, 16, v167
    v_mfma_f32_16x16x32_bf16 v[32:35], a[68:71], a[180:183], v[32:35]
    v_and_b32 v249, 0xffff0000, v167
    v_mfma_f32_16x16x32_bf16 v[36:39], a[72:75], a[176:179], v[36:39]
    v_add_f32 v198, v198, v248
    v_mfma_f32_16x16x32_bf16 v[36:39], a[76:79], a[180:183], v[36:39]
    v_add_f32 v199, v199, v249
    v_mfma_f32_16x16x32_bf16 v[48:51], a[64:67], a[184:187], v[48:51]
    s_waitcnt vmcnt(6)
    v_mfma_f32_16x16x32_bf16 v[48:51], a[68:71], a[188:191], v[48:51]
    v_mfma_f32_16x16x32_bf16 v[52:55], a[72:75], a[184:187], v[52:55]
    v_mfma_f32_16x16x32_bf16 v[52:55], a[76:79], a[188:191], v[52:55]
    s_waitcnt lgkmcnt(0)
    v_mfma_f32_16x16x32_bf16 v[8:11], a[80:83], a[160:163], v[8:11]
    v_mfma_f32_16x16x32_bf16 v[8:11], a[84:87], a[164:167], v[8:11]
    s_add_u32 s65, s80, 0
    v_cvt_pk_bf16_f32 v128, v0, v1
    v_mfma_f32_16x16x32_bf16 v[12:15], a[88:91], a[160:163], v[12:15]
    v_cvt_pk_bf16_f32 v129, v2, v3
    v_cvt_pk_bf16_f32 v130, v4, v5
    v_mfma_f32_16x16x32_bf16 v[12:15], a[92:95], a[164:167], v[12:15]
    v_cvt_pk_bf16_f32 v131, v6, v7
    v_mfma_f32_16x16x32_bf16 v[24:27], a[80:83], a[168:171], v[24:27]
    buffer_store_dwordx4 v[128:131], v255, s[4:7], s65 offen offset:0 sc1
    v_mfma_f32_16x16x32_bf16 v[24:27], a[84:87], a[172:175], v[24:27]
    v_cvt_pk_bf16_f32 v136, v16, v17
    v_cvt_pk_bf16_f32 v137, v18, v19
    v_mfma_f32_16x16x32_bf16 v[28:31], a[88:91], a[168:171], v[28:31]
    v_cvt_pk_bf16_f32 v138, v20, v21
    v_cvt_pk_bf16_f32 v139, v22, v23
    v_mfma_f32_16x16x32_bf16 v[28:31], a[92:95], a[172:175], v[28:31]
    buffer_store_dwordx4 v[136:139], v255, s[4:7], s65 offen offset:2048 sc1
    v_mfma_f32_16x16x32_bf16 v[40:43], a[80:83], a[176:179], v[40:43]
    v_cvt_pk_bf16_f32 v144, v32, v33
    v_cvt_pk_bf16_f32 v145, v34, v35
    v_mfma_f32_16x16x32_bf16 v[40:43], a[84:87], a[180:183], v[40:43]
    v_cvt_pk_bf16_f32 v146, v36, v37
    v_cvt_pk_bf16_f32 v147, v38, v39
    v_mfma_f32_16x16x32_bf16 v[44:47], a[88:91], a[176:179], v[44:47]
    s_add_u32 s65, s80, 4096
    v_mfma_f32_16x16x32_bf16 v[44:47], a[92:95], a[180:183], v[44:47]
    buffer_store_dwordx4 v[144:147], v255, s[4:7], s65 offen offset:0 sc1
    v_mfma_f32_16x16x32_bf16 v[56:59], a[80:83], a[184:187], v[56:59]
    v_cvt_pk_bf16_f32 v152, v48, v49
    v_cvt_pk_bf16_f32 v153, v50, v51
    v_mfma_f32_16x16x32_bf16 v[56:59], a[84:87], a[188:191], v[56:59]
    v_cvt_pk_bf16_f32 v154, v52, v53
    v_cvt_pk_bf16_f32 v155, v54, v55
    v_mfma_f32_16x16x32_bf16 v[60:63], a[88:91], a[184:187], v[60:63]
    buffer_store_dwordx4 v[152:155], v255, s[4:7], s65 offen offset:2048 sc1
    v_mfma_f32_16x16x32_bf16 v[60:63], a[92:95], a[188:191], v[60:63]
    s_cmp_eq_u32 s56, s85
    s_cbranch_scc1 L_own
    s_nop 1
    v_cvt_pk_bf16_f32 v132, v8, v9
    v_cvt_pk_bf16_f32 v133, v10, v11
    v_cvt_pk_bf16_f32 v134, v12, v13
    v_cvt_pk_bf16_f32 v135, v14, v15
    s_add_u32 s65, s80, 0
    buffer_store_dwordx4 v[132:135], v255, s[4:7], s65 offen offset:1024 sc1
    v_cvt_pk_bf16_f32 v140, v24, v25
    v_cvt_pk_bf16_f32 v141, v26, v27
    v_cvt_pk_bf16_f32 v142, v28, v29
    v_cvt_pk_bf16_f32 v143, v30, v31
    buffer_store_dwordx4 v[140:143], v255, s[4:7], s65 offen offset:3072 sc1
    v_cvt_pk_bf16_f32 v148, v40, v41
    v_cvt_pk_bf16_f32 v149, v42, v43
    v_cvt_pk_bf16_f32 v150, v44, v45
    v_cvt_pk_bf16_f32 v151, v46, v47
    s_add_u32 s65, s80, 4096
    buffer_store_dwordx4 v[148:151], v255, s[4:7], s65 offen offset:1024 sc1
    v_cvt_pk_bf16_f32 v156, v56, v57
    v_cvt_pk_bf16_f32 v157, v58, v59
    v_cvt_pk_bf16_f32 v158, v60, v61
    v_cvt_pk_bf16_f32 v159, v62, v63
    buffer_store_dwordx4 v[156:159], v255, s[4:7], s65 offen offset:3072 sc1
L_own_r:
    v_lshlrev_b32 v248, 16, v168
    v_and_b32 v249, 0xffff0000, v168
    v_add_f32 v184, v184, v248
    v_add_f32 v185, v185, v249
    v_lshlrev_b32 v248, 16, v169
    v_and_b32 v249, 0xffff0000, v169
    v_add_f32 v186, v186, v248
    v_add_f32 v187, v187, v249
    v_lshlrev_b32 v248, 16, v170
    v_and_b32 v249, 0xffff0000, v170
    v_add_f32 v188, v188, v248
    v_add_f32 v189, v189, v249
    v_lshlrev_b32 v248, 16, v171
    v_and_b32 v249, 0xffff0000, v171
    v_add_f32 v190, v190, v248
    v_add_f32 v191, v191, v249
    v_lshlrev_b32 v248, 16, v172
    v_and_b32 v249, 0xffff0000, v172
    v_add_f32 v192, v192, v248
    v_add_f32 v193, v193, v249
    v_lshlrev_b32 v248, 16, v173
    v_and_b32 v249, 0xffff0000, v173
    v_add_f32 v194, v194, v248
    v_add_f32 v195, v195, v249
    v_lshlrev_b32 v248, 16, v174
    v_and_b32 v249, 0xffff0000, v174
    v_add_f32 v196, v196, v248
    v_add_f32 v197, v197, v249
    v_lshlrev_b32 v248, 16, v175
    v_and_b32 v249, 0xffff0000, v175
    v_add_f32 v198, v198, v248
    v_add_f32 v199, v199, v249
    s_waitcnt vmcnt(12)
    v_lshlrev_b32 v248, 16, v176
    v_and_b32 v249, 0xffff0000, v176
    v_add_f32 v184, v184, v248
    v_add_f32 v185, v185, v249
    v_lshlrev_b32 v248, 16, v177
    v_and_b32 v249, 0xffff0000, v177
    v_add_f32 v186, v186, v248
    v_add_f32 v187, v187, v249
    v_lshlrev_b32 v248, 16, v178
    v_and_b32 v249, 0xffff0000, v178
    v_add_f32 v188, v188, v248
    v_add_f32 v189, v189, v249
    v_lshlrev_b32 v248, 16, v179
    v_and_b32 v249, 0xffff0000, v179
    v_add_f32 v190, v190, v248
    v_add_f32 v191, v191, v249
    v_lshlrev_b32 v248, 16, v180
    v_and_b32 v249, 0xffff0000, v180
    v_add_f32 v192, v192, v248
    v_add_f32 v193, v193, v249
    v_lshlrev_b32 v248, 16, v181
    v_and_b32 v249, 0xffff0000, v181
    v_add_f32 v194, v194, v248
    v_add_f32 v195, v195, v249
    v_lshlrev_b32 v248, 16, v182
    v_and_b32 v249, 0xffff0000, v182
    v_add_f32 v196, v196, v248
    v_add_f32 v197, v197, v249
    v_lshlrev_b32 v248, 16, v183
    v_and_b32 v249, 0xffff0000, v183
    v_add_f32 v198, v198, v248
    v_add_f32 v199, v199, v249
    s_waitcnt vmcnt(8)
    v_lshlrev_b32 v80, 16, v232
    v_and_b32 v81, 0xffff0000, v232
    v_lshlrev_b32 v82, 16, v233
    v_and_b32 v83, 0xffff0000, v233
    v_lshlrev_b32 v84, 16, v234
    v_and_b32 v85, 0xffff0000, v234
    v_lshlrev_b32 v86, 16, v235
    v_and_b32 v87, 0xffff0000, v235
    v_lshlrev_b32 v88, 16, v236
    v_and_b32 v89, 0xffff0000, v236
    v_lshlrev_b32 v90, 16, v237
    v_and_b32 v91, 0xffff0000, v237
    v_lshlrev_b32 v92, 16, v238
    v_and_b32 v93, 0xffff0000, v238
    v_lshlrev_b32 v94, 16, v239
    v_and_b32 v95, 0xffff0000, v239
    s_waitcnt lgkmcnt(0)
    s_barrier
    ds_read_b128 v[64:67], v212 offset:16384
    ds_read_b128 v[68:71], v212 offset:17408
    ds_read_b128 v[72:75], v212 offset:18432
    ds_read_b128 v[76:79], v212 offset:19456
    ds_read_b128 v[0:3], v212 offset:0
    ds_read_b128 v[4:7], v212 offset:1024
    ds_read_b128 v[8:11], v212 offset:2048
    ds_read_b128 v[12:15], v212 offset:3072
    buffer_load_dwordx4 v[160:163], v255, s[4:7], s92 offen offset:0 sc1
    buffer_load_dwordx4 v[164:167], v255, s[4:7], s92 offen offset:1024 sc1
    buffer_load_dwordx4 v[168:171], v255, s[4:7], s93 offen offset:0 sc1
    buffer_load_dwordx4 v[172:175], v255, s[4:7], s93 offen offset:1024 sc1
    buffer_load_dwordx4 v[176:179], v255, s[4:7], s94 offen offset:0 sc1
    buffer_load_dwordx4 v[180:183], v255, s[4:7], s94 offen offset:1024 sc1
    s_waitcnt lgkmcnt(4)
    v_pk_add_f32 v[184:185], v[184:185], v[64:65]
    v_pk_add_f32 v[186:187], v[186:187], v[66:67]
    v_pk_add_f32 v[188:189], v[188:189], v[68:69]
    v_pk_add_f32 v[190:191], v[190:191], v[70:71]
    v_pk_add_f32 v[192:193], v[192:193], v[72:73]
    v_pk_add_f32 v[194:195], v[194:195], v[74:75]
    v_pk_add_f32 v[196:197], v[196:197], v[76:77]
    v_pk_add_f32 v[198:199], v[198:199], v[78:79]
    v_mul_f32 v64, 0xbfb8aa3b, v184
    v_mul_f32 v65, 0xbfb8aa3b, v185
    v_mul_f32 v66, 0xbfb8aa3b, v186
    v_mul_f32 v67, 0xbfb8aa3b, v187
    v_mul_f32 v68, 0xbfb8aa3b, v188
    v_mul_f32 v69, 0xbfb8aa3b, v189
    v_mul_f32 v70, 0xbfb8aa3b, v190
    v_mul_f32 v71, 0xbfb8aa3b, v191
    v_mul_f32 v72, 0xbfb8aa3b, v192
    v_mul_f32 v73, 0xbfb8aa3b, v193
    v_mul_f32 v74, 0xbfb8aa3b, v194
    v_mul_f32 v75, 0xbfb8aa3b, v195
    v_mul_f32 v76, 0xbfb8aa3b, v196
    v_mul_f32 v77, 0xbfb8aa3b, v197
    v_mul_f32 v78, 0xbfb8aa3b, v198
    v_mul_f32 v79, 0xbfb8aa3b, v199
    v_exp_f32 v64, v64
    v_exp_f32 v65, v65
    v_exp_f32 v66, v66
    v_exp_f32 v67, v67
    v_exp_f32 v68, v68
    v_exp_f32 v69, v69
    v_exp_f32 v70, v70
    v_exp_f32 v71, v71
    v_exp_f32 v72, v72
    v_exp_f32 v73, v73
    v_exp_f32 v74, v74
    v_exp_f32 v75, v75
    v_exp_f32 v76, v76
    v_exp_f32 v77, v77
    v_exp_f32 v78, v78
    v_exp_f32 v79, v79
    v_add_f32 v64, 1.0, v64
    v_add_f32 v65, 1.0, v65
    v_add_f32 v66, 1.0, v66
    v_add_f32 v67, 1.0, v67
    v_add_f32 v68, 1.0, v68
    v_add_f32 v69, 1.0, v69
    v_add_f32 v70, 1.0, v70
    v_add_f32 v71, 1.0, v71
    v_add_f32 v72, 1.0, v72
    v_add_f32 v73, 1.0, v73
    v_add_f32 v74, 1.0, v74
    v_add_f32 v75, 1.0, v75
    v_add_f32 v76, 1.0, v76
    v_add_f32 v77, 1.0, v77
    v_add_f32 v78, 1.0, v78
    v_add_f32 v79, 1.0, v79
    v_rcp_f32 v64, v64
    v_rcp_f32 v65, v65
    v_rcp_f32 v66, v66
    v_rcp_f32 v67, v67
    v_rcp_f32 v68, v68
    v_rcp_f32 v69, v69
    v_rcp_f32 v70, v70
    v_rcp_f32 v71, v71
    v_rcp_f32 v72, v72
    v_rcp_f32 v73, v73
    v_rcp_f32 v74, v74
    v_rcp_f32 v75, v75
    v_rcp_f32 v76, v76
    v_rcp_f32 v77, v77
    v_rcp_f32 v78, v78
    v_rcp_f32 v79, v79
    v_pk_mul_f32 v[184:185], v[184:185], v[64:65]
    v_pk_mul_f32 v[186:187], v[186:187], v[66:67]
    v_pk_mul_f32 v[188:189], v[188:189], v[68:69]
    v_pk_mul_f32 v[190:191], v[190:191], v[70:71]
    v_pk_mul_f32 v[192:193], v[192:193], v[72:73]
    v_pk_mul_f32 v[194:195], v[194:195], v[74:75]
    v_pk_mul_f32 v[196:197], v[196:197], v[76:77]
    v_pk_mul_f32 v[198:199], v[198:199], v[78:79]
    s_waitcnt vmcnt(0) lgkmcnt(0)
    v_max3_u32 v96, v160, v161, v162
    v_max3_u32 v96, v96, v163, v164
    v_max3_u32 v96, v96, v165, v166
    v_max3_u32 v96, v96, v167, v168
    v_max3_u32 v96, v96, v169, v170
    v_max3_u32 v96, v96, v171, v172
    v_max3_u32 v96, v96, v173, v174
    v_max3_u32 v96, v96, v175, v176
    v_max3_u32 v96, v96, v177, v178
    v_max3_u32 v96, v96, v179, v180
    v_max3_u32 v96, v96, v181, v182
    v_max_u32 v96, v96, v183
    v_cmp_eq_u32 vcc, -1, v96
    s_nop 0
    s_cbranch_vccnz L_pspin
L_pspin_r:
    v_lshlrev_b32 v64, 16, v160
    v_and_b32 v65, 0xffff0000, v160
    v_lshlrev_b32 v66, 16, v161
    v_and_b32 v67, 0xffff0000, v161
    v_lshlrev_b32 v68, 16, v162
    v_and_b32 v69, 0xffff0000, v162
    v_lshlrev_b32 v70, 16, v163
    v_and_b32 v71, 0xffff0000, v163
    v_lshlrev_b32 v72, 16, v164
    v_and_b32 v73, 0xffff0000, v164
    v_lshlrev_b32 v74, 16, v165
    v_and_b32 v75, 0xffff0000, v165
    v_lshlrev_b32 v76, 16, v166
    v_and_b32 v77, 0xffff0000, v166
    v_lshlrev_b32 v78, 16, v167
    v_and_b32 v79, 0xffff0000, v167
    v_pk_add_f32 v[0:1], v[0:1], v[64:65]
    v_pk_add_f32 v[2:3], v[2:3], v[66:67]
    v_pk_add_f32 v[4:5], v[4:5], v[68:69]
    v_pk_add_f32 v[6:7], v[6:7], v[70:71]
    v_pk_add_f32 v[8:9], v[8:9], v[72:73]
    v_pk_add_f32 v[10:11], v[10:11], v[74:75]
    v_pk_add_f32 v[12:13], v[12:13], v[76:77]
    v_pk_add_f32 v[14:15], v[14:15], v[78:79]
    v_lshlrev_b32 v64, 16, v168
    v_and_b32 v65, 0xffff0000, v168
    v_lshlrev_b32 v66, 16, v169
    v_and_b32 v67, 0xffff0000, v169
    v_lshlrev_b32 v68, 16, v170
    v_and_b32 v69, 0xffff0000, v170
    v_lshlrev_b32 v70, 16, v171
    v_and_b32 v71, 0xffff0000, v171
    v_lshlrev_b32 v72, 16, v172
    v_and_b32 v73, 0xffff0000, v172
    v_lshlrev_b32 v74, 16, v173
    v_and_b32 v75, 0xffff0000, v173
    v_lshlrev_b32 v76, 16, v174
    v_and_b32 v77, 0xffff0000, v174
    v_lshlrev_b32 v78, 16, v175
    v_and_b32 v79, 0xffff0000, v175
    v_pk_add_f32 v[0:1], v[0:1], v[64:65]
    v_pk_add_f32 v[2:3], v[2:3], v[66:67]
    v_pk_add_f32 v[4:5], v[4:5], v[68:69]
    v_pk_add_f32 v[6:7], v[6:7], v[70:71]
    v_pk_add_f32 v[8:9], v[8:9], v[72:73]
    v_pk_add_f32 v[10:11], v[10:11], v[74:75]
    v_pk_add_f32 v[12:13], v[12:13], v[76:77]
    v_pk_add_f32 v[14:15], v[14:15], v[78:79]
    v_lshlrev_b32 v64, 16, v176
    v_and_b32 v65, 0xffff0000, v176
    v_lshlrev_b32 v66, 16, v177
    v_and_b32 v67, 0xffff0000, v177
    v_lshlrev_b32 v68, 16, v178
    v_and_b32 v69, 0xffff0000, v178
    v_lshlrev_b32 v70, 16, v179
    v_and_b32 v71, 0xffff0000, v179
    v_lshlrev_b32 v72, 16, v180
    v_and_b32 v73, 0xffff0000, v180
    v_lshlrev_b32 v74, 16, v181
    v_and_b32 v75, 0xffff0000, v181
    v_lshlrev_b32 v76, 16, v182
    v_and_b32 v77, 0xffff0000, v182
    v_lshlrev_b32 v78, 16, v183
    v_and_b32 v79, 0xffff0000, v183
    v_pk_add_f32 v[0:1], v[0:1], v[64:65]
    v_pk_add_f32 v[2:3], v[2:3], v[66:67]
    v_pk_add_f32 v[4:5], v[4:5], v[68:69]
    v_pk_add_f32 v[6:7], v[6:7], v[70:71]
    v_pk_add_f32 v[8:9], v[8:9], v[72:73]
    v_pk_add_f32 v[10:11], v[10:11], v[74:75]
    v_pk_add_f32 v[12:13], v[12:13], v[76:77]
    v_pk_add_f32 v[14:15], v[14:15], v[78:79]
    v_fma_f32 v0, v0, v184, v80
    v_fma_f32 v1, v1, v185, v81
    v_fma_f32 v2, v2, v186, v82
    v_fma_f32 v3, v3, v187, v83
    v_fma_f32 v4, v4, v188, v84
    v_fma_f32 v5, v5, v189, v85
    v_fma_f32 v6, v6, v190, v86
    v_fma_f32 v7, v7, v191, v87
    v_fma_f32 v8, v8, v192, v88
    v_fma_f32 v9, v9, v193, v89
    v_fma_f32 v10, v10, v194, v90
    v_fma_f32 v11, v11, v195, v91
    v_fma_f32 v12, v12, v196, v92
    v_fma_f32 v13, v13, v197, v93
    v_fma_f32 v14, v14, v198, v94
    v_fma_f32 v15, v15, v199, v95
    v_cvt_pk_bf16_f32 v16, v0, v1
    v_cvt_pk_bf16_f32 v17, v2, v3
    v_cvt_pk_bf16_f32 v18, v4, v5
    v_cvt_pk_bf16_f32 v19, v6, v7
    v_cvt_pk_bf16_f32 v20, v8, v9
    v_cvt_pk_bf16_f32 v21, v10, v11
    v_cvt_pk_bf16_f32 v22, v12, v13
    v_cvt_pk_bf16_f32 v23, v14, v15
    v_lshrrev_b32 v24, 4, v254
    v_mul_u32_u24 v24, 24, v24
    v_permlane32_swap_b32 v16, v20
    v_permlane32_swap_b32 v18, v22
    v_permlane32_swap_b32 v17, v21
    v_permlane32_swap_b32 v19, v23
    v_add_u32 v24, v24, v209
    s_nop 0
    v_permlane16_swap_b32 v16, v18
    v_permlane16_swap_b32 v20, v22
    v_permlane16_swap_b32 v17, v19
    v_permlane16_swap_b32 v21, v23
    buffer_store_dwordx4 v[16:19], v24, s[40:43], s81 offen
    buffer_store_dwordx4 v[20:23], v24, s[40:43], s81 offen offset:16
    s_waitcnt vmcnt(0)
L_exit:
    s_endpgm
L_pro_x:
    v_mfma_f32_16x16x32_bf16 v[128:131], a[64:67], a[0:3], v[192:195]
    ds_read_b128 a[80:83], v231 offset:36864
    ds_read_b128 a[84:87], v231 offset:37888
    v_mfma_f32_16x16x32_bf16 v[128:131], a[68:71], a[4:7], v[128:131]
    ds_read_b128 a[88:91], v231 offset:38912
    ds_read_b128 a[92:95], v231 offset:39936
    v_mfma_f32_16x16x32_bf16 v[128:131], a[72:75], a[8:11], v[128:131]
    v_mfma_f32_16x16x32_bf16 v[128:131], a[76:79], a[12:15], v[128:131]
    v_mfma_f32_16x16x32_bf16 v[132:135], a[64:67], a[16:19], v[196:199]
    v_mfma_f32_16x16x32_bf16 v[132:135], a[68:71], a[20:23], v[132:135]
    v_mfma_f32_16x16x32_bf16 v[132:135], a[72:75], a[24:27], v[132:135]
    v_mfma_f32_16x16x32_bf16 v[132:135], a[76:79], a[28:31], v[132:135]
    v_mfma_f32_16x16x32_bf16 v[136:139], a[64:67], a[32:35], v[200:203]
    v_mfma_f32_16x16x32_bf16 v[136:139], a[68:71], a[36:39], v[136:139]
    v_mfma_f32_16x16x32_bf16 v[136:139], a[72:75], a[40:43], v[136:139]
    v_mfma_f32_16x16x32_bf16 v[136:139], a[76:79], a[44:47], v[136:139]
    v_mfma_f32_16x16x32_bf16 v[140:143], a[64:67], a[48:51], v[204:207]
    v_exp_f32 v128, v128
    v_mfma_f32_16x16x32_bf16 v[140:143], a[68:71], a[52:55], v[140:143]
    v_exp_f32 v129, v129
    v_mfma_f32_16x16x32_bf16 v[140:143], a[72:75], a[56:59], v[140:143]
    v_exp_f32 v130, v130
    v_mfma_f32_16x16x32_bf16 v[140:143], a[76:79], a[60:63], v[140:143]
    s_waitcnt lgkmcnt(0)
    v_exp_f32 v131, v131
    v_mfma_f32_16x16x32_bf16 v[144:147], a[80:83], a[0:3], v[208:211]
    v_cvt_pk_bf16_f32 v160, v128, v129
    v_mfma_f32_16x16x32_bf16 v[144:147], a[84:87], a[4:7], v[144:147]
    v_exp_f32 v132, v132
    v_mfma_f32_16x16x32_bf16 v[144:147], a[88:91], a[8:11], v[144:147]
    v_exp_f32 v133, v133
    v_mfma_f32_16x16x32_bf16 v[144:147], a[92:95], a[12:15], v[144:147]
    v_mfma_f32_16x16x32_bf16 v[148:151], a[80:83], a[16:19], v[212:215]
    v_cvt_pk_bf16_f32 v161, v130, v131
    v_mfma_f32_16x16x32_bf16 v[148:151], a[84:87], a[20:23], v[148:151]
    v_exp_f32 v134, v134
    v_mfma_f32_16x16x32_bf16 v[148:151], a[88:91], a[24:27], v[148:151]
    v_exp_f32 v135, v135
    v_mfma_f32_16x16x32_bf16 v[148:151], a[92:95], a[28:31], v[148:151]
    v_cvt_pk_bf16_f32 v164, v132, v133
    v_mfma_f32_16x16x32_bf16 v[152:155], a[80:83], a[32:35], v[216:219]
    v_exp_f32 v136, v136
    v_mfma_f32_16x16x32_bf16 v[152:155], a[84:87], a[36:39], v[152:155]
    v_exp_f32 v137, v137
    v_mfma_f32_16x16x32_bf16 v[152:155], a[88:91], a[40:43], v[152:155]
    v_cvt_pk_bf16_f32 v165, v134, v135
    v_mfma_f32_16x16x32_bf16 v[152:155], a[92:95], a[44:47], v[152:155]
    v_exp_f32 v138, v138
    v_mfma_f32_16x16x32_bf16 v[156:159], a[80:83], a[48:51], v[220:223]
    v_exp_f32 v139, v139
    v_mfma_f32_16x16x32_bf16 v[156:159], a[84:87], a[52:55], v[156:159]
    v_cvt_pk_bf16_f32 v168, v136, v137
    v_mfma_f32_16x16x32_bf16 v[156:159], a[88:91], a[56:59], v[156:159]
    v_mfma_f32_16x16x32_bf16 v[156:159], a[92:95], a[60:63], v[156:159]
    s_waitcnt vmcnt(16)
    s_barrier
    s_branch L_pro_xr
L_own:
    ds_write_b128 v211, v[64:67] offset:16384
    ds_write_b128 v211, v[68:71] offset:17408
    ds_write_b128 v211, v[72:75] offset:18432
    ds_write_b128 v211, v[76:79] offset:19456
    ds_write_b128 v211, v[80:83] offset:20480
    ds_write_b128 v211, v[84:87] offset:21504
    ds_write_b128 v211, v[88:91] offset:22528
    ds_write_b128 v211, v[92:95] offset:23552
    ds_write_b128 v211, v[96:99] offset:24576
    ds_write_b128 v211, v[100:103] offset:25600
    ds_write_b128 v211, v[104:107] offset:26624
    ds_write_b128 v211, v[108:111] offset:27648
    s_waitcnt lgkmcnt(8)
    ds_write_b128 v211, v[112:115] offset:28672
    ds_write_b128 v211, v[116:119] offset:29696
    ds_write_b128 v211, v[120:123] offset:30720
    ds_write_b128 v211, v[124:127] offset:31744
    s_waitcnt lgkmcnt(8)
    ds_write_b128 v211, v[0:3] offset:0
    ds_write_b128 v211, v[4:7] offset:1024
    ds_write_b128 v211, v[8:11] offset:2048
    ds_write_b128 v211, v[12:15] offset:3072
    s_waitcnt lgkmcnt(8)
    ds_write_b128 v211, v[16:19] offset:4096
    ds_write_b128 v211, v[20:23] offset:5120
    ds_write_b128 v211, v[24:27] offset:6144
    ds_write_b128 v211, v[28:31] offset:7168
    s_waitcnt lgkmcnt(8)
    ds_write_b128 v211, v[32:35] offset:8192
    ds_write_b128 v211, v[36:39] offset:9216
    ds_write_b128 v211, v[40:43] offset:10240
    ds_write_b128 v211, v[44:47] offset:11264
    s_waitcnt lgkmcnt(8)
    ds_write_b128 v211, v[48:51] offset:12288
    ds_write_b128 v211, v[52:55] offset:13312
    ds_write_b128 v211, v[56:59] offset:14336
    ds_write_b128 v211, v[60:63] offset:15360
    s_add_u32 s65, s80, 0
    buffer_store_dwordx4 v[132:135], v255, s[4:7], s65 offen offset:1024 sc1
    buffer_store_dwordx4 v[140:143], v255, s[4:7], s65 offen offset:3072 sc1
    s_add_u32 s65, s80, 4096
    buffer_store_dwordx4 v[148:151], v255, s[4:7], s65 offen offset:1024 sc1
    buffer_store_dwordx4 v[156:159], v255, s[4:7], s65 offen offset:3072 sc1
    s_branch L_own_r
L_pspin:
    s_mov_b32 s100, 0
L_pspin_l:
    s_add_u32 s100, s100, 1
    s_cmp_gt_u32 s100, 0x20000
    s_cbranch_scc1 L_pspin_r
    s_sleep 1
    buffer_load_dwordx4 v[160:163], v255, s[4:7], s92 offen offset:0 sc1
    buffer_load_dwordx4 v[164:167], v255, s[4:7], s92 offen offset:1024 sc1
    buffer_load_dwordx4 v[168:171], v255, s[4:7], s93 offen offset:0 sc1
    buffer_load_dwordx4 v[172:175], v255, s[4:7], s93 offen offset:1024 sc1
    buffer_load_dwordx4 v[176:179], v255, s[4:7], s94 offen offset:0 sc1
    buffer_load_dwordx4 v[180:183], v255, s[4:7], s94 offen offset:1024 sc1
    s_waitcnt vmcnt(0)
    v_max3_u32 v96, v160, v161, v162
    v_max3_u32 v96, v96, v163, v164
    v_max3_u32 v96, v96, v165, v166
    v_max3_u32 v96, v96, v167, v168
    v_max3_u32 v96, v96, v169, v170
    v_max3_u32 v96, v96, v171, v172
    v_max3_u32 v96, v96, v173, v174
    v_max3_u32 v96, v96, v175, v176
    v_max3_u32 v96, v96, v177, v178
    v_max3_u32 v96, v96, v179, v180
    v_max3_u32 v96, v96, v181, v182
    v_max_u32 v96, v96, v183
    v_cmp_eq_u32 vcc, -1, v96
    s_nop 0
    s_cbranch_vccnz L_pspin_l
    s_branch L_pspin_r
L_ev_odd:
    v_min_u32 v252, 27, v254
    v_lshlrev_b32 v252, 2, v252
    s_bfe_u32 s89, s2, 0x30003
    s_and_b32 s90, s2, 1
    s_lshl_b32 s90, s90, 3
    s_add_u32 s89, s89, s90
    s_sub_u32 s90, 15, s89
    s_min_u32 s89, s89, s90
    s_lshl_b32 s89, s89, 9
    s_bfe_u32 s90, s2, 0x20001
    s_mul_i32 s90, s90, 112
    s_add_u32 s89, s89, s90
    s_add_u32 s89, s89, 4096
    v_add_u32 v252, s89, v252
    buffer_load_dword v253, v252, s[4:7], 0 offen sc1
    s_lshr_b32 s89, s2, 3
    s_lshl_b32 s89, s89, 2
    s_add_u32 s89, s89, s56
    s_bfe_u32 s91, s2, 0x20001
    v_lshlrev_b32 v238, 7, v254
    s_lshl_b32 s90, s91, 7
    s_add_u32 s90, s90, s89
    s_lshl_b32 s90, s90, 13
    buffer_load_dword v237, v238, s[28:31], s90 offen
    s_mul_i32 s90, s91, 56
    s_add_u32 s90, s90, s89
    s_lshl_b32 s90, s90, 13
    s_cmp_lt_u32 s89, 56
    s_cselect_b32 s90, s90, 1073741824
    buffer_load_dword v232, v238, s[36:39], s90 offen
    s_getpc_b64 s[0:1]
L_pf3:
    s_sub_u32 s0, s0, L_pf3-L_final
    s_subb_u32 s1, s1, 0
    s_bfe_u32 s89, s2, 0x50003
    s_lshl_b32 s89, s89, 2
    s_add_u32 s89, s89, s56
    s_lshl_b32 s89, s89, 13
    v_lshl_add_u32 v238, v254, 7, s89
    v_min_u32 v238, L_code_end-L_final-4, v238
    v_mov_b32 v239, s1
    v_add_co_u32 v238, vcc, s0, v238
    s_nop 1
    v_addc_co_u32 v239, vcc, 0, v239, vcc
    global_load_dword v250, v[238:239], off
    s_branch L_ev_odd_r
L_ev_b:
    v_min_u32 v252, 27, v254
    v_lshlrev_b32 v252, 2, v252
    s_bfe_u32 s89, s2, 0x30003
    s_and_b32 s90, s2, 1
    s_lshl_b32 s90, s90, 3
    s_add_u32 s89, s89, s90
    s_sub_u32 s90, 15, s89
    s_min_u32 s89, s89, s90
    s_lshl_b32 s89, s89, 9
    s_bfe_u32 s90, s2, 0x20001
    s_mul_i32 s90, s90, 112
    s_add_u32 s89, s89, s90
    s_add_u32 s89, s89, 4096
    v_add_u32 v252, s89, v252
    buffer_load_dword v253, v252, s[4:7], 0 offen sc1
    s_lshr_b32 s89, s2, 3
    s_lshl_b32 s89, s89, 2
    s_add_u32 s89, s89, s56
    s_bfe_u32 s91, s2, 0x20001
    v_lshlrev_b32 v238, 7, v254
    s_lshl_b32 s90, s91, 7
    s_add_u32 s90, s90, s89
    s_lshl_b32 s90, s90, 13
    buffer_load_dword v237, v238, s[28:31], s90 offen
    s_mul_i32 s90, s91, 56
    s_add_u32 s90, s90, s89
    s_lshl_b32 s90, s90, 13
    s_cmp_lt_u32 s89, 56
    s_cselect_b32 s90, s90, 1073741824
    buffer_load_dword v232, v238, s[36:39], s90 offen
    s_branch L_ev_b_r
L_ev_fin:
    v_accvgpr_read_b32 v240, a104
    v_accvgpr_read_b32 v241, a108
    s_lshl_b32 s89, s57, 6
    s_add_u32 s89, s89, s71
    s_lshl_b32 s89, s89, 13
    s_add_u32 s64, s89, 46141440
    s_add_u32 s88, s64, 262144
    v_cmp_nge_f32 vcc, 0x6c800000, v240
    s_nop 0
    s_or_b64 s[66:67], s[66:67], vcc
    v_cmp_nle_f32 vcc, 0x17800000, v240
    v_rcp_f32 v240, v240
    s_or_b64 s[66:67], s[66:67], vcc
    v_cmp_nge_f32 vcc, 0x6c800000, v241
    s_nop 0
    s_or_b64 s[66:67], s[66:67], vcc
    v_cmp_nle_f32 vcc, 0x17800000, v241
    v_rcp_f32 v241, v241
    s_or_b64 s[66:67], s[66:67], vcc
    v_mul_f32 v64, v64, v240
    v_mul_f32 v65, v65, v240
    v_mul_f32 v66, v66, v240
    v_mul_f32 v67, v67, v240
    v_mul_f32 v68, v68, v240
    v_mul_f32 v69, v69, v240
    v_mul_f32 v70, v70, v240
    v_mul_f32 v71, v71, v240
    v_cvt_pk_bf16_f32 v64, v64, v65
    v_cvt_pk_bf16_f32 v65, v66, v67
    v_cvt_pk_bf16_f32 v66, v68, v69
    v_cvt_pk_bf16_f32 v67, v70, v71
    buffer_store_dwordx4 v[64:67], v255, s[4:7], s64 offen offset:0 sc1
    v_mul_f32 v72, v72, v240
    v_mul_f32 v73, v73, v240
    v_mul_f32 v74, v74, v240
    v_mul_f32 v75, v75, v240
    v_mul_f32 v76, v76, v240
    v_mul_f32 v77, v77, v240
    v_mul_f32 v78, v78, v240
    v_mul_f32 v79, v79, v240
    v_cvt_pk_bf16_f32 v72, v72, v73
    v_cvt_pk_bf16_f32 v73, v74, v75
    v_cvt_pk_bf16_f32 v74, v76, v77
    v_cvt_pk_bf16_f32 v75, v78, v79
    buffer_store_dwordx4 v[72:75], v255, s[4:7], s64 offen offset:1024 sc1
    v_mul_f32 v80, v80, v240
    v_mul_f32 v81, v81, v240
    v_mul_f32 v82, v82, v240
    v_mul_f32 v83, v83, v240
    v_mul_f32 v84, v84, v240
    v_mul_f32 v85, v85, v240
    v_mul_f32 v86, v86, v240
    v_mul_f32 v87, v87, v240
    v_cvt_pk_bf16_f32 v80, v80, v81
    v_cvt_pk_bf16_f32 v81, v82, v83
    v_cvt_pk_bf16_f32 v82, v84, v85
    v_cvt_pk_bf16_f32 v83, v86, v87
    buffer_store_dwordx4 v[80:83], v255, s[4:7], s88 offen offset:0 sc1
    v_mfma_f32_32x32x16_bf16 v[64:79], a[124:127], a[124:127], 0
    v_mul_f32 v88, v88, v240
    v_mul_f32 v89, v89, v240
    v_mul_f32 v90, v90, v240
    v_mul_f32 v91, v91, v240
    v_mul_f32 v92, v92, v240
    v_mul_f32 v93, v93, v240
    v_mul_f32 v94, v94, v240
    v_mul_f32 v95, v95, v240
    v_cvt_pk_bf16_f32 v88, v88, v89
    v_cvt_pk_bf16_f32 v89, v90, v91
    v_cvt_pk_bf16_f32 v90, v92, v93
    v_cvt_pk_bf16_f32 v91, v94, v95
    buffer_store_dwordx4 v[88:91], v255, s[4:7], s88 offen offset:1024 sc1
    v_mul_f32 v96, v96, v241
    v_mul_f32 v97, v97, v241
    v_mul_f32 v98, v98, v241
    v_mul_f32 v99, v99, v241
    v_mul_f32 v100, v100, v241
    v_mul_f32 v101, v101, v241
    v_mul_f32 v102, v102, v241
    v_mul_f32 v103, v103, v241
    v_cvt_pk_bf16_f32 v96, v96, v97
    v_cvt_pk_bf16_f32 v97, v98, v99
    v_cvt_pk_bf16_f32 v98, v100, v101
    v_cvt_pk_bf16_f32 v99, v102, v103
    buffer_store_dwordx4 v[96:99], v255, s[4:7], s64 offen offset:2048 sc1
    v_mfma_f32_32x32x16_bf16 v[80:95], a[124:127], a[124:127], 0
    v_mul_f32 v104, v104, v241
    v_mul_f32 v105, v105, v241
    v_mul_f32 v106, v106, v241
    v_mul_f32 v107, v107, v241
    v_mul_f32 v108, v108, v241
    v_mul_f32 v109, v109, v241
    v_mul_f32 v110, v110, v241
    v_mul_f32 v111, v111, v241
    v_cvt_pk_bf16_f32 v104, v104, v105
    v_cvt_pk_bf16_f32 v105, v106, v107
    v_cvt_pk_bf16_f32 v106, v108, v109
    v_cvt_pk_bf16_f32 v107, v110, v111
    buffer_store_dwordx4 v[104:107], v255, s[4:7], s64 offen offset:3072 sc1
    v_mul_f32 v112, v112, v241
    v_mul_f32 v113, v113, v241
    v_mul_f32 v114, v114, v241
    v_mul_f32 v115, v115, v241
    v_mul_f32 v116, v116, v241
    v_mul_f32 v117, v117, v241
    v_mul_f32 v118, v118, v241
    v_mul_f32 v119, v119, v241
    v_cvt_pk_bf16_f32 v112, v112, v113
    v_cvt_pk_bf16_f32 v113, v114, v115
    v_cvt_pk_bf16_f32 v114, v116, v117
    v_cvt_pk_bf16_f32 v115, v118, v119
    buffer_store_dwordx4 v[112:115], v255, s[4:7], s88 offen offset:2048 sc1
    v_mfma_f32_32x32x16_bf16 v[96:111], a[124:127], a[124:127], 0
    v_mul_f32 v120, v120, v241
    v_mul_f32 v121, v121, v241
    v_mul_f32 v122, v122, v241
    v_mul_f32 v123, v123, v241
    v_mul_f32 v124, v124, v241
    v_mul_f32 v125, v125, v241
    v_mul_f32 v126, v126, v241
    v_mul_f32 v127, v127, v241
    v_cvt_pk_bf16_f32 v120, v120, v121
    v_cvt_pk_bf16_f32 v121, v122, v123
    v_cvt_pk_bf16_f32 v122, v124, v125
    v_cvt_pk_bf16_f32 v123, v126, v127
    buffer_store_dwordx4 v[120:123], v255, s[4:7], s88 offen offset:3072 sc1
    v_mfma_f32_16x16x32_bf16 a[104:107], a[124:127], a[124:127], 0
    v_mfma_f32_16x16x32_bf16 a[108:111], a[124:127], a[124:127], 0
    v_mfma_f32_32x32x16_bf16 v[112:127], a[124:127], a[124:127], 0
    s_nop 9
    s_branch L_ev_fin_r
L_ev_even:
    v_cndmask_b32 v192, v235, v242, s[82:83]
    v_cndmask_b32 v193, v235, v242, s[84:85]
    v_cndmask_b32 v194, v235, v242, s[86:87]
    v_cndmask_b32 v195, v235, v242, s[92:93]
    v_mov_b32 v208, v235
    v_mov_b32 v209, v235
    v_mov_b32 v210, v235
    v_mov_b32 v211, v235
    v_cndmask_b32 v212, v235, v243, s[82:83]
    v_cndmask_b32 v213, v235, v243, s[84:85]
    v_cndmask_b32 v214, v235, v243, s[86:87]
    v_cndmask_b32 v215, v235, v243, s[92:93]
    s_branch L_ev_even_r
L_special:
    v_cndmask_b32 v200, v235, v244, s[82:83]
    v_cndmask_b32 v201, v235, v244, s[84:85]
    v_cndmask_b32 v202, v235, v244, s[86:87]
    v_cndmask_b32 v203, v235, v244, s[92:93]
    v_cndmask_b32 v220, v235, v245, s[82:83]
    v_cndmask_b32 v221, v235, v245, s[84:85]
    v_cndmask_b32 v222, v235, v245, s[86:87]
    v_cndmask_b32 v223, v235, v245, s[92:93]
    s_nop 0
    v_mfma_f32_16x16x32_bf16 v[136:139], a[64:67], a[32:35], v[200:203]
    s_add_u32 s81, s80, 32768
    ds_read_b128 a[80:83], v231 offset:36864
    v_cvt_pk_bf16_f32 v167, v150, v151
    v_mfma_f32_16x16x32_bf16 v[136:139], a[68:71], a[36:39], v[136:139]
    s_and_b32 s81, s81, 0x1ffff
    ds_read_b128 a[84:87], v231 offset:37888
    ds_read_b128 a[88:91], v231 offset:38912
    v_mfma_f32_16x16x32_bf16 v[136:139], a[72:75], a[40:43], v[136:139]
    v_exp_f32 v154, v154
    v_mfma_f32_16x16x32_bf16 v[136:139], a[76:79], a[44:47], v[136:139]
    buffer_load_dwordx4 v255, s[4:7], s78 offen offset:0 sc1 lds
    v_mfma_f32_16x16x32_bf16 v[140:143], a[64:67], a[48:51], v[204:207]
    v_exp_f32 v155, v155
    v_mfma_f32_16x16x32_bf16 v[140:143], a[68:71], a[52:55], v[140:143]
    ds_read_b128 a[92:95], v231 offset:39936
    v_cvt_pk_bf16_f32 v170, v152, v153
    v_mfma_f32_16x16x32_bf16 v[140:143], a[72:75], a[56:59], v[140:143]
    v_add_u32 v234, s81, v230
    v_mfma_f32_16x16x32_bf16 v[140:143], a[76:79], a[60:63], v[140:143]
    s_waitcnt lgkmcnt(0)
    v_exp_f32 v156, v156
    v_exp_f32 v157, v157
    v_cvt_pk_bf16_f32 v171, v154, v155
    v_exp_f32 v158, v158
    v_exp_f32 v159, v159
    v_cvt_pk_bf16_f32 v174, v156, v157
    v_cvt_pk_bf16_f32 v175, v158, v159
    v_mfma_f32_16x16x32_bf16 v[156:159], a[80:83], a[48:51], v[220:223]
    buffer_load_dwordx4 v255, s[4:7], s78 offen offset:1024 sc1 lds
    ds_read_b128 a[64:67], v233 offset:40960
    v_mfma_f32_16x16x32_bf16 v[156:159], a[84:87], a[52:55], v[156:159]
    buffer_load_dwordx4 v255, s[4:7], s78 offen offset:2048 sc1 lds
    ds_read_b128 a[68:71], v233 offset:41984
    v_mfma_f32_16x16x32_bf16 v[156:159], a[88:91], a[56:59], v[156:159]
    buffer_load_dwordx4 v255, s[4:7], s78 offen offset:3072 sc1 lds
    ds_read_b128 a[72:75], v233 offset:43008
    ds_read_b128 a[76:79], v233 offset:44032
    v_mfma_f32_16x16x32_bf16 v[156:159], a[92:95], a[60:63], v[156:159]
    s_waitcnt vmcnt(17) lgkmcnt(0)
    s_barrier
    v_mfma_f32_16x16x32_bf16 v[0:3], a[64:67], v[160:163], v[0:3]
    ds_read_b128 a[80:83], v234 offset:45056
    v_add_u32 v228, 16384, v228
    v_mfma_f32_16x16x32_bf16 v[32:35], a[64:67], v[164:167], v[32:35]
    s_cmp_lt_u32 s79, s94
    s_cselect_b32 s76, s75, 1073741824
    ds_read_b128 a[84:87], v234 offset:46080
    v_mfma_f32_16x16x32_bf16 v[64:67], a[64:67], v[168:171], v[64:67]
    s_add_u32 m0, s80, 32768
    v_exp_f32 v136, v136
    v_mfma_f32_16x16x32_bf16 v[96:99], a[64:67], v[172:175], v[96:99]
    ds_read_b128 a[88:91], v234 offset:47104
    v_add_u32 v231, s81, v228
    v_mfma_f32_16x16x32_bf16 v[4:7], a[68:71], v[160:163], v[4:7]
    v_exp_f32 v137, v137
    v_mfma_f32_16x16x32_bf16 v[36:39], a[68:71], v[164:167], v[36:39]
    ds_read_b128 a[92:95], v234 offset:48128
    v_add_u32 v233, s81, v229
    v_mfma_f32_16x16x32_bf16 v[68:71], a[68:71], v[168:171], v[68:71]
    v_exp_f32 v138, v138
    v_mfma_f32_16x16x32_bf16 v[100:103], a[68:71], v[172:175], v[100:103]
    ds_read_b128 a[0:3], v236 offset:0
    v_cvt_pk_bf16_f32 v184, v136, v137
    v_mfma_f32_16x16x32_bf16 v[8:11], a[72:75], v[160:163], v[8:11]
    ds_read_b128 a[4:7], v236 offset:1024
    ds_read_b128 a[8:11], v236 offset:2048
    v_mfma_f32_16x16x32_bf16 v[40:43], a[72:75], v[164:167], v[40:43]
    v_exp_f32 v139, v139
    v_mfma_f32_16x16x32_bf16 v[72:75], a[72:75], v[168:171], v[72:75]
    buffer_load_dwordx4 v255, s[4:7], s76 offen offset:0 sc1 lds
    v_mfma_f32_16x16x32_bf16 v[104:107], a[72:75], v[172:175], v[104:107]
    v_exp_f32 v140, v140
    v_mfma_f32_16x16x32_bf16 v[12:15], a[76:79], v[160:163], v[12:15]
    ds_read_b128 a[12:15], v236 offset:3072
    v_cvt_pk_bf16_f32 v185, v138, v139
    v_mfma_f32_16x16x32_bf16 v[44:47], a[76:79], v[164:167], v[44:47]
    ds_read_b128 a[16:19], v236 offset:4096
    ds_read_b128 a[20:23], v236 offset:5120
    ds_read_b128 a[24:27], v236 offset:6144
    ds_read_b128 a[28:31], v236 offset:7168
    v_mfma_f32_16x16x32_bf16 v[76:79], a[76:79], v[168:171], v[76:79]
    buffer_load_dwordx4 v255, s[4:7], s76 offen offset:1024 sc1 lds
    ds_read_b128 a[32:35], v236 offset:8192
    v_mfma_f32_16x16x32_bf16 v[108:111], a[76:79], v[172:175], v[108:111]
    s_waitcnt lgkmcnt(0)
    v_exp_f32 v141, v141
    v_mfma_f32_16x16x32_bf16 v[16:19], a[80:83], v[160:163], v[16:19]
    v_exp_f32 v142, v142
    v_mfma_f32_16x16x32_bf16 v[48:51], a[80:83], v[164:167], v[48:51]
    buffer_load_dwordx4 v255, s[4:7], s76 offen offset:2048 sc1 lds
    v_mfma_f32_16x16x32_bf16 v[80:83], a[80:83], v[168:171], v[80:83]
    ds_read_b128 a[64:67], v231 offset:32768
    v_cvt_pk_bf16_f32 v188, v140, v141
    v_mfma_f32_16x16x32_bf16 v[112:115], a[80:83], v[172:175], v[112:115]
    v_exp_f32 v143, v143
    v_mfma_f32_16x16x32_bf16 v[20:23], a[84:87], v[160:163], v[20:23]
    buffer_load_dwordx4 v255, s[4:7], s76 offen offset:3072 sc1 lds
    v_mfma_f32_16x16x32_bf16 v[52:55], a[84:87], v[164:167], v[52:55]
    s_sub_u32 s78, s79, s60
    v_exp_f32 v156, v156
    v_mfma_f32_16x16x32_bf16 v[84:87], a[84:87], v[168:171], v[84:87]
    s_add_u32 s76, m0, 16384
    ds_read_b128 a[68:71], v231 offset:33792
    v_cvt_pk_bf16_f32 v189, v142, v143
    v_mfma_f32_16x16x32_bf16 v[116:119], a[84:87], v[172:175], v[116:119]
    v_exp_f32 v157, v157
    v_mfma_f32_16x16x32_bf16 v[24:27], a[88:91], v[160:163], v[24:27]
    ds_read_b128 a[72:75], v231 offset:34816
    ds_read_b128 a[76:79], v231 offset:35840
    v_mfma_f32_16x16x32_bf16 v[56:59], a[88:91], v[164:167], v[56:59]
    v_exp_f32 v158, v158
    v_mfma_f32_16x16x32_bf16 v[88:91], a[88:91], v[168:171], v[88:91]
    ds_read_b128 a[36:39], v236 offset:9216
    v_cvt_pk_bf16_f32 v190, v156, v157
    v_mfma_f32_16x16x32_bf16 v[120:123], a[88:91], v[172:175], v[120:123]
    v_exp_f32 v159, v159
    v_mfma_f32_16x16x32_bf16 v[28:31], a[92:95], v[160:163], v[28:31]
    s_cmp_lt_u32 s78, s61
    s_cselect_b32 s78, s77, 1073741824
    s_cselect_b32 m0, s76, 0x30000
    v_mfma_f32_16x16x32_bf16 v[60:63], a[92:95], v[164:167], v[60:63]
    s_nop 0
    ds_read_b128 a[40:43], v236 offset:10240
    v_cvt_pk_bf16_f32 v191, v158, v159
    v_mfma_f32_16x16x32_bf16 v[92:95], a[92:95], v[168:171], v[92:95]
    s_add_u32 s75, s75, 16384
    ds_read_b128 a[44:47], v236 offset:11264
    v_mov_b32 v186, 0
    v_mfma_f32_16x16x32_bf16 v[124:127], a[92:95], v[172:175], v[124:127]
    s_sub_u32 s77, s77, 16384
    ds_read_b128 a[48:51], v236 offset:12288
    v_mov_b32 v187, 0
    v_mfma_f32_16x16x32_bf16 a[96:99], a[112:115], v[160:163], a[96:99]
    ds_read_b128 a[52:55], v236 offset:13312
    ds_read_b128 a[56:59], v236 offset:14336
    v_mfma_f32_16x16x32_bf16 a[100:103], a[112:115], v[164:167], a[100:103]
    buffer_store_dwordx4 a[116:119], v255, s[12:15], s99 offen sc1
    v_mfma_f32_16x16x32_bf16 a[104:107], a[112:115], v[168:171], a[104:107]
    s_add_u32 s99, s99, 1024
    s_add_u32 s79, s79, 1
    ds_read_b128 a[60:63], v236 offset:15360
    v_mfma_f32_16x16x32_bf16 a[108:111], a[112:115], v[172:175], a[108:111]
    s_waitcnt lgkmcnt(0)
    s_cmp_lg_u32 s59, 0
    s_cbranch_scc1 L_rd_a
L_rd_a_r:
    v_mfma_f32_16x16x32_bf16 v[136:139], a[64:67], a[32:35], v[200:203]
    s_add_u32 s80, s81, 32768
    ds_read_b128 a[80:83], v231 offset:36864
    ds_read_b128 a[84:87], v231 offset:37888
    v_accvgpr_read_b32 v240, a96
    v_accvgpr_read_b32 v241, a100
    v_mfma_f32_16x16x32_bf16 v[136:139], a[68:71], a[36:39], v[136:139]
    s_and_b32 s80, s80, 0x1ffff
    s_lshl_b32 s89, s57, 6
    s_add_u32 s89, s89, s71
    s_lshl_b32 s89, s89, 13
    s_add_u32 s64, s89, 46137344
    s_add_u32 s88, s64, 262144
    v_cmp_nge_f32 vcc, 0x6c800000, v240
    s_nop 0
    s_or_b64 s[66:67], s[66:67], vcc
    v_cmp_nle_f32 vcc, 0x17800000, v240
    v_rcp_f32 v240, v240
    s_or_b64 s[66:67], s[66:67], vcc
    v_cmp_nge_f32 vcc, 0x6c800000, v241
    s_nop 0
    s_or_b64 s[66:67], s[66:67], vcc
    v_cmp_nle_f32 vcc, 0x17800000, v241
    v_rcp_f32 v241, v241
    s_or_b64 s[66:67], s[66:67], vcc
    buffer_load_dwordx4 v255, s[4:7], s78 offen offset:0 sc1 lds
    ds_read_b128 a[88:91], v231 offset:38912
    ds_read_b128 a[92:95], v231 offset:39936
    v_mul_f32 v0, v0, v240
    v_mul_f32 v1, v1, v240
    v_mul_f32 v2, v2, v240
    v_mul_f32 v3, v3, v240
    v_mul_f32 v4, v4, v240
    v_mul_f32 v5, v5, v240
    v_mul_f32 v6, v6, v240
    v_mfma_f32_16x16x32_bf16 v[136:139], a[72:75], a[40:43], v[136:139]
    v_add_u32 v234, s80, v230
    v_mul_f32 v7, v7, v240
    v_cvt_pk_bf16_f32 v0, v0, v1
    v_cvt_pk_bf16_f32 v1, v2, v3
    v_cvt_pk_bf16_f32 v2, v4, v5
    v_cvt_pk_bf16_f32 v3, v6, v7
    v_mfma_f32_16x16x32_bf16 v[136:139], a[76:79], a[44:47], v[136:139]
    buffer_store_dwordx4 v[0:3], v255, s[4:7], s64 offen offset:0 sc1
    buffer_load_dwordx4 v255, s[4:7], s78 offen offset:1024 sc1 lds
    v_mul_f32 v8, v8, v240
    v_mul_f32 v9, v9, v240
    v_mul_f32 v10, v10, v240
    v_mul_f32 v11, v11, v240
    v_mul_f32 v12, v12, v240
    v_mfma_f32_16x16x32_bf16 v[140:143], a[64:67], a[48:51], v[204:207]
    v_mul_f32 v13, v13, v240
    v_mul_f32 v14, v14, v240
    v_mul_f32 v15, v15, v240
    v_cvt_pk_bf16_f32 v8, v8, v9
    v_cvt_pk_bf16_f32 v9, v10, v11
    v_cvt_pk_bf16_f32 v10, v12, v13
    v_mfma_f32_16x16x32_bf16 v[140:143], a[68:71], a[52:55], v[140:143]
    buffer_load_dwordx4 v255, s[4:7], s78 offen offset:2048 sc1 lds
    v_cvt_pk_bf16_f32 v11, v14, v15
    v_mfma_f32_16x16x32_bf16 v[140:143], a[72:75], a[56:59], v[140:143]
    buffer_store_dwordx4 v[8:11], v255, s[4:7], s64 offen offset:1024 sc1
    v_mul_f32 v16, v16, v240
    v_mul_f32 v17, v17, v240
    v_mul_f32 v18, v18, v240
    v_mul_f32 v19, v19, v240
    v_mul_f32 v20, v20, v240
    v_mul_f32 v21, v21, v240
    v_mul_f32 v22, v22, v240
    v_mul_f32 v23, v23, v240
    v_cvt_pk_bf16_f32 v16, v16, v17
    v_cvt_pk_bf16_f32 v17, v18, v19
    v_mfma_f32_16x16x32_bf16 v[140:143], a[76:79], a[60:63], v[140:143]
    s_waitcnt lgkmcnt(0)
    buffer_load_dwordx4 v255, s[4:7], s78 offen offset:3072 sc1 lds
    v_cvt_pk_bf16_f32 v18, v20, v21
    v_cvt_pk_bf16_f32 v19, v22, v23
    v_mfma_f32_16x16x32_bf16 v[156:159], a[80:83], a[48:51], v[220:223]
    buffer_store_dwordx4 v[16:19], v255, s[4:7], s88 offen offset:0 sc1
    v_mfma_f32_32x32x16_bf16 v[0:15], a[124:127], a[124:127], 0
    ds_read_b128 a[64:67], v233 offset:40960
    ds_read_b128 a[68:71], v233 offset:41984
    v_mul_f32 v24, v24, v240
    v_mul_f32 v25, v25, v240
    v_mul_f32 v26, v26, v240
    v_mul_f32 v27, v27, v240
    v_mul_f32 v28, v28, v240
    v_mul_f32 v29, v29, v240
    v_mul_f32 v30, v30, v240
    v_mfma_f32_16x16x32_bf16 v[156:159], a[84:87], a[52:55], v[156:159]
    ds_read_b128 a[72:75], v233 offset:43008
    ds_read_b128 a[76:79], v233 offset:44032
    v_mul_f32 v31, v31, v240
    v_cvt_pk_bf16_f32 v24, v24, v25
    v_cvt_pk_bf16_f32 v25, v26, v27
    v_cvt_pk_bf16_f32 v26, v28, v29
    v_cvt_pk_bf16_f32 v27, v30, v31
    v_mfma_f32_16x16x32_bf16 v[156:159], a[88:91], a[56:59], v[156:159]
    buffer_store_dwordx4 v[24:27], v255, s[4:7], s88 offen offset:1024 sc1
    v_mul_f32 v32, v32, v241
    v_mul_f32 v33, v33, v241
    v_mul_f32 v34, v34, v241
    v_mul_f32 v35, v35, v241
    v_mul_f32 v36, v36, v241
    v_mfma_f32_16x16x32_bf16 v[156:159], a[92:95], a[60:63], v[156:159]
    s_waitcnt vmcnt(21) lgkmcnt(0)
    s_bitcmp1_b64 s[62:63], s79
    s_cbranch_scc1 L_ev_b
L_ev_b_r:
    s_barrier
    v_mfma_f32_16x16x32_bf16 v[64:67], a[64:67], v[184:187], v[64:67]
    s_cmp_lt_u32 s79, s94
    s_cselect_b32 s76, s75, 1073741824
    ds_read_b128 a[80:83], v234 offset:45056
    ds_read_b128 a[84:87], v234 offset:46080
    v_add_u32 v229, 16384, v229
    v_mul_f32 v37, v37, v241
    v_exp_f32 v136, v136
    v_mul_f32 v38, v38, v241
    v_mul_f32 v39, v39, v241
    v_add_u32 v230, 16384, v230
    v_exp_f32 v137, v137
    v_mfma_f32_16x16x32_bf16 v[96:99], a[64:67], v[188:191], v[96:99]
    s_add_u32 m0, s81, 32768
    ds_read_b128 a[88:91], v234 offset:47104
    ds_read_b128 a[92:95], v234 offset:48128
    v_cvt_pk_bf16_f32 v32, v32, v33
    v_cvt_pk_bf16_f32 v33, v34, v35
    v_add_u32 v231, s80, v228
    v_exp_f32 v138, v138
    v_cvt_pk_bf16_f32 v34, v36, v37
    v_mfma_f32_16x16x32_bf16 v[68:71], a[68:71], v[184:187], v[68:71]
    buffer_load_dwordx4 v255, s[4:7], s76 offen offset:0 sc1 lds
    v_cvt_pk_bf16_f32 v35, v38, v39
    v_add_u32 v233, s80, v229
    v_cvt_pk_bf16_f32 v168, v136, v137
    v_mfma_f32_16x16x32_bf16 v[100:103], a[68:71], v[188:191], v[100:103]
    buffer_store_dwordx4 v[32:35], v255, s[4:7], s64 offen offset:2048 sc1
    v_mfma_f32_32x32x16_bf16 v[16:31], a[124:127], a[124:127], 0
    v_mul_f32 v40, v40, v241
    v_exp_f32 v139, v139
    v_mul_f32 v41, v41, v241
    v_mul_f32 v42, v42, v241
    v_mfma_f32_16x16x32_bf16 v[72:75], a[72:75], v[184:187], v[72:75]
    buffer_load_dwordx4 v255, s[4:7], s76 offen offset:1024 sc1 lds
    v_mul_f32 v43, v43, v241
    v_exp_f32 v140, v140
    v_mul_f32 v44, v44, v241
    v_mul_f32 v45, v45, v241
    v_mfma_f32_16x16x32_bf16 v[104:107], a[72:75], v[188:191], v[104:107]
    buffer_load_dwordx4 v255, s[4:7], s76 offen offset:2048 sc1 lds
    v_cvt_pk_bf16_f32 v169, v138, v139
    v_mul_f32 v46, v46, v241
    v_mul_f32 v47, v47, v241
    v_cvt_pk_bf16_f32 v40, v40, v41
    v_exp_f32 v141, v141
    v_mfma_f32_16x16x32_bf16 v[76:79], a[76:79], v[184:187], v[76:79]
    v_cvt_pk_bf16_f32 v41, v42, v43
    v_cvt_pk_bf16_f32 v42, v44, v45
    v_exp_f32 v142, v142
    v_cvt_pk_bf16_f32 v43, v46, v47
    v_mfma_f32_16x16x32_bf16 v[108:111], a[76:79], v[188:191], v[108:111]
    s_waitcnt lgkmcnt(0)
    buffer_load_dwordx4 v255, s[4:7], s76 offen offset:3072 sc1 lds
    buffer_store_dwordx4 v[40:43], v255, s[4:7], s64 offen offset:3072 sc1
    v_mul_f32 v48, v48, v241
    v_cvt_pk_bf16_f32 v172, v140, v141
    v_mul_f32 v49, v49, v241
    v_mfma_f32_16x16x32_bf16 v[80:83], a[80:83], v[184:187], v[80:83]
    s_sub_u32 s78, s79, s60
    ds_read_b128 a[64:67], v231 offset:32768
    ds_read_b128 a[68:71], v231 offset:33792
    v_mul_f32 v50, v50, v241
    v_exp_f32 v143, v143
    v_mul_f32 v51, v51, v241
    v_mul_f32 v52, v52, v241
    v_mfma_f32_16x16x32_bf16 v[112:115], a[80:83], v[188:191], v[112:115]
    s_nop 0
    s_add_u32 s76, m0, 16384
    ds_read_b128 a[72:75], v231 offset:34816
    ds_read_b128 a[76:79], v231 offset:35840
    v_mul_f32 v53, v53, v241
    v_mul_f32 v54, v54, v241
    v_mfma_f32_16x16x32_bf16 v[84:87], a[84:87], v[184:187], v[84:87]
    v_mul_f32 v55, v55, v241
    v_cvt_pk_bf16_f32 v173, v142, v143
    v_cvt_pk_bf16_f32 v48, v48, v49
    v_cvt_pk_bf16_f32 v49, v50, v51
    v_mfma_f32_16x16x32_bf16 v[116:119], a[84:87], v[188:191], v[116:119]
    s_cmp_lt_u32 s78, s61
    s_cselect_b32 s78, s77, 1073741824
    s_cselect_b32 m0, s76, 0x30000
    v_cvt_pk_bf16_f32 v50, v52, v53
    v_mov_b32 v200, v248
    v_cvt_pk_bf16_f32 v51, v54, v55
    v_mov_b32 v201, v248
    v_mfma_f32_16x16x32_bf16 v[88:91], a[88:91], v[184:187], v[88:91]
    s_add_u32 s75, s75, 16384
    buffer_store_dwordx4 v[48:51], v255, s[4:7], s88 offen offset:2048 sc1
    v_mfma_f32_32x32x16_bf16 v[32:47], a[124:127], a[124:127], 0
    v_mul_f32 v56, v56, v241
    v_mul_f32 v57, v57, v241
    v_mov_b32 v202, v248
    v_mfma_f32_16x16x32_bf16 v[120:123], a[88:91], v[188:191], v[120:123]
    v_mul_f32 v58, v58, v241
    v_mul_f32 v59, v59, v241
    v_mov_b32 v203, v248
    v_mul_f32 v60, v60, v241
    v_mfma_f32_16x16x32_bf16 v[92:95], a[92:95], v[184:187], v[92:95]
    s_sub_u32 s77, s77, 16384
    v_mul_f32 v61, v61, v241
    v_mul_f32 v62, v62, v241
    v_mov_b32 v220, v249
    v_mul_f32 v63, v63, v241
    v_mfma_f32_16x16x32_bf16 v[124:127], a[92:95], v[188:191], v[124:127]
    s_add_u32 s79, s79, 1
    v_cvt_pk_bf16_f32 v56, v56, v57
    v_mov_b32 v221, v249
    v_cvt_pk_bf16_f32 v57, v58, v59
    v_cvt_pk_bf16_f32 v58, v60, v61
    v_mfma_f32_16x16x32_bf16 a[104:107], a[112:115], v[184:187], a[104:107]
    v_cvt_pk_bf16_f32 v59, v62, v63
    v_mov_b32 v222, v249
    v_mfma_f32_16x16x32_bf16 a[108:111], a[112:115], v[188:191], a[108:111]
    buffer_store_dwordx4 v[56:59], v255, s[4:7], s88 offen offset:3072 sc1
    v_mfma_f32_16x16x32_bf16 a[96:99], a[124:127], a[124:127], 0
    v_mfma_f32_16x16x32_bf16 a[100:103], a[124:127], a[124:127], 0
    v_mfma_f32_32x32x16_bf16 v[48:63], a[124:127], a[124:127], 0
    v_mov_b32 v223, v249
    s_waitcnt lgkmcnt(0)
    s_cmp_lg_u32 s59, 0
    s_cbranch_scc1 L_rd_b
L_rd_b_r:
    s_mov_b32 s65, 34
    s_cmp_eq_u32 s79, 34
    s_cbranch_scc1 L_to_final
    v_mfma_f32_16x16x32_bf16 v[128:131], a[64:67], a[0:3], v[192:195]
    s_add_u32 s81, s80, 32768
    ds_read_b128 a[80:83], v231 offset:36864
    ds_read_b128 a[84:87], v231 offset:37888
    v_exp_f32 v156, v156
    v_accvgpr_read_b32 v240, a104
    v_exp_f32 v157, v157
    v_accvgpr_read_b32 v241, a108
    v_exp_f32 v158, v158
    v_mfma_f32_16x16x32_bf16 v[128:131], a[68:71], a[4:7], v[128:131]
    s_and_b32 s81, s81, 0x1ffff
    buffer_load_dwordx4 v255, s[4:7], s78 offen offset:0 sc1 lds
    s_lshl_b32 s89, s57, 6
    s_add_u32 s89, s89, s71
    s_lshl_b32 s89, s89, 13
    s_add_u32 s64, s89, 46141440
    s_add_u32 s88, s64, 262144
    v_cmp_nge_f32 vcc, 0x6c800000, v240
    s_nop 0
    s_or_b64 s[66:67], s[66:67], vcc
    v_cmp_nle_f32 vcc, 0x17800000, v240
    v_rcp_f32 v240, v240
    s_or_b64 s[66:67], s[66:67], vcc
    ds_read_b128 a[88:91], v231 offset:38912
    ds_read_b128 a[92:95], v231 offset:39936
    v_cvt_pk_bf16_f32 v174, v156, v157
    v_exp_f32 v159, v159
    v_mfma_f32_16x16x32_bf16 v[128:131], a[72:75], a[8:11], v[128:131]
    s_nop 0
    v_cmp_nge_f32 vcc, 0x6c800000, v241
    s_nop 0
    s_or_b64 s[66:67], s[66:67], vcc
    v_cmp_nle_f32 vcc, 0x17800000, v241
    v_rcp_f32 v241, v241
    s_or_b64 s[66:67], s[66:67], vcc
    v_add_u32 v234, s81, v230
    v_cvt_pk_bf16_f32 v175, v158, v159
    v_mfma_f32_16x16x32_bf16 v[128:131], a[76:79], a[12:15], v[128:131]
    v_mul_f32 v64, v64, v240
    v_mov_b32 v170, 0
    v_mul_f32 v65, v65, v240
    v_mov_b32 v171, 0
    v_mul_f32 v66, v66, v240
    v_mfma_f32_16x16x32_bf16 v[132:135], a[64:67], a[16:19], v[196:199]
    v_mul_f32 v67, v67, v240
    v_mul_f32 v68, v68, v240
    v_mfma_f32_16x16x32_bf16 v[132:135], a[68:71], a[20:23], v[132:135]
    v_mul_f32 v69, v69, v240
    v_mul_f32 v70, v70, v240
    v_mul_f32 v71, v71, v240
    v_mfma_f32_16x16x32_bf16 v[132:135], a[72:75], a[24:27], v[132:135]
    v_cvt_pk_bf16_f32 v64, v64, v65
    v_cvt_pk_bf16_f32 v65, v66, v67
    v_mfma_f32_16x16x32_bf16 v[132:135], a[76:79], a[28:31], v[132:135]
    buffer_load_dwordx4 v255, s[4:7], s78 offen offset:1024 sc1 lds
    v_cvt_pk_bf16_f32 v66, v68, v69
    v_cvt_pk_bf16_f32 v67, v70, v71
    v_mfma_f32_16x16x32_bf16 v[136:139], a[64:67], a[32:35], v[200:203]
    buffer_store_dwordx4 v[64:67], v255, s[4:7], s64 offen offset:0 sc1
    v_mul_f32 v96, v96, v241
    v_mul_f32 v97, v97, v241
    v_mfma_f32_16x16x32_bf16 v[136:139], a[68:71], a[36:39], v[136:139]
    v_mul_f32 v98, v98, v241
    v_mul_f32 v99, v99, v241
    v_mfma_f32_16x16x32_bf16 v[136:139], a[72:75], a[40:43], v[136:139]
    v_mul_f32 v100, v100, v241
    v_mul_f32 v101, v101, v241
    v_mfma_f32_16x16x32_bf16 v[136:139], a[76:79], a[44:47], v[136:139]
    v_mul_f32 v102, v102, v241
    v_mul_f32 v103, v103, v241
    v_cvt_pk_bf16_f32 v96, v96, v97
    v_mfma_f32_16x16x32_bf16 v[140:143], a[64:67], a[48:51], v[204:207]
    v_cvt_pk_bf16_f32 v97, v98, v99
    v_cvt_pk_bf16_f32 v98, v100, v101
    v_mfma_f32_16x16x32_bf16 v[140:143], a[68:71], a[52:55], v[140:143]
    buffer_load_dwordx4 v255, s[4:7], s78 offen offset:2048 sc1 lds
    v_cvt_pk_bf16_f32 v99, v102, v103
    v_mfma_f32_16x16x32_bf16 v[140:143], a[72:75], a[56:59], v[140:143]
    buffer_store_dwordx4 v[96:99], v255, s[4:7], s64 offen offset:2048 sc1
    v_mul_f32 v72, v72, v240
    v_exp_f32 v128, v128
    v_mul_f32 v73, v73, v240
    v_mfma_f32_16x16x32_bf16 v[140:143], a[76:79], a[60:63], v[140:143]
    s_waitcnt lgkmcnt(0)
    v_mul_f32 v74, v74, v240
    v_exp_f32 v129, v129
    v_mul_f32 v75, v75, v240
    v_mfma_f32_16x16x32_bf16 v[148:151], a[80:83], a[16:19], v[212:215]
    ds_read_b128 a[64:67], v233 offset:40960
    ds_read_b128 a[68:71], v233 offset:41984
    v_mul_f32 v76, v76, v240
    v_exp_f32 v130, v130
    v_mul_f32 v77, v77, v240
    v_mfma_f32_16x16x32_bf16 v[148:151], a[84:87], a[20:23], v[148:151]
    ds_read_b128 a[72:75], v233 offset:43008
    ds_read_b128 a[76:79], v233 offset:44032
    v_mul_f32 v78, v78, v240
    v_mul_f32 v79, v79, v240
    v_exp_f32 v131, v131
    v_mfma_f32_16x16x32_bf16 v[148:151], a[88:91], a[24:27], v[148:151]
    v_cvt_pk_bf16_f32 v72, v72, v73
    v_cvt_pk_bf16_f32 v73, v74, v75
    v_cvt_pk_bf16_f32 v176, v128, v129
    v_mfma_f32_16x16x32_bf16 v[148:151], a[92:95], a[28:31], v[148:151]
    buffer_load_dwordx4 v255, s[4:7], s78 offen offset:3072 sc1 lds
    v_cvt_pk_bf16_f32 v74, v76, v77
    v_cvt_pk_bf16_f32 v75, v78, v79
    v_mfma_f32_16x16x32_bf16 v[152:155], a[80:83], a[32:35], v[216:219]
    buffer_store_dwordx4 v[72:75], v255, s[4:7], s64 offen offset:1024 sc1
    v_exp_f32 v132, v132
    v_mul_f32 v104, v104, v241
    v_mfma_f32_16x16x32_bf16 v[152:155], a[84:87], a[36:39], v[152:155]
    v_mul_f32 v105, v105, v241
    v_exp_f32 v133, v133
    v_mul_f32 v106, v106, v241
    v_mfma_f32_16x16x32_bf16 v[152:155], a[88:91], a[40:43], v[152:155]
    v_mul_f32 v107, v107, v241
    v_cvt_pk_bf16_f32 v177, v130, v131
    v_mul_f32 v108, v108, v241
    v_mfma_f32_16x16x32_bf16 v[152:155], a[92:95], a[44:47], v[152:155]
    v_mul_f32 v109, v109, v241
    v_mul_f32 v110, v110, v241
    v_exp_f32 v134, v134
    v_mfma_f32_16x16x32_bf16 v[156:159], a[80:83], a[48:51], v[220:223]
    v_mul_f32 v111, v111, v241
    v_cvt_pk_bf16_f32 v104, v104, v105
    v_exp_f32 v135, v135
    v_mfma_f32_16x16x32_bf16 v[156:159], a[84:87], a[52:55], v[156:159]
    v_cvt_pk_bf16_f32 v105, v106, v107
    v_cvt_pk_bf16_f32 v106, v108, v109
    v_mfma_f32_16x16x32_bf16 v[156:159], a[88:91], a[56:59], v[156:159]
    v_cvt_pk_bf16_f32 v107, v110, v111
    buffer_store_dwordx4 v[104:107], v255, s[4:7], s64 offen offset:3072 sc1
    v_mfma_f32_16x16x32_bf16 v[156:159], a[92:95], a[60:63], v[156:159]
    s_waitcnt vmcnt(29) lgkmcnt(0)
    s_barrier
    v_mfma_f32_16x16x32_bf16 v[64:67], a[64:67], v[168:171], 0
    s_cmp_lt_u32 s79, s94
    s_cselect_b32 s76, s75, 1073741824
    ds_read_b128 a[80:83], v234 offset:45056
    ds_read_b128 a[84:87], v234 offset:46080
    v_add_u32 v231, s81, v228
    v_mul_f32 v80, v80, v240
    v_mul_f32 v81, v81, v240
    v_mul_f32 v82, v82, v240
    v_mul_f32 v83, v83, v240
    v_mul_f32 v84, v84, v240
    v_mul_f32 v85, v85, v240
    v_mfma_f32_16x16x32_bf16 v[96:99], a[64:67], v[172:175], 0
    s_add_u32 m0, s80, 32768
    ds_read_b128 a[88:91], v234 offset:47104
    ds_read_b128 a[92:95], v234 offset:48128
    v_mul_f32 v86, v86, v240
    v_mul_f32 v87, v87, v240
    v_add_u32 v233, s81, v229
    v_cvt_pk_bf16_f32 v80, v80, v81
    v_cvt_pk_bf16_f32 v81, v82, v83
    v_cvt_pk_bf16_f32 v82, v84, v85
    v_mfma_f32_16x16x32_bf16 v[68:71], a[68:71], v[168:171], 0
    buffer_load_dwordx4 v255, s[4:7], s76 offen offset:0 sc1 lds
    v_cvt_pk_bf16_f32 v83, v86, v87
    v_mfma_f32_16x16x32_bf16 v[100:103], a[68:71], v[172:175], 0
    buffer_store_dwordx4 v[80:83], v255, s[4:7], s88 offen offset:0 sc1
    buffer_load_dwordx4 v255, s[4:7], s76 offen offset:1024 sc1 lds
    v_mul_f32 v112, v112, v241
    v_mul_f32 v113, v113, v241
    v_mul_f32 v114, v114, v241
    v_mul_f32 v115, v115, v241
    v_mul_f32 v116, v116, v241
    v_mul_f32 v117, v117, v241
    v_mul_f32 v118, v118, v241
    v_mul_f32 v119, v119, v241
    v_mfma_f32_16x16x32_bf16 v[72:75], a[72:75], v[168:171], 0
    buffer_load_dwordx4 v255, s[4:7], s76 offen offset:2048 sc1 lds
    v_cvt_pk_bf16_f32 v180, v132, v133
    v_cvt_pk_bf16_f32 v112, v112, v113
    v_cvt_pk_bf16_f32 v113, v114, v115
    v_exp_f32 v136, v136
    v_cvt_pk_bf16_f32 v114, v116, v117
    v_cvt_pk_bf16_f32 v115, v118, v119
    v_exp_f32 v137, v137
    v_mfma_f32_16x16x32_bf16 v[104:107], a[72:75], v[172:175], 0
    buffer_store_dwordx4 v[112:115], v255, s[4:7], s88 offen offset:2048 sc1
    v_mul_f32 v88, v88, v240
    v_mul_f32 v89, v89, v240
    v_cvt_pk_bf16_f32 v181, v134, v135
    v_mul_f32 v90, v90, v240
    v_mul_f32 v91, v91, v240
    v_exp_f32 v138, v138
    v_mul_f32 v92, v92, v240
    v_mul_f32 v93, v93, v240
    v_exp_f32 v139, v139
    v_mfma_f32_16x16x32_bf16 v[76:79], a[76:79], v[168:171], 0
    buffer_load_dwordx4 v255, s[4:7], s76 offen offset:3072 sc1 lds
    v_mul_f32 v94, v94, v240
    v_mul_f32 v95, v95, v240
    v_cvt_pk_bf16_f32 v184, v136, v137
    v_cvt_pk_bf16_f32 v88, v88, v89
    v_cvt_pk_bf16_f32 v89, v90, v91
    v_exp_f32 v140, v140
    v_cvt_pk_bf16_f32 v90, v92, v93
    v_mfma_f32_16x16x32_bf16 v[108:111], a[76:79], v[172:175], 0
    s_waitcnt lgkmcnt(0)
    s_sub_u32 s78, s79, s60
    v_cvt_pk_bf16_f32 v91, v94, v95
    v_exp_f32 v141, v141
    v_cvt_pk_bf16_f32 v185, v138, v139
    v_exp_f32 v142, v142
    v_mfma_f32_16x16x32_bf16 v[80:83], a[80:83], v[168:171], 0
    s_add_u32 s76, m0, 16384
    buffer_store_dwordx4 v[88:91], v255, s[4:7], s88 offen offset:1024 sc1
    ds_read_b128 a[64:67], v231 offset:32768
    ds_read_b128 a[68:71], v231 offset:33792
    v_mul_f32 v120, v120, v241
    v_mul_f32 v121, v121, v241
    v_mul_f32 v122, v122, v241
    v_mul_f32 v123, v123, v241
    v_mul_f32 v124, v124, v241
    v_exp_f32 v143, v143
    v_mul_f32 v125, v125, v241
    v_mul_f32 v126, v126, v241
    v_cvt_pk_bf16_f32 v188, v140, v141
    v_mul_f32 v127, v127, v241
    v_mfma_f32_16x16x32_bf16 v[112:115], a[80:83], v[172:175], 0
    s_cmp_lt_u32 s78, s61
    s_cselect_b32 s78, s77, 1073741824
    s_cselect_b32 m0, s76, 0x30000
    ds_read_b128 a[72:75], v231 offset:34816
    ds_read_b128 a[76:79], v231 offset:35840
    v_cvt_pk_bf16_f32 v120, v120, v121
    v_cvt_pk_bf16_f32 v189, v142, v143
    v_cvt_pk_bf16_f32 v121, v122, v123
    v_cvt_pk_bf16_f32 v122, v124, v125
    v_mov_b32 v178, 0
    v_cvt_pk_bf16_f32 v123, v126, v127
    v_mov_b32 v179, 0
    v_mfma_f32_16x16x32_bf16 v[84:87], a[84:87], v[168:171], 0
    s_add_u32 s75, s75, 16384
    buffer_store_dwordx4 v[120:123], v255, s[4:7], s88 offen offset:3072 sc1
    v_exp_f32 v148, v148
    v_exp_f32 v149, v149
    v_mfma_f32_16x16x32_bf16 v[116:119], a[84:87], v[172:175], 0
    v_exp_f32 v150, v150
    v_exp_f32 v151, v151
    v_cvt_pk_bf16_f32 v182, v148, v149
    v_mfma_f32_16x16x32_bf16 v[88:91], a[88:91], v[168:171], 0
    s_sub_u32 s77, s77, 16384
    v_exp_f32 v152, v152
    v_exp_f32 v153, v153
    v_mfma_f32_16x16x32_bf16 v[120:123], a[88:91], v[172:175], 0
    buffer_store_dwordx4 a[116:119], v255, s[12:15], s99 offen sc1
    v_mov_b32 v192, v246
    v_mov_b32 v193, v246
    v_mov_b32 v194, v246
    v_mfma_f32_16x16x32_bf16 v[92:95], a[92:95], v[168:171], 0
    s_add_u32 s99, s99, 1024
    v_mov_b32 v195, v246
    v_mov_b32 v208, v246
    v_mfma_f32_16x16x32_bf16 v[124:127], a[92:95], v[172:175], 0
    s_add_u32 s79, s79, 1
    v_mov_b32 v209, v246
    v_mov_b32 v210, v246
    v_mov_b32 v211, v246
    v_mfma_f32_16x16x32_bf16 a[104:107], a[112:115], v[168:171], 0
    v_mov_b32 v212, v247
    v_mov_b32 v213, v247
    v_mfma_f32_16x16x32_bf16 a[108:111], a[112:115], v[172:175], 0
    v_mov_b32 v214, v247
    v_mov_b32 v215, v247
    s_waitcnt lgkmcnt(0)
    s_branch L_step_odd
L_to_final:
    v_mov_b32 v160, 0
    v_mov_b32 v161, 0
    v_mov_b32 v162, 0
    v_mov_b32 v163, 0
    v_mov_b32 v164, 0
    v_mov_b32 v165, 0
    v_mov_b32 v166, 0
    v_mov_b32 v150, 0
    v_mov_b32 v151, 0
    v_mov_b32 v152, 0
    v_mov_b32 v153, 0
    v_mov_b32 v154, v235
    v_mov_b32 v155, v235
    s_branch L_final
L_code_end:
L_spin_103:
    s_mov_b32 s100, 0
L_spin_103_l:
    s_add_u32 s100, s100, 1
    s_cmp_gt_u32 s100, 0x20000
    s_cbranch_scc1 L_spinret_104
    s_sleep 1
    buffer_load_dword v253, v252, s[52:55], 0 offen sc1
    s_waitcnt vmcnt(0)
    v_cmp_gt_u32 vcc, 128, v253
    s_nop 0
    s_cbranch_vccnz L_spin_103_l
    s_branch L_spinret_104
L_spin_105:
    s_mov_b32 s100, 0
L_spin_105_l:
    s_add_u32 s100, s100, 1
    s_cmp_gt_u32 s100, 0x20000
    s_cbranch_scc1 L_spinret_106
    s_sleep 1
    buffer_load_dword v253, v252, s[4:7], 0 offen sc1
    s_waitcnt vmcnt(0)
    v_cmp_gt_u32 vcc, 1, v253
    s_nop 0
    s_cbranch_vccnz L_spin_105_l
    s_branch L_spinret_106
L_spin_107:
    s_mov_b32 s100, 0
L_spin_107_l:
    s_add_u32 s100, s100, 1
    s_cmp_gt_u32 s100, 0x20000
    s_cbranch_scc1 L_spinret_108
    s_sleep 1
    buffer_load_dword v253, v252, s[4:7], 0 offen sc1
    s_waitcnt vmcnt(0)
    v_cmp_gt_u32 vcc, 1, v253
    s_nop 0
    s_cbranch_vccnz L_spin_107_l
    s_branch L_spinret_108
L_pro_e1:
    v_cndmask_b32 v192, v235, v242, s[82:83]
    v_cndmask_b32 v193, v235, v242, s[84:85]
    v_cndmask_b32 v194, v235, v242, s[86:87]
    v_cndmask_b32 v195, v235, v242, s[92:93]
    v_mov_b32 v208, v235
    v_mov_b32 v209, v235
    v_mov_b32 v210, v235
    v_mov_b32 v211, v235
    v_cndmask_b32 v212, v235, v243, s[82:83]
    v_cndmask_b32 v213, v235, v243, s[84:85]
    v_cndmask_b32 v214, v235, v243, s[86:87]
    v_cndmask_b32 v215, v235, v243, s[92:93]
    s_branch L_pro_e1r
L_rd_a:
    v_cndmask_b32 v200, v235, v248, s[82:83]
    v_cndmask_b32 v201, v235, v248, s[84:85]
    v_cndmask_b32 v202, v235, v248, s[86:87]
    v_cndmask_b32 v203, v235, v248, s[92:93]
    v_mov_b32 v204, v249
    v_mov_b32 v205, v249
    v_mov_b32 v206, v249
    v_mov_b32 v207, v249
    v_cndmask_b32 v220, v235, v249, s[82:83]
    v_cndmask_b32 v221, v235, v249, s[84:85]
    v_cndmask_b32 v222, v235, v249, s[86:87]
    v_cndmask_b32 v223, v235, v249, s[92:93]
    s_nop 1
    s_branch L_rd_a_r
L_rd_b:
    v_cndmask_b32 v192, v235, v246, s[82:83]
    v_cndmask_b32 v193, v235, v246, s[84:85]
    v_cndmask_b32 v194, v235, v246, s[86:87]
    v_cndmask_b32 v195, v235, v246, s[92:93]
    v_mov_b32 v196, v247
    v_mov_b32 v197, v247
    v_mov_b32 v198, v247
    v_mov_b32 v199, v247
    v_cndmask_b32 v212, v235, v247, s[82:83]
    v_cndmask_b32 v213, v235, v247, s[84:85]
    v_cndmask_b32 v214, v235, v247, s[86:87]
    v_cndmask_b32 v215, v235, v247, s[92:93]
    v_mov_b32 v216, v248
    v_mov_b32 v217, v248
    v_mov_b32 v218, v248
    v_mov_b32 v219, v248
    s_nop 1
    s_branch L_rd_b_r
L_spin_136:
    s_mov_b32 s100, 0
L_spin_136_l:
    s_add_u32 s100, s100, 1
    s_cmp_gt_u32 s100, 0x20000
    s_cbranch_scc1 L_spinret_137
    s_sleep 1
    buffer_load_dword v253, v252, s[4:7], 0 offen sc1
    s_waitcnt vmcnt(0)
    v_cmp_gt_u32 vcc, 1, v253
    s_nop 0
    s_cbranch_vccnz L_spin_136_l
    s_branch L_spinret_137
L_spin_178:
    s_mov_b32 s100, 0
L_spin_178_l:
    s_add_u32 s100, s100, 1
    s_cmp_gt_u32 s100, 0x20000
    s_cbranch_scc1 L_spinret_179
    s_sleep 1
    buffer_load_dword v253, v252, s[4:7], 0 offen sc1
    s_waitcnt vmcnt(0)
    v_cmp_gt_u32 vcc, 1, v253
    s_nop 0
    s_cbranch_vccnz L_spin_178_l
    s_branch L_spinret_179
L_spin_180:
    s_mov_b32 s100, 0
L_spin_180_l:
    s_add_u32 s100, s100, 1
    s_cmp_gt_u32 s100, 0x20000
    s_cbranch_scc1 L_spinret_181
    s_sleep 1
    buffer_load_dword v253, v252, s[4:7], 0 offen sc1
    s_waitcnt vmcnt(0)
    v_cmp_gt_u32 vcc, 1, v253
    s_nop 0
    s_cbranch_vccnz L_spin_180_l
    s_branch L_spinret_181
L_redo:
    s_mov_b32 s59, 1
    s_waitcnt vmcnt(0) lgkmcnt(0)
    s_barrier
    s_lshl_b32 s87, s57, 8
    s_lshl_b32 s89, s56, 18
    s_add_u32 s87, s87, s89
    s_lshl_b32 s85, s57, 7
    s_mul_i32 s89, s56, 114688
    s_add_u32 s85, s85, s89
    s_cmp_lt_u32 s57, 28
    s_cselect_b32 s85, s85, 1073741824
    s_and_b32 s89, s56, 1
    s_lshl_b32 s90, s58, 1
    s_add_u32 s89, s89, s90
    s_sub_u32 s72, 31, s89
    s_lshl_b32 s90, s89, 1
    s_add_u32 s90, s90, 2
    s_cmp_lt_u32 s56, 2
    s_cselect_b32 s71, s72, s89
    s_cselect_b32 s70, 99, s90
    s_lshl_b32 s84, s71, 16
    s_add_u32 s84, s84, 1048576
    s_lshl_b32 s73, s58, 2
    s_add_u32 s73, s73, 2
    s_sub_u32 s74, s56, 1
    s_max_i32 s74, s74, 0
    s_lshl_b32 s69, s57, 20
    s_add_u32 s69, s69, 4194304
    s_lshl_b32 s89, s58, 17
    s_lshl_b32 s90, s56, 15
    s_add_u32 s89, s89, s90
    s_add_u32 s88, s89, s69
    s_add_u32 s69, s69, s68
    s_lshl_b32 s89, s57, 5
    s_add_u32 s89, s89, s71
    s_lshl_b32 s89, s89, 13
    s_add_u32 s61, s89, 37748736
    s_cmp_lt_u32 s57, 28
    s_cselect_b32 s61, s61, 1073741824
    s_mov_b64 s[62:63], 0
    s_sub_u32 s89, s70, 2
    s_bfm_b64 s[0:1], 1, s89
    s_min_u32 s65, s70, 34
    s_cmp_lt_u32 s56, 2
    s_cselect_b64 s[62:63], s[62:63], s[0:1]
    s_cselect_b32 s95, s72, 0
    s_cmp_eq_u32 s95, 16
    s_cselect_b32 s89, 32, 0
    s_bitset1_b64 s[62:63], s89
    s_bfe_u32 s96, s2, 0x30003
    s_mul_i32 s96, s96, 3
    s_lshr_b32 s96, s96, 3
    s_lshl_b32 s96, s96, 2
    s_add_u32 s96, s96, 17
    s_bitset1_b64 s[62:63], s96
    s_mov_b64 s[66:67], 0
    s_sub_u32 s89, 4, s74
    s_lshl_b32 s75, s89, 14
    s_add_u32 s75, s75, s69
    s_sub_u32 s90, 65, s89
    s_lshl_b32 s90, s90, 14
    s_add_u32 s77, s90, s69
    s_mov_b32 s81, s68
    s_add_u32 s80, s81, 32768
    s_mov_b32 s79, 1
    s_mov_b32 s97, 0x3e0293ee
    s_mov_b32 s61, 1073741824
    s_mov_b32 s60, 1073741824
    s_mov_b32 s88, 1073741824
    s_lshl_b32 s86, s56, 13
    v_bfe_u32 v4, v254, 2, 2
    v_lshlrev_b32 v4, 6, v4
    v_and_b32 v5, 3, v254
    v_lshl_add_u32 v4, v5, 3, v4
    v_bfe_u32 v5, v254, 4, 1
    v_lshl_add_u32 v4, v5, 5, v4
    v_lshrrev_b32 v5, 4, v254
    v_lshl_add_u32 v2, v5, 10, v4
    v_xor_b32 v3, 32, v2
    v_add_u32 v240, 98304, v2
    v_add_u32 v241, 98304, v3
    v_lshrrev_b32 v2, 5, v254
    v_bfe_u32 v3, v254, 2, 2
    v_lshl_add_u32 v2, v2, 2, v3
    v_mul_u32_u24 v2, 8192, v2
    v_bfe_u32 v3, v254, 4, 1
    v_lshl_add_u32 v2, v3, 6, v2
    v_and_b32 v3, 3, v254
    v_lshl_add_u32 v242, v3, 4, v2
    v_xor_b32 v3, 32, v242
    v_add_u32 v243, 64512, v3
    v_add_u32 v244, 129024, v242
    v_add_u32 v245, 193536, v3
    v_lshrrev_b32 v2, 4, v254
    v_and_b32 v3, 7, v254
    v_xor_b32 v3, v3, v2
    v_lshrrev_b32 v4, 3, v254
    v_lshlrev_b32 v4, 10, v4
    v_lshl_add_u32 v232, v3, 4, v4
    v_xor_b32 v3, 64, v232
    v_add_u32 v233, 7168, v3
    v_add_u32 v234, 14336, v232
    v_add_u32 v235, 21504, v3
    v_and_b32 v2, 15, v254
    v_lshrrev_b32 v3, 1, v2
    v_lshrrev_b32 v4, 4, v254
    v_xor_b32 v3, v3, v4
    v_lshlrev_b32 v2, 7, v2
    v_lshl_add_u32 v2, v3, 4, v2
    v_add_u32 v236, s86, v2
    v_xor_b32 v237, 64, v236
    s_add_u32 m0, s68, 114688
    s_add_u32 s64, s87, 0
    buffer_load_dwordx4 v242, s[16:19], s64 offen offset:0 lds
    buffer_load_dwordx4 v243, s[16:19], s64 offen offset:1024 lds
    buffer_load_dwordx4 v244, s[16:19], s64 offen offset:2048 lds
    buffer_load_dwordx4 v245, s[16:19], s64 offen offset:3072 lds
    s_add_u32 m0, s68, 131072
    s_add_u32 s64, s85, 458752
    buffer_load_dwordx4 v228, s[32:35], s64 offen offset:0 lds
    buffer_load_dwordx4 v229, s[32:35], s64 offen offset:1024 lds
    buffer_load_dwordx4 v230, s[32:35], s64 offen offset:2048 lds
    buffer_load_dwordx4 v231, s[32:35], s64 offen offset:3072 lds
    s_add_u32 m0, s68, 147456
    s_add_u32 s64, s87, 1048576
    buffer_load_dwordx4 v242, s[16:19], s64 offen offset:0 lds
    buffer_load_dwordx4 v243, s[16:19], s64 offen offset:1024 lds
    buffer_load_dwordx4 v244, s[16:19], s64 offen offset:2048 lds
    buffer_load_dwordx4 v245, s[16:19], s64 offen offset:3072 lds
    s_add_u32 m0, s86, 0
    s_add_u32 s64, s84, 0
    buffer_load_dwordx4 v232, s[4:7], s64 offen offset:0 sc1 lds
    buffer_load_dwordx4 v233, s[4:7], s64 offen offset:1024 sc1 lds
    buffer_load_dwordx4 v234, s[4:7], s64 offen offset:2048 sc1 lds
    buffer_load_dwordx4 v235, s[4:7], s64 offen offset:3072 sc1 lds
    s_add_u32 m0, s86, 4096
    s_add_u32 s64, s84, 32768
    buffer_load_dwordx4 v232, s[4:7], s64 offen offset:0 sc1 lds
    buffer_load_dwordx4 v233, s[4:7], s64 offen offset:1024 sc1 lds
    buffer_load_dwordx4 v234, s[4:7], s64 offen offset:2048 sc1 lds
    buffer_load_dwordx4 v235, s[4:7], s64 offen offset:3072 sc1 lds
    s_waitcnt vmcnt(0)
    ds_read_b128 a[0:3], v236 offset:0
    ds_read_b128 a[4:7], v237 offset:0
    ds_read_b128 a[8:11], v236 offset:2048
    ds_read_b128 a[12:15], v237 offset:2048
    ds_read_b128 a[16:19], v236 offset:4096
    ds_read_b128 a[20:23], v237 offset:4096
    ds_read_b128 a[24:27], v236 offset:6144
    ds_read_b128 a[28:31], v237 offset:6144
    s_waitcnt lgkmcnt(0)
    s_add_u32 m0, s86, 32768
    s_add_u32 s64, s84, 128
    buffer_load_dwordx4 v232, s[4:7], s64 offen offset:0 sc1 lds
    buffer_load_dwordx4 v233, s[4:7], s64 offen offset:1024 sc1 lds
    buffer_load_dwordx4 v234, s[4:7], s64 offen offset:2048 sc1 lds
    buffer_load_dwordx4 v235, s[4:7], s64 offen offset:3072 sc1 lds
    s_add_u32 m0, s86, 36864
    s_add_u32 s64, s84, 32896
    buffer_load_dwordx4 v232, s[4:7], s64 offen offset:0 sc1 lds
    buffer_load_dwordx4 v233, s[4:7], s64 offen offset:1024 sc1 lds
    buffer_load_dwordx4 v234, s[4:7], s64 offen offset:2048 sc1 lds
    buffer_load_dwordx4 v235, s[4:7], s64 offen offset:3072 sc1 lds
    s_waitcnt vmcnt(0)
    ds_read_b128 a[32:35], v236 offset:32768
    ds_read_b128 a[36:39], v237 offset:32768
    ds_read_b128 a[40:43], v236 offset:34816
    ds_read_b128 a[44:47], v237 offset:34816
    ds_read_b128 a[48:51], v236 offset:36864
    ds_read_b128 a[52:55], v237 offset:36864
    ds_read_b128 a[56:59], v236 offset:38912
    ds_read_b128 a[60:63], v237 offset:38912
    s_waitcnt lgkmcnt(0)
    s_add_u32 m0, s86, 65536
    s_add_u32 s64, s84, 256
    buffer_load_dwordx4 v232, s[4:7], s64 offen offset:0 sc1 lds
    buffer_load_dwordx4 v233, s[4:7], s64 offen offset:1024 sc1 lds
    buffer_load_dwordx4 v234, s[4:7], s64 offen offset:2048 sc1 lds
    buffer_load_dwordx4 v235, s[4:7], s64 offen offset:3072 sc1 lds
    s_add_u32 m0, s86, 69632
    s_add_u32 s64, s84, 33024
    buffer_load_dwordx4 v232, s[4:7], s64 offen offset:0 sc1 lds
    buffer_load_dwordx4 v233, s[4:7], s64 offen offset:1024 sc1 lds
    buffer_load_dwordx4 v234, s[4:7], s64 offen offset:2048 sc1 lds
    buffer_load_dwordx4 v235, s[4:7], s64 offen offset:3072 sc1 lds
    v_add_u32 v236, 65536, v236
    v_add_u32 v237, 65536, v237
    s_waitcnt vmcnt(0)
    ds_read_b128 a[64:67], v236 offset:0
    ds_read_b128 a[68:71], v237 offset:0
    ds_read_b128 a[72:75], v236 offset:2048
    ds_read_b128 a[76:79], v237 offset:2048
    ds_read_b128 a[80:83], v236 offset:4096
    ds_read_b128 a[84:87], v237 offset:4096
    ds_read_b128 a[88:91], v236 offset:6144
    ds_read_b128 a[92:95], v237 offset:6144
    s_waitcnt lgkmcnt(0)
    s_add_u32 m0, s86, 0
    s_add_u32 s64, s84, 384
    buffer_load_dwordx4 v232, s[4:7], s64 offen offset:0 sc1 lds
    buffer_load_dwordx4 v233, s[4:7], s64 offen offset:1024 sc1 lds
    buffer_load_dwordx4 v234, s[4:7], s64 offen offset:2048 sc1 lds
    buffer_load_dwordx4 v235, s[4:7], s64 offen offset:3072 sc1 lds
    s_add_u32 m0, s86, 4096
    s_add_u32 s64, s84, 33152
    buffer_load_dwordx4 v232, s[4:7], s64 offen offset:0 sc1 lds
    buffer_load_dwordx4 v233, s[4:7], s64 offen offset:1024 sc1 lds
    buffer_load_dwordx4 v234, s[4:7], s64 offen offset:2048 sc1 lds
    buffer_load_dwordx4 v235, s[4:7], s64 offen offset:3072 sc1 lds
    v_subrev_u32 v236, 65536, v236
    v_subrev_u32 v237, 65536, v237
    s_waitcnt vmcnt(0)
    ds_read_b128 a[96:99], v236 offset:0
    ds_read_b128 a[100:103], v237 offset:0
    ds_read_b128 a[104:107], v236 offset:2048
    ds_read_b128 a[108:111], v237 offset:2048
    ds_read_b128 a[112:115], v236 offset:4096
    ds_read_b128 a[116:119], v237 offset:4096
    ds_read_b128 a[120:123], v236 offset:6144
    ds_read_b128 a[124:127], v237 offset:6144
    s_waitcnt lgkmcnt(0)
    s_add_u32 m0, s86, 32768
    s_add_u32 s64, s84, 512
    buffer_load_dwordx4 v232, s[4:7], s64 offen offset:0 sc1 lds
    buffer_load_dwordx4 v233, s[4:7], s64 offen offset:1024 sc1 lds
    buffer_load_dwordx4 v234, s[4:7], s64 offen offset:2048 sc1 lds
    buffer_load_dwordx4 v235, s[4:7], s64 offen offset:3072 sc1 lds
    s_add_u32 m0, s86, 36864
    s_add_u32 s64, s84, 33280
    buffer_load_dwordx4 v232, s[4:7], s64 offen offset:0 sc1 lds
    buffer_load_dwordx4 v233, s[4:7], s64 offen offset:1024 sc1 lds
    buffer_load_dwordx4 v234, s[4:7], s64 offen offset:2048 sc1 lds
    buffer_load_dwordx4 v235, s[4:7], s64 offen offset:3072 sc1 lds
    s_waitcnt vmcnt(0)
    ds_read_b128 a[128:131], v236 offset:32768
    ds_read_b128 a[132:135], v237 offset:32768
    ds_read_b128 a[136:139], v236 offset:34816
    ds_read_b128 a[140:143], v237 offset:34816
    ds_read_b128 a[144:147], v236 offset:36864
    ds_read_b128 a[148:151], v237 offset:36864
    ds_read_b128 a[152:155], v236 offset:38912
    ds_read_b128 a[156:159], v237 offset:38912
    s_waitcnt lgkmcnt(0)
    s_add_u32 m0, s86, 65536
    s_add_u32 s64, s84, 640
    buffer_load_dwordx4 v232, s[4:7], s64 offen offset:0 sc1 lds
    buffer_load_dwordx4 v233, s[4:7], s64 offen offset:1024 sc1 lds
    buffer_load_dwordx4 v234, s[4:7], s64 offen offset:2048 sc1 lds
    buffer_load_dwordx4 v235, s[4:7], s64 offen offset:3072 sc1 lds
    s_add_u32 m0, s86, 69632
    s_add_u32 s64, s84, 33408
    buffer_load_dwordx4 v232, s[4:7], s64 offen offset:0 sc1 lds
    buffer_load_dwordx4 v233, s[4:7], s64 offen offset:1024 sc1 lds
    buffer_load_dwordx4 v234, s[4:7], s64 offen offset:2048 sc1 lds
    buffer_load_dwordx4 v235, s[4:7], s64 offen offset:3072 sc1 lds
    v_add_u32 v236, 65536, v236
    v_add_u32 v237, 65536, v237
    s_waitcnt vmcnt(0)
    ds_read_b128 a[160:163], v236 offset:0
    ds_read_b128 a[164:167], v237 offset:0
    ds_read_b128 a[168:171], v236 offset:2048
    ds_read_b128 a[172:175], v237 offset:2048
    ds_read_b128 a[176:179], v236 offset:4096
    ds_read_b128 a[180:183], v237 offset:4096
    ds_read_b128 a[184:187], v236 offset:6144
    ds_read_b128 a[188:191], v237 offset:6144
    s_waitcnt lgkmcnt(0)
    s_add_u32 m0, s86, 0
    s_add_u32 s64, s84, 768
    buffer_load_dwordx4 v232, s[4:7], s64 offen offset:0 sc1 lds
    buffer_load_dwordx4 v233, s[4:7], s64 offen offset:1024 sc1 lds
    buffer_load_dwordx4 v234, s[4:7], s64 offen offset:2048 sc1 lds
    buffer_load_dwordx4 v235, s[4:7], s64 offen offset:3072 sc1 lds
    s_add_u32 m0, s86, 4096
    s_add_u32 s64, s84, 33536
    buffer_load_dwordx4 v232, s[4:7], s64 offen offset:0 sc1 lds
    buffer_load_dwordx4 v233, s[4:7], s64 offen offset:1024 sc1 lds
    buffer_load_dwordx4 v234, s[4:7], s64 offen offset:2048 sc1 lds
    buffer_load_dwordx4 v235, s[4:7], s64 offen offset:3072 sc1 lds
    v_subrev_u32 v236, 65536, v236
    v_subrev_u32 v237, 65536, v237
    s_waitcnt vmcnt(0)
    ds_read_b128 a[192:195], v236 offset:0
    ds_read_b128 a[196:199], v237 offset:0
    ds_read_b128 a[200:203], v236 offset:2048
    ds_read_b128 a[204:207], v237 offset:2048
    ds_read_b128 a[208:211], v236 offset:4096
    ds_read_b128 a[212:215], v237 offset:4096
    ds_read_b128 a[216:219], v236 offset:6144
    ds_read_b128 a[220:223], v237 offset:6144
    s_waitcnt lgkmcnt(0)
    s_add_u32 m0, s86, 32768
    s_add_u32 s64, s84, 896
    buffer_load_dwordx4 v232, s[4:7], s64 offen offset:0 sc1 lds
    buffer_load_dwordx4 v233, s[4:7], s64 offen offset:1024 sc1 lds
    buffer_load_dwordx4 v234, s[4:7], s64 offen offset:2048 sc1 lds
    buffer_load_dwordx4 v235, s[4:7], s64 offen offset:3072 sc1 lds
    s_add_u32 m0, s86, 36864
    s_add_u32 s64, s84, 33664
    buffer_load_dwordx4 v232, s[4:7], s64 offen offset:0 sc1 lds
    buffer_load_dwordx4 v233, s[4:7], s64 offen offset:1024 sc1 lds
    buffer_load_dwordx4 v234, s[4:7], s64 offen offset:2048 sc1 lds
    buffer_load_dwordx4 v235, s[4:7], s64 offen offset:3072 sc1 lds
    s_waitcnt vmcnt(0)
    ds_read_b128 a[224:227], v236 offset:32768
    ds_read_b128 a[228:231], v237 offset:32768
    ds_read_b128 a[232:235], v236 offset:34816
    ds_read_b128 a[236:239], v237 offset:34816
    ds_read_b128 a[240:243], v236 offset:36864
    ds_read_b128 a[244:247], v237 offset:36864
    ds_read_b128 a[248:251], v236 offset:38912
    ds_read_b128 a[252:255], v237 offset:38912
    s_waitcnt lgkmcnt(0)
    s_add_u32 m0, s86, 32768
    s_add_u32 s64, s84, 512
    buffer_load_dwordx4 v232, s[4:7], s64 offen offset:0 sc1 lds
    buffer_load_dwordx4 v233, s[4:7], s64 offen offset:1024 sc1 lds
    buffer_load_dwordx4 v234, s[4:7], s64 offen offset:2048 sc1 lds
    buffer_load_dwordx4 v235, s[4:7], s64 offen offset:3072 sc1 lds
    s_add_u32 m0, s86, 36864
    s_add_u32 s64, s84, 33280
    buffer_load_dwordx4 v232, s[4:7], s64 offen offset:0 sc1 lds
    buffer_load_dwordx4 v233, s[4:7], s64 offen offset:1024 sc1 lds
    buffer_load_dwordx4 v234, s[4:7], s64 offen offset:2048 sc1 lds
    buffer_load_dwordx4 v235, s[4:7], s64 offen offset:3072 sc1 lds
    s_add_u32 m0, s86, 65536
    s_add_u32 s64, s84, 640
    buffer_load_dwordx4 v232, s[4:7], s64 offen offset:0 sc1 lds
    buffer_load_dwordx4 v233, s[4:7], s64 offen offset:1024 sc1 lds
    buffer_load_dwordx4 v234, s[4:7], s64 offen offset:2048 sc1 lds
    buffer_load_dwordx4 v235, s[4:7], s64 offen offset:3072 sc1 lds
    s_add_u32 m0, s86, 69632
    s_add_u32 s64, s84, 33408
    buffer_load_dwordx4 v232, s[4:7], s64 offen offset:0 sc1 lds
    buffer_load_dwordx4 v233, s[4:7], s64 offen offset:1024 sc1 lds
    buffer_load_dwordx4 v234, s[4:7], s64 offen offset:2048 sc1 lds
    buffer_load_dwordx4 v235, s[4:7], s64 offen offset:3072 sc1 lds
    s_waitcnt vmcnt(0)
    s_barrier
    ds_read_b64_tr_b16 v[192:193], v240 offset:16384
    ds_read_b64_tr_b16 v[194:195], v240 offset:16896
    ds_read_b64_tr_b16 v[196:197], v240 offset:20480
    ds_read_b64_tr_b16 v[198:199], v240 offset:20992
    ds_read_b64_tr_b16 v[200:201], v240 offset:24576
    ds_read_b64_tr_b16 v[202:203], v240 offset:25088
    ds_read_b64_tr_b16 v[204:205], v240 offset:28672
    ds_read_b64_tr_b16 v[206:207], v240 offset:29184
    s_waitcnt lgkmcnt(0)
    s_branch L_q_start
L_maxpass:
    s_waitcnt vmcnt(0) lgkmcnt(0)
    s_cmp_ge_u32 s56, 2
    s_cbranch_scc1 L_mp_0
    ds_write_b128 v236, a[0:3] offset:0
    ds_write_b128 v236, a[4:7] offset:1024
    ds_write_b128 v236, a[8:11] offset:2048
    ds_write_b128 v236, a[12:15] offset:3072
    ds_write_b128 v236, a[16:19] offset:4096
    ds_write_b128 v236, a[20:23] offset:5120
    ds_write_b128 v236, a[24:27] offset:6144
    ds_write_b128 v236, a[28:31] offset:7168
    s_waitcnt lgkmcnt(0)
    ds_write_b128 v236, a[32:35] offset:8192
    ds_write_b128 v236, a[36:39] offset:9216
    ds_write_b128 v236, a[40:43] offset:10240
    ds_write_b128 v236, a[44:47] offset:11264
    ds_write_b128 v236, a[48:51] offset:12288
    ds_write_b128 v236, a[52:55] offset:13312
    ds_write_b128 v236, a[56:59] offset:14336
    ds_write_b128 v236, a[60:63] offset:15360
    s_waitcnt lgkmcnt(0)
L_mp_0:
    s_barrier
    v_accvgpr_mov_b32 a128, a0
    v_accvgpr_mov_b32 a129, a1
    v_accvgpr_mov_b32 a130, a2
    v_accvgpr_mov_b32 a131, a3
    v_accvgpr_mov_b32 a132, a4
    v_accvgpr_mov_b32 a133, a5
    v_accvgpr_mov_b32 a134, a6
    v_accvgpr_mov_b32 a135, a7
    v_accvgpr_mov_b32 a136, a8
    v_accvgpr_mov_b32 a137, a9
    v_accvgpr_mov_b32 a138, a10
    v_accvgpr_mov_b32 a139, a11
    v_accvgpr_mov_b32 a140, a12
    v_accvgpr_mov_b32 a141, a13
    v_accvgpr_mov_b32 a142, a14
    v_accvgpr_mov_b32 a143, a15
    v_accvgpr_mov_b32 a144, a16
    v_accvgpr_mov_b32 a145, a17
    v_accvgpr_mov_b32 a146, a18
    v_accvgpr_mov_b32 a147, a19
    v_accvgpr_mov_b32 a148, a20
    v_accvgpr_mov_b32 a149, a21
    v_accvgpr_mov_b32 a150, a22
    v_accvgpr_mov_b32 a151, a23
    v_accvgpr_mov_b32 a152, a24
    v_accvgpr_mov_b32 a153, a25
    v_accvgpr_mov_b32 a154, a26
    v_accvgpr_mov_b32 a155, a27
    v_accvgpr_mov_b32 a156, a28
    v_accvgpr_mov_b32 a157, a29
    v_accvgpr_mov_b32 a158, a30
    v_accvgpr_mov_b32 a159, a31
    v_accvgpr_mov_b32 a160, a32
    v_accvgpr_mov_b32 a161, a33
    v_accvgpr_mov_b32 a162, a34
    v_accvgpr_mov_b32 a163, a35
    v_accvgpr_mov_b32 a164, a36
    v_accvgpr_mov_b32 a165, a37
    v_accvgpr_mov_b32 a166, a38
    v_accvgpr_mov_b32 a167, a39
    v_accvgpr_mov_b32 a168, a40
    v_accvgpr_mov_b32 a169, a41
    v_accvgpr_mov_b32 a170, a42
    v_accvgpr_mov_b32 a171, a43
    v_accvgpr_mov_b32 a172, a44
    v_accvgpr_mov_b32 a173, a45
    v_accvgpr_mov_b32 a174, a46
    v_accvgpr_mov_b32 a175, a47
    v_accvgpr_mov_b32 a176, a48
    v_accvgpr_mov_b32 a177, a49
    v_accvgpr_mov_b32 a178, a50
    v_accvgpr_mov_b32 a179, a51
    v_accvgpr_mov_b32 a180, a52
    v_accvgpr_mov_b32 a181, a53
    v_accvgpr_mov_b32 a182, a54
    v_accvgpr_mov_b32 a183, a55
    v_accvgpr_mov_b32 a184, a56
    v_accvgpr_mov_b32 a185, a57
    v_accvgpr_mov_b32 a186, a58
    v_accvgpr_mov_b32 a187, a59
    v_accvgpr_mov_b32 a188, a60
    v_accvgpr_mov_b32 a189, a61
    v_accvgpr_mov_b32 a190, a62
    v_accvgpr_mov_b32 a191, a63
    s_mov_b32 s80, 0
    s_mov_b32 s81, s71
L_mp_pass:
    v_mov_b32 v160, v235
    v_mov_b32 v164, 0
    v_mov_b32 v161, v235
    v_mov_b32 v165, 0
    v_mov_b32 v162, v235
    v_mov_b32 v166, 0
    v_mov_b32 v163, v235
    v_mov_b32 v167, 0
    v_mov_b32 v192, v164
    v_mov_b32 v193, v164
    v_mov_b32 v194, v164
    v_mov_b32 v195, v164
    v_mov_b32 v196, v165
    v_mov_b32 v197, v165
    v_mov_b32 v198, v165
    v_mov_b32 v199, v165
    v_mov_b32 v200, v166
    v_mov_b32 v201, v166
    v_mov_b32 v202, v166
    v_mov_b32 v203, v166
    v_mov_b32 v204, v167
    v_mov_b32 v205, v167
    v_mov_b32 v206, v167
    v_mov_b32 v207, v167
    v_mov_b32 v208, v164
    v_mov_b32 v209, v164
    v_mov_b32 v210, v164
    v_mov_b32 v211, v164
    v_mov_b32 v212, v165
    v_mov_b32 v213, v165
    v_mov_b32 v214, v165
    v_mov_b32 v215, v165
    v_mov_b32 v216, v166
    v_mov_b32 v217, v166
    v_mov_b32 v218, v166
    v_mov_b32 v219, v166
    v_mov_b32 v220, v167
    v_mov_b32 v221, v167
    v_mov_b32 v222, v167
    v_mov_b32 v223, v167
    s_mov_b32 s79, 0
L_mp_loop:
    s_lshl_b32 s90, s79, 14
    s_add_u32 s90, s90, s69
    s_sub_u32 s90, s90, s68
    s_add_u32 s91, s90, 4096
    buffer_load_dwordx4 a[64:67], v255, s[4:7], s90 offen offset:0 sc1
    buffer_load_dwordx4 a[68:71], v255, s[4:7], s90 offen offset:1024 sc1
    buffer_load_dwordx4 a[72:75], v255, s[4:7], s90 offen offset:2048 sc1
    buffer_load_dwordx4 a[76:79], v255, s[4:7], s90 offen offset:3072 sc1
    buffer_load_dwordx4 a[80:83], v255, s[4:7], s91 offen offset:0 sc1
    buffer_load_dwordx4 a[84:87], v255, s[4:7], s91 offen offset:1024 sc1
    buffer_load_dwordx4 a[88:91], v255, s[4:7], s91 offen offset:2048 sc1
    buffer_load_dwordx4 a[92:95], v255, s[4:7], s91 offen offset:3072 sc1
    s_lshl_b32 s89, s81, 1
    s_sub_u32 s89, s79, s89
    s_cmp_eq_u32 s89, 0
    s_cbranch_scc0 L_mp_1
    v_cndmask_b32 v192, v235, v164, s[82:83]
    v_cndmask_b32 v193, v235, v164, s[84:85]
    v_cndmask_b32 v194, v235, v164, s[86:87]
    v_cndmask_b32 v195, v235, v164, s[92:93]
    v_mov_b32 v208, v235
    v_mov_b32 v209, v235
    v_mov_b32 v210, v235
    v_mov_b32 v211, v235
    v_cndmask_b32 v212, v235, v165, s[82:83]
    v_cndmask_b32 v213, v235, v165, s[84:85]
    v_cndmask_b32 v214, v235, v165, s[86:87]
    v_cndmask_b32 v215, v235, v165, s[92:93]
L_mp_1:
    s_cmp_eq_u32 s89, 1
    s_cbranch_scc0 L_mp_2
    v_mov_b32 v192, v235
    v_mov_b32 v193, v235
    v_mov_b32 v194, v235
    v_mov_b32 v195, v235
    v_mov_b32 v196, v235
    v_mov_b32 v197, v235
    v_mov_b32 v198, v235
    v_mov_b32 v199, v235
    v_mov_b32 v212, v235
    v_mov_b32 v213, v235
    v_mov_b32 v214, v235
    v_mov_b32 v215, v235
    v_mov_b32 v216, v235
    v_mov_b32 v217, v235
    v_mov_b32 v218, v235
    v_mov_b32 v219, v235
    v_cndmask_b32 v200, v235, v166, s[82:83]
    v_cndmask_b32 v201, v235, v166, s[84:85]
    v_cndmask_b32 v202, v235, v166, s[86:87]
    v_cndmask_b32 v203, v235, v166, s[92:93]
    v_cndmask_b32 v220, v235, v167, s[82:83]
    v_cndmask_b32 v221, v235, v167, s[84:85]
    v_cndmask_b32 v222, v235, v167, s[86:87]
    v_cndmask_b32 v223, v235, v167, s[92:93]
L_mp_2:
    s_waitcnt vmcnt(0)
    s_nop 0
    v_mfma_f32_16x16x32_bf16 v[128:131], a[64:67], a[0:3], v[192:195]
    v_mfma_f32_16x16x32_bf16 v[128:131], a[68:71], a[4:7], v[128:131]
    v_mfma_f32_16x16x32_bf16 v[128:131], a[72:75], a[8:11], v[128:131]
    v_mfma_f32_16x16x32_bf16 v[128:131], a[76:79], a[12:15], v[128:131]
    v_mfma_f32_16x16x32_bf16 v[132:135], a[64:67], a[16:19], v[196:199]
    v_mfma_f32_16x16x32_bf16 v[132:135], a[68:71], a[20:23], v[132:135]
    v_mfma_f32_16x16x32_bf16 v[132:135], a[72:75], a[24:27], v[132:135]
    v_mfma_f32_16x16x32_bf16 v[132:135], a[76:79], a[28:31], v[132:135]
    v_mfma_f32_16x16x32_bf16 v[136:139], a[64:67], a[32:35], v[200:203]
    v_mfma_f32_16x16x32_bf16 v[136:139], a[68:71], a[36:39], v[136:139]
    v_mfma_f32_16x16x32_bf16 v[136:139], a[72:75], a[40:43], v[136:139]
    v_mfma_f32_16x16x32_bf16 v[136:139], a[76:79], a[44:47], v[136:139]
    v_mfma_f32_16x16x32_bf16 v[140:143], a[64:67], a[48:51], v[204:207]
    v_mfma_f32_16x16x32_bf16 v[140:143], a[68:71], a[52:55], v[140:143]
    v_mfma_f32_16x16x32_bf16 v[140:143], a[72:75], a[56:59], v[140:143]
    v_mfma_f32_16x16x32_bf16 v[140:143], a[76:79], a[60:63], v[140:143]
    v_mfma_f32_16x16x32_bf16 v[144:147], a[80:83], a[0:3], v[208:211]
    v_mfma_f32_16x16x32_bf16 v[144:147], a[84:87], a[4:7], v[144:147]
    v_mfma_f32_16x16x32_bf16 v[144:147], a[88:91], a[8:11], v[144:147]
    v_mfma_f32_16x16x32_bf16 v[144:147], a[92:95], a[12:15], v[144:147]
    v_mfma_f32_16x16x32_bf16 v[148:151], a[80:83], a[16:19], v[212:215]
    v_mfma_f32_16x16x32_bf16 v[148:151], a[84:87], a[20:23], v[148:151]
    v_mfma_f32_16x16x32_bf16 v[148:151], a[88:91], a[24:27], v[148:151]
    v_mfma_f32_16x16x32_bf16 v[148:151], a[92:95], a[28:31], v[148:151]
    v_mfma_f32_16x16x32_bf16 v[152:155], a[80:83], a[32:35], v[216:219]
    v_mfma_f32_16x16x32_bf16 v[152:155], a[84:87], a[36:39], v[152:155]
    v_mfma_f32_16x16x32_bf16 v[152:155], a[88:91], a[40:43], v[152:155]
    v_mfma_f32_16x16x32_bf16 v[152:155], a[92:95], a[44:47], v[152:155]
    v_mfma_f32_16x16x32_bf16 v[156:159], a[80:83], a[48:51], v[220:223]
    v_mfma_f32_16x16x32_bf16 v[156:159], a[84:87], a[52:55], v[156:159]
    v_mfma_f32_16x16x32_bf16 v[156:159], a[88:91], a[56:59], v[156:159]
    v_mfma_f32_16x16x32_bf16 v[156:159], a[92:95], a[60:63], v[156:159]
    s_nop 7
    v_max3_f32 v160, v160, v128, v129
    v_max3_f32 v160, v160, v130, v131
    v_max3_f32 v160, v160, v144, v145
    v_max3_f32 v160, v160, v146, v147
    v_max3_f32 v161, v161, v132, v133
    v_max3_f32 v161, v161, v134, v135
    v_max3_f32 v161, v161, v148, v149
    v_max3_f32 v161, v161, v150, v151
    v_max3_f32 v162, v162, v136, v137
    v_max3_f32 v162, v162, v138, v139
    v_max3_f32 v162, v162, v152, v153
    v_max3_f32 v162, v162, v154, v155
    v_max3_f32 v163, v163, v140, v141
    v_max3_f32 v163, v163, v142, v143
    v_max3_f32 v163, v163, v156, v157
    v_max3_f32 v163, v163, v158, v159
    s_add_u32 s79, s79, 1
    s_lshl_b32 s89, s81, 1
    s_add_u32 s89, s89, 2
    s_cmp_lt_u32 s79, s89
    s_cbranch_scc1 L_mp_loop
    v_xor_b32 v238, 16, v254
    v_lshlrev_b32 v238, 2, v238
    ds_bpermute_b32 v164, v238, v160
    ds_bpermute_b32 v165, v238, v161
    ds_bpermute_b32 v166, v238, v162
    ds_bpermute_b32 v167, v238, v163
    s_waitcnt lgkmcnt(0)
    v_max_f32 v160, v160, v164
    v_max_f32 v161, v161, v165
    v_max_f32 v162, v162, v166
    v_max_f32 v163, v163, v167
    v_xor_b32 v238, 32, v254
    v_lshlrev_b32 v238, 2, v238
    ds_bpermute_b32 v164, v238, v160
    ds_bpermute_b32 v165, v238, v161
    ds_bpermute_b32 v166, v238, v162
    ds_bpermute_b32 v167, v238, v163
    s_waitcnt lgkmcnt(0)
    v_max_f32 v160, v160, v164
    v_max_f32 v161, v161, v165
    v_max_f32 v162, v162, v166
    v_max_f32 v163, v163, v167
    s_cmp_lg_u32 s80, 0
    s_cbranch_scc1 L_mp_second
    v_sub_f32 v242, 0, v160
    v_sub_f32 v243, 0, v161
    v_sub_f32 v244, 0, v162
    v_sub_f32 v245, 0, v163
    ds_read_b128 a[0:3], v236 offset:0
    ds_read_b128 a[4:7], v236 offset:1024
    ds_read_b128 a[8:11], v236 offset:2048
    ds_read_b128 a[12:15], v236 offset:3072
    ds_read_b128 a[16:19], v236 offset:4096
    ds_read_b128 a[20:23], v236 offset:5120
    ds_read_b128 a[24:27], v236 offset:6144
    ds_read_b128 a[28:31], v236 offset:7168
    ds_read_b128 a[32:35], v236 offset:8192
    ds_read_b128 a[36:39], v236 offset:9216
    ds_read_b128 a[40:43], v236 offset:10240
    ds_read_b128 a[44:47], v236 offset:11264
    s_waitcnt lgkmcnt(0)
    ds_read_b128 a[48:51], v236 offset:12288
    ds_read_b128 a[52:55], v236 offset:13312
    ds_read_b128 a[56:59], v236 offset:14336
    ds_read_b128 a[60:63], v236 offset:15360
    s_waitcnt lgkmcnt(0)
    s_mov_b32 s80, 1
    s_mov_b32 s81, s72
    s_branch L_mp_pass
L_mp_second:
    v_sub_f32 v246, 0, v160
    v_sub_f32 v247, 0, v161
    v_sub_f32 v248, 0, v162
    v_sub_f32 v249, 0, v163
    v_accvgpr_mov_b32 a0, a128
    v_accvgpr_mov_b32 a1, a129
    v_accvgpr_mov_b32 a2, a130
    v_accvgpr_mov_b32 a3, a131
    v_accvgpr_mov_b32 a4, a132
    v_accvgpr_mov_b32 a5, a133
    v_accvgpr_mov_b32 a6, a134
    v_accvgpr_mov_b32 a7, a135
    v_accvgpr_mov_b32 a8, a136
    v_accvgpr_mov_b32 a9, a137
    v_accvgpr_mov_b32 a10, a138
    v_accvgpr_mov_b32 a11, a139
    v_accvgpr_mov_b32 a12, a140
    v_accvgpr_mov_b32 a13, a141
    v_accvgpr_mov_b32 a14, a142
    v_accvgpr_mov_b32 a15, a143
    v_accvgpr_mov_b32 a16, a144
    v_accvgpr_mov_b32 a17, a145
    v_accvgpr_mov_b32 a18, a146
    v_accvgpr_mov_b32 a19, a147
    v_accvgpr_mov_b32 a20, a148
    v_accvgpr_mov_b32 a21, a149
    v_accvgpr_mov_b32 a22, a150
    v_accvgpr_mov_b32 a23, a151
    v_accvgpr_mov_b32 a24, a152
    v_accvgpr_mov_b32 a25, a153
    v_accvgpr_mov_b32 a26, a154
    v_accvgpr_mov_b32 a27, a155
    v_accvgpr_mov_b32 a28, a156
    v_accvgpr_mov_b32 a29, a157
    v_accvgpr_mov_b32 a30, a158
    v_accvgpr_mov_b32 a31, a159
    v_accvgpr_mov_b32 a32, a160
    v_accvgpr_mov_b32 a33, a161
    v_accvgpr_mov_b32 a34, a162
    v_accvgpr_mov_b32 a35, a163
    v_accvgpr_mov_b32 a36, a164
    v_accvgpr_mov_b32 a37, a165
    v_accvgpr_mov_b32 a38, a166
    v_accvgpr_mov_b32 a39, a167
    v_accvgpr_mov_b32 a40, a168
    v_accvgpr_mov_b32 a41, a169
    v_accvgpr_mov_b32 a42, a170
    v_accvgpr_mov_b32 a43, a171
    v_accvgpr_mov_b32 a44, a172
    v_accvgpr_mov_b32 a45, a173
    v_accvgpr_mov_b32 a46, a174
    v_accvgpr_mov_b32 a47, a175
    v_accvgpr_mov_b32 a48, a176
    v_accvgpr_mov_b32 a49, a177
    v_accvgpr_mov_b32 a50, a178
    v_accvgpr_mov_b32 a51, a179
    v_accvgpr_mov_b32 a52, a180
    v_accvgpr_mov_b32 a53, a181
    v_accvgpr_mov_b32 a54, a182
    v_accvgpr_mov_b32 a55, a183
    v_accvgpr_mov_b32 a56, a184
    v_accvgpr_mov_b32 a57, a185
    v_accvgpr_mov_b32 a58, a186
    v_accvgpr_mov_b32 a59, a187
    v_accvgpr_mov_b32 a60, a188
    v_accvgpr_mov_b32 a61, a189
    v_accvgpr_mov_b32 a62, a190
    v_accvgpr_mov_b32 a63, a191
    v_mov_b32 v192, v242
    v_mov_b32 v193, v242
    v_mov_b32 v194, v242
    v_mov_b32 v195, v242
    v_mov_b32 v196, v243
    v_mov_b32 v197, v243
    v_mov_b32 v198, v243
    v_mov_b32 v199, v243
    v_mov_b32 v200, v244
    v_mov_b32 v201, v244
    v_mov_b32 v202, v244
    v_mov_b32 v203, v244
    v_mov_b32 v204, v245
    v_mov_b32 v205, v245
    v_mov_b32 v206, v245
    v_mov_b32 v207, v245
    v_mov_b32 v208, v242
    v_mov_b32 v209, v242
    v_mov_b32 v210, v242
    v_mov_b32 v211, v242
    v_mov_b32 v212, v243
    v_mov_b32 v213, v243
    v_mov_b32 v214, v243
    v_mov_b32 v215, v243
    v_mov_b32 v216, v244
    v_mov_b32 v217, v244
    v_mov_b32 v218, v244
    v_mov_b32 v219, v244
    v_mov_b32 v220, v245
    v_mov_b32 v221, v245
    v_mov_b32 v222, v245
    v_mov_b32 v223, v245
    ds_read_b128 a[64:67], v231 offset:32768
    ds_read_b128 a[68:71], v231 offset:33792
    ds_read_b128 a[72:75], v231 offset:34816
    ds_read_b128 a[76:79], v231 offset:35840
    s_mov_b32 s81, s68
    s_add_u32 s80, s81, 32768
    s_mov_b32 s79, 1
    s_barrier
    s_branch L_maxret
.section .rodata,"a"
.p2align 6
.amdhsa_kernel recurrent_scan__compressed_kv_cla__dense_activation_squared_relu__prompt_kernel
  .amdhsa_next_free_vgpr 512
  .amdhsa_next_free_sgpr 102
  .amdhsa_accum_offset 256
  .amdhsa_group_segment_fixed_size 0
  .amdhsa_kernarg_size 112
  .amdhsa_user_sgpr_count 2
  .amdhsa_user_sgpr_kernarg_segment_ptr 1
  .amdhsa_system_sgpr_workgroup_id_x 1
.end_amdhsa_kernel
```
